```python
import torch

def _softmax(x, axis=-1):
    return torch.softmax(x, dim=axis)

def _gelu(x):
    return torch.nn.functional.gelu(x, approximate='tanh')

def _silu(x):
    return torch.nn.functional.silu(x)

def _sigmoid(x):
    return torch.sigmoid(x)

def _layernorm(x, axis=-1, eps=1e-05):
    m = x.mean(dim=axis, keepdim=True)
    v = x.var(dim=axis, keepdim=True, unbiased=False)
    return (x - m) / torch.sqrt(v + eps)

def _scatter_add(tgt, idx, src, axis=0):
    return tgt.clone().index_add_(axis, idx, src)

def _segment_sum(src, seg, n):
    out = torch.zeros((n,) + src.shape[1:], dtype=src.dtype)
    return out.index_add_(0, seg, src)

def _pad(x, pw):
    flat = tuple((v for pair in reversed(pw) for v in pair))
    return torch.nn.functional.pad(x, flat)
kernel_name = 'sequential_preLN__memory_aug_recurrent_mem_tr__dense_activation_relu__prompt'

def setup_inputs():

    _w = lambda a: (lambda t: t.to(torch.bfloat16) if t.is_floating_point() else t)(torch.as_tensor(a))

    def _A_setup():
        B, S, Dm = (1, 2048, 512)
        H, Dh = (32, 128)
        M, seg = (8, 32)
        seg = min(seg, S)
        S = S // seg * seg
        return {'x': _w((lambda *s: torch.randn(*s, dtype=torch.bfloat16) * 0.05)(B, S, Dm)), 'mem0': _w((lambda *s: torch.randn(*s, dtype=torch.bfloat16) * 0.2)(B, M, Dm)), 'Wq': _w((lambda *s: torch.randn(*s, dtype=torch.bfloat16) * 1.6)(Dm, H, Dh) * Dm ** (-0.5)), 'Wk': _w((lambda *s: torch.randn(*s, dtype=torch.bfloat16) * 1.6)(Dm, H, Dh) * Dm ** (-0.5)), 'Wv': _w((lambda *s: torch.randn(*s, dtype=torch.bfloat16) * 0.2)(Dm, H, Dh) * Dm ** (-0.5)), 'Wo': _w((lambda *s: torch.randn(*s, dtype=torch.bfloat16) * 0.2)(H, Dh, Dm) * (H * Dh) ** (-0.5)), 'seg_len': seg}
    _A_in = _A_setup()

    def _B_setup():
        B, S, D, Dff = (1, 2048, 512, 1376)
        return {'x': _w((lambda *s: torch.randn(*s, dtype=torch.bfloat16) * 0.05)(B, S, D)), 'w1': _w((lambda *s: torch.randn(*s, dtype=torch.bfloat16) * 0.05)(D, Dff)), 'w2': _w((lambda *s: torch.randn(*s, dtype=torch.bfloat16) * 0.05)(Dff, D))}
    _B_in = _B_setup()
    return {'A_x': _A_in['x'], 'A_mem0': _A_in['mem0'], 'A_Wq': _A_in['Wq'], 'A_Wk': _A_in['Wk'], 'A_Wv': _A_in['Wv'], 'A_Wo': _A_in['Wo'], 'A_seg_len': _A_in['seg_len'], 'B_x': _B_in['x'], 'B_w1': _B_in['w1'], 'B_w2': _B_in['w2']}

def reference(A_x, A_mem0, A_Wq, A_Wk, A_Wv, A_Wo, A_seg_len, B_x, B_w1, B_w2):

    def _A_ref(x, mem0, Wq, Wk, Wv, Wo, seg_len):
        B, S, Dm = x.shape
        H, Dh = (Wq.shape[1], Wq.shape[2])
        M = mem0.shape[1]
        scale = Dh ** (-0.5)
        n_seg = S // seg_len
        L = M + seg_len
        idx = torch.arange(L)
        mask = (idx[:, None] < M) | (idx[:, None] >= idx[None, :])
        mem = mem0
        outs = []
        for s in range(n_seg):
            xs = x[:, s * seg_len:(s + 1) * seg_len, :].clone()
            h = torch.concatenate([mem, xs], axis=1)
            q = torch.einsum('btd,dhe->bhte', h, Wq)
            k = torch.einsum('btd,dhe->bhte', h, Wk)
            v = torch.einsum('btd,dhe->bhte', h, Wv)
            scores = torch.einsum('bhqe,bhke->bhqk', q, k) * scale
            scores = torch.where(mask[None, None], scores, -1000000000.0)
            p = _softmax(scores, axis=-1)
            o = torch.einsum('bhqk,bhke->bhqe', p, v)
            o = torch.einsum('bhte,hed->btd', o, Wo)
            mem = o[:, :M, :].clone()
            outs.append(o[:, M:, :])
        return torch.concatenate(outs, axis=1)

    def _B_ref(x, w1, w2):
        h = torch.einsum('bsd,df->bsf', x, w1)
        zero = torch.zeros_like(h)
        h = torch.maximum(h, zero)
        return torch.einsum('bsf,fd->bsd', h, w2)
    x = A_x
    h = x + _A_ref(_layernorm(x, axis=-1), A_mem0, A_Wq, A_Wk, A_Wv, A_Wo, A_seg_len)
    h2 = h + _B_ref(_layernorm(h, axis=-1), B_w1, B_w2)
    return h2
```

```asm
; @launch grid=(256,1,1) block=(256,1,1) lds=163840
.amdgcn_target "amdgcn-amd-amdhsa--gfx950"
.text
.globl sequential_preLN__memory_aug_recurrent_mem_tr__dense_activation_relu__prompt_kernel
.p2align 8
.type sequential_preLN__memory_aug_recurrent_mem_tr__dense_activation_relu__prompt_kernel,@function
sequential_preLN__memory_aug_recurrent_mem_tr__dense_activation_relu__prompt_kernel:
  s_cmp_ge_u32 s2, 256
  s_cbranch_scc1 L_end
  s_load_dwordx16 s[36:51], s[0:1], 0
  s_load_dwordx8 s[52:59], s[0:1], 64
  s_load_dwordx2 s[60:61], s[0:1], 96
  s_getreg_b32 s6, hwreg(HW_REG_XCC_ID, 0, 4)
  v_lshrrev_b32 v1, 6, v0
  s_lshr_b32 s4, s2, 3
  s_and_b32 s3, s2, 7
  v_readfirstlane_b32 s5, v1
  v_and_b32 v0, 63, v0
  s_mul_i32 s28, s6, s6
  s_lshl_b32 s28, s28, 15
  s_lshl_b32 s7, s6, 6
  s_add_u32 s7, s7, s28
  s_add_u32 s7, s7, 1
  s_mov_b32 s35, 0
  s_waitcnt lgkmcnt(0)
  s_mov_b32 s8, s60
  s_mov_b32 s9, s61
  s_mov_b32 s10, 0x10000000
  s_mov_b32 s11, 0x20000
  s_mov_b32 s16, s36
  s_mov_b32 s17, s37
  s_mov_b32 s18, 0x200000
  s_mov_b32 s19, 0x20000
  s_mov_b32 s20, s56
  s_mov_b32 s21, s57
  s_mov_b32 s22, 0x200000
  s_mov_b32 s23, 0x20000
  s_mov_b32 s24, s58
  s_mov_b32 s25, s59
  s_mov_b32 s26, 0x100
  s_mov_b32 s27, 0x20000
  s_cmp_lg_u32 s3, 0
  s_cbranch_scc1 L_worker
  v_and_b32 v20, 15, v0
  v_lshrrev_b32 v21, 4, v0
  v_mov_b32 v1, 0x44444444
  v_mov_b32 v22, 0xeeeeeeee
  v_mov_b32 v1, 0xff004444
  v_mov_b32 v22, 0xfe014444
  v_cmp_eq_u32 vcc, 0, v20
  s_nop 1
  v_cndmask_b32 v1, v1, v22, vcc
  v_mov_b32 v22, 0xff00eeee
  v_cmp_lt_u32 vcc, 7, v20
  s_nop 1
  v_cndmask_b32 v1, v1, v22, vcc
  s_lshl_b32 s28, s5, 16
  s_lshl_b32 s29, s4, 6
  s_add_u32 s28, s28, s29
  v_lshrrev_b32 v22, 2, v0
  v_lshlrev_b32 v22, 11, v22
  v_and_b32 v23, 3, v0
  v_lshl_add_u32 v22, v23, 4, v22
  v_add_u32 v2, s28, v22
  s_lshr_b32 s28, s4, 2
  s_lshl_b32 s28, s28, 10
  s_lshl_b32 s29, s5, 8
  s_add_u32 s28, s28, s29
  s_and_b32 s29, s4, 3
  s_lshl_b32 s29, s29, 6
  s_add_u32 s28, s28, s29
  v_lshlrev_b32 v22, 2, v20
  v_lshl_add_u32 v22, v21, 4, v22
  v_add_u32 v22, s28, v22
  v_cmp_lt_u32 vcc, 3, v20
  v_mov_b32 v23, 0x10000000
  s_nop 0
  v_cndmask_b32 v3, v22, v23, vcc
  s_mul_i32 s28, s5, 640
  v_lshrrev_b32 v22, 5, v0
  v_mul_u32_u24 v24, 640, v22
  v_mul_u32_u24 v22, 20, v22
  v_add_u32 v22, v22, v20
  v_lshlrev_b32 v22, 4, v22
  v_bfe_u32 v23, v0, 3, 1
  v_mul_u32_u24 v23, 320, v23
  v_add_u32 v24, v24, v23
  v_bfe_u32 v23, v0, 4, 1
  v_lshl_add_u32 v24, v23, 7, v24
  v_bfe_u32 v23, v0, 1, 1
  v_lshl_add_u32 v24, v23, 5, v24
  v_bfe_u32 v23, v0, 2, 1
  v_lshl_add_u32 v24, v23, 4, v24
  v_bfe_u32 v23, v0, 0, 1
  v_lshl_add_u32 v13, v23, 3, v24
  v_and_b32 v23, 1, v21
  v_lshl_add_u32 v22, v23, 3, v22
  v_add_u32 v4, s28, v22
  v_lshrrev_b32 v22, 2, v0
  v_lshlrev_b32 v22, 4, v22
  v_and_b32 v23, 1, v0
  v_lshl_add_u32 v5, v23, 3, v22
  s_lshl_b32 s28, s5, 15
  s_add_u32 s28, s28, 32768
  v_lshl_add_u32 v6, v0, 4, s28
  s_lshl_b32 s28, s5, 11
  v_lshl_add_u32 v7, v0, 4, s28
  v_xor_b32 v8, 2048, v7
  v_xor_b32 v9, 4096, v7
  v_xor_b32 v10, 6144, v7
  v_xor_b32 v11, 0x80, v10
  v_mov_b32 v124, 0x3f803f80
  v_mov_b32 v125, 0x3f803f80
  v_mov_b32 v126, 0x3f803f80
  v_mov_b32 v127, 0x3f803f80
  s_mov_b32 s74, 32768
  v_mov_b32 v24, 1
  v_mov_b32 v25, 1
  v_mov_b32 v26, 1
  v_mov_b32 v27, 1
  v_mov_b32 v15, -1
  buffer_store_dwordx4 v[24:27], v2, s[8:11], 0 offen sc1
  buffer_store_dwordx4 v[24:27], v2, s[8:11], s74 offen sc1
  s_mov_b32 s28, 270336
  buffer_store_dword v15, v3, s[8:11], s28 offen sc1
  s_mov_b32 s16, s38
  s_mov_b32 s17, s39
  s_mov_b32 s18, 0x2000
  s_mov_b32 s19, 0x20000
  v_and_b32 v22, 7, v0
  v_lshlrev_b32 v22, 10, v22
  v_bfe_u32 v23, v0, 3, 1
  v_lshl_add_u32 v22, v23, 5, v22
  v_lshl_add_u32 v22, v21, 3, v22
  s_lshl_b32 s28, s5, 8
  buffer_load_dwordx2 v[32:33], v22, s[16:19], s28 offen offset:0
  buffer_load_dwordx2 v[34:35], v22, s[16:19], s28 offen offset:64
  buffer_load_dwordx2 v[36:37], v22, s[16:19], s28 offen offset:128
  buffer_load_dwordx2 v[38:39], v22, s[16:19], s28 offen offset:192
  s_mov_b32 s64, s40
  s_mov_b32 s65, s41
  s_mov_b32 s66, 0x400000
  s_mov_b32 s67, 0x20000
  s_mov_b32 s68, s42
  s_mov_b32 s69, s43
  s_mov_b32 s70, 0x400000
  s_mov_b32 s71, 0x20000
  s_mov_b32 s72, s44
  s_mov_b32 s73, s45
  s_mov_b32 s74, 0x400000
  s_mov_b32 s75, 0x20000
  s_mov_b32 s12, s46
  s_mov_b32 s13, s47
  s_mov_b32 s14, 0x400000
  s_mov_b32 s15, 0x20000
  v_and_b32 v22, 1, v21
  v_lshlrev_b32 v22, 4, v22
  v_lshrrev_b32 v23, 1, v21
  v_add_u32 v22, v22, v23
  v_lshlrev_b32 v22, 14, v22
  v_lshl_add_u32 v96, v20, 4, v22
  v_lshrrev_b32 v22, 2, v20
  v_add_u32 v22, v22, v21
  v_and_b32 v22, 3, v22
  v_lshlrev_b32 v22, 6, v22
  v_lshl_add_u32 v22, v21, 8, v22
  v_and_b32 v23, 3, v0
  v_lshl_add_u32 v22, v23, 4, v22
  s_lshl_b32 s28, s5, 12
  v_add_u32 v98, s28, v22
  v_bfe_u32 v22, v0, 2, 1
  v_lshl_add_u32 v22, v21, 1, v22
  v_add_u32 v23, s5, v22
  v_and_b32 v23, 3, v23
  v_lshlrev_b32 v23, 6, v23
  v_lshl_add_u32 v23, v22, 8, v23
  v_and_b32 v24, 3, v0
  v_lshlrev_b32 v24, 3, v24
  v_bfe_u32 v25, v0, 3, 1
  v_lshl_add_u32 v24, v25, 5, v24
  v_add_u32 v23, v23, v24
  v_lshl_add_u32 v100, v25, 13, v23
  v_xor_b32 v101, 0x2000, v100
  v_and_b32 v23, 1, v21
  v_lshl_add_u32 v24, v23, 6, v24
  v_lshl_add_u32 v24, v22, 7, v24
  s_lshl_b32 s28, s5, 15
  s_add_u32 s28, s28, 57344
  s_and_b32 s29, s5, 1
  s_lshl_b32 s29, s29, 12
  s_add_u32 s29, s29, s28
  v_add_u32 v102, s29, v24
  v_xor_b32 v103, 64, v102
  v_xor_b32 v104, 0x1000, v102
  v_xor_b32 v105, 0x1000, v103
  v_bfe_u32 v22, v0, 3, 1
  v_bfe_u32 v23, v0, 4, 1
  v_lshl_add_u32 v22, v23, 4, v22
  v_lshrrev_b32 v24, 5, v0
  v_lshl_add_u32 v22, v24, 2, v22
  v_lshlrev_b32 v22, 10, v22
  v_and_b32 v24, 7, v0
  v_lshl_add_u32 v97, v24, 4, v22
  v_lshlrev_b32 v22, 4, v0
  v_lshlrev_b32 v23, 6, v23
  v_xor_b32 v22, v22, v23
  v_add_u32 v99, s28, v22
  s_lshl_b32 s29, s4, 8
  s_lshl_b32 s30, s5, 16
  s_add_u32 s92, s29, s30
  s_lshl_b32 s29, s4, 17
  s_lshl_b32 s30, s5, 8
  s_add_u32 s29, s29, s30
  s_lshr_b32 s30, s5, 1
  s_xor_b32 s30, s30, 0
  s_lshl_b32 s30, s30, 16
  s_add_u32 s96, s29, s30
  s_lshr_b32 s30, s5, 1
  s_xor_b32 s30, s30, 1
  s_lshl_b32 s30, s30, 16
  s_add_u32 s97, s29, s30
  s_cmp_eq_u32 s5, 1
  s_cbranch_scc1 L_wv_2
  s_cmp_eq_u32 s5, 2
  s_cbranch_scc1 L_wv_3
  s_cmp_eq_u32 s5, 3
  s_cbranch_scc1 L_wv_4
L_wv_1:
  s_add_u32 s28, s92, 0x0
  buffer_load_dwordx4 a[160:163], v96, s[64:67], s28 offen
  s_add_u32 s28, s92, 0x8000
  buffer_load_dwordx4 a[164:167], v96, s[64:67], s28 offen
  s_add_u32 s28, s92, 0x2000
  buffer_load_dwordx4 a[168:171], v96, s[64:67], s28 offen
  s_add_u32 s28, s92, 0xa000
  buffer_load_dwordx4 a[172:175], v96, s[64:67], s28 offen
  s_add_u32 s28, s92, 0x100000
  buffer_load_dwordx4 v[160:163], v96, s[64:67], s28 offen
  s_add_u32 s28, s92, 0x108000
  buffer_load_dwordx4 v[164:167], v96, s[64:67], s28 offen
  s_add_u32 s28, s92, 0x102000
  buffer_load_dwordx4 v[168:171], v96, s[64:67], s28 offen
  s_add_u32 s28, s92, 0x10a000
  buffer_load_dwordx4 v[172:175], v96, s[64:67], s28 offen
  s_add_u32 s28, s92, 0x200000
  buffer_load_dwordx4 a[0:3], v96, s[64:67], s28 offen
  s_add_u32 s28, s92, 0x208000
  buffer_load_dwordx4 a[4:7], v96, s[64:67], s28 offen
  s_add_u32 s28, s92, 0x202000
  buffer_load_dwordx4 a[8:11], v96, s[64:67], s28 offen
  s_add_u32 s28, s92, 0x20a000
  buffer_load_dwordx4 a[12:15], v96, s[64:67], s28 offen
  s_add_u32 s28, s92, 0x300000
  buffer_load_dwordx4 a[176:179], v96, s[64:67], s28 offen
  s_add_u32 s28, s92, 0x308000
  buffer_load_dwordx4 a[180:183], v96, s[64:67], s28 offen
  s_add_u32 s28, s92, 0x302000
  buffer_load_dwordx4 a[184:187], v96, s[64:67], s28 offen
  s_add_u32 s28, s92, 0x30a000
  buffer_load_dwordx4 a[188:191], v96, s[64:67], s28 offen
  s_add_u32 s28, s92, 0x80000
  buffer_load_dwordx4 a[192:195], v96, s[64:67], s28 offen
  s_add_u32 s28, s92, 0x88000
  buffer_load_dwordx4 a[196:199], v96, s[64:67], s28 offen
  s_add_u32 s28, s92, 0x82000
  buffer_load_dwordx4 a[200:203], v96, s[64:67], s28 offen
  s_add_u32 s28, s92, 0x8a000
  buffer_load_dwordx4 a[204:207], v96, s[64:67], s28 offen
  s_add_u32 s28, s92, 0x180000
  buffer_load_dwordx4 v[208:211], v96, s[64:67], s28 offen
  s_add_u32 s28, s92, 0x188000
  buffer_load_dwordx4 v[212:215], v96, s[64:67], s28 offen
  s_add_u32 s28, s92, 0x182000
  buffer_load_dwordx4 v[216:219], v96, s[64:67], s28 offen
  s_add_u32 s28, s92, 0x18a000
  buffer_load_dwordx4 v[220:223], v96, s[64:67], s28 offen
  s_add_u32 s28, s92, 0x280000
  buffer_load_dwordx4 a[48:51], v96, s[64:67], s28 offen
  s_add_u32 s28, s92, 0x288000
  buffer_load_dwordx4 a[52:55], v96, s[64:67], s28 offen
  s_add_u32 s28, s92, 0x282000
  buffer_load_dwordx4 a[56:59], v96, s[64:67], s28 offen
  s_add_u32 s28, s92, 0x28a000
  buffer_load_dwordx4 a[60:63], v96, s[64:67], s28 offen
  s_add_u32 s28, s92, 0x380000
  buffer_load_dwordx4 a[208:211], v96, s[64:67], s28 offen
  s_add_u32 s28, s92, 0x388000
  buffer_load_dwordx4 a[212:215], v96, s[64:67], s28 offen
  s_add_u32 s28, s92, 0x382000
  buffer_load_dwordx4 a[216:219], v96, s[64:67], s28 offen
  s_add_u32 s28, s92, 0x38a000
  buffer_load_dwordx4 a[220:223], v96, s[64:67], s28 offen
  s_add_u32 s28, s92, 0x0
  buffer_load_dwordx4 a[224:227], v96, s[68:71], s28 offen
  s_add_u32 s28, s92, 0x8000
  buffer_load_dwordx4 a[228:231], v96, s[68:71], s28 offen
  s_add_u32 s28, s92, 0x2000
  buffer_load_dwordx4 a[232:235], v96, s[68:71], s28 offen
  s_add_u32 s28, s92, 0xa000
  buffer_load_dwordx4 a[236:239], v96, s[68:71], s28 offen
  s_add_u32 s28, s92, 0x100000
  buffer_load_dwordx4 v[176:179], v96, s[68:71], s28 offen
  s_add_u32 s28, s92, 0x108000
  buffer_load_dwordx4 v[180:183], v96, s[68:71], s28 offen
  s_add_u32 s28, s92, 0x102000
  buffer_load_dwordx4 v[184:187], v96, s[68:71], s28 offen
  s_add_u32 s28, s92, 0x10a000
  buffer_load_dwordx4 v[188:191], v96, s[68:71], s28 offen
  s_waitcnt vmcnt(44)
  s_barrier
  s_cmp_lg_u32 s5, 0
  s_cbranch_scc1 L_arr_6
  s_lshl_b32 s28, s3, 5
  v_mov_b32 v47, s7
  s_mov_b64 exec, 1
  buffer_atomic_add v47, off, s[24:27], s28 offset:0 sc1
  s_mov_b64 exec, -1
L_arr_6:
  s_mov_b32 s28, 0x05040100
  s_mov_b32 s29, 0x07060302
  s_waitcnt vmcnt(42)
  v_perm_b32 v48, v34, v32, s28
  v_perm_b32 v49, v34, v32, s29
  v_perm_b32 v50, v35, v33, s28
  v_perm_b32 v51, v35, v33, s29
  v_or_b32 v48, 1, v48
  s_waitcnt vmcnt(40)
  v_perm_b32 v52, v38, v36, s28
  v_perm_b32 v53, v38, v36, s29
  v_perm_b32 v54, v39, v37, s28
  v_perm_b32 v55, v39, v37, s29
  v_or_b32 v52, 1, v52
  s_waitcnt vmcnt(39)
  ds_write_b128 v98, a[160:163] offset:0
  s_waitcnt vmcnt(38)
  ds_write_b128 v98, a[164:167] offset:1024
  s_waitcnt vmcnt(37)
  ds_write_b128 v98, a[168:171] offset:2048
  s_waitcnt vmcnt(36)
  ds_write_b128 v98, a[172:175] offset:3072
  s_waitcnt lgkmcnt(0)
  s_barrier
  ds_read_b64_tr_b16 a[160:161], v100 offset:0
  ds_read_b64_tr_b16 a[162:163], v100 offset:2048
  ds_read_b64_tr_b16 a[164:165], v100 offset:4096
  ds_read_b64_tr_b16 a[166:167], v100 offset:6144
  ds_read_b64_tr_b16 a[168:169], v101 offset:0
  ds_read_b64_tr_b16 a[170:171], v101 offset:2048
  ds_read_b64_tr_b16 a[172:173], v101 offset:4096
  ds_read_b64_tr_b16 a[174:175], v101 offset:6144
  s_waitcnt lgkmcnt(6)
  ds_write_b128 v6, a[160:163] offset:0
  s_waitcnt lgkmcnt(5)
  ds_write_b128 v6, a[164:167] offset:1024
  s_waitcnt lgkmcnt(4)
  ds_write_b128 v6, a[168:171] offset:2048
  s_waitcnt lgkmcnt(3)
  ds_write_b128 v6, a[172:175] offset:3072
  s_add_u32 s28, s92, 0x200000
  buffer_load_dwordx4 a[16:19], v96, s[68:71], s28 offen
  s_add_u32 s28, s92, 0x208000
  buffer_load_dwordx4 a[20:23], v96, s[68:71], s28 offen
  s_add_u32 s28, s92, 0x202000
  buffer_load_dwordx4 a[24:27], v96, s[68:71], s28 offen
  s_add_u32 s28, s92, 0x20a000
  buffer_load_dwordx4 a[28:31], v96, s[68:71], s28 offen
  s_waitcnt vmcnt(39)
  ds_write_b128 v98, v[160:163] offset:16384
  s_waitcnt vmcnt(38)
  ds_write_b128 v98, v[164:167] offset:17408
  s_waitcnt vmcnt(37)
  ds_write_b128 v98, v[168:171] offset:18432
  s_waitcnt vmcnt(36)
  ds_write_b128 v98, v[172:175] offset:19456
  s_waitcnt lgkmcnt(0)
  s_barrier
  ds_read_b64_tr_b16 v[160:161], v100 offset:16384
  ds_read_b64_tr_b16 v[162:163], v100 offset:18432
  ds_read_b64_tr_b16 v[164:165], v100 offset:20480
  ds_read_b64_tr_b16 v[166:167], v100 offset:22528
  ds_read_b64_tr_b16 v[168:169], v101 offset:16384
  ds_read_b64_tr_b16 v[170:171], v101 offset:18432
  ds_read_b64_tr_b16 v[172:173], v101 offset:20480
  ds_read_b64_tr_b16 v[174:175], v101 offset:22528
  s_add_u32 s28, s92, 0x300000
  buffer_load_dwordx4 a[96:99], v96, s[68:71], s28 offen
  s_add_u32 s28, s92, 0x308000
  buffer_load_dwordx4 a[100:103], v96, s[68:71], s28 offen
  s_add_u32 s28, s92, 0x302000
  buffer_load_dwordx4 a[104:107], v96, s[68:71], s28 offen
  s_add_u32 s28, s92, 0x30a000
  buffer_load_dwordx4 a[108:111], v96, s[68:71], s28 offen
  s_waitcnt vmcnt(39)
  ds_write_b128 v98, a[0:3] offset:0
  s_waitcnt vmcnt(38)
  ds_write_b128 v98, a[4:7] offset:1024
  s_waitcnt vmcnt(37)
  ds_write_b128 v98, a[8:11] offset:2048
  s_waitcnt vmcnt(36)
  ds_write_b128 v98, a[12:15] offset:3072
  s_waitcnt lgkmcnt(0)
  s_barrier
  ds_read_b64_tr_b16 a[0:1], v100 offset:0
  ds_read_b64_tr_b16 a[2:3], v100 offset:2048
  ds_read_b64_tr_b16 a[4:5], v100 offset:4096
  ds_read_b64_tr_b16 a[6:7], v100 offset:6144
  ds_read_b64_tr_b16 a[8:9], v101 offset:0
  ds_read_b64_tr_b16 a[10:11], v101 offset:2048
  ds_read_b64_tr_b16 a[12:13], v101 offset:4096
  ds_read_b64_tr_b16 a[14:15], v101 offset:6144
  s_add_u32 s28, s92, 0x0
  buffer_load_dwordx4 a[240:243], v96, s[72:75], s28 offen
  s_add_u32 s28, s92, 0x8000
  buffer_load_dwordx4 a[244:247], v96, s[72:75], s28 offen
  s_add_u32 s28, s92, 0x2000
  buffer_load_dwordx4 a[248:251], v96, s[72:75], s28 offen
  s_add_u32 s28, s92, 0xa000
  buffer_load_dwordx4 a[252:255], v96, s[72:75], s28 offen
  s_waitcnt vmcnt(39)
  ds_write_b128 v98, a[176:179] offset:16384
  s_waitcnt vmcnt(38)
  ds_write_b128 v98, a[180:183] offset:17408
  s_waitcnt vmcnt(37)
  ds_write_b128 v98, a[184:187] offset:18432
  s_waitcnt vmcnt(36)
  ds_write_b128 v98, a[188:191] offset:19456
  s_waitcnt lgkmcnt(0)
  s_barrier
  ds_read_b64_tr_b16 a[176:177], v100 offset:16384
  ds_read_b64_tr_b16 a[178:179], v100 offset:18432
  ds_read_b64_tr_b16 a[180:181], v100 offset:20480
  ds_read_b64_tr_b16 a[182:183], v100 offset:22528
  ds_read_b64_tr_b16 a[184:185], v101 offset:16384
  ds_read_b64_tr_b16 a[186:187], v101 offset:18432
  ds_read_b64_tr_b16 a[188:189], v101 offset:20480
  ds_read_b64_tr_b16 a[190:191], v101 offset:22528
  s_waitcnt lgkmcnt(6)
  ds_write_b128 v6, a[176:179] offset:16384
  s_waitcnt lgkmcnt(5)
  ds_write_b128 v6, a[180:183] offset:17408
  s_waitcnt lgkmcnt(4)
  ds_write_b128 v6, a[184:187] offset:18432
  s_waitcnt lgkmcnt(3)
  ds_write_b128 v6, a[188:191] offset:19456
  s_add_u32 s28, s92, 0x100000
  buffer_load_dwordx4 v[192:195], v96, s[72:75], s28 offen
  s_add_u32 s28, s92, 0x108000
  buffer_load_dwordx4 v[196:199], v96, s[72:75], s28 offen
  s_add_u32 s28, s92, 0x102000
  buffer_load_dwordx4 v[200:203], v96, s[72:75], s28 offen
  s_add_u32 s28, s92, 0x10a000
  buffer_load_dwordx4 v[204:207], v96, s[72:75], s28 offen
  s_waitcnt vmcnt(39)
  ds_write_b128 v98, a[192:195] offset:0
  s_waitcnt vmcnt(38)
  ds_write_b128 v98, a[196:199] offset:1024
  s_waitcnt vmcnt(37)
  ds_write_b128 v98, a[200:203] offset:2048
  s_waitcnt vmcnt(36)
  ds_write_b128 v98, a[204:207] offset:3072
  s_waitcnt lgkmcnt(0)
  s_barrier
  ds_read_b64_tr_b16 a[192:193], v100 offset:0
  ds_read_b64_tr_b16 a[194:195], v100 offset:2048
  ds_read_b64_tr_b16 a[196:197], v100 offset:4096
  ds_read_b64_tr_b16 a[198:199], v100 offset:6144
  ds_read_b64_tr_b16 a[200:201], v101 offset:0
  ds_read_b64_tr_b16 a[202:203], v101 offset:2048
  ds_read_b64_tr_b16 a[204:205], v101 offset:4096
  ds_read_b64_tr_b16 a[206:207], v101 offset:6144
  s_waitcnt lgkmcnt(6)
  ds_write_b128 v6, a[192:195] offset:12288
  s_waitcnt lgkmcnt(5)
  ds_write_b128 v6, a[196:199] offset:13312
  s_waitcnt lgkmcnt(4)
  ds_write_b128 v6, a[200:203] offset:14336
  s_waitcnt lgkmcnt(3)
  ds_write_b128 v6, a[204:207] offset:15360
  s_add_u32 s28, s92, 0x200000
  buffer_load_dwordx4 a[32:35], v96, s[72:75], s28 offen
  s_add_u32 s28, s92, 0x208000
  buffer_load_dwordx4 a[36:39], v96, s[72:75], s28 offen
  s_add_u32 s28, s92, 0x202000
  buffer_load_dwordx4 a[40:43], v96, s[72:75], s28 offen
  s_add_u32 s28, s92, 0x20a000
  buffer_load_dwordx4 a[44:47], v96, s[72:75], s28 offen
  s_waitcnt vmcnt(39)
  ds_write_b128 v98, v[208:211] offset:16384
  s_waitcnt vmcnt(38)
  ds_write_b128 v98, v[212:215] offset:17408
  s_waitcnt vmcnt(37)
  ds_write_b128 v98, v[216:219] offset:18432
  s_waitcnt vmcnt(36)
  ds_write_b128 v98, v[220:223] offset:19456
  s_waitcnt lgkmcnt(0)
  s_barrier
  ds_read_b64_tr_b16 v[208:209], v100 offset:16384
  ds_read_b64_tr_b16 v[210:211], v100 offset:18432
  ds_read_b64_tr_b16 v[212:213], v100 offset:20480
  ds_read_b64_tr_b16 v[214:215], v100 offset:22528
  ds_read_b64_tr_b16 v[216:217], v101 offset:16384
  ds_read_b64_tr_b16 v[218:219], v101 offset:18432
  ds_read_b64_tr_b16 v[220:221], v101 offset:20480
  ds_read_b64_tr_b16 v[222:223], v101 offset:22528
  s_add_u32 s28, s92, 0x300000
  buffer_load_dwordx4 a[112:115], v96, s[72:75], s28 offen
  s_add_u32 s28, s92, 0x308000
  buffer_load_dwordx4 a[116:119], v96, s[72:75], s28 offen
  s_add_u32 s28, s92, 0x302000
  buffer_load_dwordx4 a[120:123], v96, s[72:75], s28 offen
  s_add_u32 s28, s92, 0x30a000
  buffer_load_dwordx4 a[124:127], v96, s[72:75], s28 offen
  s_waitcnt vmcnt(39)
  ds_write_b128 v98, a[48:51] offset:0
  s_waitcnt vmcnt(38)
  ds_write_b128 v98, a[52:55] offset:1024
  s_waitcnt vmcnt(37)
  ds_write_b128 v98, a[56:59] offset:2048
  s_waitcnt vmcnt(36)
  ds_write_b128 v98, a[60:63] offset:3072
  s_waitcnt lgkmcnt(0)
  s_barrier
  ds_read_b64_tr_b16 a[48:49], v100 offset:0
  ds_read_b64_tr_b16 a[50:51], v100 offset:2048
  ds_read_b64_tr_b16 a[52:53], v100 offset:4096
  ds_read_b64_tr_b16 a[54:55], v100 offset:6144
  ds_read_b64_tr_b16 a[56:57], v101 offset:0
  ds_read_b64_tr_b16 a[58:59], v101 offset:2048
  ds_read_b64_tr_b16 a[60:61], v101 offset:4096
  ds_read_b64_tr_b16 a[62:63], v101 offset:6144
  s_add_u32 s28, s92, 0x80000
  buffer_load_dwordx4 v[128:131], v96, s[68:71], s28 offen
  s_add_u32 s28, s92, 0x88000
  buffer_load_dwordx4 v[132:135], v96, s[68:71], s28 offen
  s_add_u32 s28, s92, 0x82000
  buffer_load_dwordx4 v[136:139], v96, s[68:71], s28 offen
  s_add_u32 s28, s92, 0x8a000
  buffer_load_dwordx4 v[140:143], v96, s[68:71], s28 offen
  s_waitcnt vmcnt(39)
  ds_write_b128 v98, a[208:211] offset:16384
  s_waitcnt vmcnt(38)
  ds_write_b128 v98, a[212:215] offset:17408
  s_waitcnt vmcnt(37)
  ds_write_b128 v98, a[216:219] offset:18432
  s_waitcnt vmcnt(36)
  ds_write_b128 v98, a[220:223] offset:19456
  s_waitcnt lgkmcnt(0)
  s_barrier
  ds_read_b64_tr_b16 a[208:209], v100 offset:16384
  ds_read_b64_tr_b16 a[210:211], v100 offset:18432
  ds_read_b64_tr_b16 a[212:213], v100 offset:20480
  ds_read_b64_tr_b16 a[214:215], v100 offset:22528
  ds_read_b64_tr_b16 a[216:217], v101 offset:16384
  ds_read_b64_tr_b16 a[218:219], v101 offset:18432
  ds_read_b64_tr_b16 a[220:221], v101 offset:20480
  ds_read_b64_tr_b16 a[222:223], v101 offset:22528
  s_waitcnt lgkmcnt(6)
  ds_write_b128 v6, a[208:211] offset:20480
  s_waitcnt lgkmcnt(5)
  ds_write_b128 v6, a[212:215] offset:21504
  s_waitcnt lgkmcnt(4)
  ds_write_b128 v6, a[216:219] offset:22528
  s_waitcnt lgkmcnt(3)
  ds_write_b128 v6, a[220:223] offset:23552
  s_add_u32 s28, s92, 0x180000
  buffer_load_dwordx4 v[224:227], v96, s[68:71], s28 offen
  s_add_u32 s28, s92, 0x188000
  buffer_load_dwordx4 v[228:231], v96, s[68:71], s28 offen
  s_add_u32 s28, s92, 0x182000
  buffer_load_dwordx4 v[232:235], v96, s[68:71], s28 offen
  s_add_u32 s28, s92, 0x18a000
  buffer_load_dwordx4 v[236:239], v96, s[68:71], s28 offen
  s_waitcnt vmcnt(39)
  ds_write_b128 v98, a[224:227] offset:0
  s_waitcnt vmcnt(38)
  ds_write_b128 v98, a[228:231] offset:1024
  s_waitcnt vmcnt(37)
  ds_write_b128 v98, a[232:235] offset:2048
  s_waitcnt vmcnt(36)
  ds_write_b128 v98, a[236:239] offset:3072
  s_waitcnt lgkmcnt(0)
  s_barrier
  ds_read_b64_tr_b16 a[224:225], v100 offset:0
  ds_read_b64_tr_b16 a[226:227], v100 offset:2048
  ds_read_b64_tr_b16 a[228:229], v100 offset:4096
  ds_read_b64_tr_b16 a[230:231], v100 offset:6144
  ds_read_b64_tr_b16 a[232:233], v101 offset:0
  ds_read_b64_tr_b16 a[234:235], v101 offset:2048
  ds_read_b64_tr_b16 a[236:237], v101 offset:4096
  ds_read_b64_tr_b16 a[238:239], v101 offset:6144
  s_waitcnt lgkmcnt(6)
  ds_write_b128 v6, a[224:227] offset:4096
  s_waitcnt lgkmcnt(5)
  ds_write_b128 v6, a[228:231] offset:5120
  s_waitcnt lgkmcnt(4)
  ds_write_b128 v6, a[232:235] offset:6144
  s_waitcnt lgkmcnt(3)
  ds_write_b128 v6, a[236:239] offset:7168
  s_add_u32 s28, s92, 0x280000
  buffer_load_dwordx4 a[64:67], v96, s[68:71], s28 offen
  s_add_u32 s28, s92, 0x288000
  buffer_load_dwordx4 a[68:71], v96, s[68:71], s28 offen
  s_add_u32 s28, s92, 0x282000
  buffer_load_dwordx4 a[72:75], v96, s[68:71], s28 offen
  s_add_u32 s28, s92, 0x28a000
  buffer_load_dwordx4 a[76:79], v96, s[68:71], s28 offen
  s_waitcnt vmcnt(39)
  ds_write_b128 v98, v[176:179] offset:16384
  s_waitcnt vmcnt(38)
  ds_write_b128 v98, v[180:183] offset:17408
  s_waitcnt vmcnt(37)
  ds_write_b128 v98, v[184:187] offset:18432
  s_waitcnt vmcnt(36)
  ds_write_b128 v98, v[188:191] offset:19456
  s_waitcnt lgkmcnt(0)
  s_barrier
  ds_read_b64_tr_b16 v[176:177], v100 offset:16384
  ds_read_b64_tr_b16 v[178:179], v100 offset:18432
  ds_read_b64_tr_b16 v[180:181], v100 offset:20480
  ds_read_b64_tr_b16 v[182:183], v100 offset:22528
  ds_read_b64_tr_b16 v[184:185], v101 offset:16384
  ds_read_b64_tr_b16 v[186:187], v101 offset:18432
  ds_read_b64_tr_b16 v[188:189], v101 offset:20480
  ds_read_b64_tr_b16 v[190:191], v101 offset:22528
  s_add_u32 s28, s92, 0x380000
  buffer_load_dwordx4 a[128:131], v96, s[68:71], s28 offen
  s_add_u32 s28, s92, 0x388000
  buffer_load_dwordx4 a[132:135], v96, s[68:71], s28 offen
  s_add_u32 s28, s92, 0x382000
  buffer_load_dwordx4 a[136:139], v96, s[68:71], s28 offen
  s_add_u32 s28, s92, 0x38a000
  buffer_load_dwordx4 a[140:143], v96, s[68:71], s28 offen
  s_waitcnt vmcnt(39)
  ds_write_b128 v98, a[16:19] offset:0
  s_waitcnt vmcnt(38)
  ds_write_b128 v98, a[20:23] offset:1024
  s_waitcnt vmcnt(37)
  ds_write_b128 v98, a[24:27] offset:2048
  s_waitcnt vmcnt(36)
  ds_write_b128 v98, a[28:31] offset:3072
  s_waitcnt lgkmcnt(0)
  s_barrier
  ds_read_b64_tr_b16 a[16:17], v100 offset:0
  ds_read_b64_tr_b16 a[18:19], v100 offset:2048
  ds_read_b64_tr_b16 a[20:21], v100 offset:4096
  ds_read_b64_tr_b16 a[22:23], v100 offset:6144
  ds_read_b64_tr_b16 a[24:25], v101 offset:0
  ds_read_b64_tr_b16 a[26:27], v101 offset:2048
  ds_read_b64_tr_b16 a[28:29], v101 offset:4096
  ds_read_b64_tr_b16 a[30:31], v101 offset:6144
  s_add_u32 s28, s92, 0x80000
  buffer_load_dwordx4 v[144:147], v96, s[72:75], s28 offen
  s_add_u32 s28, s92, 0x88000
  buffer_load_dwordx4 v[148:151], v96, s[72:75], s28 offen
  s_add_u32 s28, s92, 0x82000
  buffer_load_dwordx4 v[152:155], v96, s[72:75], s28 offen
  s_add_u32 s28, s92, 0x8a000
  buffer_load_dwordx4 v[156:159], v96, s[72:75], s28 offen
  s_waitcnt vmcnt(39)
  ds_write_b128 v98, a[96:99] offset:16384
  s_waitcnt vmcnt(38)
  ds_write_b128 v98, a[100:103] offset:17408
  s_waitcnt vmcnt(37)
  ds_write_b128 v98, a[104:107] offset:18432
  s_waitcnt vmcnt(36)
  ds_write_b128 v98, a[108:111] offset:19456
  s_waitcnt lgkmcnt(0)
  s_barrier
  ds_read_b64_tr_b16 a[96:97], v100 offset:16384
  ds_read_b64_tr_b16 a[98:99], v100 offset:18432
  ds_read_b64_tr_b16 a[100:101], v100 offset:20480
  ds_read_b64_tr_b16 a[102:103], v100 offset:22528
  ds_read_b64_tr_b16 a[104:105], v101 offset:16384
  ds_read_b64_tr_b16 a[106:107], v101 offset:18432
  ds_read_b64_tr_b16 a[108:109], v101 offset:20480
  ds_read_b64_tr_b16 a[110:111], v101 offset:22528
  s_add_u32 s28, s92, 0x180000
  buffer_load_dwordx4 v[240:243], v96, s[72:75], s28 offen
  s_add_u32 s28, s92, 0x188000
  buffer_load_dwordx4 v[244:247], v96, s[72:75], s28 offen
  s_add_u32 s28, s92, 0x182000
  buffer_load_dwordx4 v[248:251], v96, s[72:75], s28 offen
  s_add_u32 s28, s92, 0x18a000
  buffer_load_dwordx4 v[252:255], v96, s[72:75], s28 offen
  v_and_b32 v44, 7, v0
  v_lshlrev_b32 v44, 5, v44
  buffer_load_dword v46, v44, s[24:27], 0 offen sc1
  v_lshlrev_b32 v41, 4, v0
  s_waitcnt vmcnt(40)
  ds_write_b128 v98, a[240:243] offset:0
  s_waitcnt vmcnt(39)
  ds_write_b128 v98, a[244:247] offset:1024
  s_waitcnt vmcnt(38)
  ds_write_b128 v98, a[248:251] offset:2048
  s_waitcnt vmcnt(37)
  ds_write_b128 v98, a[252:255] offset:3072
  s_waitcnt lgkmcnt(0)
  s_barrier
  ds_read_b64_tr_b16 a[240:241], v100 offset:0
  ds_read_b64_tr_b16 a[242:243], v100 offset:2048
  ds_read_b64_tr_b16 a[244:245], v100 offset:4096
  ds_read_b64_tr_b16 a[246:247], v100 offset:6144
  ds_read_b64_tr_b16 a[248:249], v101 offset:0
  ds_read_b64_tr_b16 a[250:251], v101 offset:2048
  ds_read_b64_tr_b16 a[252:253], v101 offset:4096
  ds_read_b64_tr_b16 a[254:255], v101 offset:6144
  s_waitcnt lgkmcnt(6)
  ds_write_b128 v6, a[240:243] offset:8192
  s_waitcnt lgkmcnt(5)
  ds_write_b128 v6, a[244:247] offset:9216
  s_waitcnt lgkmcnt(4)
  ds_write_b128 v6, a[248:251] offset:10240
  s_waitcnt lgkmcnt(3)
  ds_write_b128 v6, a[252:255] offset:11264
  s_add_u32 s28, s92, 0x280000
  buffer_load_dwordx4 a[80:83], v96, s[72:75], s28 offen
  s_add_u32 s28, s92, 0x288000
  buffer_load_dwordx4 a[84:87], v96, s[72:75], s28 offen
  s_add_u32 s28, s92, 0x282000
  buffer_load_dwordx4 a[88:91], v96, s[72:75], s28 offen
  s_add_u32 s28, s92, 0x28a000
  buffer_load_dwordx4 a[92:95], v96, s[72:75], s28 offen
  s_waitcnt vmcnt(40)
  ds_write_b128 v98, v[192:195] offset:16384
  s_waitcnt vmcnt(39)
  ds_write_b128 v98, v[196:199] offset:17408
  s_waitcnt vmcnt(38)
  ds_write_b128 v98, v[200:203] offset:18432
  s_waitcnt vmcnt(37)
  ds_write_b128 v98, v[204:207] offset:19456
  s_waitcnt lgkmcnt(0)
  s_barrier
  ds_read_b64_tr_b16 v[192:193], v100 offset:16384
  ds_read_b64_tr_b16 v[194:195], v100 offset:18432
  ds_read_b64_tr_b16 v[196:197], v100 offset:20480
  ds_read_b64_tr_b16 v[198:199], v100 offset:22528
  ds_read_b64_tr_b16 v[200:201], v101 offset:16384
  ds_read_b64_tr_b16 v[202:203], v101 offset:18432
  ds_read_b64_tr_b16 v[204:205], v101 offset:20480
  ds_read_b64_tr_b16 v[206:207], v101 offset:22528
  s_add_u32 s28, s92, 0x380000
  buffer_load_dwordx4 a[144:147], v96, s[72:75], s28 offen
  s_add_u32 s28, s92, 0x388000
  buffer_load_dwordx4 a[148:151], v96, s[72:75], s28 offen
  s_add_u32 s28, s92, 0x382000
  buffer_load_dwordx4 a[152:155], v96, s[72:75], s28 offen
  s_add_u32 s28, s92, 0x38a000
  buffer_load_dwordx4 a[156:159], v96, s[72:75], s28 offen
  s_waitcnt vmcnt(40)
  ds_write_b128 v98, a[32:35] offset:0
  s_waitcnt vmcnt(39)
  ds_write_b128 v98, a[36:39] offset:1024
  s_waitcnt vmcnt(38)
  ds_write_b128 v98, a[40:43] offset:2048
  s_waitcnt vmcnt(37)
  ds_write_b128 v98, a[44:47] offset:3072
  s_waitcnt lgkmcnt(0)
  s_barrier
  ds_read_b64_tr_b16 a[32:33], v100 offset:0
  ds_read_b64_tr_b16 a[34:35], v100 offset:2048
  ds_read_b64_tr_b16 a[36:37], v100 offset:4096
  ds_read_b64_tr_b16 a[38:39], v100 offset:6144
  ds_read_b64_tr_b16 a[40:41], v101 offset:0
  ds_read_b64_tr_b16 a[42:43], v101 offset:2048
  ds_read_b64_tr_b16 a[44:45], v101 offset:4096
  ds_read_b64_tr_b16 a[46:47], v101 offset:6144
  s_add_u32 s28, s96, 0x0
  buffer_load_dwordx4 a[160:163], v97, s[12:15], s28 offen
  s_add_u32 s28, s96, 0x800
  buffer_load_dwordx4 a[164:167], v97, s[12:15], s28 offen
  s_add_u32 s28, s96, 0x2000
  buffer_load_dwordx4 a[168:171], v97, s[12:15], s28 offen
  s_add_u32 s28, s96, 0x2800
  buffer_load_dwordx4 a[172:175], v97, s[12:15], s28 offen
  s_waitcnt vmcnt(40)
  ds_write_b128 v98, a[112:115] offset:16384
  s_waitcnt vmcnt(39)
  ds_write_b128 v98, a[116:119] offset:17408
  s_waitcnt vmcnt(38)
  ds_write_b128 v98, a[120:123] offset:18432
  s_waitcnt vmcnt(37)
  ds_write_b128 v98, a[124:127] offset:19456
  s_waitcnt lgkmcnt(0)
  s_barrier
  ds_read_b64_tr_b16 a[112:113], v100 offset:16384
  ds_read_b64_tr_b16 a[114:115], v100 offset:18432
  ds_read_b64_tr_b16 a[116:117], v100 offset:20480
  ds_read_b64_tr_b16 a[118:119], v100 offset:22528
  ds_read_b64_tr_b16 a[120:121], v101 offset:16384
  ds_read_b64_tr_b16 a[122:123], v101 offset:18432
  ds_read_b64_tr_b16 a[124:125], v101 offset:20480
  ds_read_b64_tr_b16 a[126:127], v101 offset:22528
  s_add_u32 s28, s96, 0x8000
  buffer_load_dwordx4 a[176:179], v97, s[12:15], s28 offen
  s_add_u32 s28, s96, 0x8800
  buffer_load_dwordx4 a[180:183], v97, s[12:15], s28 offen
  s_add_u32 s28, s96, 0xa000
  buffer_load_dwordx4 a[184:187], v97, s[12:15], s28 offen
  s_add_u32 s28, s96, 0xa800
  buffer_load_dwordx4 a[188:191], v97, s[12:15], s28 offen
  s_waitcnt vmcnt(40)
  ds_write_b128 v98, v[128:131] offset:0
  s_waitcnt vmcnt(39)
  ds_write_b128 v98, v[132:135] offset:1024
  s_waitcnt vmcnt(38)
  ds_write_b128 v98, v[136:139] offset:2048
  s_waitcnt vmcnt(37)
  ds_write_b128 v98, v[140:143] offset:3072
  s_waitcnt lgkmcnt(0)
  s_barrier
  ds_read_b64_tr_b16 v[128:129], v100 offset:0
  ds_read_b64_tr_b16 v[130:131], v100 offset:2048
  ds_read_b64_tr_b16 v[132:133], v100 offset:4096
  ds_read_b64_tr_b16 v[134:135], v100 offset:6144
  ds_read_b64_tr_b16 v[136:137], v101 offset:0
  ds_read_b64_tr_b16 v[138:139], v101 offset:2048
  ds_read_b64_tr_b16 v[140:141], v101 offset:4096
  ds_read_b64_tr_b16 v[142:143], v101 offset:6144
  s_add_u32 s28, s96, 0x80
  buffer_load_dwordx4 a[192:195], v97, s[12:15], s28 offen
  s_add_u32 s28, s96, 0x880
  buffer_load_dwordx4 a[196:199], v97, s[12:15], s28 offen
  s_add_u32 s28, s96, 0x2080
  buffer_load_dwordx4 a[200:203], v97, s[12:15], s28 offen
  s_add_u32 s28, s96, 0x2880
  buffer_load_dwordx4 a[204:207], v97, s[12:15], s28 offen
  s_waitcnt vmcnt(40)
  ds_write_b128 v98, v[224:227] offset:16384
  s_waitcnt vmcnt(39)
  ds_write_b128 v98, v[228:231] offset:17408
  s_waitcnt vmcnt(38)
  ds_write_b128 v98, v[232:235] offset:18432
  s_waitcnt vmcnt(37)
  ds_write_b128 v98, v[236:239] offset:19456
  s_waitcnt lgkmcnt(0)
  s_barrier
  ds_read_b64_tr_b16 v[224:225], v100 offset:16384
  ds_read_b64_tr_b16 v[226:227], v100 offset:18432
  ds_read_b64_tr_b16 v[228:229], v100 offset:20480
  ds_read_b64_tr_b16 v[230:231], v100 offset:22528
  ds_read_b64_tr_b16 v[232:233], v101 offset:16384
  ds_read_b64_tr_b16 v[234:235], v101 offset:18432
  ds_read_b64_tr_b16 v[236:237], v101 offset:20480
  ds_read_b64_tr_b16 v[238:239], v101 offset:22528
  s_add_u32 s28, s96, 0x8080
  buffer_load_dwordx4 a[208:211], v97, s[12:15], s28 offen
  s_add_u32 s28, s96, 0x8880
  buffer_load_dwordx4 a[212:215], v97, s[12:15], s28 offen
  s_add_u32 s28, s96, 0xa080
  buffer_load_dwordx4 a[216:219], v97, s[12:15], s28 offen
  s_add_u32 s28, s96, 0xa880
  buffer_load_dwordx4 a[220:223], v97, s[12:15], s28 offen
  s_waitcnt vmcnt(40)
  ds_write_b128 v98, a[64:67] offset:0
  s_waitcnt vmcnt(39)
  ds_write_b128 v98, a[68:71] offset:1024
  s_waitcnt vmcnt(38)
  ds_write_b128 v98, a[72:75] offset:2048
  s_waitcnt vmcnt(37)
  ds_write_b128 v98, a[76:79] offset:3072
  s_waitcnt lgkmcnt(0)
  s_barrier
  ds_read_b64_tr_b16 a[64:65], v100 offset:0
  ds_read_b64_tr_b16 a[66:67], v100 offset:2048
  ds_read_b64_tr_b16 a[68:69], v100 offset:4096
  ds_read_b64_tr_b16 a[70:71], v100 offset:6144
  ds_read_b64_tr_b16 a[72:73], v101 offset:0
  ds_read_b64_tr_b16 a[74:75], v101 offset:2048
  ds_read_b64_tr_b16 a[76:77], v101 offset:4096
  ds_read_b64_tr_b16 a[78:79], v101 offset:6144
  s_add_u32 s28, s97, 0x80
  buffer_load_dwordx4 a[224:227], v97, s[12:15], s28 offen
  s_add_u32 s28, s97, 0x880
  buffer_load_dwordx4 a[228:231], v97, s[12:15], s28 offen
  s_add_u32 s28, s97, 0x2080
  buffer_load_dwordx4 a[232:235], v97, s[12:15], s28 offen
  s_add_u32 s28, s97, 0x2880
  buffer_load_dwordx4 a[236:239], v97, s[12:15], s28 offen
  s_waitcnt vmcnt(40)
  ds_write_b128 v98, a[128:131] offset:16384
  s_waitcnt vmcnt(39)
  ds_write_b128 v98, a[132:135] offset:17408
  s_waitcnt vmcnt(38)
  ds_write_b128 v98, a[136:139] offset:18432
  s_waitcnt vmcnt(37)
  ds_write_b128 v98, a[140:143] offset:19456
  s_waitcnt lgkmcnt(0)
  s_barrier
  ds_read_b64_tr_b16 a[128:129], v100 offset:16384
  ds_read_b64_tr_b16 a[130:131], v100 offset:18432
  ds_read_b64_tr_b16 a[132:133], v100 offset:20480
  ds_read_b64_tr_b16 a[134:135], v100 offset:22528
  ds_read_b64_tr_b16 a[136:137], v101 offset:16384
  ds_read_b64_tr_b16 a[138:139], v101 offset:18432
  ds_read_b64_tr_b16 a[140:141], v101 offset:20480
  ds_read_b64_tr_b16 a[142:143], v101 offset:22528
  s_add_u32 s28, s97, 0x8080
  buffer_load_dwordx4 a[240:243], v97, s[12:15], s28 offen
  s_add_u32 s28, s97, 0x8880
  buffer_load_dwordx4 a[244:247], v97, s[12:15], s28 offen
  s_add_u32 s28, s97, 0xa080
  buffer_load_dwordx4 a[248:251], v97, s[12:15], s28 offen
  s_add_u32 s28, s97, 0xa880
  buffer_load_dwordx4 a[252:255], v97, s[12:15], s28 offen
  s_waitcnt vmcnt(40)
  ds_write_b128 v98, v[144:147] offset:0
  s_waitcnt vmcnt(39)
  ds_write_b128 v98, v[148:151] offset:1024
  s_waitcnt vmcnt(38)
  ds_write_b128 v98, v[152:155] offset:2048
  s_waitcnt vmcnt(37)
  ds_write_b128 v98, v[156:159] offset:3072
  s_waitcnt lgkmcnt(0)
  s_barrier
  ds_read_b64_tr_b16 v[144:145], v100 offset:0
  ds_read_b64_tr_b16 v[146:147], v100 offset:2048
  ds_read_b64_tr_b16 v[148:149], v100 offset:4096
  ds_read_b64_tr_b16 v[150:151], v100 offset:6144
  ds_read_b64_tr_b16 v[152:153], v101 offset:0
  ds_read_b64_tr_b16 v[154:155], v101 offset:2048
  ds_read_b64_tr_b16 v[156:157], v101 offset:4096
  ds_read_b64_tr_b16 v[158:159], v101 offset:6144
  s_add_u32 s28, s97, 0x0
  buffer_load_dwordx4 v[64:67], v97, s[12:15], s28 offen
  s_add_u32 s28, s97, 0x800
  buffer_load_dwordx4 v[68:71], v97, s[12:15], s28 offen
  s_add_u32 s28, s97, 0x2000
  buffer_load_dwordx4 v[72:75], v97, s[12:15], s28 offen
  s_add_u32 s28, s97, 0x2800
  buffer_load_dwordx4 v[76:79], v97, s[12:15], s28 offen
  s_waitcnt vmcnt(40)
  ds_write_b128 v98, v[240:243] offset:16384
  s_waitcnt vmcnt(39)
  ds_write_b128 v98, v[244:247] offset:17408
  s_waitcnt vmcnt(38)
  ds_write_b128 v98, v[248:251] offset:18432
  s_waitcnt vmcnt(37)
  ds_write_b128 v98, v[252:255] offset:19456
  s_waitcnt lgkmcnt(0)
  s_barrier
  ds_read_b64_tr_b16 v[240:241], v100 offset:16384
  ds_read_b64_tr_b16 v[242:243], v100 offset:18432
  ds_read_b64_tr_b16 v[244:245], v100 offset:20480
  ds_read_b64_tr_b16 v[246:247], v100 offset:22528
  ds_read_b64_tr_b16 v[248:249], v101 offset:16384
  ds_read_b64_tr_b16 v[250:251], v101 offset:18432
  ds_read_b64_tr_b16 v[252:253], v101 offset:20480
  ds_read_b64_tr_b16 v[254:255], v101 offset:22528
  s_add_u32 s28, s97, 0x8000
  buffer_load_dwordx4 v[80:83], v97, s[12:15], s28 offen
  s_add_u32 s28, s97, 0x8800
  buffer_load_dwordx4 v[84:87], v97, s[12:15], s28 offen
  s_add_u32 s28, s97, 0xa000
  buffer_load_dwordx4 v[88:91], v97, s[12:15], s28 offen
  s_add_u32 s28, s97, 0xa800
  buffer_load_dwordx4 v[92:95], v97, s[12:15], s28 offen
  s_mov_b32 s62, 0
  s_mov_b32 s74, 32768
  s_mul_i32 s28, s4, 29696
  s_add_u32 s28, s28, 0x1800000
  s_lshl_b32 s29, s5, 11
  s_add_u32 s63, s28, s29
  s_add_u32 s64, s63, 8192
  s_lshl_b32 s30, s5, 10
  s_add_u32 s30, s30, s28
  s_add_u32 s65, s30, 24576
  s_sub_u32 s65, s65, 0x100000
  s_mov_b32 s88, 0x3f803f80
  s_mov_b32 s89, 0x3f803f80
  s_add_u32 s90, s29, 12288
  s_add_u32 s91, s29, 20480
  s_lshl_b32 s30, s4, 13
  s_add_u32 s73, s30, s29
  s_mov_b32 s67, 270336
  s_add_u32 s66, s29, 270336
  s_mov_b32 s68, 286720
  s_mov_b32 s78, 0x3e0293ee
  s_mov_b32 s79, 0x3e0293ee
  s_lshl_b32 s30, s4, 7
  s_add_u32 s75, s30, 335872
  s_mov_b32 s70, 1
  s_waitcnt vmcnt(40)
  v_and_b32 v45, 63, v46
  v_cmp_ne_u32 vcc, 32, v45
  s_cbranch_vccnz L_cgs_7
L_cgb_8:
  v_readlane_b32 s28, v46, s3
  s_lshl_b32 s29, s7, 5
  s_nop 1
  s_cmp_lg_u32 s28, s29
  s_cselect_b32 s93, 1, 0
  s_waitcnt vmcnt(39)
  ds_write_b128 v98, a[80:83] offset:0
  s_waitcnt vmcnt(38)
  ds_write_b128 v98, a[84:87] offset:1024
  s_waitcnt vmcnt(37)
  ds_write_b128 v98, a[88:91] offset:2048
  s_waitcnt vmcnt(36)
  ds_write_b128 v98, a[92:95] offset:3072
  s_waitcnt lgkmcnt(0)
  s_barrier
  ds_read_b64_tr_b16 a[80:81], v100 offset:0
  ds_read_b64_tr_b16 a[82:83], v100 offset:2048
  ds_read_b64_tr_b16 a[84:85], v100 offset:4096
  ds_read_b64_tr_b16 a[86:87], v100 offset:6144
  ds_read_b64_tr_b16 a[88:89], v101 offset:0
  ds_read_b64_tr_b16 a[90:91], v101 offset:2048
  ds_read_b64_tr_b16 a[92:93], v101 offset:4096
  ds_read_b64_tr_b16 a[94:95], v101 offset:6144
  s_waitcnt vmcnt(35)
  ds_write_b128 v98, a[144:147] offset:16384
  s_waitcnt vmcnt(34)
  ds_write_b128 v98, a[148:151] offset:17408
  s_waitcnt vmcnt(33)
  ds_write_b128 v98, a[152:155] offset:18432
  s_waitcnt vmcnt(32)
  ds_write_b128 v98, a[156:159] offset:19456
  s_waitcnt lgkmcnt(0)
  s_barrier
  ds_read_b64_tr_b16 a[144:145], v100 offset:16384
  ds_read_b64_tr_b16 a[146:147], v100 offset:18432
  ds_read_b64_tr_b16 a[148:149], v100 offset:20480
  ds_read_b64_tr_b16 a[150:151], v100 offset:22528
  ds_read_b64_tr_b16 a[152:153], v101 offset:16384
  ds_read_b64_tr_b16 a[154:155], v101 offset:18432
  ds_read_b64_tr_b16 a[156:157], v101 offset:20480
  ds_read_b64_tr_b16 a[158:159], v101 offset:22528
  s_waitcnt lgkmcnt(0)
  s_barrier
  s_waitcnt vmcnt(31)
  ds_write_b128 v99, a[160:163] offset:0
  s_waitcnt vmcnt(30)
  ds_write_b128 v99, a[164:167] offset:1024
  s_waitcnt vmcnt(29)
  ds_write_b128 v99, a[168:171] offset:2048
  s_waitcnt vmcnt(28)
  ds_write_b128 v99, a[172:175] offset:3072
  s_waitcnt vmcnt(27)
  ds_write_b128 v99, a[176:179] offset:4096
  s_waitcnt vmcnt(26)
  ds_write_b128 v99, a[180:183] offset:5120
  s_waitcnt vmcnt(25)
  ds_write_b128 v99, a[184:187] offset:6144
  s_waitcnt vmcnt(24)
  ds_write_b128 v99, a[188:191] offset:7168
  ds_read_b64_tr_b16 a[160:161], v102 offset:0
  ds_read_b64_tr_b16 a[162:163], v102 offset:1024
  ds_read_b64_tr_b16 a[164:165], v102 offset:2048
  ds_read_b64_tr_b16 a[166:167], v102 offset:3072
  ds_read_b64_tr_b16 a[168:169], v104 offset:0
  ds_read_b64_tr_b16 a[170:171], v104 offset:1024
  ds_read_b64_tr_b16 a[172:173], v104 offset:2048
  s_waitcnt lgkmcnt(14)
  ds_read_b64_tr_b16 a[174:175], v104 offset:3072
  s_waitcnt lgkmcnt(14)
  ds_read_b64_tr_b16 a[176:177], v103 offset:0
  s_waitcnt lgkmcnt(14)
  ds_read_b64_tr_b16 a[178:179], v103 offset:1024
  s_waitcnt lgkmcnt(14)
  ds_read_b64_tr_b16 a[180:181], v103 offset:2048
  s_waitcnt lgkmcnt(14)
  ds_read_b64_tr_b16 a[182:183], v103 offset:3072
  s_waitcnt lgkmcnt(14)
  ds_read_b64_tr_b16 a[184:185], v105 offset:0
  s_waitcnt lgkmcnt(14)
  ds_read_b64_tr_b16 a[186:187], v105 offset:1024
  s_waitcnt lgkmcnt(14)
  ds_read_b64_tr_b16 a[188:189], v105 offset:2048
  s_waitcnt lgkmcnt(14)
  ds_read_b64_tr_b16 a[190:191], v105 offset:3072
  buffer_load_dword v12, off, s[8:11], s75 sc1
  s_add_u32 s28, s75, 4096
  buffer_load_dword v40, off, s[8:11], s28 sc1
  s_waitcnt vmcnt(25)
  s_waitcnt lgkmcnt(14)
  ds_write_b128 v99, a[192:195] offset:0
  s_waitcnt vmcnt(24)
  s_waitcnt lgkmcnt(14)
  ds_write_b128 v99, a[196:199] offset:1024
  s_waitcnt vmcnt(23)
  s_waitcnt lgkmcnt(14)
  ds_write_b128 v99, a[200:203] offset:2048
  s_waitcnt vmcnt(22)
  s_waitcnt lgkmcnt(14)
  ds_write_b128 v99, a[204:207] offset:3072
  s_waitcnt vmcnt(21)
  s_waitcnt lgkmcnt(14)
  ds_write_b128 v99, a[208:211] offset:4096
  s_waitcnt vmcnt(20)
  s_waitcnt lgkmcnt(14)
  ds_write_b128 v99, a[212:215] offset:5120
  s_waitcnt vmcnt(19)
  s_waitcnt lgkmcnt(14)
  ds_write_b128 v99, a[216:219] offset:6144
  s_waitcnt vmcnt(18)
  s_waitcnt lgkmcnt(14)
  ds_write_b128 v99, a[220:223] offset:7168
  s_waitcnt lgkmcnt(14)
  ds_read_b64_tr_b16 a[192:193], v102 offset:0
  s_waitcnt lgkmcnt(14)
  ds_read_b64_tr_b16 a[194:195], v102 offset:1024
  s_waitcnt lgkmcnt(14)
  ds_read_b64_tr_b16 a[196:197], v102 offset:2048
  s_waitcnt lgkmcnt(14)
  ds_read_b64_tr_b16 a[198:199], v102 offset:3072
  s_waitcnt lgkmcnt(14)
  ds_read_b64_tr_b16 a[200:201], v104 offset:0
  s_waitcnt lgkmcnt(14)
  ds_read_b64_tr_b16 a[202:203], v104 offset:1024
  s_waitcnt lgkmcnt(14)
  ds_read_b64_tr_b16 a[204:205], v104 offset:2048
  s_waitcnt lgkmcnt(14)
  ds_read_b64_tr_b16 a[206:207], v104 offset:3072
  s_waitcnt lgkmcnt(14)
  ds_read_b64_tr_b16 a[208:209], v103 offset:0
  s_waitcnt lgkmcnt(14)
  ds_read_b64_tr_b16 a[210:211], v103 offset:1024
  s_waitcnt lgkmcnt(14)
  ds_read_b64_tr_b16 a[212:213], v103 offset:2048
  s_waitcnt lgkmcnt(14)
  ds_read_b64_tr_b16 a[214:215], v103 offset:3072
  s_waitcnt lgkmcnt(14)
  ds_read_b64_tr_b16 a[216:217], v105 offset:0
  s_waitcnt lgkmcnt(14)
  ds_read_b64_tr_b16 a[218:219], v105 offset:1024
  s_waitcnt lgkmcnt(14)
  ds_read_b64_tr_b16 a[220:221], v105 offset:2048
  s_waitcnt lgkmcnt(14)
  ds_read_b64_tr_b16 a[222:223], v105 offset:3072
  s_waitcnt vmcnt(17)
  s_waitcnt lgkmcnt(14)
  ds_write_b128 v99, a[224:227] offset:0
  s_waitcnt vmcnt(16)
  s_waitcnt lgkmcnt(14)
  ds_write_b128 v99, a[228:231] offset:1024
  s_waitcnt vmcnt(15)
  s_waitcnt lgkmcnt(14)
  ds_write_b128 v99, a[232:235] offset:2048
  s_waitcnt vmcnt(14)
  s_waitcnt lgkmcnt(14)
  ds_write_b128 v99, a[236:239] offset:3072
  s_waitcnt vmcnt(13)
  s_waitcnt lgkmcnt(14)
  ds_write_b128 v99, a[240:243] offset:4096
  s_waitcnt vmcnt(12)
  s_waitcnt lgkmcnt(14)
  ds_write_b128 v99, a[244:247] offset:5120
  s_waitcnt vmcnt(11)
  s_waitcnt lgkmcnt(14)
  ds_write_b128 v99, a[248:251] offset:6144
  s_waitcnt vmcnt(10)
  s_waitcnt lgkmcnt(14)
  ds_write_b128 v99, a[252:255] offset:7168
  s_waitcnt lgkmcnt(14)
  ds_read_b64_tr_b16 a[224:225], v102 offset:0
  s_waitcnt lgkmcnt(14)
  ds_read_b64_tr_b16 a[226:227], v102 offset:1024
  s_waitcnt lgkmcnt(14)
  ds_read_b64_tr_b16 a[228:229], v102 offset:2048
  s_waitcnt lgkmcnt(14)
  ds_read_b64_tr_b16 a[230:231], v102 offset:3072
  s_waitcnt lgkmcnt(14)
  ds_read_b64_tr_b16 a[232:233], v104 offset:0
  s_waitcnt lgkmcnt(14)
  ds_read_b64_tr_b16 a[234:235], v104 offset:1024
  s_waitcnt lgkmcnt(14)
  ds_read_b64_tr_b16 a[236:237], v104 offset:2048
  s_waitcnt lgkmcnt(14)
  ds_read_b64_tr_b16 a[238:239], v104 offset:3072
  s_waitcnt lgkmcnt(14)
  ds_read_b64_tr_b16 a[240:241], v103 offset:0
  s_waitcnt lgkmcnt(14)
  ds_read_b64_tr_b16 a[242:243], v103 offset:1024
  s_waitcnt lgkmcnt(14)
  ds_read_b64_tr_b16 a[244:245], v103 offset:2048
  s_waitcnt lgkmcnt(14)
  ds_read_b64_tr_b16 a[246:247], v103 offset:3072
  s_waitcnt lgkmcnt(14)
  ds_read_b64_tr_b16 a[248:249], v105 offset:0
  s_waitcnt lgkmcnt(14)
  ds_read_b64_tr_b16 a[250:251], v105 offset:1024
  s_waitcnt lgkmcnt(14)
  ds_read_b64_tr_b16 a[252:253], v105 offset:2048
  s_waitcnt lgkmcnt(14)
  ds_read_b64_tr_b16 a[254:255], v105 offset:3072
  s_waitcnt vmcnt(1)
  v_cmp_gt_u32 vcc, s70, v12
  s_mov_b32 m0, s90
  s_cbranch_vccnz L_cps_9
L_cpb_10:
  buffer_load_dwordx4 v41, s[8:11], s63 offen offset:0 sc1 lds
  buffer_load_dwordx4 v41, s[8:11], s63 offen offset:1024 sc1 lds
  buffer_load_dwordx4 v[108:111], v41, s[8:11], s64 offen offset:0 sc1
  buffer_load_dwordx4 v[112:115], v41, s[8:11], s64 offen offset:1024 sc1
  s_waitcnt lgkmcnt(14)
  ds_write_b128 v99, v[64:67] offset:0
  s_waitcnt lgkmcnt(14)
  ds_write_b128 v99, v[68:71] offset:1024
  s_waitcnt lgkmcnt(14)
  ds_write_b128 v99, v[72:75] offset:2048
  s_waitcnt lgkmcnt(14)
  ds_write_b128 v99, v[76:79] offset:3072
  s_waitcnt lgkmcnt(14)
  ds_write_b128 v99, v[80:83] offset:4096
  s_waitcnt lgkmcnt(14)
  ds_write_b128 v99, v[84:87] offset:5120
  s_waitcnt lgkmcnt(14)
  ds_write_b128 v99, v[88:91] offset:6144
  s_waitcnt lgkmcnt(14)
  ds_write_b128 v99, v[92:95] offset:7168
  s_waitcnt lgkmcnt(14)
  ds_read_b64_tr_b16 v[64:65], v102 offset:0
  s_waitcnt lgkmcnt(14)
  ds_read_b64_tr_b16 v[66:67], v102 offset:1024
  s_waitcnt lgkmcnt(14)
  ds_read_b64_tr_b16 v[68:69], v102 offset:2048
  s_waitcnt lgkmcnt(14)
  ds_read_b64_tr_b16 v[70:71], v102 offset:3072
  s_waitcnt lgkmcnt(14)
  ds_read_b64_tr_b16 v[72:73], v104 offset:0
  s_waitcnt lgkmcnt(14)
  ds_read_b64_tr_b16 v[74:75], v104 offset:1024
  s_waitcnt lgkmcnt(14)
  ds_read_b64_tr_b16 v[76:77], v104 offset:2048
  s_waitcnt lgkmcnt(14)
  ds_read_b64_tr_b16 v[78:79], v104 offset:3072
  s_waitcnt lgkmcnt(14)
  ds_read_b64_tr_b16 v[80:81], v103 offset:0
  s_waitcnt lgkmcnt(14)
  ds_read_b64_tr_b16 v[82:83], v103 offset:1024
  s_waitcnt lgkmcnt(14)
  ds_read_b64_tr_b16 v[84:85], v103 offset:2048
  s_waitcnt lgkmcnt(14)
  ds_read_b64_tr_b16 v[86:87], v103 offset:3072
  s_waitcnt lgkmcnt(14)
  ds_read_b64_tr_b16 v[88:89], v105 offset:0
  s_waitcnt lgkmcnt(14)
  ds_read_b64_tr_b16 v[90:91], v105 offset:1024
  s_waitcnt lgkmcnt(14)
  ds_read_b64_tr_b16 v[92:93], v105 offset:2048
  s_waitcnt lgkmcnt(14)
  ds_read_b64_tr_b16 v[94:95], v105 offset:3072
  s_waitcnt lgkmcnt(14)
  ds_write_b128 v6, v[64:67] offset:24576
  s_waitcnt lgkmcnt(13)
  ds_write_b128 v6, v[68:71] offset:25600
  s_waitcnt lgkmcnt(12)
  ds_write_b128 v6, v[72:75] offset:26624
  s_waitcnt lgkmcnt(11)
  ds_write_b128 v6, v[76:79] offset:27648
  s_waitcnt lgkmcnt(10)
  ds_write_b128 v6, v[80:83] offset:28672
  s_waitcnt lgkmcnt(9)
  ds_write_b128 v6, v[84:87] offset:29696
  s_waitcnt lgkmcnt(8)
  ds_write_b128 v6, v[88:91] offset:30720
  s_waitcnt lgkmcnt(7)
  ds_write_b128 v6, v[92:95] offset:31744
  s_waitcnt lgkmcnt(0)
  s_branch L_wj_5
L_wv_2:
  s_add_u32 s28, s92, 0x0
  buffer_load_dwordx4 v[160:163], v96, s[64:67], s28 offen
  s_add_u32 s28, s92, 0x8000
  buffer_load_dwordx4 v[164:167], v96, s[64:67], s28 offen
  s_add_u32 s28, s92, 0x2000
  buffer_load_dwordx4 v[168:171], v96, s[64:67], s28 offen
  s_add_u32 s28, s92, 0xa000
  buffer_load_dwordx4 v[172:175], v96, s[64:67], s28 offen
  s_add_u32 s28, s92, 0x100000
  buffer_load_dwordx4 a[160:163], v96, s[64:67], s28 offen
  s_add_u32 s28, s92, 0x108000
  buffer_load_dwordx4 a[164:167], v96, s[64:67], s28 offen
  s_add_u32 s28, s92, 0x102000
  buffer_load_dwordx4 a[168:171], v96, s[64:67], s28 offen
  s_add_u32 s28, s92, 0x10a000
  buffer_load_dwordx4 a[172:175], v96, s[64:67], s28 offen
  s_add_u32 s28, s92, 0x200000
  buffer_load_dwordx4 a[176:179], v96, s[64:67], s28 offen
  s_add_u32 s28, s92, 0x208000
  buffer_load_dwordx4 a[180:183], v96, s[64:67], s28 offen
  s_add_u32 s28, s92, 0x202000
  buffer_load_dwordx4 a[184:187], v96, s[64:67], s28 offen
  s_add_u32 s28, s92, 0x20a000
  buffer_load_dwordx4 a[188:191], v96, s[64:67], s28 offen
  s_add_u32 s28, s92, 0x300000
  buffer_load_dwordx4 a[0:3], v96, s[64:67], s28 offen
  s_add_u32 s28, s92, 0x308000
  buffer_load_dwordx4 a[4:7], v96, s[64:67], s28 offen
  s_add_u32 s28, s92, 0x302000
  buffer_load_dwordx4 a[8:11], v96, s[64:67], s28 offen
  s_add_u32 s28, s92, 0x30a000
  buffer_load_dwordx4 a[12:15], v96, s[64:67], s28 offen
  s_add_u32 s28, s92, 0x80000
  buffer_load_dwordx4 v[208:211], v96, s[64:67], s28 offen
  s_add_u32 s28, s92, 0x88000
  buffer_load_dwordx4 v[212:215], v96, s[64:67], s28 offen
  s_add_u32 s28, s92, 0x82000
  buffer_load_dwordx4 v[216:219], v96, s[64:67], s28 offen
  s_add_u32 s28, s92, 0x8a000
  buffer_load_dwordx4 v[220:223], v96, s[64:67], s28 offen
  s_add_u32 s28, s92, 0x180000
  buffer_load_dwordx4 a[192:195], v96, s[64:67], s28 offen
  s_add_u32 s28, s92, 0x188000
  buffer_load_dwordx4 a[196:199], v96, s[64:67], s28 offen
  s_add_u32 s28, s92, 0x182000
  buffer_load_dwordx4 a[200:203], v96, s[64:67], s28 offen
  s_add_u32 s28, s92, 0x18a000
  buffer_load_dwordx4 a[204:207], v96, s[64:67], s28 offen
  s_add_u32 s28, s92, 0x280000
  buffer_load_dwordx4 a[208:211], v96, s[64:67], s28 offen
  s_add_u32 s28, s92, 0x288000
  buffer_load_dwordx4 a[212:215], v96, s[64:67], s28 offen
  s_add_u32 s28, s92, 0x282000
  buffer_load_dwordx4 a[216:219], v96, s[64:67], s28 offen
  s_add_u32 s28, s92, 0x28a000
  buffer_load_dwordx4 a[220:223], v96, s[64:67], s28 offen
  s_add_u32 s28, s92, 0x380000
  buffer_load_dwordx4 a[48:51], v96, s[64:67], s28 offen
  s_add_u32 s28, s92, 0x388000
  buffer_load_dwordx4 a[52:55], v96, s[64:67], s28 offen
  s_add_u32 s28, s92, 0x382000
  buffer_load_dwordx4 a[56:59], v96, s[64:67], s28 offen
  s_add_u32 s28, s92, 0x38a000
  buffer_load_dwordx4 a[60:63], v96, s[64:67], s28 offen
  s_add_u32 s28, s92, 0x0
  buffer_load_dwordx4 v[176:179], v96, s[68:71], s28 offen
  s_add_u32 s28, s92, 0x8000
  buffer_load_dwordx4 v[180:183], v96, s[68:71], s28 offen
  s_add_u32 s28, s92, 0x2000
  buffer_load_dwordx4 v[184:187], v96, s[68:71], s28 offen
  s_add_u32 s28, s92, 0xa000
  buffer_load_dwordx4 v[188:191], v96, s[68:71], s28 offen
  s_add_u32 s28, s92, 0x100000
  buffer_load_dwordx4 a[224:227], v96, s[68:71], s28 offen
  s_add_u32 s28, s92, 0x108000
  buffer_load_dwordx4 a[228:231], v96, s[68:71], s28 offen
  s_add_u32 s28, s92, 0x102000
  buffer_load_dwordx4 a[232:235], v96, s[68:71], s28 offen
  s_add_u32 s28, s92, 0x10a000
  buffer_load_dwordx4 a[236:239], v96, s[68:71], s28 offen
  s_waitcnt vmcnt(44)
  s_barrier
  s_cmp_lg_u32 s5, 0
  s_cbranch_scc1 L_arr_11
  s_lshl_b32 s28, s3, 5
  v_mov_b32 v47, s7
  s_mov_b64 exec, 1
  buffer_atomic_add v47, off, s[24:27], s28 offset:0 sc1
  s_mov_b64 exec, -1
L_arr_11:
  s_mov_b32 s28, 0x05040100
  s_mov_b32 s29, 0x07060302
  s_waitcnt vmcnt(42)
  v_perm_b32 v48, v34, v32, s28
  v_perm_b32 v49, v34, v32, s29
  v_perm_b32 v50, v35, v33, s28
  v_perm_b32 v51, v35, v33, s29
  v_or_b32 v48, 1, v48
  s_waitcnt vmcnt(40)
  v_perm_b32 v52, v38, v36, s28
  v_perm_b32 v53, v38, v36, s29
  v_perm_b32 v54, v39, v37, s28
  v_perm_b32 v55, v39, v37, s29
  v_or_b32 v52, 1, v52
  s_waitcnt vmcnt(39)
  ds_write_b128 v98, v[160:163] offset:0
  s_waitcnt vmcnt(38)
  ds_write_b128 v98, v[164:167] offset:1024
  s_waitcnt vmcnt(37)
  ds_write_b128 v98, v[168:171] offset:2048
  s_waitcnt vmcnt(36)
  ds_write_b128 v98, v[172:175] offset:3072
  s_waitcnt lgkmcnt(0)
  s_barrier
  ds_read_b64_tr_b16 v[160:161], v100 offset:0
  ds_read_b64_tr_b16 v[162:163], v100 offset:2048
  ds_read_b64_tr_b16 v[164:165], v100 offset:4096
  ds_read_b64_tr_b16 v[166:167], v100 offset:6144
  ds_read_b64_tr_b16 v[168:169], v101 offset:0
  ds_read_b64_tr_b16 v[170:171], v101 offset:2048
  ds_read_b64_tr_b16 v[172:173], v101 offset:4096
  ds_read_b64_tr_b16 v[174:175], v101 offset:6144
  s_add_u32 s28, s92, 0x200000
  buffer_load_dwordx4 a[96:99], v96, s[68:71], s28 offen
  s_add_u32 s28, s92, 0x208000
  buffer_load_dwordx4 a[100:103], v96, s[68:71], s28 offen
  s_add_u32 s28, s92, 0x202000
  buffer_load_dwordx4 a[104:107], v96, s[68:71], s28 offen
  s_add_u32 s28, s92, 0x20a000
  buffer_load_dwordx4 a[108:111], v96, s[68:71], s28 offen
  s_waitcnt vmcnt(39)
  ds_write_b128 v98, a[160:163] offset:16384
  s_waitcnt vmcnt(38)
  ds_write_b128 v98, a[164:167] offset:17408
  s_waitcnt vmcnt(37)
  ds_write_b128 v98, a[168:171] offset:18432
  s_waitcnt vmcnt(36)
  ds_write_b128 v98, a[172:175] offset:19456
  s_waitcnt lgkmcnt(0)
  s_barrier
  ds_read_b64_tr_b16 a[160:161], v100 offset:16384
  ds_read_b64_tr_b16 a[162:163], v100 offset:18432
  ds_read_b64_tr_b16 a[164:165], v100 offset:20480
  ds_read_b64_tr_b16 a[166:167], v100 offset:22528
  ds_read_b64_tr_b16 a[168:169], v101 offset:16384
  ds_read_b64_tr_b16 a[170:171], v101 offset:18432
  ds_read_b64_tr_b16 a[172:173], v101 offset:20480
  ds_read_b64_tr_b16 a[174:175], v101 offset:22528
  s_waitcnt lgkmcnt(6)
  ds_write_b128 v6, a[160:163] offset:0
  s_waitcnt lgkmcnt(5)
  ds_write_b128 v6, a[164:167] offset:1024
  s_waitcnt lgkmcnt(4)
  ds_write_b128 v6, a[168:171] offset:2048
  s_waitcnt lgkmcnt(3)
  ds_write_b128 v6, a[172:175] offset:3072
  s_add_u32 s28, s92, 0x300000
  buffer_load_dwordx4 a[16:19], v96, s[68:71], s28 offen
  s_add_u32 s28, s92, 0x308000
  buffer_load_dwordx4 a[20:23], v96, s[68:71], s28 offen
  s_add_u32 s28, s92, 0x302000
  buffer_load_dwordx4 a[24:27], v96, s[68:71], s28 offen
  s_add_u32 s28, s92, 0x30a000
  buffer_load_dwordx4 a[28:31], v96, s[68:71], s28 offen
  s_waitcnt vmcnt(39)
  ds_write_b128 v98, a[176:179] offset:0
  s_waitcnt vmcnt(38)
  ds_write_b128 v98, a[180:183] offset:1024
  s_waitcnt vmcnt(37)
  ds_write_b128 v98, a[184:187] offset:2048
  s_waitcnt vmcnt(36)
  ds_write_b128 v98, a[188:191] offset:3072
  s_waitcnt lgkmcnt(0)
  s_barrier
  ds_read_b64_tr_b16 a[176:177], v100 offset:0
  ds_read_b64_tr_b16 a[178:179], v100 offset:2048
  ds_read_b64_tr_b16 a[180:181], v100 offset:4096
  ds_read_b64_tr_b16 a[182:183], v100 offset:6144
  ds_read_b64_tr_b16 a[184:185], v101 offset:0
  ds_read_b64_tr_b16 a[186:187], v101 offset:2048
  ds_read_b64_tr_b16 a[188:189], v101 offset:4096
  ds_read_b64_tr_b16 a[190:191], v101 offset:6144
  s_waitcnt lgkmcnt(6)
  ds_write_b128 v6, a[176:179] offset:16384
  s_waitcnt lgkmcnt(5)
  ds_write_b128 v6, a[180:183] offset:17408
  s_waitcnt lgkmcnt(4)
  ds_write_b128 v6, a[184:187] offset:18432
  s_waitcnt lgkmcnt(3)
  ds_write_b128 v6, a[188:191] offset:19456
  s_add_u32 s28, s92, 0x0
  buffer_load_dwordx4 v[192:195], v96, s[72:75], s28 offen
  s_add_u32 s28, s92, 0x8000
  buffer_load_dwordx4 v[196:199], v96, s[72:75], s28 offen
  s_add_u32 s28, s92, 0x2000
  buffer_load_dwordx4 v[200:203], v96, s[72:75], s28 offen
  s_add_u32 s28, s92, 0xa000
  buffer_load_dwordx4 v[204:207], v96, s[72:75], s28 offen
  s_waitcnt vmcnt(39)
  ds_write_b128 v98, a[0:3] offset:16384
  s_waitcnt vmcnt(38)
  ds_write_b128 v98, a[4:7] offset:17408
  s_waitcnt vmcnt(37)
  ds_write_b128 v98, a[8:11] offset:18432
  s_waitcnt vmcnt(36)
  ds_write_b128 v98, a[12:15] offset:19456
  s_waitcnt lgkmcnt(0)
  s_barrier
  ds_read_b64_tr_b16 a[0:1], v100 offset:16384
  ds_read_b64_tr_b16 a[2:3], v100 offset:18432
  ds_read_b64_tr_b16 a[4:5], v100 offset:20480
  ds_read_b64_tr_b16 a[6:7], v100 offset:22528
  ds_read_b64_tr_b16 a[8:9], v101 offset:16384
  ds_read_b64_tr_b16 a[10:11], v101 offset:18432
  ds_read_b64_tr_b16 a[12:13], v101 offset:20480
  ds_read_b64_tr_b16 a[14:15], v101 offset:22528
  s_add_u32 s28, s92, 0x100000
  buffer_load_dwordx4 a[240:243], v96, s[72:75], s28 offen
  s_add_u32 s28, s92, 0x108000
  buffer_load_dwordx4 a[244:247], v96, s[72:75], s28 offen
  s_add_u32 s28, s92, 0x102000
  buffer_load_dwordx4 a[248:251], v96, s[72:75], s28 offen
  s_add_u32 s28, s92, 0x10a000
  buffer_load_dwordx4 a[252:255], v96, s[72:75], s28 offen
  s_waitcnt vmcnt(39)
  ds_write_b128 v98, v[208:211] offset:0
  s_waitcnt vmcnt(38)
  ds_write_b128 v98, v[212:215] offset:1024
  s_waitcnt vmcnt(37)
  ds_write_b128 v98, v[216:219] offset:2048
  s_waitcnt vmcnt(36)
  ds_write_b128 v98, v[220:223] offset:3072
  s_waitcnt lgkmcnt(0)
  s_barrier
  ds_read_b64_tr_b16 v[208:209], v100 offset:0
  ds_read_b64_tr_b16 v[210:211], v100 offset:2048
  ds_read_b64_tr_b16 v[212:213], v100 offset:4096
  ds_read_b64_tr_b16 v[214:215], v100 offset:6144
  ds_read_b64_tr_b16 v[216:217], v101 offset:0
  ds_read_b64_tr_b16 v[218:219], v101 offset:2048
  ds_read_b64_tr_b16 v[220:221], v101 offset:4096
  ds_read_b64_tr_b16 v[222:223], v101 offset:6144
  s_add_u32 s28, s92, 0x200000
  buffer_load_dwordx4 a[112:115], v96, s[72:75], s28 offen
  s_add_u32 s28, s92, 0x208000
  buffer_load_dwordx4 a[116:119], v96, s[72:75], s28 offen
  s_add_u32 s28, s92, 0x202000
  buffer_load_dwordx4 a[120:123], v96, s[72:75], s28 offen
  s_add_u32 s28, s92, 0x20a000
  buffer_load_dwordx4 a[124:127], v96, s[72:75], s28 offen
  s_waitcnt vmcnt(39)
  ds_write_b128 v98, a[192:195] offset:16384
  s_waitcnt vmcnt(38)
  ds_write_b128 v98, a[196:199] offset:17408
  s_waitcnt vmcnt(37)
  ds_write_b128 v98, a[200:203] offset:18432
  s_waitcnt vmcnt(36)
  ds_write_b128 v98, a[204:207] offset:19456
  s_waitcnt lgkmcnt(0)
  s_barrier
  ds_read_b64_tr_b16 a[192:193], v100 offset:16384
  ds_read_b64_tr_b16 a[194:195], v100 offset:18432
  ds_read_b64_tr_b16 a[196:197], v100 offset:20480
  ds_read_b64_tr_b16 a[198:199], v100 offset:22528
  ds_read_b64_tr_b16 a[200:201], v101 offset:16384
  ds_read_b64_tr_b16 a[202:203], v101 offset:18432
  ds_read_b64_tr_b16 a[204:205], v101 offset:20480
  ds_read_b64_tr_b16 a[206:207], v101 offset:22528
  s_waitcnt lgkmcnt(6)
  ds_write_b128 v6, a[192:195] offset:12288
  s_waitcnt lgkmcnt(5)
  ds_write_b128 v6, a[196:199] offset:13312
  s_waitcnt lgkmcnt(4)
  ds_write_b128 v6, a[200:203] offset:14336
  s_waitcnt lgkmcnt(3)
  ds_write_b128 v6, a[204:207] offset:15360
  s_add_u32 s28, s92, 0x300000
  buffer_load_dwordx4 a[32:35], v96, s[72:75], s28 offen
  s_add_u32 s28, s92, 0x308000
  buffer_load_dwordx4 a[36:39], v96, s[72:75], s28 offen
  s_add_u32 s28, s92, 0x302000
  buffer_load_dwordx4 a[40:43], v96, s[72:75], s28 offen
  s_add_u32 s28, s92, 0x30a000
  buffer_load_dwordx4 a[44:47], v96, s[72:75], s28 offen
  s_waitcnt vmcnt(39)
  ds_write_b128 v98, a[208:211] offset:0
  s_waitcnt vmcnt(38)
  ds_write_b128 v98, a[212:215] offset:1024
  s_waitcnt vmcnt(37)
  ds_write_b128 v98, a[216:219] offset:2048
  s_waitcnt vmcnt(36)
  ds_write_b128 v98, a[220:223] offset:3072
  s_waitcnt lgkmcnt(0)
  s_barrier
  ds_read_b64_tr_b16 a[208:209], v100 offset:0
  ds_read_b64_tr_b16 a[210:211], v100 offset:2048
  ds_read_b64_tr_b16 a[212:213], v100 offset:4096
  ds_read_b64_tr_b16 a[214:215], v100 offset:6144
  ds_read_b64_tr_b16 a[216:217], v101 offset:0
  ds_read_b64_tr_b16 a[218:219], v101 offset:2048
  ds_read_b64_tr_b16 a[220:221], v101 offset:4096
  ds_read_b64_tr_b16 a[222:223], v101 offset:6144
  s_waitcnt lgkmcnt(6)
  ds_write_b128 v6, a[208:211] offset:20480
  s_waitcnt lgkmcnt(5)
  ds_write_b128 v6, a[212:215] offset:21504
  s_waitcnt lgkmcnt(4)
  ds_write_b128 v6, a[216:219] offset:22528
  s_waitcnt lgkmcnt(3)
  ds_write_b128 v6, a[220:223] offset:23552
  s_add_u32 s28, s92, 0x80000
  buffer_load_dwordx4 v[224:227], v96, s[68:71], s28 offen
  s_add_u32 s28, s92, 0x88000
  buffer_load_dwordx4 v[228:231], v96, s[68:71], s28 offen
  s_add_u32 s28, s92, 0x82000
  buffer_load_dwordx4 v[232:235], v96, s[68:71], s28 offen
  s_add_u32 s28, s92, 0x8a000
  buffer_load_dwordx4 v[236:239], v96, s[68:71], s28 offen
  s_waitcnt vmcnt(39)
  ds_write_b128 v98, a[48:51] offset:16384
  s_waitcnt vmcnt(38)
  ds_write_b128 v98, a[52:55] offset:17408
  s_waitcnt vmcnt(37)
  ds_write_b128 v98, a[56:59] offset:18432
  s_waitcnt vmcnt(36)
  ds_write_b128 v98, a[60:63] offset:19456
  s_waitcnt lgkmcnt(0)
  s_barrier
  ds_read_b64_tr_b16 a[48:49], v100 offset:16384
  ds_read_b64_tr_b16 a[50:51], v100 offset:18432
  ds_read_b64_tr_b16 a[52:53], v100 offset:20480
  ds_read_b64_tr_b16 a[54:55], v100 offset:22528
  ds_read_b64_tr_b16 a[56:57], v101 offset:16384
  ds_read_b64_tr_b16 a[58:59], v101 offset:18432
  ds_read_b64_tr_b16 a[60:61], v101 offset:20480
  ds_read_b64_tr_b16 a[62:63], v101 offset:22528
  s_add_u32 s28, s92, 0x180000
  buffer_load_dwordx4 v[128:131], v96, s[68:71], s28 offen
  s_add_u32 s28, s92, 0x188000
  buffer_load_dwordx4 v[132:135], v96, s[68:71], s28 offen
  s_add_u32 s28, s92, 0x182000
  buffer_load_dwordx4 v[136:139], v96, s[68:71], s28 offen
  s_add_u32 s28, s92, 0x18a000
  buffer_load_dwordx4 v[140:143], v96, s[68:71], s28 offen
  s_waitcnt vmcnt(39)
  ds_write_b128 v98, v[176:179] offset:0
  s_waitcnt vmcnt(38)
  ds_write_b128 v98, v[180:183] offset:1024
  s_waitcnt vmcnt(37)
  ds_write_b128 v98, v[184:187] offset:2048
  s_waitcnt vmcnt(36)
  ds_write_b128 v98, v[188:191] offset:3072
  s_waitcnt lgkmcnt(0)
  s_barrier
  ds_read_b64_tr_b16 v[176:177], v100 offset:0
  ds_read_b64_tr_b16 v[178:179], v100 offset:2048
  ds_read_b64_tr_b16 v[180:181], v100 offset:4096
  ds_read_b64_tr_b16 v[182:183], v100 offset:6144
  ds_read_b64_tr_b16 v[184:185], v101 offset:0
  ds_read_b64_tr_b16 v[186:187], v101 offset:2048
  ds_read_b64_tr_b16 v[188:189], v101 offset:4096
  ds_read_b64_tr_b16 v[190:191], v101 offset:6144
  s_add_u32 s28, s92, 0x280000
  buffer_load_dwordx4 a[128:131], v96, s[68:71], s28 offen
  s_add_u32 s28, s92, 0x288000
  buffer_load_dwordx4 a[132:135], v96, s[68:71], s28 offen
  s_add_u32 s28, s92, 0x282000
  buffer_load_dwordx4 a[136:139], v96, s[68:71], s28 offen
  s_add_u32 s28, s92, 0x28a000
  buffer_load_dwordx4 a[140:143], v96, s[68:71], s28 offen
  s_waitcnt vmcnt(39)
  ds_write_b128 v98, a[224:227] offset:16384
  s_waitcnt vmcnt(38)
  ds_write_b128 v98, a[228:231] offset:17408
  s_waitcnt vmcnt(37)
  ds_write_b128 v98, a[232:235] offset:18432
  s_waitcnt vmcnt(36)
  ds_write_b128 v98, a[236:239] offset:19456
  s_waitcnt lgkmcnt(0)
  s_barrier
  ds_read_b64_tr_b16 a[224:225], v100 offset:16384
  ds_read_b64_tr_b16 a[226:227], v100 offset:18432
  ds_read_b64_tr_b16 a[228:229], v100 offset:20480
  ds_read_b64_tr_b16 a[230:231], v100 offset:22528
  ds_read_b64_tr_b16 a[232:233], v101 offset:16384
  ds_read_b64_tr_b16 a[234:235], v101 offset:18432
  ds_read_b64_tr_b16 a[236:237], v101 offset:20480
  ds_read_b64_tr_b16 a[238:239], v101 offset:22528
  s_waitcnt lgkmcnt(6)
  ds_write_b128 v6, a[224:227] offset:4096
  s_waitcnt lgkmcnt(5)
  ds_write_b128 v6, a[228:231] offset:5120
  s_waitcnt lgkmcnt(4)
  ds_write_b128 v6, a[232:235] offset:6144
  s_waitcnt lgkmcnt(3)
  ds_write_b128 v6, a[236:239] offset:7168
  s_add_u32 s28, s92, 0x380000
  buffer_load_dwordx4 a[64:67], v96, s[68:71], s28 offen
  s_add_u32 s28, s92, 0x388000
  buffer_load_dwordx4 a[68:71], v96, s[68:71], s28 offen
  s_add_u32 s28, s92, 0x382000
  buffer_load_dwordx4 a[72:75], v96, s[68:71], s28 offen
  s_add_u32 s28, s92, 0x38a000
  buffer_load_dwordx4 a[76:79], v96, s[68:71], s28 offen
  s_waitcnt vmcnt(39)
  ds_write_b128 v98, a[96:99] offset:0
  s_waitcnt vmcnt(38)
  ds_write_b128 v98, a[100:103] offset:1024
  s_waitcnt vmcnt(37)
  ds_write_b128 v98, a[104:107] offset:2048
  s_waitcnt vmcnt(36)
  ds_write_b128 v98, a[108:111] offset:3072
  s_waitcnt lgkmcnt(0)
  s_barrier
  ds_read_b64_tr_b16 a[96:97], v100 offset:0
  ds_read_b64_tr_b16 a[98:99], v100 offset:2048
  ds_read_b64_tr_b16 a[100:101], v100 offset:4096
  ds_read_b64_tr_b16 a[102:103], v100 offset:6144
  ds_read_b64_tr_b16 a[104:105], v101 offset:0
  ds_read_b64_tr_b16 a[106:107], v101 offset:2048
  ds_read_b64_tr_b16 a[108:109], v101 offset:4096
  ds_read_b64_tr_b16 a[110:111], v101 offset:6144
  s_add_u32 s28, s92, 0x80000
  buffer_load_dwordx4 v[240:243], v96, s[72:75], s28 offen
  s_add_u32 s28, s92, 0x88000
  buffer_load_dwordx4 v[244:247], v96, s[72:75], s28 offen
  s_add_u32 s28, s92, 0x82000
  buffer_load_dwordx4 v[248:251], v96, s[72:75], s28 offen
  s_add_u32 s28, s92, 0x8a000
  buffer_load_dwordx4 v[252:255], v96, s[72:75], s28 offen
  s_waitcnt vmcnt(39)
  ds_write_b128 v98, a[16:19] offset:16384
  s_waitcnt vmcnt(38)
  ds_write_b128 v98, a[20:23] offset:17408
  s_waitcnt vmcnt(37)
  ds_write_b128 v98, a[24:27] offset:18432
  s_waitcnt vmcnt(36)
  ds_write_b128 v98, a[28:31] offset:19456
  s_waitcnt lgkmcnt(0)
  s_barrier
  ds_read_b64_tr_b16 a[16:17], v100 offset:16384
  ds_read_b64_tr_b16 a[18:19], v100 offset:18432
  ds_read_b64_tr_b16 a[20:21], v100 offset:20480
  ds_read_b64_tr_b16 a[22:23], v100 offset:22528
  ds_read_b64_tr_b16 a[24:25], v101 offset:16384
  ds_read_b64_tr_b16 a[26:27], v101 offset:18432
  ds_read_b64_tr_b16 a[28:29], v101 offset:20480
  ds_read_b64_tr_b16 a[30:31], v101 offset:22528
  s_add_u32 s28, s92, 0x180000
  buffer_load_dwordx4 v[144:147], v96, s[72:75], s28 offen
  s_add_u32 s28, s92, 0x188000
  buffer_load_dwordx4 v[148:151], v96, s[72:75], s28 offen
  s_add_u32 s28, s92, 0x182000
  buffer_load_dwordx4 v[152:155], v96, s[72:75], s28 offen
  s_add_u32 s28, s92, 0x18a000
  buffer_load_dwordx4 v[156:159], v96, s[72:75], s28 offen
  v_and_b32 v44, 7, v0
  v_lshlrev_b32 v44, 5, v44
  buffer_load_dword v46, v44, s[24:27], 0 offen sc1
  v_lshlrev_b32 v41, 4, v0
  s_waitcnt vmcnt(40)
  ds_write_b128 v98, v[192:195] offset:0
  s_waitcnt vmcnt(39)
  ds_write_b128 v98, v[196:199] offset:1024
  s_waitcnt vmcnt(38)
  ds_write_b128 v98, v[200:203] offset:2048
  s_waitcnt vmcnt(37)
  ds_write_b128 v98, v[204:207] offset:3072
  s_waitcnt lgkmcnt(0)
  s_barrier
  ds_read_b64_tr_b16 v[192:193], v100 offset:0
  ds_read_b64_tr_b16 v[194:195], v100 offset:2048
  ds_read_b64_tr_b16 v[196:197], v100 offset:4096
  ds_read_b64_tr_b16 v[198:199], v100 offset:6144
  ds_read_b64_tr_b16 v[200:201], v101 offset:0
  ds_read_b64_tr_b16 v[202:203], v101 offset:2048
  ds_read_b64_tr_b16 v[204:205], v101 offset:4096
  ds_read_b64_tr_b16 v[206:207], v101 offset:6144
  s_add_u32 s28, s92, 0x280000
  buffer_load_dwordx4 a[144:147], v96, s[72:75], s28 offen
  s_add_u32 s28, s92, 0x288000
  buffer_load_dwordx4 a[148:151], v96, s[72:75], s28 offen
  s_add_u32 s28, s92, 0x282000
  buffer_load_dwordx4 a[152:155], v96, s[72:75], s28 offen
  s_add_u32 s28, s92, 0x28a000
  buffer_load_dwordx4 a[156:159], v96, s[72:75], s28 offen
  s_waitcnt vmcnt(40)
  ds_write_b128 v98, a[240:243] offset:16384
  s_waitcnt vmcnt(39)
  ds_write_b128 v98, a[244:247] offset:17408
  s_waitcnt vmcnt(38)
  ds_write_b128 v98, a[248:251] offset:18432
  s_waitcnt vmcnt(37)
  ds_write_b128 v98, a[252:255] offset:19456
  s_waitcnt lgkmcnt(0)
  s_barrier
  ds_read_b64_tr_b16 a[240:241], v100 offset:16384
  ds_read_b64_tr_b16 a[242:243], v100 offset:18432
  ds_read_b64_tr_b16 a[244:245], v100 offset:20480
  ds_read_b64_tr_b16 a[246:247], v100 offset:22528
  ds_read_b64_tr_b16 a[248:249], v101 offset:16384
  ds_read_b64_tr_b16 a[250:251], v101 offset:18432
  ds_read_b64_tr_b16 a[252:253], v101 offset:20480
  ds_read_b64_tr_b16 a[254:255], v101 offset:22528
  s_waitcnt lgkmcnt(6)
  ds_write_b128 v6, a[240:243] offset:8192
  s_waitcnt lgkmcnt(5)
  ds_write_b128 v6, a[244:247] offset:9216
  s_waitcnt lgkmcnt(4)
  ds_write_b128 v6, a[248:251] offset:10240
  s_waitcnt lgkmcnt(3)
  ds_write_b128 v6, a[252:255] offset:11264
  s_add_u32 s28, s92, 0x380000
  buffer_load_dwordx4 a[80:83], v96, s[72:75], s28 offen
  s_add_u32 s28, s92, 0x388000
  buffer_load_dwordx4 a[84:87], v96, s[72:75], s28 offen
  s_add_u32 s28, s92, 0x382000
  buffer_load_dwordx4 a[88:91], v96, s[72:75], s28 offen
  s_add_u32 s28, s92, 0x38a000
  buffer_load_dwordx4 a[92:95], v96, s[72:75], s28 offen
  s_waitcnt vmcnt(40)
  ds_write_b128 v98, a[112:115] offset:0
  s_waitcnt vmcnt(39)
  ds_write_b128 v98, a[116:119] offset:1024
  s_waitcnt vmcnt(38)
  ds_write_b128 v98, a[120:123] offset:2048
  s_waitcnt vmcnt(37)
  ds_write_b128 v98, a[124:127] offset:3072
  s_waitcnt lgkmcnt(0)
  s_barrier
  ds_read_b64_tr_b16 a[112:113], v100 offset:0
  ds_read_b64_tr_b16 a[114:115], v100 offset:2048
  ds_read_b64_tr_b16 a[116:117], v100 offset:4096
  ds_read_b64_tr_b16 a[118:119], v100 offset:6144
  ds_read_b64_tr_b16 a[120:121], v101 offset:0
  ds_read_b64_tr_b16 a[122:123], v101 offset:2048
  ds_read_b64_tr_b16 a[124:125], v101 offset:4096
  ds_read_b64_tr_b16 a[126:127], v101 offset:6144
  s_add_u32 s28, s96, 0x0
  buffer_load_dwordx4 a[160:163], v97, s[12:15], s28 offen
  s_add_u32 s28, s96, 0x800
  buffer_load_dwordx4 a[164:167], v97, s[12:15], s28 offen
  s_add_u32 s28, s96, 0x2000
  buffer_load_dwordx4 a[168:171], v97, s[12:15], s28 offen
  s_add_u32 s28, s96, 0x2800
  buffer_load_dwordx4 a[172:175], v97, s[12:15], s28 offen
  s_waitcnt vmcnt(40)
  ds_write_b128 v98, a[32:35] offset:16384
  s_waitcnt vmcnt(39)
  ds_write_b128 v98, a[36:39] offset:17408
  s_waitcnt vmcnt(38)
  ds_write_b128 v98, a[40:43] offset:18432
  s_waitcnt vmcnt(37)
  ds_write_b128 v98, a[44:47] offset:19456
  s_waitcnt lgkmcnt(0)
  s_barrier
  ds_read_b64_tr_b16 a[32:33], v100 offset:16384
  ds_read_b64_tr_b16 a[34:35], v100 offset:18432
  ds_read_b64_tr_b16 a[36:37], v100 offset:20480
  ds_read_b64_tr_b16 a[38:39], v100 offset:22528
  ds_read_b64_tr_b16 a[40:41], v101 offset:16384
  ds_read_b64_tr_b16 a[42:43], v101 offset:18432
  ds_read_b64_tr_b16 a[44:45], v101 offset:20480
  ds_read_b64_tr_b16 a[46:47], v101 offset:22528
  s_add_u32 s28, s96, 0x8000
  buffer_load_dwordx4 a[176:179], v97, s[12:15], s28 offen
  s_add_u32 s28, s96, 0x8800
  buffer_load_dwordx4 a[180:183], v97, s[12:15], s28 offen
  s_add_u32 s28, s96, 0xa000
  buffer_load_dwordx4 a[184:187], v97, s[12:15], s28 offen
  s_add_u32 s28, s96, 0xa800
  buffer_load_dwordx4 a[188:191], v97, s[12:15], s28 offen
  s_waitcnt vmcnt(40)
  ds_write_b128 v98, v[224:227] offset:0
  s_waitcnt vmcnt(39)
  ds_write_b128 v98, v[228:231] offset:1024
  s_waitcnt vmcnt(38)
  ds_write_b128 v98, v[232:235] offset:2048
  s_waitcnt vmcnt(37)
  ds_write_b128 v98, v[236:239] offset:3072
  s_waitcnt lgkmcnt(0)
  s_barrier
  ds_read_b64_tr_b16 v[224:225], v100 offset:0
  ds_read_b64_tr_b16 v[226:227], v100 offset:2048
  ds_read_b64_tr_b16 v[228:229], v100 offset:4096
  ds_read_b64_tr_b16 v[230:231], v100 offset:6144
  ds_read_b64_tr_b16 v[232:233], v101 offset:0
  ds_read_b64_tr_b16 v[234:235], v101 offset:2048
  ds_read_b64_tr_b16 v[236:237], v101 offset:4096
  ds_read_b64_tr_b16 v[238:239], v101 offset:6144
  s_add_u32 s28, s96, 0x80
  buffer_load_dwordx4 a[192:195], v97, s[12:15], s28 offen
  s_add_u32 s28, s96, 0x880
  buffer_load_dwordx4 a[196:199], v97, s[12:15], s28 offen
  s_add_u32 s28, s96, 0x2080
  buffer_load_dwordx4 a[200:203], v97, s[12:15], s28 offen
  s_add_u32 s28, s96, 0x2880
  buffer_load_dwordx4 a[204:207], v97, s[12:15], s28 offen
  s_waitcnt vmcnt(40)
  ds_write_b128 v98, v[128:131] offset:16384
  s_waitcnt vmcnt(39)
  ds_write_b128 v98, v[132:135] offset:17408
  s_waitcnt vmcnt(38)
  ds_write_b128 v98, v[136:139] offset:18432
  s_waitcnt vmcnt(37)
  ds_write_b128 v98, v[140:143] offset:19456
  s_waitcnt lgkmcnt(0)
  s_barrier
  ds_read_b64_tr_b16 v[128:129], v100 offset:16384
  ds_read_b64_tr_b16 v[130:131], v100 offset:18432
  ds_read_b64_tr_b16 v[132:133], v100 offset:20480
  ds_read_b64_tr_b16 v[134:135], v100 offset:22528
  ds_read_b64_tr_b16 v[136:137], v101 offset:16384
  ds_read_b64_tr_b16 v[138:139], v101 offset:18432
  ds_read_b64_tr_b16 v[140:141], v101 offset:20480
  ds_read_b64_tr_b16 v[142:143], v101 offset:22528
  s_add_u32 s28, s96, 0x8080
  buffer_load_dwordx4 a[208:211], v97, s[12:15], s28 offen
  s_add_u32 s28, s96, 0x8880
  buffer_load_dwordx4 a[212:215], v97, s[12:15], s28 offen
  s_add_u32 s28, s96, 0xa080
  buffer_load_dwordx4 a[216:219], v97, s[12:15], s28 offen
  s_add_u32 s28, s96, 0xa880
  buffer_load_dwordx4 a[220:223], v97, s[12:15], s28 offen
  s_waitcnt vmcnt(40)
  ds_write_b128 v98, a[128:131] offset:0
  s_waitcnt vmcnt(39)
  ds_write_b128 v98, a[132:135] offset:1024
  s_waitcnt vmcnt(38)
  ds_write_b128 v98, a[136:139] offset:2048
  s_waitcnt vmcnt(37)
  ds_write_b128 v98, a[140:143] offset:3072
  s_waitcnt lgkmcnt(0)
  s_barrier
  ds_read_b64_tr_b16 a[128:129], v100 offset:0
  ds_read_b64_tr_b16 a[130:131], v100 offset:2048
  ds_read_b64_tr_b16 a[132:133], v100 offset:4096
  ds_read_b64_tr_b16 a[134:135], v100 offset:6144
  ds_read_b64_tr_b16 a[136:137], v101 offset:0
  ds_read_b64_tr_b16 a[138:139], v101 offset:2048
  ds_read_b64_tr_b16 a[140:141], v101 offset:4096
  ds_read_b64_tr_b16 a[142:143], v101 offset:6144
  s_add_u32 s28, s97, 0x80
  buffer_load_dwordx4 a[224:227], v97, s[12:15], s28 offen
  s_add_u32 s28, s97, 0x880
  buffer_load_dwordx4 a[228:231], v97, s[12:15], s28 offen
  s_add_u32 s28, s97, 0x2080
  buffer_load_dwordx4 a[232:235], v97, s[12:15], s28 offen
  s_add_u32 s28, s97, 0x2880
  buffer_load_dwordx4 a[236:239], v97, s[12:15], s28 offen
  s_waitcnt vmcnt(40)
  ds_write_b128 v98, a[64:67] offset:16384
  s_waitcnt vmcnt(39)
  ds_write_b128 v98, a[68:71] offset:17408
  s_waitcnt vmcnt(38)
  ds_write_b128 v98, a[72:75] offset:18432
  s_waitcnt vmcnt(37)
  ds_write_b128 v98, a[76:79] offset:19456
  s_waitcnt lgkmcnt(0)
  s_barrier
  ds_read_b64_tr_b16 a[64:65], v100 offset:16384
  ds_read_b64_tr_b16 a[66:67], v100 offset:18432
  ds_read_b64_tr_b16 a[68:69], v100 offset:20480
  ds_read_b64_tr_b16 a[70:71], v100 offset:22528
  ds_read_b64_tr_b16 a[72:73], v101 offset:16384
  ds_read_b64_tr_b16 a[74:75], v101 offset:18432
  ds_read_b64_tr_b16 a[76:77], v101 offset:20480
  ds_read_b64_tr_b16 a[78:79], v101 offset:22528
  s_add_u32 s28, s97, 0x8080
  buffer_load_dwordx4 a[240:243], v97, s[12:15], s28 offen
  s_add_u32 s28, s97, 0x8880
  buffer_load_dwordx4 a[244:247], v97, s[12:15], s28 offen
  s_add_u32 s28, s97, 0xa080
  buffer_load_dwordx4 a[248:251], v97, s[12:15], s28 offen
  s_add_u32 s28, s97, 0xa880
  buffer_load_dwordx4 a[252:255], v97, s[12:15], s28 offen
  s_waitcnt vmcnt(40)
  ds_write_b128 v98, v[240:243] offset:0
  s_waitcnt vmcnt(39)
  ds_write_b128 v98, v[244:247] offset:1024
  s_waitcnt vmcnt(38)
  ds_write_b128 v98, v[248:251] offset:2048
  s_waitcnt vmcnt(37)
  ds_write_b128 v98, v[252:255] offset:3072
  s_waitcnt lgkmcnt(0)
  s_barrier
  ds_read_b64_tr_b16 v[240:241], v100 offset:0
  ds_read_b64_tr_b16 v[242:243], v100 offset:2048
  ds_read_b64_tr_b16 v[244:245], v100 offset:4096
  ds_read_b64_tr_b16 v[246:247], v100 offset:6144
  ds_read_b64_tr_b16 v[248:249], v101 offset:0
  ds_read_b64_tr_b16 v[250:251], v101 offset:2048
  ds_read_b64_tr_b16 v[252:253], v101 offset:4096
  ds_read_b64_tr_b16 v[254:255], v101 offset:6144
  s_add_u32 s28, s97, 0x0
  buffer_load_dwordx4 v[64:67], v97, s[12:15], s28 offen
  s_add_u32 s28, s97, 0x800
  buffer_load_dwordx4 v[68:71], v97, s[12:15], s28 offen
  s_add_u32 s28, s97, 0x2000
  buffer_load_dwordx4 v[72:75], v97, s[12:15], s28 offen
  s_add_u32 s28, s97, 0x2800
  buffer_load_dwordx4 v[76:79], v97, s[12:15], s28 offen
  s_waitcnt vmcnt(40)
  ds_write_b128 v98, v[144:147] offset:16384
  s_waitcnt vmcnt(39)
  ds_write_b128 v98, v[148:151] offset:17408
  s_waitcnt vmcnt(38)
  ds_write_b128 v98, v[152:155] offset:18432
  s_waitcnt vmcnt(37)
  ds_write_b128 v98, v[156:159] offset:19456
  s_waitcnt lgkmcnt(0)
  s_barrier
  ds_read_b64_tr_b16 v[144:145], v100 offset:16384
  ds_read_b64_tr_b16 v[146:147], v100 offset:18432
  ds_read_b64_tr_b16 v[148:149], v100 offset:20480
  ds_read_b64_tr_b16 v[150:151], v100 offset:22528
  ds_read_b64_tr_b16 v[152:153], v101 offset:16384
  ds_read_b64_tr_b16 v[154:155], v101 offset:18432
  ds_read_b64_tr_b16 v[156:157], v101 offset:20480
  ds_read_b64_tr_b16 v[158:159], v101 offset:22528
  s_add_u32 s28, s97, 0x8000
  buffer_load_dwordx4 v[80:83], v97, s[12:15], s28 offen
  s_add_u32 s28, s97, 0x8800
  buffer_load_dwordx4 v[84:87], v97, s[12:15], s28 offen
  s_add_u32 s28, s97, 0xa000
  buffer_load_dwordx4 v[88:91], v97, s[12:15], s28 offen
  s_add_u32 s28, s97, 0xa800
  buffer_load_dwordx4 v[92:95], v97, s[12:15], s28 offen
  s_mov_b32 s62, 0
  s_mov_b32 s74, 32768
  s_mul_i32 s28, s4, 29696
  s_add_u32 s28, s28, 0x1800000
  s_lshl_b32 s29, s5, 11
  s_add_u32 s63, s28, s29
  s_add_u32 s64, s63, 8192
  s_lshl_b32 s30, s5, 10
  s_add_u32 s30, s30, s28
  s_add_u32 s65, s30, 24576
  s_sub_u32 s65, s65, 0x100000
  s_mov_b32 s88, 0x3f803f80
  s_mov_b32 s89, 0x3f803f80
  s_add_u32 s90, s29, 12288
  s_add_u32 s91, s29, 20480
  s_lshl_b32 s30, s4, 13
  s_add_u32 s73, s30, s29
  s_mov_b32 s67, 270336
  s_add_u32 s66, s29, 270336
  s_mov_b32 s68, 286720
  s_mov_b32 s78, 0x3e0293ee
  s_mov_b32 s79, 0x3e0293ee
  s_lshl_b32 s30, s4, 7
  s_add_u32 s75, s30, 335872
  s_mov_b32 s70, 1
  s_waitcnt vmcnt(40)
  v_and_b32 v45, 63, v46
  v_cmp_ne_u32 vcc, 32, v45
  s_cbranch_vccnz L_cgs_12
L_cgb_13:
  v_readlane_b32 s28, v46, s3
  s_lshl_b32 s29, s7, 5
  s_nop 1
  s_cmp_lg_u32 s28, s29
  s_cselect_b32 s93, 1, 0
  s_waitcnt vmcnt(39)
  ds_write_b128 v98, a[144:147] offset:0
  s_waitcnt vmcnt(38)
  ds_write_b128 v98, a[148:151] offset:1024
  s_waitcnt vmcnt(37)
  ds_write_b128 v98, a[152:155] offset:2048
  s_waitcnt vmcnt(36)
  ds_write_b128 v98, a[156:159] offset:3072
  s_waitcnt lgkmcnt(0)
  s_barrier
  ds_read_b64_tr_b16 a[144:145], v100 offset:0
  ds_read_b64_tr_b16 a[146:147], v100 offset:2048
  ds_read_b64_tr_b16 a[148:149], v100 offset:4096
  ds_read_b64_tr_b16 a[150:151], v100 offset:6144
  ds_read_b64_tr_b16 a[152:153], v101 offset:0
  ds_read_b64_tr_b16 a[154:155], v101 offset:2048
  ds_read_b64_tr_b16 a[156:157], v101 offset:4096
  ds_read_b64_tr_b16 a[158:159], v101 offset:6144
  s_waitcnt vmcnt(35)
  ds_write_b128 v98, a[80:83] offset:16384
  s_waitcnt vmcnt(34)
  ds_write_b128 v98, a[84:87] offset:17408
  s_waitcnt vmcnt(33)
  ds_write_b128 v98, a[88:91] offset:18432
  s_waitcnt vmcnt(32)
  ds_write_b128 v98, a[92:95] offset:19456
  s_waitcnt lgkmcnt(0)
  s_barrier
  ds_read_b64_tr_b16 a[80:81], v100 offset:16384
  ds_read_b64_tr_b16 a[82:83], v100 offset:18432
  ds_read_b64_tr_b16 a[84:85], v100 offset:20480
  ds_read_b64_tr_b16 a[86:87], v100 offset:22528
  ds_read_b64_tr_b16 a[88:89], v101 offset:16384
  ds_read_b64_tr_b16 a[90:91], v101 offset:18432
  ds_read_b64_tr_b16 a[92:93], v101 offset:20480
  ds_read_b64_tr_b16 a[94:95], v101 offset:22528
  s_waitcnt lgkmcnt(0)
  s_barrier
  s_waitcnt vmcnt(31)
  ds_write_b128 v99, a[160:163] offset:0
  s_waitcnt vmcnt(30)
  ds_write_b128 v99, a[164:167] offset:1024
  s_waitcnt vmcnt(29)
  ds_write_b128 v99, a[168:171] offset:2048
  s_waitcnt vmcnt(28)
  ds_write_b128 v99, a[172:175] offset:3072
  s_waitcnt vmcnt(27)
  ds_write_b128 v99, a[176:179] offset:4096
  s_waitcnt vmcnt(26)
  ds_write_b128 v99, a[180:183] offset:5120
  s_waitcnt vmcnt(25)
  ds_write_b128 v99, a[184:187] offset:6144
  s_waitcnt vmcnt(24)
  ds_write_b128 v99, a[188:191] offset:7168
  ds_read_b64_tr_b16 a[160:161], v102 offset:0
  ds_read_b64_tr_b16 a[162:163], v102 offset:1024
  ds_read_b64_tr_b16 a[164:165], v102 offset:2048
  ds_read_b64_tr_b16 a[166:167], v102 offset:3072
  ds_read_b64_tr_b16 a[168:169], v104 offset:0
  ds_read_b64_tr_b16 a[170:171], v104 offset:1024
  ds_read_b64_tr_b16 a[172:173], v104 offset:2048
  s_waitcnt lgkmcnt(14)
  ds_read_b64_tr_b16 a[174:175], v104 offset:3072
  s_waitcnt lgkmcnt(14)
  ds_read_b64_tr_b16 a[176:177], v103 offset:0
  s_waitcnt lgkmcnt(14)
  ds_read_b64_tr_b16 a[178:179], v103 offset:1024
  s_waitcnt lgkmcnt(14)
  ds_read_b64_tr_b16 a[180:181], v103 offset:2048
  s_waitcnt lgkmcnt(14)
  ds_read_b64_tr_b16 a[182:183], v103 offset:3072
  s_waitcnt lgkmcnt(14)
  ds_read_b64_tr_b16 a[184:185], v105 offset:0
  s_waitcnt lgkmcnt(14)
  ds_read_b64_tr_b16 a[186:187], v105 offset:1024
  s_waitcnt lgkmcnt(14)
  ds_read_b64_tr_b16 a[188:189], v105 offset:2048
  s_waitcnt lgkmcnt(14)
  ds_read_b64_tr_b16 a[190:191], v105 offset:3072
  buffer_load_dword v12, off, s[8:11], s75 sc1
  s_add_u32 s28, s75, 4096
  buffer_load_dword v40, off, s[8:11], s28 sc1
  s_waitcnt vmcnt(25)
  s_waitcnt lgkmcnt(14)
  ds_write_b128 v99, a[192:195] offset:0
  s_waitcnt vmcnt(24)
  s_waitcnt lgkmcnt(14)
  ds_write_b128 v99, a[196:199] offset:1024
  s_waitcnt vmcnt(23)
  s_waitcnt lgkmcnt(14)
  ds_write_b128 v99, a[200:203] offset:2048
  s_waitcnt vmcnt(22)
  s_waitcnt lgkmcnt(14)
  ds_write_b128 v99, a[204:207] offset:3072
  s_waitcnt vmcnt(21)
  s_waitcnt lgkmcnt(14)
  ds_write_b128 v99, a[208:211] offset:4096
  s_waitcnt vmcnt(20)
  s_waitcnt lgkmcnt(14)
  ds_write_b128 v99, a[212:215] offset:5120
  s_waitcnt vmcnt(19)
  s_waitcnt lgkmcnt(14)
  ds_write_b128 v99, a[216:219] offset:6144
  s_waitcnt vmcnt(18)
  s_waitcnt lgkmcnt(14)
  ds_write_b128 v99, a[220:223] offset:7168
  s_waitcnt lgkmcnt(14)
  ds_read_b64_tr_b16 a[192:193], v102 offset:0
  s_waitcnt lgkmcnt(14)
  ds_read_b64_tr_b16 a[194:195], v102 offset:1024
  s_waitcnt lgkmcnt(14)
  ds_read_b64_tr_b16 a[196:197], v102 offset:2048
  s_waitcnt lgkmcnt(14)
  ds_read_b64_tr_b16 a[198:199], v102 offset:3072
  s_waitcnt lgkmcnt(14)
  ds_read_b64_tr_b16 a[200:201], v104 offset:0
  s_waitcnt lgkmcnt(14)
  ds_read_b64_tr_b16 a[202:203], v104 offset:1024
  s_waitcnt lgkmcnt(14)
  ds_read_b64_tr_b16 a[204:205], v104 offset:2048
  s_waitcnt lgkmcnt(14)
  ds_read_b64_tr_b16 a[206:207], v104 offset:3072
  s_waitcnt lgkmcnt(14)
  ds_read_b64_tr_b16 a[208:209], v103 offset:0
  s_waitcnt lgkmcnt(14)
  ds_read_b64_tr_b16 a[210:211], v103 offset:1024
  s_waitcnt lgkmcnt(14)
  ds_read_b64_tr_b16 a[212:213], v103 offset:2048
  s_waitcnt lgkmcnt(14)
  ds_read_b64_tr_b16 a[214:215], v103 offset:3072
  s_waitcnt lgkmcnt(14)
  ds_read_b64_tr_b16 a[216:217], v105 offset:0
  s_waitcnt lgkmcnt(14)
  ds_read_b64_tr_b16 a[218:219], v105 offset:1024
  s_waitcnt lgkmcnt(14)
  ds_read_b64_tr_b16 a[220:221], v105 offset:2048
  s_waitcnt lgkmcnt(14)
  ds_read_b64_tr_b16 a[222:223], v105 offset:3072
  s_waitcnt vmcnt(17)
  s_waitcnt lgkmcnt(14)
  ds_write_b128 v99, a[224:227] offset:0
  s_waitcnt vmcnt(16)
  s_waitcnt lgkmcnt(14)
  ds_write_b128 v99, a[228:231] offset:1024
  s_waitcnt vmcnt(15)
  s_waitcnt lgkmcnt(14)
  ds_write_b128 v99, a[232:235] offset:2048
  s_waitcnt vmcnt(14)
  s_waitcnt lgkmcnt(14)
  ds_write_b128 v99, a[236:239] offset:3072
  s_waitcnt vmcnt(13)
  s_waitcnt lgkmcnt(14)
  ds_write_b128 v99, a[240:243] offset:4096
  s_waitcnt vmcnt(12)
  s_waitcnt lgkmcnt(14)
  ds_write_b128 v99, a[244:247] offset:5120
  s_waitcnt vmcnt(11)
  s_waitcnt lgkmcnt(14)
  ds_write_b128 v99, a[248:251] offset:6144
  s_waitcnt vmcnt(10)
  s_waitcnt lgkmcnt(14)
  ds_write_b128 v99, a[252:255] offset:7168
  s_waitcnt lgkmcnt(14)
  ds_read_b64_tr_b16 a[224:225], v102 offset:0
  s_waitcnt lgkmcnt(14)
  ds_read_b64_tr_b16 a[226:227], v102 offset:1024
  s_waitcnt lgkmcnt(14)
  ds_read_b64_tr_b16 a[228:229], v102 offset:2048
  s_waitcnt lgkmcnt(14)
  ds_read_b64_tr_b16 a[230:231], v102 offset:3072
  s_waitcnt lgkmcnt(14)
  ds_read_b64_tr_b16 a[232:233], v104 offset:0
  s_waitcnt lgkmcnt(14)
  ds_read_b64_tr_b16 a[234:235], v104 offset:1024
  s_waitcnt lgkmcnt(14)
  ds_read_b64_tr_b16 a[236:237], v104 offset:2048
  s_waitcnt lgkmcnt(14)
  ds_read_b64_tr_b16 a[238:239], v104 offset:3072
  s_waitcnt lgkmcnt(14)
  ds_read_b64_tr_b16 a[240:241], v103 offset:0
  s_waitcnt lgkmcnt(14)
  ds_read_b64_tr_b16 a[242:243], v103 offset:1024
  s_waitcnt lgkmcnt(14)
  ds_read_b64_tr_b16 a[244:245], v103 offset:2048
  s_waitcnt lgkmcnt(14)
  ds_read_b64_tr_b16 a[246:247], v103 offset:3072
  s_waitcnt lgkmcnt(14)
  ds_read_b64_tr_b16 a[248:249], v105 offset:0
  s_waitcnt lgkmcnt(14)
  ds_read_b64_tr_b16 a[250:251], v105 offset:1024
  s_waitcnt lgkmcnt(14)
  ds_read_b64_tr_b16 a[252:253], v105 offset:2048
  s_waitcnt lgkmcnt(14)
  ds_read_b64_tr_b16 a[254:255], v105 offset:3072
  s_waitcnt vmcnt(1)
  v_cmp_gt_u32 vcc, s70, v12
  s_mov_b32 m0, s90
  s_cbranch_vccnz L_cps_14
L_cpb_15:
  buffer_load_dwordx4 v41, s[8:11], s63 offen offset:0 sc1 lds
  buffer_load_dwordx4 v41, s[8:11], s63 offen offset:1024 sc1 lds
  buffer_load_dwordx4 v[108:111], v41, s[8:11], s64 offen offset:0 sc1
  buffer_load_dwordx4 v[112:115], v41, s[8:11], s64 offen offset:1024 sc1
  s_waitcnt lgkmcnt(14)
  ds_write_b128 v99, v[64:67] offset:0
  s_waitcnt lgkmcnt(14)
  ds_write_b128 v99, v[68:71] offset:1024
  s_waitcnt lgkmcnt(14)
  ds_write_b128 v99, v[72:75] offset:2048
  s_waitcnt lgkmcnt(14)
  ds_write_b128 v99, v[76:79] offset:3072
  s_waitcnt lgkmcnt(14)
  ds_write_b128 v99, v[80:83] offset:4096
  s_waitcnt lgkmcnt(14)
  ds_write_b128 v99, v[84:87] offset:5120
  s_waitcnt lgkmcnt(14)
  ds_write_b128 v99, v[88:91] offset:6144
  s_waitcnt lgkmcnt(14)
  ds_write_b128 v99, v[92:95] offset:7168
  s_waitcnt lgkmcnt(14)
  ds_read_b64_tr_b16 v[64:65], v102 offset:0
  s_waitcnt lgkmcnt(14)
  ds_read_b64_tr_b16 v[66:67], v102 offset:1024
  s_waitcnt lgkmcnt(14)
  ds_read_b64_tr_b16 v[68:69], v102 offset:2048
  s_waitcnt lgkmcnt(14)
  ds_read_b64_tr_b16 v[70:71], v102 offset:3072
  s_waitcnt lgkmcnt(14)
  ds_read_b64_tr_b16 v[72:73], v104 offset:0
  s_waitcnt lgkmcnt(14)
  ds_read_b64_tr_b16 v[74:75], v104 offset:1024
  s_waitcnt lgkmcnt(14)
  ds_read_b64_tr_b16 v[76:77], v104 offset:2048
  s_waitcnt lgkmcnt(14)
  ds_read_b64_tr_b16 v[78:79], v104 offset:3072
  s_waitcnt lgkmcnt(14)
  ds_read_b64_tr_b16 v[80:81], v103 offset:0
  s_waitcnt lgkmcnt(14)
  ds_read_b64_tr_b16 v[82:83], v103 offset:1024
  s_waitcnt lgkmcnt(14)
  ds_read_b64_tr_b16 v[84:85], v103 offset:2048
  s_waitcnt lgkmcnt(14)
  ds_read_b64_tr_b16 v[86:87], v103 offset:3072
  s_waitcnt lgkmcnt(14)
  ds_read_b64_tr_b16 v[88:89], v105 offset:0
  s_waitcnt lgkmcnt(14)
  ds_read_b64_tr_b16 v[90:91], v105 offset:1024
  s_waitcnt lgkmcnt(14)
  ds_read_b64_tr_b16 v[92:93], v105 offset:2048
  s_waitcnt lgkmcnt(14)
  ds_read_b64_tr_b16 v[94:95], v105 offset:3072
  s_waitcnt lgkmcnt(14)
  ds_write_b128 v6, v[64:67] offset:24576
  s_waitcnt lgkmcnt(13)
  ds_write_b128 v6, v[68:71] offset:25600
  s_waitcnt lgkmcnt(12)
  ds_write_b128 v6, v[72:75] offset:26624
  s_waitcnt lgkmcnt(11)
  ds_write_b128 v6, v[76:79] offset:27648
  s_waitcnt lgkmcnt(10)
  ds_write_b128 v6, v[80:83] offset:28672
  s_waitcnt lgkmcnt(9)
  ds_write_b128 v6, v[84:87] offset:29696
  s_waitcnt lgkmcnt(8)
  ds_write_b128 v6, v[88:91] offset:30720
  s_waitcnt lgkmcnt(7)
  ds_write_b128 v6, v[92:95] offset:31744
  s_waitcnt lgkmcnt(0)
  s_branch L_wj_5
L_wv_3:
  s_add_u32 s28, s92, 0x0
  buffer_load_dwordx4 a[0:3], v96, s[64:67], s28 offen
  s_add_u32 s28, s92, 0x8000
  buffer_load_dwordx4 a[4:7], v96, s[64:67], s28 offen
  s_add_u32 s28, s92, 0x2000
  buffer_load_dwordx4 a[8:11], v96, s[64:67], s28 offen
  s_add_u32 s28, s92, 0xa000
  buffer_load_dwordx4 a[12:15], v96, s[64:67], s28 offen
  s_add_u32 s28, s92, 0x100000
  buffer_load_dwordx4 a[160:163], v96, s[64:67], s28 offen
  s_add_u32 s28, s92, 0x108000
  buffer_load_dwordx4 a[164:167], v96, s[64:67], s28 offen
  s_add_u32 s28, s92, 0x102000
  buffer_load_dwordx4 a[168:171], v96, s[64:67], s28 offen
  s_add_u32 s28, s92, 0x10a000
  buffer_load_dwordx4 a[172:175], v96, s[64:67], s28 offen
  s_add_u32 s28, s92, 0x200000
  buffer_load_dwordx4 a[176:179], v96, s[64:67], s28 offen
  s_add_u32 s28, s92, 0x208000
  buffer_load_dwordx4 a[180:183], v96, s[64:67], s28 offen
  s_add_u32 s28, s92, 0x202000
  buffer_load_dwordx4 a[184:187], v96, s[64:67], s28 offen
  s_add_u32 s28, s92, 0x20a000
  buffer_load_dwordx4 a[188:191], v96, s[64:67], s28 offen
  s_add_u32 s28, s92, 0x300000
  buffer_load_dwordx4 v[160:163], v96, s[64:67], s28 offen
  s_add_u32 s28, s92, 0x308000
  buffer_load_dwordx4 v[164:167], v96, s[64:67], s28 offen
  s_add_u32 s28, s92, 0x302000
  buffer_load_dwordx4 v[168:171], v96, s[64:67], s28 offen
  s_add_u32 s28, s92, 0x30a000
  buffer_load_dwordx4 v[172:175], v96, s[64:67], s28 offen
  s_add_u32 s28, s92, 0x80000
  buffer_load_dwordx4 a[48:51], v96, s[64:67], s28 offen
  s_add_u32 s28, s92, 0x88000
  buffer_load_dwordx4 a[52:55], v96, s[64:67], s28 offen
  s_add_u32 s28, s92, 0x82000
  buffer_load_dwordx4 a[56:59], v96, s[64:67], s28 offen
  s_add_u32 s28, s92, 0x8a000
  buffer_load_dwordx4 a[60:63], v96, s[64:67], s28 offen
  s_add_u32 s28, s92, 0x180000
  buffer_load_dwordx4 a[192:195], v96, s[64:67], s28 offen
  s_add_u32 s28, s92, 0x188000
  buffer_load_dwordx4 a[196:199], v96, s[64:67], s28 offen
  s_add_u32 s28, s92, 0x182000
  buffer_load_dwordx4 a[200:203], v96, s[64:67], s28 offen
  s_add_u32 s28, s92, 0x18a000
  buffer_load_dwordx4 a[204:207], v96, s[64:67], s28 offen
  s_add_u32 s28, s92, 0x280000
  buffer_load_dwordx4 a[208:211], v96, s[64:67], s28 offen
  s_add_u32 s28, s92, 0x288000
  buffer_load_dwordx4 a[212:215], v96, s[64:67], s28 offen
  s_add_u32 s28, s92, 0x282000
  buffer_load_dwordx4 a[216:219], v96, s[64:67], s28 offen
  s_add_u32 s28, s92, 0x28a000
  buffer_load_dwordx4 a[220:223], v96, s[64:67], s28 offen
  s_add_u32 s28, s92, 0x380000
  buffer_load_dwordx4 v[208:211], v96, s[64:67], s28 offen
  s_add_u32 s28, s92, 0x388000
  buffer_load_dwordx4 v[212:215], v96, s[64:67], s28 offen
  s_add_u32 s28, s92, 0x382000
  buffer_load_dwordx4 v[216:219], v96, s[64:67], s28 offen
  s_add_u32 s28, s92, 0x38a000
  buffer_load_dwordx4 v[220:223], v96, s[64:67], s28 offen
  s_add_u32 s28, s92, 0x0
  buffer_load_dwordx4 a[16:19], v96, s[68:71], s28 offen
  s_add_u32 s28, s92, 0x8000
  buffer_load_dwordx4 a[20:23], v96, s[68:71], s28 offen
  s_add_u32 s28, s92, 0x2000
  buffer_load_dwordx4 a[24:27], v96, s[68:71], s28 offen
  s_add_u32 s28, s92, 0xa000
  buffer_load_dwordx4 a[28:31], v96, s[68:71], s28 offen
  s_add_u32 s28, s92, 0x100000
  buffer_load_dwordx4 a[96:99], v96, s[68:71], s28 offen
  s_add_u32 s28, s92, 0x108000
  buffer_load_dwordx4 a[100:103], v96, s[68:71], s28 offen
  s_add_u32 s28, s92, 0x102000
  buffer_load_dwordx4 a[104:107], v96, s[68:71], s28 offen
  s_add_u32 s28, s92, 0x10a000
  buffer_load_dwordx4 a[108:111], v96, s[68:71], s28 offen
  s_waitcnt vmcnt(44)
  s_barrier
  s_cmp_lg_u32 s5, 0
  s_cbranch_scc1 L_arr_16
  s_lshl_b32 s28, s3, 5
  v_mov_b32 v47, s7
  s_mov_b64 exec, 1
  buffer_atomic_add v47, off, s[24:27], s28 offset:0 sc1
  s_mov_b64 exec, -1
L_arr_16:
  s_mov_b32 s28, 0x05040100
  s_mov_b32 s29, 0x07060302
  s_waitcnt vmcnt(42)
  v_perm_b32 v48, v34, v32, s28
  v_perm_b32 v49, v34, v32, s29
  v_perm_b32 v50, v35, v33, s28
  v_perm_b32 v51, v35, v33, s29
  v_or_b32 v48, 1, v48
  s_waitcnt vmcnt(40)
  v_perm_b32 v52, v38, v36, s28
  v_perm_b32 v53, v38, v36, s29
  v_perm_b32 v54, v39, v37, s28
  v_perm_b32 v55, v39, v37, s29
  v_or_b32 v52, 1, v52
  s_waitcnt vmcnt(39)
  ds_write_b128 v98, a[0:3] offset:0
  s_waitcnt vmcnt(38)
  ds_write_b128 v98, a[4:7] offset:1024
  s_waitcnt vmcnt(37)
  ds_write_b128 v98, a[8:11] offset:2048
  s_waitcnt vmcnt(36)
  ds_write_b128 v98, a[12:15] offset:3072
  s_waitcnt lgkmcnt(0)
  s_barrier
  ds_read_b64_tr_b16 a[0:1], v100 offset:0
  ds_read_b64_tr_b16 a[2:3], v100 offset:2048
  ds_read_b64_tr_b16 a[4:5], v100 offset:4096
  ds_read_b64_tr_b16 a[6:7], v100 offset:6144
  ds_read_b64_tr_b16 a[8:9], v101 offset:0
  ds_read_b64_tr_b16 a[10:11], v101 offset:2048
  ds_read_b64_tr_b16 a[12:13], v101 offset:4096
  ds_read_b64_tr_b16 a[14:15], v101 offset:6144
  s_add_u32 s28, s92, 0x200000
  buffer_load_dwordx4 a[224:227], v96, s[68:71], s28 offen
  s_add_u32 s28, s92, 0x208000
  buffer_load_dwordx4 a[228:231], v96, s[68:71], s28 offen
  s_add_u32 s28, s92, 0x202000
  buffer_load_dwordx4 a[232:235], v96, s[68:71], s28 offen
  s_add_u32 s28, s92, 0x20a000
  buffer_load_dwordx4 a[236:239], v96, s[68:71], s28 offen
  s_waitcnt vmcnt(39)
  ds_write_b128 v98, a[160:163] offset:16384
  s_waitcnt vmcnt(38)
  ds_write_b128 v98, a[164:167] offset:17408
  s_waitcnt vmcnt(37)
  ds_write_b128 v98, a[168:171] offset:18432
  s_waitcnt vmcnt(36)
  ds_write_b128 v98, a[172:175] offset:19456
  s_waitcnt lgkmcnt(0)
  s_barrier
  ds_read_b64_tr_b16 a[160:161], v100 offset:16384
  ds_read_b64_tr_b16 a[162:163], v100 offset:18432
  ds_read_b64_tr_b16 a[164:165], v100 offset:20480
  ds_read_b64_tr_b16 a[166:167], v100 offset:22528
  ds_read_b64_tr_b16 a[168:169], v101 offset:16384
  ds_read_b64_tr_b16 a[170:171], v101 offset:18432
  ds_read_b64_tr_b16 a[172:173], v101 offset:20480
  ds_read_b64_tr_b16 a[174:175], v101 offset:22528
  s_waitcnt lgkmcnt(6)
  ds_write_b128 v6, a[160:163] offset:16384
  s_waitcnt lgkmcnt(5)
  ds_write_b128 v6, a[164:167] offset:17408
  s_waitcnt lgkmcnt(4)
  ds_write_b128 v6, a[168:171] offset:18432
  s_waitcnt lgkmcnt(3)
  ds_write_b128 v6, a[172:175] offset:19456
  s_add_u32 s28, s92, 0x300000
  buffer_load_dwordx4 v[176:179], v96, s[68:71], s28 offen
  s_add_u32 s28, s92, 0x308000
  buffer_load_dwordx4 v[180:183], v96, s[68:71], s28 offen
  s_add_u32 s28, s92, 0x302000
  buffer_load_dwordx4 v[184:187], v96, s[68:71], s28 offen
  s_add_u32 s28, s92, 0x30a000
  buffer_load_dwordx4 v[188:191], v96, s[68:71], s28 offen
  s_waitcnt vmcnt(39)
  ds_write_b128 v98, a[176:179] offset:0
  s_waitcnt vmcnt(38)
  ds_write_b128 v98, a[180:183] offset:1024
  s_waitcnt vmcnt(37)
  ds_write_b128 v98, a[184:187] offset:2048
  s_waitcnt vmcnt(36)
  ds_write_b128 v98, a[188:191] offset:3072
  s_waitcnt lgkmcnt(0)
  s_barrier
  ds_read_b64_tr_b16 a[176:177], v100 offset:0
  ds_read_b64_tr_b16 a[178:179], v100 offset:2048
  ds_read_b64_tr_b16 a[180:181], v100 offset:4096
  ds_read_b64_tr_b16 a[182:183], v100 offset:6144
  ds_read_b64_tr_b16 a[184:185], v101 offset:0
  ds_read_b64_tr_b16 a[186:187], v101 offset:2048
  ds_read_b64_tr_b16 a[188:189], v101 offset:4096
  ds_read_b64_tr_b16 a[190:191], v101 offset:6144
  s_waitcnt lgkmcnt(6)
  ds_write_b128 v6, a[176:179] offset:0
  s_waitcnt lgkmcnt(5)
  ds_write_b128 v6, a[180:183] offset:1024
  s_waitcnt lgkmcnt(4)
  ds_write_b128 v6, a[184:187] offset:2048
  s_waitcnt lgkmcnt(3)
  ds_write_b128 v6, a[188:191] offset:3072
  s_add_u32 s28, s92, 0x0
  buffer_load_dwordx4 a[32:35], v96, s[72:75], s28 offen
  s_add_u32 s28, s92, 0x8000
  buffer_load_dwordx4 a[36:39], v96, s[72:75], s28 offen
  s_add_u32 s28, s92, 0x2000
  buffer_load_dwordx4 a[40:43], v96, s[72:75], s28 offen
  s_add_u32 s28, s92, 0xa000
  buffer_load_dwordx4 a[44:47], v96, s[72:75], s28 offen
  s_waitcnt vmcnt(39)
  ds_write_b128 v98, v[160:163] offset:16384
  s_waitcnt vmcnt(38)
  ds_write_b128 v98, v[164:167] offset:17408
  s_waitcnt vmcnt(37)
  ds_write_b128 v98, v[168:171] offset:18432
  s_waitcnt vmcnt(36)
  ds_write_b128 v98, v[172:175] offset:19456
  s_waitcnt lgkmcnt(0)
  s_barrier
  ds_read_b64_tr_b16 v[160:161], v100 offset:16384
  ds_read_b64_tr_b16 v[162:163], v100 offset:18432
  ds_read_b64_tr_b16 v[164:165], v100 offset:20480
  ds_read_b64_tr_b16 v[166:167], v100 offset:22528
  ds_read_b64_tr_b16 v[168:169], v101 offset:16384
  ds_read_b64_tr_b16 v[170:171], v101 offset:18432
  ds_read_b64_tr_b16 v[172:173], v101 offset:20480
  ds_read_b64_tr_b16 v[174:175], v101 offset:22528
  s_add_u32 s28, s92, 0x100000
  buffer_load_dwordx4 a[112:115], v96, s[72:75], s28 offen
  s_add_u32 s28, s92, 0x108000
  buffer_load_dwordx4 a[116:119], v96, s[72:75], s28 offen
  s_add_u32 s28, s92, 0x102000
  buffer_load_dwordx4 a[120:123], v96, s[72:75], s28 offen
  s_add_u32 s28, s92, 0x10a000
  buffer_load_dwordx4 a[124:127], v96, s[72:75], s28 offen
  s_waitcnt vmcnt(39)
  ds_write_b128 v98, a[48:51] offset:0
  s_waitcnt vmcnt(38)
  ds_write_b128 v98, a[52:55] offset:1024
  s_waitcnt vmcnt(37)
  ds_write_b128 v98, a[56:59] offset:2048
  s_waitcnt vmcnt(36)
  ds_write_b128 v98, a[60:63] offset:3072
  s_waitcnt lgkmcnt(0)
  s_barrier
  ds_read_b64_tr_b16 a[48:49], v100 offset:0
  ds_read_b64_tr_b16 a[50:51], v100 offset:2048
  ds_read_b64_tr_b16 a[52:53], v100 offset:4096
  ds_read_b64_tr_b16 a[54:55], v100 offset:6144
  ds_read_b64_tr_b16 a[56:57], v101 offset:0
  ds_read_b64_tr_b16 a[58:59], v101 offset:2048
  ds_read_b64_tr_b16 a[60:61], v101 offset:4096
  ds_read_b64_tr_b16 a[62:63], v101 offset:6144
  s_add_u32 s28, s92, 0x200000
  buffer_load_dwordx4 a[240:243], v96, s[72:75], s28 offen
  s_add_u32 s28, s92, 0x208000
  buffer_load_dwordx4 a[244:247], v96, s[72:75], s28 offen
  s_add_u32 s28, s92, 0x202000
  buffer_load_dwordx4 a[248:251], v96, s[72:75], s28 offen
  s_add_u32 s28, s92, 0x20a000
  buffer_load_dwordx4 a[252:255], v96, s[72:75], s28 offen
  s_waitcnt vmcnt(39)
  ds_write_b128 v98, a[192:195] offset:16384
  s_waitcnt vmcnt(38)
  ds_write_b128 v98, a[196:199] offset:17408
  s_waitcnt vmcnt(37)
  ds_write_b128 v98, a[200:203] offset:18432
  s_waitcnt vmcnt(36)
  ds_write_b128 v98, a[204:207] offset:19456
  s_waitcnt lgkmcnt(0)
  s_barrier
  ds_read_b64_tr_b16 a[192:193], v100 offset:16384
  ds_read_b64_tr_b16 a[194:195], v100 offset:18432
  ds_read_b64_tr_b16 a[196:197], v100 offset:20480
  ds_read_b64_tr_b16 a[198:199], v100 offset:22528
  ds_read_b64_tr_b16 a[200:201], v101 offset:16384
  ds_read_b64_tr_b16 a[202:203], v101 offset:18432
  ds_read_b64_tr_b16 a[204:205], v101 offset:20480
  ds_read_b64_tr_b16 a[206:207], v101 offset:22528
  s_waitcnt lgkmcnt(6)
  ds_write_b128 v6, a[192:195] offset:20480
  s_waitcnt lgkmcnt(5)
  ds_write_b128 v6, a[196:199] offset:21504
  s_waitcnt lgkmcnt(4)
  ds_write_b128 v6, a[200:203] offset:22528
  s_waitcnt lgkmcnt(3)
  ds_write_b128 v6, a[204:207] offset:23552
  s_add_u32 s28, s92, 0x300000
  buffer_load_dwordx4 v[192:195], v96, s[72:75], s28 offen
  s_add_u32 s28, s92, 0x308000
  buffer_load_dwordx4 v[196:199], v96, s[72:75], s28 offen
  s_add_u32 s28, s92, 0x302000
  buffer_load_dwordx4 v[200:203], v96, s[72:75], s28 offen
  s_add_u32 s28, s92, 0x30a000
  buffer_load_dwordx4 v[204:207], v96, s[72:75], s28 offen
  s_waitcnt vmcnt(39)
  ds_write_b128 v98, a[208:211] offset:0
  s_waitcnt vmcnt(38)
  ds_write_b128 v98, a[212:215] offset:1024
  s_waitcnt vmcnt(37)
  ds_write_b128 v98, a[216:219] offset:2048
  s_waitcnt vmcnt(36)
  ds_write_b128 v98, a[220:223] offset:3072
  s_waitcnt lgkmcnt(0)
  s_barrier
  ds_read_b64_tr_b16 a[208:209], v100 offset:0
  ds_read_b64_tr_b16 a[210:211], v100 offset:2048
  ds_read_b64_tr_b16 a[212:213], v100 offset:4096
  ds_read_b64_tr_b16 a[214:215], v100 offset:6144
  ds_read_b64_tr_b16 a[216:217], v101 offset:0
  ds_read_b64_tr_b16 a[218:219], v101 offset:2048
  ds_read_b64_tr_b16 a[220:221], v101 offset:4096
  ds_read_b64_tr_b16 a[222:223], v101 offset:6144
  s_waitcnt lgkmcnt(6)
  ds_write_b128 v6, a[208:211] offset:12288
  s_waitcnt lgkmcnt(5)
  ds_write_b128 v6, a[212:215] offset:13312
  s_waitcnt lgkmcnt(4)
  ds_write_b128 v6, a[216:219] offset:14336
  s_waitcnt lgkmcnt(3)
  ds_write_b128 v6, a[220:223] offset:15360
  s_add_u32 s28, s92, 0x80000
  buffer_load_dwordx4 a[64:67], v96, s[68:71], s28 offen
  s_add_u32 s28, s92, 0x88000
  buffer_load_dwordx4 a[68:71], v96, s[68:71], s28 offen
  s_add_u32 s28, s92, 0x82000
  buffer_load_dwordx4 a[72:75], v96, s[68:71], s28 offen
  s_add_u32 s28, s92, 0x8a000
  buffer_load_dwordx4 a[76:79], v96, s[68:71], s28 offen
  s_waitcnt vmcnt(39)
  ds_write_b128 v98, v[208:211] offset:16384
  s_waitcnt vmcnt(38)
  ds_write_b128 v98, v[212:215] offset:17408
  s_waitcnt vmcnt(37)
  ds_write_b128 v98, v[216:219] offset:18432
  s_waitcnt vmcnt(36)
  ds_write_b128 v98, v[220:223] offset:19456
  s_waitcnt lgkmcnt(0)
  s_barrier
  ds_read_b64_tr_b16 v[208:209], v100 offset:16384
  ds_read_b64_tr_b16 v[210:211], v100 offset:18432
  ds_read_b64_tr_b16 v[212:213], v100 offset:20480
  ds_read_b64_tr_b16 v[214:215], v100 offset:22528
  ds_read_b64_tr_b16 v[216:217], v101 offset:16384
  ds_read_b64_tr_b16 v[218:219], v101 offset:18432
  ds_read_b64_tr_b16 v[220:221], v101 offset:20480
  ds_read_b64_tr_b16 v[222:223], v101 offset:22528
  s_add_u32 s28, s92, 0x180000
  buffer_load_dwordx4 a[128:131], v96, s[68:71], s28 offen
  s_add_u32 s28, s92, 0x188000
  buffer_load_dwordx4 a[132:135], v96, s[68:71], s28 offen
  s_add_u32 s28, s92, 0x182000
  buffer_load_dwordx4 a[136:139], v96, s[68:71], s28 offen
  s_add_u32 s28, s92, 0x18a000
  buffer_load_dwordx4 a[140:143], v96, s[68:71], s28 offen
  s_waitcnt vmcnt(39)
  ds_write_b128 v98, a[16:19] offset:0
  s_waitcnt vmcnt(38)
  ds_write_b128 v98, a[20:23] offset:1024
  s_waitcnt vmcnt(37)
  ds_write_b128 v98, a[24:27] offset:2048
  s_waitcnt vmcnt(36)
  ds_write_b128 v98, a[28:31] offset:3072
  s_waitcnt lgkmcnt(0)
  s_barrier
  ds_read_b64_tr_b16 a[16:17], v100 offset:0
  ds_read_b64_tr_b16 a[18:19], v100 offset:2048
  ds_read_b64_tr_b16 a[20:21], v100 offset:4096
  ds_read_b64_tr_b16 a[22:23], v100 offset:6144
  ds_read_b64_tr_b16 a[24:25], v101 offset:0
  ds_read_b64_tr_b16 a[26:27], v101 offset:2048
  ds_read_b64_tr_b16 a[28:29], v101 offset:4096
  ds_read_b64_tr_b16 a[30:31], v101 offset:6144
  s_add_u32 s28, s92, 0x280000
  buffer_load_dwordx4 v[128:131], v96, s[68:71], s28 offen
  s_add_u32 s28, s92, 0x288000
  buffer_load_dwordx4 v[132:135], v96, s[68:71], s28 offen
  s_add_u32 s28, s92, 0x282000
  buffer_load_dwordx4 v[136:139], v96, s[68:71], s28 offen
  s_add_u32 s28, s92, 0x28a000
  buffer_load_dwordx4 v[140:143], v96, s[68:71], s28 offen
  s_waitcnt vmcnt(39)
  ds_write_b128 v98, a[96:99] offset:16384
  s_waitcnt vmcnt(38)
  ds_write_b128 v98, a[100:103] offset:17408
  s_waitcnt vmcnt(37)
  ds_write_b128 v98, a[104:107] offset:18432
  s_waitcnt vmcnt(36)
  ds_write_b128 v98, a[108:111] offset:19456
  s_waitcnt lgkmcnt(0)
  s_barrier
  ds_read_b64_tr_b16 a[96:97], v100 offset:16384
  ds_read_b64_tr_b16 a[98:99], v100 offset:18432
  ds_read_b64_tr_b16 a[100:101], v100 offset:20480
  ds_read_b64_tr_b16 a[102:103], v100 offset:22528
  ds_read_b64_tr_b16 a[104:105], v101 offset:16384
  ds_read_b64_tr_b16 a[106:107], v101 offset:18432
  ds_read_b64_tr_b16 a[108:109], v101 offset:20480
  ds_read_b64_tr_b16 a[110:111], v101 offset:22528
  s_add_u32 s28, s92, 0x380000
  buffer_load_dwordx4 v[224:227], v96, s[68:71], s28 offen
  s_add_u32 s28, s92, 0x388000
  buffer_load_dwordx4 v[228:231], v96, s[68:71], s28 offen
  s_add_u32 s28, s92, 0x382000
  buffer_load_dwordx4 v[232:235], v96, s[68:71], s28 offen
  s_add_u32 s28, s92, 0x38a000
  buffer_load_dwordx4 v[236:239], v96, s[68:71], s28 offen
  s_waitcnt vmcnt(39)
  ds_write_b128 v98, a[224:227] offset:0
  s_waitcnt vmcnt(38)
  ds_write_b128 v98, a[228:231] offset:1024
  s_waitcnt vmcnt(37)
  ds_write_b128 v98, a[232:235] offset:2048
  s_waitcnt vmcnt(36)
  ds_write_b128 v98, a[236:239] offset:3072
  s_waitcnt lgkmcnt(0)
  s_barrier
  ds_read_b64_tr_b16 a[224:225], v100 offset:0
  ds_read_b64_tr_b16 a[226:227], v100 offset:2048
  ds_read_b64_tr_b16 a[228:229], v100 offset:4096
  ds_read_b64_tr_b16 a[230:231], v100 offset:6144
  ds_read_b64_tr_b16 a[232:233], v101 offset:0
  ds_read_b64_tr_b16 a[234:235], v101 offset:2048
  ds_read_b64_tr_b16 a[236:237], v101 offset:4096
  ds_read_b64_tr_b16 a[238:239], v101 offset:6144
  s_waitcnt lgkmcnt(6)
  ds_write_b128 v6, a[224:227] offset:4096
  s_waitcnt lgkmcnt(5)
  ds_write_b128 v6, a[228:231] offset:5120
  s_waitcnt lgkmcnt(4)
  ds_write_b128 v6, a[232:235] offset:6144
  s_waitcnt lgkmcnt(3)
  ds_write_b128 v6, a[236:239] offset:7168
  s_add_u32 s28, s92, 0x80000
  buffer_load_dwordx4 a[80:83], v96, s[72:75], s28 offen
  s_add_u32 s28, s92, 0x88000
  buffer_load_dwordx4 a[84:87], v96, s[72:75], s28 offen
  s_add_u32 s28, s92, 0x82000
  buffer_load_dwordx4 a[88:91], v96, s[72:75], s28 offen
  s_add_u32 s28, s92, 0x8a000
  buffer_load_dwordx4 a[92:95], v96, s[72:75], s28 offen
  s_waitcnt vmcnt(39)
  ds_write_b128 v98, v[176:179] offset:16384
  s_waitcnt vmcnt(38)
  ds_write_b128 v98, v[180:183] offset:17408
  s_waitcnt vmcnt(37)
  ds_write_b128 v98, v[184:187] offset:18432
  s_waitcnt vmcnt(36)
  ds_write_b128 v98, v[188:191] offset:19456
  s_waitcnt lgkmcnt(0)
  s_barrier
  ds_read_b64_tr_b16 v[176:177], v100 offset:16384
  ds_read_b64_tr_b16 v[178:179], v100 offset:18432
  ds_read_b64_tr_b16 v[180:181], v100 offset:20480
  ds_read_b64_tr_b16 v[182:183], v100 offset:22528
  ds_read_b64_tr_b16 v[184:185], v101 offset:16384
  ds_read_b64_tr_b16 v[186:187], v101 offset:18432
  ds_read_b64_tr_b16 v[188:189], v101 offset:20480
  ds_read_b64_tr_b16 v[190:191], v101 offset:22528
  s_add_u32 s28, s92, 0x180000
  buffer_load_dwordx4 a[144:147], v96, s[72:75], s28 offen
  s_add_u32 s28, s92, 0x188000
  buffer_load_dwordx4 a[148:151], v96, s[72:75], s28 offen
  s_add_u32 s28, s92, 0x182000
  buffer_load_dwordx4 a[152:155], v96, s[72:75], s28 offen
  s_add_u32 s28, s92, 0x18a000
  buffer_load_dwordx4 a[156:159], v96, s[72:75], s28 offen
  v_and_b32 v44, 7, v0
  v_lshlrev_b32 v44, 5, v44
  buffer_load_dword v46, v44, s[24:27], 0 offen sc1
  v_lshlrev_b32 v41, 4, v0
  s_waitcnt vmcnt(40)
  ds_write_b128 v98, a[32:35] offset:0
  s_waitcnt vmcnt(39)
  ds_write_b128 v98, a[36:39] offset:1024
  s_waitcnt vmcnt(38)
  ds_write_b128 v98, a[40:43] offset:2048
  s_waitcnt vmcnt(37)
  ds_write_b128 v98, a[44:47] offset:3072
  s_waitcnt lgkmcnt(0)
  s_barrier
  ds_read_b64_tr_b16 a[32:33], v100 offset:0
  ds_read_b64_tr_b16 a[34:35], v100 offset:2048
  ds_read_b64_tr_b16 a[36:37], v100 offset:4096
  ds_read_b64_tr_b16 a[38:39], v100 offset:6144
  ds_read_b64_tr_b16 a[40:41], v101 offset:0
  ds_read_b64_tr_b16 a[42:43], v101 offset:2048
  ds_read_b64_tr_b16 a[44:45], v101 offset:4096
  ds_read_b64_tr_b16 a[46:47], v101 offset:6144
  s_add_u32 s28, s92, 0x280000
  buffer_load_dwordx4 v[144:147], v96, s[72:75], s28 offen
  s_add_u32 s28, s92, 0x288000
  buffer_load_dwordx4 v[148:151], v96, s[72:75], s28 offen
  s_add_u32 s28, s92, 0x282000
  buffer_load_dwordx4 v[152:155], v96, s[72:75], s28 offen
  s_add_u32 s28, s92, 0x28a000
  buffer_load_dwordx4 v[156:159], v96, s[72:75], s28 offen
  s_waitcnt vmcnt(40)
  ds_write_b128 v98, a[112:115] offset:16384
  s_waitcnt vmcnt(39)
  ds_write_b128 v98, a[116:119] offset:17408
  s_waitcnt vmcnt(38)
  ds_write_b128 v98, a[120:123] offset:18432
  s_waitcnt vmcnt(37)
  ds_write_b128 v98, a[124:127] offset:19456
  s_waitcnt lgkmcnt(0)
  s_barrier
  ds_read_b64_tr_b16 a[112:113], v100 offset:16384
  ds_read_b64_tr_b16 a[114:115], v100 offset:18432
  ds_read_b64_tr_b16 a[116:117], v100 offset:20480
  ds_read_b64_tr_b16 a[118:119], v100 offset:22528
  ds_read_b64_tr_b16 a[120:121], v101 offset:16384
  ds_read_b64_tr_b16 a[122:123], v101 offset:18432
  ds_read_b64_tr_b16 a[124:125], v101 offset:20480
  ds_read_b64_tr_b16 a[126:127], v101 offset:22528
  s_add_u32 s28, s92, 0x380000
  buffer_load_dwordx4 v[240:243], v96, s[72:75], s28 offen
  s_add_u32 s28, s92, 0x388000
  buffer_load_dwordx4 v[244:247], v96, s[72:75], s28 offen
  s_add_u32 s28, s92, 0x382000
  buffer_load_dwordx4 v[248:251], v96, s[72:75], s28 offen
  s_add_u32 s28, s92, 0x38a000
  buffer_load_dwordx4 v[252:255], v96, s[72:75], s28 offen
  s_waitcnt vmcnt(40)
  ds_write_b128 v98, a[240:243] offset:0
  s_waitcnt vmcnt(39)
  ds_write_b128 v98, a[244:247] offset:1024
  s_waitcnt vmcnt(38)
  ds_write_b128 v98, a[248:251] offset:2048
  s_waitcnt vmcnt(37)
  ds_write_b128 v98, a[252:255] offset:3072
  s_waitcnt lgkmcnt(0)
  s_barrier
  ds_read_b64_tr_b16 a[240:241], v100 offset:0
  ds_read_b64_tr_b16 a[242:243], v100 offset:2048
  ds_read_b64_tr_b16 a[244:245], v100 offset:4096
  ds_read_b64_tr_b16 a[246:247], v100 offset:6144
  ds_read_b64_tr_b16 a[248:249], v101 offset:0
  ds_read_b64_tr_b16 a[250:251], v101 offset:2048
  ds_read_b64_tr_b16 a[252:253], v101 offset:4096
  ds_read_b64_tr_b16 a[254:255], v101 offset:6144
  s_waitcnt lgkmcnt(6)
  ds_write_b128 v6, a[240:243] offset:8192
  s_waitcnt lgkmcnt(5)
  ds_write_b128 v6, a[244:247] offset:9216
  s_waitcnt lgkmcnt(4)
  ds_write_b128 v6, a[248:251] offset:10240
  s_waitcnt lgkmcnt(3)
  ds_write_b128 v6, a[252:255] offset:11264
  s_add_u32 s28, s96, 0x0
  buffer_load_dwordx4 a[160:163], v97, s[12:15], s28 offen
  s_add_u32 s28, s96, 0x800
  buffer_load_dwordx4 a[164:167], v97, s[12:15], s28 offen
  s_add_u32 s28, s96, 0x2000
  buffer_load_dwordx4 a[168:171], v97, s[12:15], s28 offen
  s_add_u32 s28, s96, 0x2800
  buffer_load_dwordx4 a[172:175], v97, s[12:15], s28 offen
  s_waitcnt vmcnt(40)
  ds_write_b128 v98, v[192:195] offset:16384
  s_waitcnt vmcnt(39)
  ds_write_b128 v98, v[196:199] offset:17408
  s_waitcnt vmcnt(38)
  ds_write_b128 v98, v[200:203] offset:18432
  s_waitcnt vmcnt(37)
  ds_write_b128 v98, v[204:207] offset:19456
  s_waitcnt lgkmcnt(0)
  s_barrier
  ds_read_b64_tr_b16 v[192:193], v100 offset:16384
  ds_read_b64_tr_b16 v[194:195], v100 offset:18432
  ds_read_b64_tr_b16 v[196:197], v100 offset:20480
  ds_read_b64_tr_b16 v[198:199], v100 offset:22528
  ds_read_b64_tr_b16 v[200:201], v101 offset:16384
  ds_read_b64_tr_b16 v[202:203], v101 offset:18432
  ds_read_b64_tr_b16 v[204:205], v101 offset:20480
  ds_read_b64_tr_b16 v[206:207], v101 offset:22528
  s_add_u32 s28, s96, 0x8000
  buffer_load_dwordx4 a[176:179], v97, s[12:15], s28 offen
  s_add_u32 s28, s96, 0x8800
  buffer_load_dwordx4 a[180:183], v97, s[12:15], s28 offen
  s_add_u32 s28, s96, 0xa000
  buffer_load_dwordx4 a[184:187], v97, s[12:15], s28 offen
  s_add_u32 s28, s96, 0xa800
  buffer_load_dwordx4 a[188:191], v97, s[12:15], s28 offen
  s_waitcnt vmcnt(40)
  ds_write_b128 v98, a[64:67] offset:0
  s_waitcnt vmcnt(39)
  ds_write_b128 v98, a[68:71] offset:1024
  s_waitcnt vmcnt(38)
  ds_write_b128 v98, a[72:75] offset:2048
  s_waitcnt vmcnt(37)
  ds_write_b128 v98, a[76:79] offset:3072
  s_waitcnt lgkmcnt(0)
  s_barrier
  ds_read_b64_tr_b16 a[64:65], v100 offset:0
  ds_read_b64_tr_b16 a[66:67], v100 offset:2048
  ds_read_b64_tr_b16 a[68:69], v100 offset:4096
  ds_read_b64_tr_b16 a[70:71], v100 offset:6144
  ds_read_b64_tr_b16 a[72:73], v101 offset:0
  ds_read_b64_tr_b16 a[74:75], v101 offset:2048
  ds_read_b64_tr_b16 a[76:77], v101 offset:4096
  ds_read_b64_tr_b16 a[78:79], v101 offset:6144
  s_add_u32 s28, s96, 0x80
  buffer_load_dwordx4 a[192:195], v97, s[12:15], s28 offen
  s_add_u32 s28, s96, 0x880
  buffer_load_dwordx4 a[196:199], v97, s[12:15], s28 offen
  s_add_u32 s28, s96, 0x2080
  buffer_load_dwordx4 a[200:203], v97, s[12:15], s28 offen
  s_add_u32 s28, s96, 0x2880
  buffer_load_dwordx4 a[204:207], v97, s[12:15], s28 offen
  s_waitcnt vmcnt(40)
  ds_write_b128 v98, a[128:131] offset:16384
  s_waitcnt vmcnt(39)
  ds_write_b128 v98, a[132:135] offset:17408
  s_waitcnt vmcnt(38)
  ds_write_b128 v98, a[136:139] offset:18432
  s_waitcnt vmcnt(37)
  ds_write_b128 v98, a[140:143] offset:19456
  s_waitcnt lgkmcnt(0)
  s_barrier
  ds_read_b64_tr_b16 a[128:129], v100 offset:16384
  ds_read_b64_tr_b16 a[130:131], v100 offset:18432
  ds_read_b64_tr_b16 a[132:133], v100 offset:20480
  ds_read_b64_tr_b16 a[134:135], v100 offset:22528
  ds_read_b64_tr_b16 a[136:137], v101 offset:16384
  ds_read_b64_tr_b16 a[138:139], v101 offset:18432
  ds_read_b64_tr_b16 a[140:141], v101 offset:20480
  ds_read_b64_tr_b16 a[142:143], v101 offset:22528
  s_add_u32 s28, s96, 0x8080
  buffer_load_dwordx4 a[208:211], v97, s[12:15], s28 offen
  s_add_u32 s28, s96, 0x8880
  buffer_load_dwordx4 a[212:215], v97, s[12:15], s28 offen
  s_add_u32 s28, s96, 0xa080
  buffer_load_dwordx4 a[216:219], v97, s[12:15], s28 offen
  s_add_u32 s28, s96, 0xa880
  buffer_load_dwordx4 a[220:223], v97, s[12:15], s28 offen
  s_waitcnt vmcnt(40)
  ds_write_b128 v98, v[128:131] offset:0
  s_waitcnt vmcnt(39)
  ds_write_b128 v98, v[132:135] offset:1024
  s_waitcnt vmcnt(38)
  ds_write_b128 v98, v[136:139] offset:2048
  s_waitcnt vmcnt(37)
  ds_write_b128 v98, v[140:143] offset:3072
  s_waitcnt lgkmcnt(0)
  s_barrier
  ds_read_b64_tr_b16 v[128:129], v100 offset:0
  ds_read_b64_tr_b16 v[130:131], v100 offset:2048
  ds_read_b64_tr_b16 v[132:133], v100 offset:4096
  ds_read_b64_tr_b16 v[134:135], v100 offset:6144
  ds_read_b64_tr_b16 v[136:137], v101 offset:0
  ds_read_b64_tr_b16 v[138:139], v101 offset:2048
  ds_read_b64_tr_b16 v[140:141], v101 offset:4096
  ds_read_b64_tr_b16 v[142:143], v101 offset:6144
  s_add_u32 s28, s97, 0x80
  buffer_load_dwordx4 a[224:227], v97, s[12:15], s28 offen
  s_add_u32 s28, s97, 0x880
  buffer_load_dwordx4 a[228:231], v97, s[12:15], s28 offen
  s_add_u32 s28, s97, 0x2080
  buffer_load_dwordx4 a[232:235], v97, s[12:15], s28 offen
  s_add_u32 s28, s97, 0x2880
  buffer_load_dwordx4 a[236:239], v97, s[12:15], s28 offen
  s_waitcnt vmcnt(40)
  ds_write_b128 v98, v[224:227] offset:16384
  s_waitcnt vmcnt(39)
  ds_write_b128 v98, v[228:231] offset:17408
  s_waitcnt vmcnt(38)
  ds_write_b128 v98, v[232:235] offset:18432
  s_waitcnt vmcnt(37)
  ds_write_b128 v98, v[236:239] offset:19456
  s_waitcnt lgkmcnt(0)
  s_barrier
  ds_read_b64_tr_b16 v[224:225], v100 offset:16384
  ds_read_b64_tr_b16 v[226:227], v100 offset:18432
  ds_read_b64_tr_b16 v[228:229], v100 offset:20480
  ds_read_b64_tr_b16 v[230:231], v100 offset:22528
  ds_read_b64_tr_b16 v[232:233], v101 offset:16384
  ds_read_b64_tr_b16 v[234:235], v101 offset:18432
  ds_read_b64_tr_b16 v[236:237], v101 offset:20480
  ds_read_b64_tr_b16 v[238:239], v101 offset:22528
  s_add_u32 s28, s97, 0x8080
  buffer_load_dwordx4 a[240:243], v97, s[12:15], s28 offen
  s_add_u32 s28, s97, 0x8880
  buffer_load_dwordx4 a[244:247], v97, s[12:15], s28 offen
  s_add_u32 s28, s97, 0xa080
  buffer_load_dwordx4 a[248:251], v97, s[12:15], s28 offen
  s_add_u32 s28, s97, 0xa880
  buffer_load_dwordx4 a[252:255], v97, s[12:15], s28 offen
  s_waitcnt vmcnt(40)
  ds_write_b128 v98, a[80:83] offset:0
  s_waitcnt vmcnt(39)
  ds_write_b128 v98, a[84:87] offset:1024
  s_waitcnt vmcnt(38)
  ds_write_b128 v98, a[88:91] offset:2048
  s_waitcnt vmcnt(37)
  ds_write_b128 v98, a[92:95] offset:3072
  s_waitcnt lgkmcnt(0)
  s_barrier
  ds_read_b64_tr_b16 a[80:81], v100 offset:0
  ds_read_b64_tr_b16 a[82:83], v100 offset:2048
  ds_read_b64_tr_b16 a[84:85], v100 offset:4096
  ds_read_b64_tr_b16 a[86:87], v100 offset:6144
  ds_read_b64_tr_b16 a[88:89], v101 offset:0
  ds_read_b64_tr_b16 a[90:91], v101 offset:2048
  ds_read_b64_tr_b16 a[92:93], v101 offset:4096
  ds_read_b64_tr_b16 a[94:95], v101 offset:6144
  s_add_u32 s28, s97, 0x0
  buffer_load_dwordx4 v[64:67], v97, s[12:15], s28 offen
  s_add_u32 s28, s97, 0x800
  buffer_load_dwordx4 v[68:71], v97, s[12:15], s28 offen
  s_add_u32 s28, s97, 0x2000
  buffer_load_dwordx4 v[72:75], v97, s[12:15], s28 offen
  s_add_u32 s28, s97, 0x2800
  buffer_load_dwordx4 v[76:79], v97, s[12:15], s28 offen
  s_waitcnt vmcnt(40)
  ds_write_b128 v98, a[144:147] offset:16384
  s_waitcnt vmcnt(39)
  ds_write_b128 v98, a[148:151] offset:17408
  s_waitcnt vmcnt(38)
  ds_write_b128 v98, a[152:155] offset:18432
  s_waitcnt vmcnt(37)
  ds_write_b128 v98, a[156:159] offset:19456
  s_waitcnt lgkmcnt(0)
  s_barrier
  ds_read_b64_tr_b16 a[144:145], v100 offset:16384
  ds_read_b64_tr_b16 a[146:147], v100 offset:18432
  ds_read_b64_tr_b16 a[148:149], v100 offset:20480
  ds_read_b64_tr_b16 a[150:151], v100 offset:22528
  ds_read_b64_tr_b16 a[152:153], v101 offset:16384
  ds_read_b64_tr_b16 a[154:155], v101 offset:18432
  ds_read_b64_tr_b16 a[156:157], v101 offset:20480
  ds_read_b64_tr_b16 a[158:159], v101 offset:22528
  s_add_u32 s28, s97, 0x8000
  buffer_load_dwordx4 v[80:83], v97, s[12:15], s28 offen
  s_add_u32 s28, s97, 0x8800
  buffer_load_dwordx4 v[84:87], v97, s[12:15], s28 offen
  s_add_u32 s28, s97, 0xa000
  buffer_load_dwordx4 v[88:91], v97, s[12:15], s28 offen
  s_add_u32 s28, s97, 0xa800
  buffer_load_dwordx4 v[92:95], v97, s[12:15], s28 offen
  s_mov_b32 s62, 0
  s_mov_b32 s74, 32768
  s_mul_i32 s28, s4, 29696
  s_add_u32 s28, s28, 0x1800000
  s_lshl_b32 s29, s5, 11
  s_add_u32 s63, s28, s29
  s_add_u32 s64, s63, 8192
  s_lshl_b32 s30, s5, 10
  s_add_u32 s30, s30, s28
  s_add_u32 s65, s30, 24576
  s_sub_u32 s65, s65, 0x100000
  s_mov_b32 s88, 0x3f803f80
  s_mov_b32 s89, 0x3f803f80
  s_add_u32 s90, s29, 12288
  s_add_u32 s91, s29, 20480
  s_lshl_b32 s30, s4, 13
  s_add_u32 s73, s30, s29
  s_mov_b32 s67, 270336
  s_add_u32 s66, s29, 270336
  s_mov_b32 s68, 286720
  s_mov_b32 s78, 0x3e0293ee
  s_mov_b32 s79, 0x3e0293ee
  s_lshl_b32 s30, s4, 7
  s_add_u32 s75, s30, 335872
  s_mov_b32 s70, 1
  s_waitcnt vmcnt(40)
  v_and_b32 v45, 63, v46
  v_cmp_ne_u32 vcc, 32, v45
  s_cbranch_vccnz L_cgs_17
L_cgb_18:
  v_readlane_b32 s28, v46, s3
  s_lshl_b32 s29, s7, 5
  s_nop 1
  s_cmp_lg_u32 s28, s29
  s_cselect_b32 s93, 1, 0
  s_waitcnt vmcnt(39)
  ds_write_b128 v98, v[144:147] offset:0
  s_waitcnt vmcnt(38)
  ds_write_b128 v98, v[148:151] offset:1024
  s_waitcnt vmcnt(37)
  ds_write_b128 v98, v[152:155] offset:2048
  s_waitcnt vmcnt(36)
  ds_write_b128 v98, v[156:159] offset:3072
  s_waitcnt lgkmcnt(0)
  s_barrier
  ds_read_b64_tr_b16 v[144:145], v100 offset:0
  ds_read_b64_tr_b16 v[146:147], v100 offset:2048
  ds_read_b64_tr_b16 v[148:149], v100 offset:4096
  ds_read_b64_tr_b16 v[150:151], v100 offset:6144
  ds_read_b64_tr_b16 v[152:153], v101 offset:0
  ds_read_b64_tr_b16 v[154:155], v101 offset:2048
  ds_read_b64_tr_b16 v[156:157], v101 offset:4096
  ds_read_b64_tr_b16 v[158:159], v101 offset:6144
  s_waitcnt vmcnt(35)
  ds_write_b128 v98, v[240:243] offset:16384
  s_waitcnt vmcnt(34)
  ds_write_b128 v98, v[244:247] offset:17408
  s_waitcnt vmcnt(33)
  ds_write_b128 v98, v[248:251] offset:18432
  s_waitcnt vmcnt(32)
  ds_write_b128 v98, v[252:255] offset:19456
  s_waitcnt lgkmcnt(0)
  s_barrier
  ds_read_b64_tr_b16 v[240:241], v100 offset:16384
  ds_read_b64_tr_b16 v[242:243], v100 offset:18432
  ds_read_b64_tr_b16 v[244:245], v100 offset:20480
  ds_read_b64_tr_b16 v[246:247], v100 offset:22528
  ds_read_b64_tr_b16 v[248:249], v101 offset:16384
  ds_read_b64_tr_b16 v[250:251], v101 offset:18432
  ds_read_b64_tr_b16 v[252:253], v101 offset:20480
  ds_read_b64_tr_b16 v[254:255], v101 offset:22528
  s_waitcnt lgkmcnt(0)
  s_barrier
  s_waitcnt vmcnt(31)
  ds_write_b128 v99, a[160:163] offset:0
  s_waitcnt vmcnt(30)
  ds_write_b128 v99, a[164:167] offset:1024
  s_waitcnt vmcnt(29)
  ds_write_b128 v99, a[168:171] offset:2048
  s_waitcnt vmcnt(28)
  ds_write_b128 v99, a[172:175] offset:3072
  s_waitcnt vmcnt(27)
  ds_write_b128 v99, a[176:179] offset:4096
  s_waitcnt vmcnt(26)
  ds_write_b128 v99, a[180:183] offset:5120
  s_waitcnt vmcnt(25)
  ds_write_b128 v99, a[184:187] offset:6144
  s_waitcnt vmcnt(24)
  ds_write_b128 v99, a[188:191] offset:7168
  ds_read_b64_tr_b16 a[160:161], v102 offset:0
  ds_read_b64_tr_b16 a[162:163], v102 offset:1024
  ds_read_b64_tr_b16 a[164:165], v102 offset:2048
  ds_read_b64_tr_b16 a[166:167], v102 offset:3072
  ds_read_b64_tr_b16 a[168:169], v104 offset:0
  ds_read_b64_tr_b16 a[170:171], v104 offset:1024
  ds_read_b64_tr_b16 a[172:173], v104 offset:2048
  s_waitcnt lgkmcnt(14)
  ds_read_b64_tr_b16 a[174:175], v104 offset:3072
  s_waitcnt lgkmcnt(14)
  ds_read_b64_tr_b16 a[176:177], v103 offset:0
  s_waitcnt lgkmcnt(14)
  ds_read_b64_tr_b16 a[178:179], v103 offset:1024
  s_waitcnt lgkmcnt(14)
  ds_read_b64_tr_b16 a[180:181], v103 offset:2048
  s_waitcnt lgkmcnt(14)
  ds_read_b64_tr_b16 a[182:183], v103 offset:3072
  s_waitcnt lgkmcnt(14)
  ds_read_b64_tr_b16 a[184:185], v105 offset:0
  s_waitcnt lgkmcnt(14)
  ds_read_b64_tr_b16 a[186:187], v105 offset:1024
  s_waitcnt lgkmcnt(14)
  ds_read_b64_tr_b16 a[188:189], v105 offset:2048
  s_waitcnt lgkmcnt(14)
  ds_read_b64_tr_b16 a[190:191], v105 offset:3072
  buffer_load_dword v12, off, s[8:11], s75 sc1
  s_add_u32 s28, s75, 4096
  buffer_load_dword v40, off, s[8:11], s28 sc1
  s_waitcnt vmcnt(25)
  s_waitcnt lgkmcnt(14)
  ds_write_b128 v99, a[192:195] offset:0
  s_waitcnt vmcnt(24)
  s_waitcnt lgkmcnt(14)
  ds_write_b128 v99, a[196:199] offset:1024
  s_waitcnt vmcnt(23)
  s_waitcnt lgkmcnt(14)
  ds_write_b128 v99, a[200:203] offset:2048
  s_waitcnt vmcnt(22)
  s_waitcnt lgkmcnt(14)
  ds_write_b128 v99, a[204:207] offset:3072
  s_waitcnt vmcnt(21)
  s_waitcnt lgkmcnt(14)
  ds_write_b128 v99, a[208:211] offset:4096
  s_waitcnt vmcnt(20)
  s_waitcnt lgkmcnt(14)
  ds_write_b128 v99, a[212:215] offset:5120
  s_waitcnt vmcnt(19)
  s_waitcnt lgkmcnt(14)
  ds_write_b128 v99, a[216:219] offset:6144
  s_waitcnt vmcnt(18)
  s_waitcnt lgkmcnt(14)
  ds_write_b128 v99, a[220:223] offset:7168
  s_waitcnt lgkmcnt(14)
  ds_read_b64_tr_b16 a[192:193], v102 offset:0
  s_waitcnt lgkmcnt(14)
  ds_read_b64_tr_b16 a[194:195], v102 offset:1024
  s_waitcnt lgkmcnt(14)
  ds_read_b64_tr_b16 a[196:197], v102 offset:2048
  s_waitcnt lgkmcnt(14)
  ds_read_b64_tr_b16 a[198:199], v102 offset:3072
  s_waitcnt lgkmcnt(14)
  ds_read_b64_tr_b16 a[200:201], v104 offset:0
  s_waitcnt lgkmcnt(14)
  ds_read_b64_tr_b16 a[202:203], v104 offset:1024
  s_waitcnt lgkmcnt(14)
  ds_read_b64_tr_b16 a[204:205], v104 offset:2048
  s_waitcnt lgkmcnt(14)
  ds_read_b64_tr_b16 a[206:207], v104 offset:3072
  s_waitcnt lgkmcnt(14)
  ds_read_b64_tr_b16 a[208:209], v103 offset:0
  s_waitcnt lgkmcnt(14)
  ds_read_b64_tr_b16 a[210:211], v103 offset:1024
  s_waitcnt lgkmcnt(14)
  ds_read_b64_tr_b16 a[212:213], v103 offset:2048
  s_waitcnt lgkmcnt(14)
  ds_read_b64_tr_b16 a[214:215], v103 offset:3072
  s_waitcnt lgkmcnt(14)
  ds_read_b64_tr_b16 a[216:217], v105 offset:0
  s_waitcnt lgkmcnt(14)
  ds_read_b64_tr_b16 a[218:219], v105 offset:1024
  s_waitcnt lgkmcnt(14)
  ds_read_b64_tr_b16 a[220:221], v105 offset:2048
  s_waitcnt lgkmcnt(14)
  ds_read_b64_tr_b16 a[222:223], v105 offset:3072
  s_waitcnt vmcnt(17)
  s_waitcnt lgkmcnt(14)
  ds_write_b128 v99, a[224:227] offset:0
  s_waitcnt vmcnt(16)
  s_waitcnt lgkmcnt(14)
  ds_write_b128 v99, a[228:231] offset:1024
  s_waitcnt vmcnt(15)
  s_waitcnt lgkmcnt(14)
  ds_write_b128 v99, a[232:235] offset:2048
  s_waitcnt vmcnt(14)
  s_waitcnt lgkmcnt(14)
  ds_write_b128 v99, a[236:239] offset:3072
  s_waitcnt vmcnt(13)
  s_waitcnt lgkmcnt(14)
  ds_write_b128 v99, a[240:243] offset:4096
  s_waitcnt vmcnt(12)
  s_waitcnt lgkmcnt(14)
  ds_write_b128 v99, a[244:247] offset:5120
  s_waitcnt vmcnt(11)
  s_waitcnt lgkmcnt(14)
  ds_write_b128 v99, a[248:251] offset:6144
  s_waitcnt vmcnt(10)
  s_waitcnt lgkmcnt(14)
  ds_write_b128 v99, a[252:255] offset:7168
  s_waitcnt lgkmcnt(14)
  ds_read_b64_tr_b16 a[224:225], v102 offset:0
  s_waitcnt lgkmcnt(14)
  ds_read_b64_tr_b16 a[226:227], v102 offset:1024
  s_waitcnt lgkmcnt(14)
  ds_read_b64_tr_b16 a[228:229], v102 offset:2048
  s_waitcnt lgkmcnt(14)
  ds_read_b64_tr_b16 a[230:231], v102 offset:3072
  s_waitcnt lgkmcnt(14)
  ds_read_b64_tr_b16 a[232:233], v104 offset:0
  s_waitcnt lgkmcnt(14)
  ds_read_b64_tr_b16 a[234:235], v104 offset:1024
  s_waitcnt lgkmcnt(14)
  ds_read_b64_tr_b16 a[236:237], v104 offset:2048
  s_waitcnt lgkmcnt(14)
  ds_read_b64_tr_b16 a[238:239], v104 offset:3072
  s_waitcnt lgkmcnt(14)
  ds_read_b64_tr_b16 a[240:241], v103 offset:0
  s_waitcnt lgkmcnt(14)
  ds_read_b64_tr_b16 a[242:243], v103 offset:1024
  s_waitcnt lgkmcnt(14)
  ds_read_b64_tr_b16 a[244:245], v103 offset:2048
  s_waitcnt lgkmcnt(14)
  ds_read_b64_tr_b16 a[246:247], v103 offset:3072
  s_waitcnt lgkmcnt(14)
  ds_read_b64_tr_b16 a[248:249], v105 offset:0
  s_waitcnt lgkmcnt(14)
  ds_read_b64_tr_b16 a[250:251], v105 offset:1024
  s_waitcnt lgkmcnt(14)
  ds_read_b64_tr_b16 a[252:253], v105 offset:2048
  s_waitcnt lgkmcnt(14)
  ds_read_b64_tr_b16 a[254:255], v105 offset:3072
  s_waitcnt vmcnt(1)
  v_cmp_gt_u32 vcc, s70, v12
  s_mov_b32 m0, s90
  s_cbranch_vccnz L_cps_19
L_cpb_20:
  buffer_load_dwordx4 v41, s[8:11], s63 offen offset:0 sc1 lds
  buffer_load_dwordx4 v41, s[8:11], s63 offen offset:1024 sc1 lds
  buffer_load_dwordx4 v[108:111], v41, s[8:11], s64 offen offset:0 sc1
  buffer_load_dwordx4 v[112:115], v41, s[8:11], s64 offen offset:1024 sc1
  s_waitcnt lgkmcnt(14)
  ds_write_b128 v99, v[64:67] offset:0
  s_waitcnt lgkmcnt(14)
  ds_write_b128 v99, v[68:71] offset:1024
  s_waitcnt lgkmcnt(14)
  ds_write_b128 v99, v[72:75] offset:2048
  s_waitcnt lgkmcnt(14)
  ds_write_b128 v99, v[76:79] offset:3072
  s_waitcnt lgkmcnt(14)
  ds_write_b128 v99, v[80:83] offset:4096
  s_waitcnt lgkmcnt(14)
  ds_write_b128 v99, v[84:87] offset:5120
  s_waitcnt lgkmcnt(14)
  ds_write_b128 v99, v[88:91] offset:6144
  s_waitcnt lgkmcnt(14)
  ds_write_b128 v99, v[92:95] offset:7168
  s_waitcnt lgkmcnt(14)
  ds_read_b64_tr_b16 v[64:65], v102 offset:0
  s_waitcnt lgkmcnt(14)
  ds_read_b64_tr_b16 v[66:67], v102 offset:1024
  s_waitcnt lgkmcnt(14)
  ds_read_b64_tr_b16 v[68:69], v102 offset:2048
  s_waitcnt lgkmcnt(14)
  ds_read_b64_tr_b16 v[70:71], v102 offset:3072
  s_waitcnt lgkmcnt(14)
  ds_read_b64_tr_b16 v[72:73], v104 offset:0
  s_waitcnt lgkmcnt(14)
  ds_read_b64_tr_b16 v[74:75], v104 offset:1024
  s_waitcnt lgkmcnt(14)
  ds_read_b64_tr_b16 v[76:77], v104 offset:2048
  s_waitcnt lgkmcnt(14)
  ds_read_b64_tr_b16 v[78:79], v104 offset:3072
  s_waitcnt lgkmcnt(14)
  ds_read_b64_tr_b16 v[80:81], v103 offset:0
  s_waitcnt lgkmcnt(14)
  ds_read_b64_tr_b16 v[82:83], v103 offset:1024
  s_waitcnt lgkmcnt(14)
  ds_read_b64_tr_b16 v[84:85], v103 offset:2048
  s_waitcnt lgkmcnt(14)
  ds_read_b64_tr_b16 v[86:87], v103 offset:3072
  s_waitcnt lgkmcnt(14)
  ds_read_b64_tr_b16 v[88:89], v105 offset:0
  s_waitcnt lgkmcnt(14)
  ds_read_b64_tr_b16 v[90:91], v105 offset:1024
  s_waitcnt lgkmcnt(14)
  ds_read_b64_tr_b16 v[92:93], v105 offset:2048
  s_waitcnt lgkmcnt(14)
  ds_read_b64_tr_b16 v[94:95], v105 offset:3072
  s_waitcnt lgkmcnt(14)
  ds_write_b128 v6, v[64:67] offset:24576
  s_waitcnt lgkmcnt(13)
  ds_write_b128 v6, v[68:71] offset:25600
  s_waitcnt lgkmcnt(12)
  ds_write_b128 v6, v[72:75] offset:26624
  s_waitcnt lgkmcnt(11)
  ds_write_b128 v6, v[76:79] offset:27648
  s_waitcnt lgkmcnt(10)
  ds_write_b128 v6, v[80:83] offset:28672
  s_waitcnt lgkmcnt(9)
  ds_write_b128 v6, v[84:87] offset:29696
  s_waitcnt lgkmcnt(8)
  ds_write_b128 v6, v[88:91] offset:30720
  s_waitcnt lgkmcnt(7)
  ds_write_b128 v6, v[92:95] offset:31744
  s_waitcnt lgkmcnt(0)
  s_branch L_wj_5
L_wv_4:
  s_add_u32 s28, s92, 0x0
  buffer_load_dwordx4 a[160:163], v96, s[64:67], s28 offen
  s_add_u32 s28, s92, 0x8000
  buffer_load_dwordx4 a[164:167], v96, s[64:67], s28 offen
  s_add_u32 s28, s92, 0x2000
  buffer_load_dwordx4 a[168:171], v96, s[64:67], s28 offen
  s_add_u32 s28, s92, 0xa000
  buffer_load_dwordx4 a[172:175], v96, s[64:67], s28 offen
  s_add_u32 s28, s92, 0x100000
  buffer_load_dwordx4 a[0:3], v96, s[64:67], s28 offen
  s_add_u32 s28, s92, 0x108000
  buffer_load_dwordx4 a[4:7], v96, s[64:67], s28 offen
  s_add_u32 s28, s92, 0x102000
  buffer_load_dwordx4 a[8:11], v96, s[64:67], s28 offen
  s_add_u32 s28, s92, 0x10a000
  buffer_load_dwordx4 a[12:15], v96, s[64:67], s28 offen
  s_add_u32 s28, s92, 0x200000
  buffer_load_dwordx4 v[160:163], v96, s[64:67], s28 offen
  s_add_u32 s28, s92, 0x208000
  buffer_load_dwordx4 v[164:167], v96, s[64:67], s28 offen
  s_add_u32 s28, s92, 0x202000
  buffer_load_dwordx4 v[168:171], v96, s[64:67], s28 offen
  s_add_u32 s28, s92, 0x20a000
  buffer_load_dwordx4 v[172:175], v96, s[64:67], s28 offen
  s_add_u32 s28, s92, 0x300000
  buffer_load_dwordx4 a[176:179], v96, s[64:67], s28 offen
  s_add_u32 s28, s92, 0x308000
  buffer_load_dwordx4 a[180:183], v96, s[64:67], s28 offen
  s_add_u32 s28, s92, 0x302000
  buffer_load_dwordx4 a[184:187], v96, s[64:67], s28 offen
  s_add_u32 s28, s92, 0x30a000
  buffer_load_dwordx4 a[188:191], v96, s[64:67], s28 offen
  s_add_u32 s28, s92, 0x80000
  buffer_load_dwordx4 a[192:195], v96, s[64:67], s28 offen
  s_add_u32 s28, s92, 0x88000
  buffer_load_dwordx4 a[196:199], v96, s[64:67], s28 offen
  s_add_u32 s28, s92, 0x82000
  buffer_load_dwordx4 a[200:203], v96, s[64:67], s28 offen
  s_add_u32 s28, s92, 0x8a000
  buffer_load_dwordx4 a[204:207], v96, s[64:67], s28 offen
  s_add_u32 s28, s92, 0x180000
  buffer_load_dwordx4 a[48:51], v96, s[64:67], s28 offen
  s_add_u32 s28, s92, 0x188000
  buffer_load_dwordx4 a[52:55], v96, s[64:67], s28 offen
  s_add_u32 s28, s92, 0x182000
  buffer_load_dwordx4 a[56:59], v96, s[64:67], s28 offen
  s_add_u32 s28, s92, 0x18a000
  buffer_load_dwordx4 a[60:63], v96, s[64:67], s28 offen
  s_add_u32 s28, s92, 0x280000
  buffer_load_dwordx4 v[208:211], v96, s[64:67], s28 offen
  s_add_u32 s28, s92, 0x288000
  buffer_load_dwordx4 v[212:215], v96, s[64:67], s28 offen
  s_add_u32 s28, s92, 0x282000
  buffer_load_dwordx4 v[216:219], v96, s[64:67], s28 offen
  s_add_u32 s28, s92, 0x28a000
  buffer_load_dwordx4 v[220:223], v96, s[64:67], s28 offen
  s_add_u32 s28, s92, 0x380000
  buffer_load_dwordx4 a[208:211], v96, s[64:67], s28 offen
  s_add_u32 s28, s92, 0x388000
  buffer_load_dwordx4 a[212:215], v96, s[64:67], s28 offen
  s_add_u32 s28, s92, 0x382000
  buffer_load_dwordx4 a[216:219], v96, s[64:67], s28 offen
  s_add_u32 s28, s92, 0x38a000
  buffer_load_dwordx4 a[220:223], v96, s[64:67], s28 offen
  s_add_u32 s28, s92, 0x0
  buffer_load_dwordx4 a[96:99], v96, s[68:71], s28 offen
  s_add_u32 s28, s92, 0x8000
  buffer_load_dwordx4 a[100:103], v96, s[68:71], s28 offen
  s_add_u32 s28, s92, 0x2000
  buffer_load_dwordx4 a[104:107], v96, s[68:71], s28 offen
  s_add_u32 s28, s92, 0xa000
  buffer_load_dwordx4 a[108:111], v96, s[68:71], s28 offen
  s_add_u32 s28, s92, 0x100000
  buffer_load_dwordx4 a[16:19], v96, s[68:71], s28 offen
  s_add_u32 s28, s92, 0x108000
  buffer_load_dwordx4 a[20:23], v96, s[68:71], s28 offen
  s_add_u32 s28, s92, 0x102000
  buffer_load_dwordx4 a[24:27], v96, s[68:71], s28 offen
  s_add_u32 s28, s92, 0x10a000
  buffer_load_dwordx4 a[28:31], v96, s[68:71], s28 offen
  s_waitcnt vmcnt(44)
  s_barrier
  s_cmp_lg_u32 s5, 0
  s_cbranch_scc1 L_arr_21
  s_lshl_b32 s28, s3, 5
  v_mov_b32 v47, s7
  s_mov_b64 exec, 1
  buffer_atomic_add v47, off, s[24:27], s28 offset:0 sc1
  s_mov_b64 exec, -1
L_arr_21:
  s_mov_b32 s28, 0x05040100
  s_mov_b32 s29, 0x07060302
  s_waitcnt vmcnt(42)
  v_perm_b32 v48, v34, v32, s28
  v_perm_b32 v49, v34, v32, s29
  v_perm_b32 v50, v35, v33, s28
  v_perm_b32 v51, v35, v33, s29
  v_or_b32 v48, 1, v48
  s_waitcnt vmcnt(40)
  v_perm_b32 v52, v38, v36, s28
  v_perm_b32 v53, v38, v36, s29
  v_perm_b32 v54, v39, v37, s28
  v_perm_b32 v55, v39, v37, s29
  v_or_b32 v52, 1, v52
  s_waitcnt vmcnt(39)
  ds_write_b128 v98, a[160:163] offset:0
  s_waitcnt vmcnt(38)
  ds_write_b128 v98, a[164:167] offset:1024
  s_waitcnt vmcnt(37)
  ds_write_b128 v98, a[168:171] offset:2048
  s_waitcnt vmcnt(36)
  ds_write_b128 v98, a[172:175] offset:3072
  s_waitcnt lgkmcnt(0)
  s_barrier
  ds_read_b64_tr_b16 a[160:161], v100 offset:0
  ds_read_b64_tr_b16 a[162:163], v100 offset:2048
  ds_read_b64_tr_b16 a[164:165], v100 offset:4096
  ds_read_b64_tr_b16 a[166:167], v100 offset:6144
  ds_read_b64_tr_b16 a[168:169], v101 offset:0
  ds_read_b64_tr_b16 a[170:171], v101 offset:2048
  ds_read_b64_tr_b16 a[172:173], v101 offset:4096
  ds_read_b64_tr_b16 a[174:175], v101 offset:6144
  s_waitcnt lgkmcnt(6)
  ds_write_b128 v6, a[160:163] offset:16384
  s_waitcnt lgkmcnt(5)
  ds_write_b128 v6, a[164:167] offset:17408
  s_waitcnt lgkmcnt(4)
  ds_write_b128 v6, a[168:171] offset:18432
  s_waitcnt lgkmcnt(3)
  ds_write_b128 v6, a[172:175] offset:19456
  s_add_u32 s28, s92, 0x200000
  buffer_load_dwordx4 v[176:179], v96, s[68:71], s28 offen
  s_add_u32 s28, s92, 0x208000
  buffer_load_dwordx4 v[180:183], v96, s[68:71], s28 offen
  s_add_u32 s28, s92, 0x202000
  buffer_load_dwordx4 v[184:187], v96, s[68:71], s28 offen
  s_add_u32 s28, s92, 0x20a000
  buffer_load_dwordx4 v[188:191], v96, s[68:71], s28 offen
  s_waitcnt vmcnt(39)
  ds_write_b128 v98, a[0:3] offset:16384
  s_waitcnt vmcnt(38)
  ds_write_b128 v98, a[4:7] offset:17408
  s_waitcnt vmcnt(37)
  ds_write_b128 v98, a[8:11] offset:18432
  s_waitcnt vmcnt(36)
  ds_write_b128 v98, a[12:15] offset:19456
  s_waitcnt lgkmcnt(0)
  s_barrier
  ds_read_b64_tr_b16 a[0:1], v100 offset:16384
  ds_read_b64_tr_b16 a[2:3], v100 offset:18432
  ds_read_b64_tr_b16 a[4:5], v100 offset:20480
  ds_read_b64_tr_b16 a[6:7], v100 offset:22528
  ds_read_b64_tr_b16 a[8:9], v101 offset:16384
  ds_read_b64_tr_b16 a[10:11], v101 offset:18432
  ds_read_b64_tr_b16 a[12:13], v101 offset:20480
  ds_read_b64_tr_b16 a[14:15], v101 offset:22528
  s_add_u32 s28, s92, 0x300000
  buffer_load_dwordx4 a[224:227], v96, s[68:71], s28 offen
  s_add_u32 s28, s92, 0x308000
  buffer_load_dwordx4 a[228:231], v96, s[68:71], s28 offen
  s_add_u32 s28, s92, 0x302000
  buffer_load_dwordx4 a[232:235], v96, s[68:71], s28 offen
  s_add_u32 s28, s92, 0x30a000
  buffer_load_dwordx4 a[236:239], v96, s[68:71], s28 offen
  s_waitcnt vmcnt(39)
  ds_write_b128 v98, v[160:163] offset:0
  s_waitcnt vmcnt(38)
  ds_write_b128 v98, v[164:167] offset:1024
  s_waitcnt vmcnt(37)
  ds_write_b128 v98, v[168:171] offset:2048
  s_waitcnt vmcnt(36)
  ds_write_b128 v98, v[172:175] offset:3072
  s_waitcnt lgkmcnt(0)
  s_barrier
  ds_read_b64_tr_b16 v[160:161], v100 offset:0
  ds_read_b64_tr_b16 v[162:163], v100 offset:2048
  ds_read_b64_tr_b16 v[164:165], v100 offset:4096
  ds_read_b64_tr_b16 v[166:167], v100 offset:6144
  ds_read_b64_tr_b16 v[168:169], v101 offset:0
  ds_read_b64_tr_b16 v[170:171], v101 offset:2048
  ds_read_b64_tr_b16 v[172:173], v101 offset:4096
  ds_read_b64_tr_b16 v[174:175], v101 offset:6144
  s_add_u32 s28, s92, 0x0
  buffer_load_dwordx4 a[112:115], v96, s[72:75], s28 offen
  s_add_u32 s28, s92, 0x8000
  buffer_load_dwordx4 a[116:119], v96, s[72:75], s28 offen
  s_add_u32 s28, s92, 0x2000
  buffer_load_dwordx4 a[120:123], v96, s[72:75], s28 offen
  s_add_u32 s28, s92, 0xa000
  buffer_load_dwordx4 a[124:127], v96, s[72:75], s28 offen
  s_waitcnt vmcnt(39)
  ds_write_b128 v98, a[176:179] offset:16384
  s_waitcnt vmcnt(38)
  ds_write_b128 v98, a[180:183] offset:17408
  s_waitcnt vmcnt(37)
  ds_write_b128 v98, a[184:187] offset:18432
  s_waitcnt vmcnt(36)
  ds_write_b128 v98, a[188:191] offset:19456
  s_waitcnt lgkmcnt(0)
  s_barrier
  ds_read_b64_tr_b16 a[176:177], v100 offset:16384
  ds_read_b64_tr_b16 a[178:179], v100 offset:18432
  ds_read_b64_tr_b16 a[180:181], v100 offset:20480
  ds_read_b64_tr_b16 a[182:183], v100 offset:22528
  ds_read_b64_tr_b16 a[184:185], v101 offset:16384
  ds_read_b64_tr_b16 a[186:187], v101 offset:18432
  ds_read_b64_tr_b16 a[188:189], v101 offset:20480
  ds_read_b64_tr_b16 a[190:191], v101 offset:22528
  s_waitcnt lgkmcnt(6)
  ds_write_b128 v6, a[176:179] offset:0
  s_waitcnt lgkmcnt(5)
  ds_write_b128 v6, a[180:183] offset:1024
  s_waitcnt lgkmcnt(4)
  ds_write_b128 v6, a[184:187] offset:2048
  s_waitcnt lgkmcnt(3)
  ds_write_b128 v6, a[188:191] offset:3072
  s_add_u32 s28, s92, 0x100000
  buffer_load_dwordx4 a[32:35], v96, s[72:75], s28 offen
  s_add_u32 s28, s92, 0x108000
  buffer_load_dwordx4 a[36:39], v96, s[72:75], s28 offen
  s_add_u32 s28, s92, 0x102000
  buffer_load_dwordx4 a[40:43], v96, s[72:75], s28 offen
  s_add_u32 s28, s92, 0x10a000
  buffer_load_dwordx4 a[44:47], v96, s[72:75], s28 offen
  s_waitcnt vmcnt(39)
  ds_write_b128 v98, a[192:195] offset:0
  s_waitcnt vmcnt(38)
  ds_write_b128 v98, a[196:199] offset:1024
  s_waitcnt vmcnt(37)
  ds_write_b128 v98, a[200:203] offset:2048
  s_waitcnt vmcnt(36)
  ds_write_b128 v98, a[204:207] offset:3072
  s_waitcnt lgkmcnt(0)
  s_barrier
  ds_read_b64_tr_b16 a[192:193], v100 offset:0
  ds_read_b64_tr_b16 a[194:195], v100 offset:2048
  ds_read_b64_tr_b16 a[196:197], v100 offset:4096
  ds_read_b64_tr_b16 a[198:199], v100 offset:6144
  ds_read_b64_tr_b16 a[200:201], v101 offset:0
  ds_read_b64_tr_b16 a[202:203], v101 offset:2048
  ds_read_b64_tr_b16 a[204:205], v101 offset:4096
  ds_read_b64_tr_b16 a[206:207], v101 offset:6144
  s_waitcnt lgkmcnt(6)
  ds_write_b128 v6, a[192:195] offset:20480
  s_waitcnt lgkmcnt(5)
  ds_write_b128 v6, a[196:199] offset:21504
  s_waitcnt lgkmcnt(4)
  ds_write_b128 v6, a[200:203] offset:22528
  s_waitcnt lgkmcnt(3)
  ds_write_b128 v6, a[204:207] offset:23552
  s_add_u32 s28, s92, 0x200000
  buffer_load_dwordx4 v[192:195], v96, s[72:75], s28 offen
  s_add_u32 s28, s92, 0x208000
  buffer_load_dwordx4 v[196:199], v96, s[72:75], s28 offen
  s_add_u32 s28, s92, 0x202000
  buffer_load_dwordx4 v[200:203], v96, s[72:75], s28 offen
  s_add_u32 s28, s92, 0x20a000
  buffer_load_dwordx4 v[204:207], v96, s[72:75], s28 offen
  s_waitcnt vmcnt(39)
  ds_write_b128 v98, a[48:51] offset:16384
  s_waitcnt vmcnt(38)
  ds_write_b128 v98, a[52:55] offset:17408
  s_waitcnt vmcnt(37)
  ds_write_b128 v98, a[56:59] offset:18432
  s_waitcnt vmcnt(36)
  ds_write_b128 v98, a[60:63] offset:19456
  s_waitcnt lgkmcnt(0)
  s_barrier
  ds_read_b64_tr_b16 a[48:49], v100 offset:16384
  ds_read_b64_tr_b16 a[50:51], v100 offset:18432
  ds_read_b64_tr_b16 a[52:53], v100 offset:20480
  ds_read_b64_tr_b16 a[54:55], v100 offset:22528
  ds_read_b64_tr_b16 a[56:57], v101 offset:16384
  ds_read_b64_tr_b16 a[58:59], v101 offset:18432
  ds_read_b64_tr_b16 a[60:61], v101 offset:20480
  ds_read_b64_tr_b16 a[62:63], v101 offset:22528
  s_add_u32 s28, s92, 0x300000
  buffer_load_dwordx4 a[240:243], v96, s[72:75], s28 offen
  s_add_u32 s28, s92, 0x308000
  buffer_load_dwordx4 a[244:247], v96, s[72:75], s28 offen
  s_add_u32 s28, s92, 0x302000
  buffer_load_dwordx4 a[248:251], v96, s[72:75], s28 offen
  s_add_u32 s28, s92, 0x30a000
  buffer_load_dwordx4 a[252:255], v96, s[72:75], s28 offen
  s_waitcnt vmcnt(39)
  ds_write_b128 v98, v[208:211] offset:0
  s_waitcnt vmcnt(38)
  ds_write_b128 v98, v[212:215] offset:1024
  s_waitcnt vmcnt(37)
  ds_write_b128 v98, v[216:219] offset:2048
  s_waitcnt vmcnt(36)
  ds_write_b128 v98, v[220:223] offset:3072
  s_waitcnt lgkmcnt(0)
  s_barrier
  ds_read_b64_tr_b16 v[208:209], v100 offset:0
  ds_read_b64_tr_b16 v[210:211], v100 offset:2048
  ds_read_b64_tr_b16 v[212:213], v100 offset:4096
  ds_read_b64_tr_b16 v[214:215], v100 offset:6144
  ds_read_b64_tr_b16 v[216:217], v101 offset:0
  ds_read_b64_tr_b16 v[218:219], v101 offset:2048
  ds_read_b64_tr_b16 v[220:221], v101 offset:4096
  ds_read_b64_tr_b16 v[222:223], v101 offset:6144
  s_add_u32 s28, s92, 0x80000
  buffer_load_dwordx4 a[128:131], v96, s[68:71], s28 offen
  s_add_u32 s28, s92, 0x88000
  buffer_load_dwordx4 a[132:135], v96, s[68:71], s28 offen
  s_add_u32 s28, s92, 0x82000
  buffer_load_dwordx4 a[136:139], v96, s[68:71], s28 offen
  s_add_u32 s28, s92, 0x8a000
  buffer_load_dwordx4 a[140:143], v96, s[68:71], s28 offen
  s_waitcnt vmcnt(39)
  ds_write_b128 v98, a[208:211] offset:16384
  s_waitcnt vmcnt(38)
  ds_write_b128 v98, a[212:215] offset:17408
  s_waitcnt vmcnt(37)
  ds_write_b128 v98, a[216:219] offset:18432
  s_waitcnt vmcnt(36)
  ds_write_b128 v98, a[220:223] offset:19456
  s_waitcnt lgkmcnt(0)
  s_barrier
  ds_read_b64_tr_b16 a[208:209], v100 offset:16384
  ds_read_b64_tr_b16 a[210:211], v100 offset:18432
  ds_read_b64_tr_b16 a[212:213], v100 offset:20480
  ds_read_b64_tr_b16 a[214:215], v100 offset:22528
  ds_read_b64_tr_b16 a[216:217], v101 offset:16384
  ds_read_b64_tr_b16 a[218:219], v101 offset:18432
  ds_read_b64_tr_b16 a[220:221], v101 offset:20480
  ds_read_b64_tr_b16 a[222:223], v101 offset:22528
  s_waitcnt lgkmcnt(6)
  ds_write_b128 v6, a[208:211] offset:12288
  s_waitcnt lgkmcnt(5)
  ds_write_b128 v6, a[212:215] offset:13312
  s_waitcnt lgkmcnt(4)
  ds_write_b128 v6, a[216:219] offset:14336
  s_waitcnt lgkmcnt(3)
  ds_write_b128 v6, a[220:223] offset:15360
  s_add_u32 s28, s92, 0x180000
  buffer_load_dwordx4 a[64:67], v96, s[68:71], s28 offen
  s_add_u32 s28, s92, 0x188000
  buffer_load_dwordx4 a[68:71], v96, s[68:71], s28 offen
  s_add_u32 s28, s92, 0x182000
  buffer_load_dwordx4 a[72:75], v96, s[68:71], s28 offen
  s_add_u32 s28, s92, 0x18a000
  buffer_load_dwordx4 a[76:79], v96, s[68:71], s28 offen
  s_waitcnt vmcnt(39)
  ds_write_b128 v98, a[96:99] offset:0
  s_waitcnt vmcnt(38)
  ds_write_b128 v98, a[100:103] offset:1024
  s_waitcnt vmcnt(37)
  ds_write_b128 v98, a[104:107] offset:2048
  s_waitcnt vmcnt(36)
  ds_write_b128 v98, a[108:111] offset:3072
  s_waitcnt lgkmcnt(0)
  s_barrier
  ds_read_b64_tr_b16 a[96:97], v100 offset:0
  ds_read_b64_tr_b16 a[98:99], v100 offset:2048
  ds_read_b64_tr_b16 a[100:101], v100 offset:4096
  ds_read_b64_tr_b16 a[102:103], v100 offset:6144
  ds_read_b64_tr_b16 a[104:105], v101 offset:0
  ds_read_b64_tr_b16 a[106:107], v101 offset:2048
  ds_read_b64_tr_b16 a[108:109], v101 offset:4096
  ds_read_b64_tr_b16 a[110:111], v101 offset:6144
  s_add_u32 s28, s92, 0x280000
  buffer_load_dwordx4 v[224:227], v96, s[68:71], s28 offen
  s_add_u32 s28, s92, 0x288000
  buffer_load_dwordx4 v[228:231], v96, s[68:71], s28 offen
  s_add_u32 s28, s92, 0x282000
  buffer_load_dwordx4 v[232:235], v96, s[68:71], s28 offen
  s_add_u32 s28, s92, 0x28a000
  buffer_load_dwordx4 v[236:239], v96, s[68:71], s28 offen
  s_waitcnt vmcnt(39)
  ds_write_b128 v98, a[16:19] offset:16384
  s_waitcnt vmcnt(38)
  ds_write_b128 v98, a[20:23] offset:17408
  s_waitcnt vmcnt(37)
  ds_write_b128 v98, a[24:27] offset:18432
  s_waitcnt vmcnt(36)
  ds_write_b128 v98, a[28:31] offset:19456
  s_waitcnt lgkmcnt(0)
  s_barrier
  ds_read_b64_tr_b16 a[16:17], v100 offset:16384
  ds_read_b64_tr_b16 a[18:19], v100 offset:18432
  ds_read_b64_tr_b16 a[20:21], v100 offset:20480
  ds_read_b64_tr_b16 a[22:23], v100 offset:22528
  ds_read_b64_tr_b16 a[24:25], v101 offset:16384
  ds_read_b64_tr_b16 a[26:27], v101 offset:18432
  ds_read_b64_tr_b16 a[28:29], v101 offset:20480
  ds_read_b64_tr_b16 a[30:31], v101 offset:22528
  s_add_u32 s28, s92, 0x380000
  buffer_load_dwordx4 v[128:131], v96, s[68:71], s28 offen
  s_add_u32 s28, s92, 0x388000
  buffer_load_dwordx4 v[132:135], v96, s[68:71], s28 offen
  s_add_u32 s28, s92, 0x382000
  buffer_load_dwordx4 v[136:139], v96, s[68:71], s28 offen
  s_add_u32 s28, s92, 0x38a000
  buffer_load_dwordx4 v[140:143], v96, s[68:71], s28 offen
  s_waitcnt vmcnt(39)
  ds_write_b128 v98, v[176:179] offset:0
  s_waitcnt vmcnt(38)
  ds_write_b128 v98, v[180:183] offset:1024
  s_waitcnt vmcnt(37)
  ds_write_b128 v98, v[184:187] offset:2048
  s_waitcnt vmcnt(36)
  ds_write_b128 v98, v[188:191] offset:3072
  s_waitcnt lgkmcnt(0)
  s_barrier
  ds_read_b64_tr_b16 v[176:177], v100 offset:0
  ds_read_b64_tr_b16 v[178:179], v100 offset:2048
  ds_read_b64_tr_b16 v[180:181], v100 offset:4096
  ds_read_b64_tr_b16 v[182:183], v100 offset:6144
  ds_read_b64_tr_b16 v[184:185], v101 offset:0
  ds_read_b64_tr_b16 v[186:187], v101 offset:2048
  ds_read_b64_tr_b16 v[188:189], v101 offset:4096
  ds_read_b64_tr_b16 v[190:191], v101 offset:6144
  s_add_u32 s28, s92, 0x80000
  buffer_load_dwordx4 a[144:147], v96, s[72:75], s28 offen
  s_add_u32 s28, s92, 0x88000
  buffer_load_dwordx4 a[148:151], v96, s[72:75], s28 offen
  s_add_u32 s28, s92, 0x82000
  buffer_load_dwordx4 a[152:155], v96, s[72:75], s28 offen
  s_add_u32 s28, s92, 0x8a000
  buffer_load_dwordx4 a[156:159], v96, s[72:75], s28 offen
  s_waitcnt vmcnt(39)
  ds_write_b128 v98, a[224:227] offset:16384
  s_waitcnt vmcnt(38)
  ds_write_b128 v98, a[228:231] offset:17408
  s_waitcnt vmcnt(37)
  ds_write_b128 v98, a[232:235] offset:18432
  s_waitcnt vmcnt(36)
  ds_write_b128 v98, a[236:239] offset:19456
  s_waitcnt lgkmcnt(0)
  s_barrier
  ds_read_b64_tr_b16 a[224:225], v100 offset:16384
  ds_read_b64_tr_b16 a[226:227], v100 offset:18432
  ds_read_b64_tr_b16 a[228:229], v100 offset:20480
  ds_read_b64_tr_b16 a[230:231], v100 offset:22528
  ds_read_b64_tr_b16 a[232:233], v101 offset:16384
  ds_read_b64_tr_b16 a[234:235], v101 offset:18432
  ds_read_b64_tr_b16 a[236:237], v101 offset:20480
  ds_read_b64_tr_b16 a[238:239], v101 offset:22528
  s_waitcnt lgkmcnt(6)
  ds_write_b128 v6, a[224:227] offset:4096
  s_waitcnt lgkmcnt(5)
  ds_write_b128 v6, a[228:231] offset:5120
  s_waitcnt lgkmcnt(4)
  ds_write_b128 v6, a[232:235] offset:6144
  s_waitcnt lgkmcnt(3)
  ds_write_b128 v6, a[236:239] offset:7168
  s_add_u32 s28, s92, 0x180000
  buffer_load_dwordx4 a[80:83], v96, s[72:75], s28 offen
  s_add_u32 s28, s92, 0x188000
  buffer_load_dwordx4 a[84:87], v96, s[72:75], s28 offen
  s_add_u32 s28, s92, 0x182000
  buffer_load_dwordx4 a[88:91], v96, s[72:75], s28 offen
  s_add_u32 s28, s92, 0x18a000
  buffer_load_dwordx4 a[92:95], v96, s[72:75], s28 offen
  v_and_b32 v44, 7, v0
  v_lshlrev_b32 v44, 5, v44
  buffer_load_dword v46, v44, s[24:27], 0 offen sc1
  v_lshlrev_b32 v41, 4, v0
  s_waitcnt vmcnt(40)
  ds_write_b128 v98, a[112:115] offset:0
  s_waitcnt vmcnt(39)
  ds_write_b128 v98, a[116:119] offset:1024
  s_waitcnt vmcnt(38)
  ds_write_b128 v98, a[120:123] offset:2048
  s_waitcnt vmcnt(37)
  ds_write_b128 v98, a[124:127] offset:3072
  s_waitcnt lgkmcnt(0)
  s_barrier
  ds_read_b64_tr_b16 a[112:113], v100 offset:0
  ds_read_b64_tr_b16 a[114:115], v100 offset:2048
  ds_read_b64_tr_b16 a[116:117], v100 offset:4096
  ds_read_b64_tr_b16 a[118:119], v100 offset:6144
  ds_read_b64_tr_b16 a[120:121], v101 offset:0
  ds_read_b64_tr_b16 a[122:123], v101 offset:2048
  ds_read_b64_tr_b16 a[124:125], v101 offset:4096
  ds_read_b64_tr_b16 a[126:127], v101 offset:6144
  s_add_u32 s28, s92, 0x280000
  buffer_load_dwordx4 v[240:243], v96, s[72:75], s28 offen
  s_add_u32 s28, s92, 0x288000
  buffer_load_dwordx4 v[244:247], v96, s[72:75], s28 offen
  s_add_u32 s28, s92, 0x282000
  buffer_load_dwordx4 v[248:251], v96, s[72:75], s28 offen
  s_add_u32 s28, s92, 0x28a000
  buffer_load_dwordx4 v[252:255], v96, s[72:75], s28 offen
  s_waitcnt vmcnt(40)
  ds_write_b128 v98, a[32:35] offset:16384
  s_waitcnt vmcnt(39)
  ds_write_b128 v98, a[36:39] offset:17408
  s_waitcnt vmcnt(38)
  ds_write_b128 v98, a[40:43] offset:18432
  s_waitcnt vmcnt(37)
  ds_write_b128 v98, a[44:47] offset:19456
  s_waitcnt lgkmcnt(0)
  s_barrier
  ds_read_b64_tr_b16 a[32:33], v100 offset:16384
  ds_read_b64_tr_b16 a[34:35], v100 offset:18432
  ds_read_b64_tr_b16 a[36:37], v100 offset:20480
  ds_read_b64_tr_b16 a[38:39], v100 offset:22528
  ds_read_b64_tr_b16 a[40:41], v101 offset:16384
  ds_read_b64_tr_b16 a[42:43], v101 offset:18432
  ds_read_b64_tr_b16 a[44:45], v101 offset:20480
  ds_read_b64_tr_b16 a[46:47], v101 offset:22528
  s_add_u32 s28, s92, 0x380000
  buffer_load_dwordx4 v[144:147], v96, s[72:75], s28 offen
  s_add_u32 s28, s92, 0x388000
  buffer_load_dwordx4 v[148:151], v96, s[72:75], s28 offen
  s_add_u32 s28, s92, 0x382000
  buffer_load_dwordx4 v[152:155], v96, s[72:75], s28 offen
  s_add_u32 s28, s92, 0x38a000
  buffer_load_dwordx4 v[156:159], v96, s[72:75], s28 offen
  s_waitcnt vmcnt(40)
  ds_write_b128 v98, v[192:195] offset:0
  s_waitcnt vmcnt(39)
  ds_write_b128 v98, v[196:199] offset:1024
  s_waitcnt vmcnt(38)
  ds_write_b128 v98, v[200:203] offset:2048
  s_waitcnt vmcnt(37)
  ds_write_b128 v98, v[204:207] offset:3072
  s_waitcnt lgkmcnt(0)
  s_barrier
  ds_read_b64_tr_b16 v[192:193], v100 offset:0
  ds_read_b64_tr_b16 v[194:195], v100 offset:2048
  ds_read_b64_tr_b16 v[196:197], v100 offset:4096
  ds_read_b64_tr_b16 v[198:199], v100 offset:6144
  ds_read_b64_tr_b16 v[200:201], v101 offset:0
  ds_read_b64_tr_b16 v[202:203], v101 offset:2048
  ds_read_b64_tr_b16 v[204:205], v101 offset:4096
  ds_read_b64_tr_b16 v[206:207], v101 offset:6144
  s_add_u32 s28, s96, 0x0
  buffer_load_dwordx4 a[160:163], v97, s[12:15], s28 offen
  s_add_u32 s28, s96, 0x800
  buffer_load_dwordx4 a[164:167], v97, s[12:15], s28 offen
  s_add_u32 s28, s96, 0x2000
  buffer_load_dwordx4 a[168:171], v97, s[12:15], s28 offen
  s_add_u32 s28, s96, 0x2800
  buffer_load_dwordx4 a[172:175], v97, s[12:15], s28 offen
  s_waitcnt vmcnt(40)
  ds_write_b128 v98, a[240:243] offset:16384
  s_waitcnt vmcnt(39)
  ds_write_b128 v98, a[244:247] offset:17408
  s_waitcnt vmcnt(38)
  ds_write_b128 v98, a[248:251] offset:18432
  s_waitcnt vmcnt(37)
  ds_write_b128 v98, a[252:255] offset:19456
  s_waitcnt lgkmcnt(0)
  s_barrier
  ds_read_b64_tr_b16 a[240:241], v100 offset:16384
  ds_read_b64_tr_b16 a[242:243], v100 offset:18432
  ds_read_b64_tr_b16 a[244:245], v100 offset:20480
  ds_read_b64_tr_b16 a[246:247], v100 offset:22528
  ds_read_b64_tr_b16 a[248:249], v101 offset:16384
  ds_read_b64_tr_b16 a[250:251], v101 offset:18432
  ds_read_b64_tr_b16 a[252:253], v101 offset:20480
  ds_read_b64_tr_b16 a[254:255], v101 offset:22528
  s_waitcnt lgkmcnt(6)
  ds_write_b128 v6, a[240:243] offset:8192
  s_waitcnt lgkmcnt(5)
  ds_write_b128 v6, a[244:247] offset:9216
  s_waitcnt lgkmcnt(4)
  ds_write_b128 v6, a[248:251] offset:10240
  s_waitcnt lgkmcnt(3)
  ds_write_b128 v6, a[252:255] offset:11264
  s_add_u32 s28, s96, 0x8000
  buffer_load_dwordx4 a[176:179], v97, s[12:15], s28 offen
  s_add_u32 s28, s96, 0x8800
  buffer_load_dwordx4 a[180:183], v97, s[12:15], s28 offen
  s_add_u32 s28, s96, 0xa000
  buffer_load_dwordx4 a[184:187], v97, s[12:15], s28 offen
  s_add_u32 s28, s96, 0xa800
  buffer_load_dwordx4 a[188:191], v97, s[12:15], s28 offen
  s_waitcnt vmcnt(40)
  ds_write_b128 v98, a[128:131] offset:0
  s_waitcnt vmcnt(39)
  ds_write_b128 v98, a[132:135] offset:1024
  s_waitcnt vmcnt(38)
  ds_write_b128 v98, a[136:139] offset:2048
  s_waitcnt vmcnt(37)
  ds_write_b128 v98, a[140:143] offset:3072
  s_waitcnt lgkmcnt(0)
  s_barrier
  ds_read_b64_tr_b16 a[128:129], v100 offset:0
  ds_read_b64_tr_b16 a[130:131], v100 offset:2048
  ds_read_b64_tr_b16 a[132:133], v100 offset:4096
  ds_read_b64_tr_b16 a[134:135], v100 offset:6144
  ds_read_b64_tr_b16 a[136:137], v101 offset:0
  ds_read_b64_tr_b16 a[138:139], v101 offset:2048
  ds_read_b64_tr_b16 a[140:141], v101 offset:4096
  ds_read_b64_tr_b16 a[142:143], v101 offset:6144
  s_add_u32 s28, s96, 0x80
  buffer_load_dwordx4 a[192:195], v97, s[12:15], s28 offen
  s_add_u32 s28, s96, 0x880
  buffer_load_dwordx4 a[196:199], v97, s[12:15], s28 offen
  s_add_u32 s28, s96, 0x2080
  buffer_load_dwordx4 a[200:203], v97, s[12:15], s28 offen
  s_add_u32 s28, s96, 0x2880
  buffer_load_dwordx4 a[204:207], v97, s[12:15], s28 offen
  s_waitcnt vmcnt(40)
  ds_write_b128 v98, a[64:67] offset:16384
  s_waitcnt vmcnt(39)
  ds_write_b128 v98, a[68:71] offset:17408
  s_waitcnt vmcnt(38)
  ds_write_b128 v98, a[72:75] offset:18432
  s_waitcnt vmcnt(37)
  ds_write_b128 v98, a[76:79] offset:19456
  s_waitcnt lgkmcnt(0)
  s_barrier
  ds_read_b64_tr_b16 a[64:65], v100 offset:16384
  ds_read_b64_tr_b16 a[66:67], v100 offset:18432
  ds_read_b64_tr_b16 a[68:69], v100 offset:20480
  ds_read_b64_tr_b16 a[70:71], v100 offset:22528
  ds_read_b64_tr_b16 a[72:73], v101 offset:16384
  ds_read_b64_tr_b16 a[74:75], v101 offset:18432
  ds_read_b64_tr_b16 a[76:77], v101 offset:20480
  ds_read_b64_tr_b16 a[78:79], v101 offset:22528
  s_add_u32 s28, s96, 0x8080
  buffer_load_dwordx4 a[208:211], v97, s[12:15], s28 offen
  s_add_u32 s28, s96, 0x8880
  buffer_load_dwordx4 a[212:215], v97, s[12:15], s28 offen
  s_add_u32 s28, s96, 0xa080
  buffer_load_dwordx4 a[216:219], v97, s[12:15], s28 offen
  s_add_u32 s28, s96, 0xa880
  buffer_load_dwordx4 a[220:223], v97, s[12:15], s28 offen
  s_waitcnt vmcnt(40)
  ds_write_b128 v98, v[224:227] offset:0
  s_waitcnt vmcnt(39)
  ds_write_b128 v98, v[228:231] offset:1024
  s_waitcnt vmcnt(38)
  ds_write_b128 v98, v[232:235] offset:2048
  s_waitcnt vmcnt(37)
  ds_write_b128 v98, v[236:239] offset:3072
  s_waitcnt lgkmcnt(0)
  s_barrier
  ds_read_b64_tr_b16 v[224:225], v100 offset:0
  ds_read_b64_tr_b16 v[226:227], v100 offset:2048
  ds_read_b64_tr_b16 v[228:229], v100 offset:4096
  ds_read_b64_tr_b16 v[230:231], v100 offset:6144
  ds_read_b64_tr_b16 v[232:233], v101 offset:0
  ds_read_b64_tr_b16 v[234:235], v101 offset:2048
  ds_read_b64_tr_b16 v[236:237], v101 offset:4096
  ds_read_b64_tr_b16 v[238:239], v101 offset:6144
  s_add_u32 s28, s97, 0x80
  buffer_load_dwordx4 a[224:227], v97, s[12:15], s28 offen
  s_add_u32 s28, s97, 0x880
  buffer_load_dwordx4 a[228:231], v97, s[12:15], s28 offen
  s_add_u32 s28, s97, 0x2080
  buffer_load_dwordx4 a[232:235], v97, s[12:15], s28 offen
  s_add_u32 s28, s97, 0x2880
  buffer_load_dwordx4 a[236:239], v97, s[12:15], s28 offen
  s_waitcnt vmcnt(40)
  ds_write_b128 v98, v[128:131] offset:16384
  s_waitcnt vmcnt(39)
  ds_write_b128 v98, v[132:135] offset:17408
  s_waitcnt vmcnt(38)
  ds_write_b128 v98, v[136:139] offset:18432
  s_waitcnt vmcnt(37)
  ds_write_b128 v98, v[140:143] offset:19456
  s_waitcnt lgkmcnt(0)
  s_barrier
  ds_read_b64_tr_b16 v[128:129], v100 offset:16384
  ds_read_b64_tr_b16 v[130:131], v100 offset:18432
  ds_read_b64_tr_b16 v[132:133], v100 offset:20480
  ds_read_b64_tr_b16 v[134:135], v100 offset:22528
  ds_read_b64_tr_b16 v[136:137], v101 offset:16384
  ds_read_b64_tr_b16 v[138:139], v101 offset:18432
  ds_read_b64_tr_b16 v[140:141], v101 offset:20480
  ds_read_b64_tr_b16 v[142:143], v101 offset:22528
  s_add_u32 s28, s97, 0x8080
  buffer_load_dwordx4 a[240:243], v97, s[12:15], s28 offen
  s_add_u32 s28, s97, 0x8880
  buffer_load_dwordx4 a[244:247], v97, s[12:15], s28 offen
  s_add_u32 s28, s97, 0xa080
  buffer_load_dwordx4 a[248:251], v97, s[12:15], s28 offen
  s_add_u32 s28, s97, 0xa880
  buffer_load_dwordx4 a[252:255], v97, s[12:15], s28 offen
  s_waitcnt vmcnt(40)
  ds_write_b128 v98, a[144:147] offset:0
  s_waitcnt vmcnt(39)
  ds_write_b128 v98, a[148:151] offset:1024
  s_waitcnt vmcnt(38)
  ds_write_b128 v98, a[152:155] offset:2048
  s_waitcnt vmcnt(37)
  ds_write_b128 v98, a[156:159] offset:3072
  s_waitcnt lgkmcnt(0)
  s_barrier
  ds_read_b64_tr_b16 a[144:145], v100 offset:0
  ds_read_b64_tr_b16 a[146:147], v100 offset:2048
  ds_read_b64_tr_b16 a[148:149], v100 offset:4096
  ds_read_b64_tr_b16 a[150:151], v100 offset:6144
  ds_read_b64_tr_b16 a[152:153], v101 offset:0
  ds_read_b64_tr_b16 a[154:155], v101 offset:2048
  ds_read_b64_tr_b16 a[156:157], v101 offset:4096
  ds_read_b64_tr_b16 a[158:159], v101 offset:6144
  s_add_u32 s28, s97, 0x0
  buffer_load_dwordx4 v[64:67], v97, s[12:15], s28 offen
  s_add_u32 s28, s97, 0x800
  buffer_load_dwordx4 v[68:71], v97, s[12:15], s28 offen
  s_add_u32 s28, s97, 0x2000
  buffer_load_dwordx4 v[72:75], v97, s[12:15], s28 offen
  s_add_u32 s28, s97, 0x2800
  buffer_load_dwordx4 v[76:79], v97, s[12:15], s28 offen
  s_waitcnt vmcnt(40)
  ds_write_b128 v98, a[80:83] offset:16384
  s_waitcnt vmcnt(39)
  ds_write_b128 v98, a[84:87] offset:17408
  s_waitcnt vmcnt(38)
  ds_write_b128 v98, a[88:91] offset:18432
  s_waitcnt vmcnt(37)
  ds_write_b128 v98, a[92:95] offset:19456
  s_waitcnt lgkmcnt(0)
  s_barrier
  ds_read_b64_tr_b16 a[80:81], v100 offset:16384
  ds_read_b64_tr_b16 a[82:83], v100 offset:18432
  ds_read_b64_tr_b16 a[84:85], v100 offset:20480
  ds_read_b64_tr_b16 a[86:87], v100 offset:22528
  ds_read_b64_tr_b16 a[88:89], v101 offset:16384
  ds_read_b64_tr_b16 a[90:91], v101 offset:18432
  ds_read_b64_tr_b16 a[92:93], v101 offset:20480
  ds_read_b64_tr_b16 a[94:95], v101 offset:22528
  s_add_u32 s28, s97, 0x8000
  buffer_load_dwordx4 v[80:83], v97, s[12:15], s28 offen
  s_add_u32 s28, s97, 0x8800
  buffer_load_dwordx4 v[84:87], v97, s[12:15], s28 offen
  s_add_u32 s28, s97, 0xa000
  buffer_load_dwordx4 v[88:91], v97, s[12:15], s28 offen
  s_add_u32 s28, s97, 0xa800
  buffer_load_dwordx4 v[92:95], v97, s[12:15], s28 offen
  s_mov_b32 s62, 0
  s_mov_b32 s74, 32768
  s_mul_i32 s28, s4, 29696
  s_add_u32 s28, s28, 0x1800000
  s_lshl_b32 s29, s5, 11
  s_add_u32 s63, s28, s29
  s_add_u32 s64, s63, 8192
  s_lshl_b32 s30, s5, 10
  s_add_u32 s30, s30, s28
  s_add_u32 s65, s30, 24576
  s_sub_u32 s65, s65, 0x100000
  s_mov_b32 s88, 0x3f803f80
  s_mov_b32 s89, 0x3f803f80
  s_add_u32 s90, s29, 12288
  s_add_u32 s91, s29, 20480
  s_lshl_b32 s30, s4, 13
  s_add_u32 s73, s30, s29
  s_mov_b32 s67, 270336
  s_add_u32 s66, s29, 270336
  s_mov_b32 s68, 286720
  s_mov_b32 s78, 0x3e0293ee
  s_mov_b32 s79, 0x3e0293ee
  s_lshl_b32 s30, s4, 7
  s_add_u32 s75, s30, 335872
  s_mov_b32 s70, 1
  s_waitcnt vmcnt(40)
  v_and_b32 v45, 63, v46
  v_cmp_ne_u32 vcc, 32, v45
  s_cbranch_vccnz L_cgs_22
L_cgb_23:
  v_readlane_b32 s28, v46, s3
  s_lshl_b32 s29, s7, 5
  s_nop 1
  s_cmp_lg_u32 s28, s29
  s_cselect_b32 s93, 1, 0
  s_waitcnt vmcnt(39)
  ds_write_b128 v98, v[240:243] offset:0
  s_waitcnt vmcnt(38)
  ds_write_b128 v98, v[244:247] offset:1024
  s_waitcnt vmcnt(37)
  ds_write_b128 v98, v[248:251] offset:2048
  s_waitcnt vmcnt(36)
  ds_write_b128 v98, v[252:255] offset:3072
  s_waitcnt lgkmcnt(0)
  s_barrier
  ds_read_b64_tr_b16 v[240:241], v100 offset:0
  ds_read_b64_tr_b16 v[242:243], v100 offset:2048
  ds_read_b64_tr_b16 v[244:245], v100 offset:4096
  ds_read_b64_tr_b16 v[246:247], v100 offset:6144
  ds_read_b64_tr_b16 v[248:249], v101 offset:0
  ds_read_b64_tr_b16 v[250:251], v101 offset:2048
  ds_read_b64_tr_b16 v[252:253], v101 offset:4096
  ds_read_b64_tr_b16 v[254:255], v101 offset:6144
  s_waitcnt vmcnt(35)
  ds_write_b128 v98, v[144:147] offset:16384
  s_waitcnt vmcnt(34)
  ds_write_b128 v98, v[148:151] offset:17408
  s_waitcnt vmcnt(33)
  ds_write_b128 v98, v[152:155] offset:18432
  s_waitcnt vmcnt(32)
  ds_write_b128 v98, v[156:159] offset:19456
  s_waitcnt lgkmcnt(0)
  s_barrier
  ds_read_b64_tr_b16 v[144:145], v100 offset:16384
  ds_read_b64_tr_b16 v[146:147], v100 offset:18432
  ds_read_b64_tr_b16 v[148:149], v100 offset:20480
  ds_read_b64_tr_b16 v[150:151], v100 offset:22528
  ds_read_b64_tr_b16 v[152:153], v101 offset:16384
  ds_read_b64_tr_b16 v[154:155], v101 offset:18432
  ds_read_b64_tr_b16 v[156:157], v101 offset:20480
  ds_read_b64_tr_b16 v[158:159], v101 offset:22528
  s_waitcnt lgkmcnt(0)
  s_barrier
  s_waitcnt vmcnt(31)
  ds_write_b128 v99, a[160:163] offset:0
  s_waitcnt vmcnt(30)
  ds_write_b128 v99, a[164:167] offset:1024
  s_waitcnt vmcnt(29)
  ds_write_b128 v99, a[168:171] offset:2048
  s_waitcnt vmcnt(28)
  ds_write_b128 v99, a[172:175] offset:3072
  s_waitcnt vmcnt(27)
  ds_write_b128 v99, a[176:179] offset:4096
  s_waitcnt vmcnt(26)
  ds_write_b128 v99, a[180:183] offset:5120
  s_waitcnt vmcnt(25)
  ds_write_b128 v99, a[184:187] offset:6144
  s_waitcnt vmcnt(24)
  ds_write_b128 v99, a[188:191] offset:7168
  ds_read_b64_tr_b16 a[160:161], v102 offset:0
  ds_read_b64_tr_b16 a[162:163], v102 offset:1024
  ds_read_b64_tr_b16 a[164:165], v102 offset:2048
  ds_read_b64_tr_b16 a[166:167], v102 offset:3072
  ds_read_b64_tr_b16 a[168:169], v104 offset:0
  ds_read_b64_tr_b16 a[170:171], v104 offset:1024
  ds_read_b64_tr_b16 a[172:173], v104 offset:2048
  s_waitcnt lgkmcnt(14)
  ds_read_b64_tr_b16 a[174:175], v104 offset:3072
  s_waitcnt lgkmcnt(14)
  ds_read_b64_tr_b16 a[176:177], v103 offset:0
  s_waitcnt lgkmcnt(14)
  ds_read_b64_tr_b16 a[178:179], v103 offset:1024
  s_waitcnt lgkmcnt(14)
  ds_read_b64_tr_b16 a[180:181], v103 offset:2048
  s_waitcnt lgkmcnt(14)
  ds_read_b64_tr_b16 a[182:183], v103 offset:3072
  s_waitcnt lgkmcnt(14)
  ds_read_b64_tr_b16 a[184:185], v105 offset:0
  s_waitcnt lgkmcnt(14)
  ds_read_b64_tr_b16 a[186:187], v105 offset:1024
  s_waitcnt lgkmcnt(14)
  ds_read_b64_tr_b16 a[188:189], v105 offset:2048
  s_waitcnt lgkmcnt(14)
  ds_read_b64_tr_b16 a[190:191], v105 offset:3072
  buffer_load_dword v12, off, s[8:11], s75 sc1
  s_add_u32 s28, s75, 4096
  buffer_load_dword v40, off, s[8:11], s28 sc1
  s_waitcnt vmcnt(25)
  s_waitcnt lgkmcnt(14)
  ds_write_b128 v99, a[192:195] offset:0
  s_waitcnt vmcnt(24)
  s_waitcnt lgkmcnt(14)
  ds_write_b128 v99, a[196:199] offset:1024
  s_waitcnt vmcnt(23)
  s_waitcnt lgkmcnt(14)
  ds_write_b128 v99, a[200:203] offset:2048
  s_waitcnt vmcnt(22)
  s_waitcnt lgkmcnt(14)
  ds_write_b128 v99, a[204:207] offset:3072
  s_waitcnt vmcnt(21)
  s_waitcnt lgkmcnt(14)
  ds_write_b128 v99, a[208:211] offset:4096
  s_waitcnt vmcnt(20)
  s_waitcnt lgkmcnt(14)
  ds_write_b128 v99, a[212:215] offset:5120
  s_waitcnt vmcnt(19)
  s_waitcnt lgkmcnt(14)
  ds_write_b128 v99, a[216:219] offset:6144
  s_waitcnt vmcnt(18)
  s_waitcnt lgkmcnt(14)
  ds_write_b128 v99, a[220:223] offset:7168
  s_waitcnt lgkmcnt(14)
  ds_read_b64_tr_b16 a[192:193], v102 offset:0
  s_waitcnt lgkmcnt(14)
  ds_read_b64_tr_b16 a[194:195], v102 offset:1024
  s_waitcnt lgkmcnt(14)
  ds_read_b64_tr_b16 a[196:197], v102 offset:2048
  s_waitcnt lgkmcnt(14)
  ds_read_b64_tr_b16 a[198:199], v102 offset:3072
  s_waitcnt lgkmcnt(14)
  ds_read_b64_tr_b16 a[200:201], v104 offset:0
  s_waitcnt lgkmcnt(14)
  ds_read_b64_tr_b16 a[202:203], v104 offset:1024
  s_waitcnt lgkmcnt(14)
  ds_read_b64_tr_b16 a[204:205], v104 offset:2048
  s_waitcnt lgkmcnt(14)
  ds_read_b64_tr_b16 a[206:207], v104 offset:3072
  s_waitcnt lgkmcnt(14)
  ds_read_b64_tr_b16 a[208:209], v103 offset:0
  s_waitcnt lgkmcnt(14)
  ds_read_b64_tr_b16 a[210:211], v103 offset:1024
  s_waitcnt lgkmcnt(14)
  ds_read_b64_tr_b16 a[212:213], v103 offset:2048
  s_waitcnt lgkmcnt(14)
  ds_read_b64_tr_b16 a[214:215], v103 offset:3072
  s_waitcnt lgkmcnt(14)
  ds_read_b64_tr_b16 a[216:217], v105 offset:0
  s_waitcnt lgkmcnt(14)
  ds_read_b64_tr_b16 a[218:219], v105 offset:1024
  s_waitcnt lgkmcnt(14)
  ds_read_b64_tr_b16 a[220:221], v105 offset:2048
  s_waitcnt lgkmcnt(14)
  ds_read_b64_tr_b16 a[222:223], v105 offset:3072
  s_waitcnt vmcnt(17)
  s_waitcnt lgkmcnt(14)
  ds_write_b128 v99, a[224:227] offset:0
  s_waitcnt vmcnt(16)
  s_waitcnt lgkmcnt(14)
  ds_write_b128 v99, a[228:231] offset:1024
  s_waitcnt vmcnt(15)
  s_waitcnt lgkmcnt(14)
  ds_write_b128 v99, a[232:235] offset:2048
  s_waitcnt vmcnt(14)
  s_waitcnt lgkmcnt(14)
  ds_write_b128 v99, a[236:239] offset:3072
  s_waitcnt vmcnt(13)
  s_waitcnt lgkmcnt(14)
  ds_write_b128 v99, a[240:243] offset:4096
  s_waitcnt vmcnt(12)
  s_waitcnt lgkmcnt(14)
  ds_write_b128 v99, a[244:247] offset:5120
  s_waitcnt vmcnt(11)
  s_waitcnt lgkmcnt(14)
  ds_write_b128 v99, a[248:251] offset:6144
  s_waitcnt vmcnt(10)
  s_waitcnt lgkmcnt(14)
  ds_write_b128 v99, a[252:255] offset:7168
  s_waitcnt lgkmcnt(14)
  ds_read_b64_tr_b16 a[224:225], v102 offset:0
  s_waitcnt lgkmcnt(14)
  ds_read_b64_tr_b16 a[226:227], v102 offset:1024
  s_waitcnt lgkmcnt(14)
  ds_read_b64_tr_b16 a[228:229], v102 offset:2048
  s_waitcnt lgkmcnt(14)
  ds_read_b64_tr_b16 a[230:231], v102 offset:3072
  s_waitcnt lgkmcnt(14)
  ds_read_b64_tr_b16 a[232:233], v104 offset:0
  s_waitcnt lgkmcnt(14)
  ds_read_b64_tr_b16 a[234:235], v104 offset:1024
  s_waitcnt lgkmcnt(14)
  ds_read_b64_tr_b16 a[236:237], v104 offset:2048
  s_waitcnt lgkmcnt(14)
  ds_read_b64_tr_b16 a[238:239], v104 offset:3072
  s_waitcnt lgkmcnt(14)
  ds_read_b64_tr_b16 a[240:241], v103 offset:0
  s_waitcnt lgkmcnt(14)
  ds_read_b64_tr_b16 a[242:243], v103 offset:1024
  s_waitcnt lgkmcnt(14)
  ds_read_b64_tr_b16 a[244:245], v103 offset:2048
  s_waitcnt lgkmcnt(14)
  ds_read_b64_tr_b16 a[246:247], v103 offset:3072
  s_waitcnt lgkmcnt(14)
  ds_read_b64_tr_b16 a[248:249], v105 offset:0
  s_waitcnt lgkmcnt(14)
  ds_read_b64_tr_b16 a[250:251], v105 offset:1024
  s_waitcnt lgkmcnt(14)
  ds_read_b64_tr_b16 a[252:253], v105 offset:2048
  s_waitcnt lgkmcnt(14)
  ds_read_b64_tr_b16 a[254:255], v105 offset:3072
  s_waitcnt vmcnt(1)
  v_cmp_gt_u32 vcc, s70, v12
  s_mov_b32 m0, s90
  s_cbranch_vccnz L_cps_24
L_cpb_25:
  buffer_load_dwordx4 v41, s[8:11], s63 offen offset:0 sc1 lds
  buffer_load_dwordx4 v41, s[8:11], s63 offen offset:1024 sc1 lds
  buffer_load_dwordx4 v[108:111], v41, s[8:11], s64 offen offset:0 sc1
  buffer_load_dwordx4 v[112:115], v41, s[8:11], s64 offen offset:1024 sc1
  s_waitcnt lgkmcnt(14)
  ds_write_b128 v99, v[64:67] offset:0
  s_waitcnt lgkmcnt(14)
  ds_write_b128 v99, v[68:71] offset:1024
  s_waitcnt lgkmcnt(14)
  ds_write_b128 v99, v[72:75] offset:2048
  s_waitcnt lgkmcnt(14)
  ds_write_b128 v99, v[76:79] offset:3072
  s_waitcnt lgkmcnt(14)
  ds_write_b128 v99, v[80:83] offset:4096
  s_waitcnt lgkmcnt(14)
  ds_write_b128 v99, v[84:87] offset:5120
  s_waitcnt lgkmcnt(14)
  ds_write_b128 v99, v[88:91] offset:6144
  s_waitcnt lgkmcnt(14)
  ds_write_b128 v99, v[92:95] offset:7168
  s_waitcnt lgkmcnt(14)
  ds_read_b64_tr_b16 v[64:65], v102 offset:0
  s_waitcnt lgkmcnt(14)
  ds_read_b64_tr_b16 v[66:67], v102 offset:1024
  s_waitcnt lgkmcnt(14)
  ds_read_b64_tr_b16 v[68:69], v102 offset:2048
  s_waitcnt lgkmcnt(14)
  ds_read_b64_tr_b16 v[70:71], v102 offset:3072
  s_waitcnt lgkmcnt(14)
  ds_read_b64_tr_b16 v[72:73], v104 offset:0
  s_waitcnt lgkmcnt(14)
  ds_read_b64_tr_b16 v[74:75], v104 offset:1024
  s_waitcnt lgkmcnt(14)
  ds_read_b64_tr_b16 v[76:77], v104 offset:2048
  s_waitcnt lgkmcnt(14)
  ds_read_b64_tr_b16 v[78:79], v104 offset:3072
  s_waitcnt lgkmcnt(14)
  ds_read_b64_tr_b16 v[80:81], v103 offset:0
  s_waitcnt lgkmcnt(14)
  ds_read_b64_tr_b16 v[82:83], v103 offset:1024
  s_waitcnt lgkmcnt(14)
  ds_read_b64_tr_b16 v[84:85], v103 offset:2048
  s_waitcnt lgkmcnt(14)
  ds_read_b64_tr_b16 v[86:87], v103 offset:3072
  s_waitcnt lgkmcnt(14)
  ds_read_b64_tr_b16 v[88:89], v105 offset:0
  s_waitcnt lgkmcnt(14)
  ds_read_b64_tr_b16 v[90:91], v105 offset:1024
  s_waitcnt lgkmcnt(14)
  ds_read_b64_tr_b16 v[92:93], v105 offset:2048
  s_waitcnt lgkmcnt(14)
  ds_read_b64_tr_b16 v[94:95], v105 offset:3072
  s_waitcnt lgkmcnt(14)
  ds_write_b128 v6, v[64:67] offset:24576
  s_waitcnt lgkmcnt(13)
  ds_write_b128 v6, v[68:71] offset:25600
  s_waitcnt lgkmcnt(12)
  ds_write_b128 v6, v[72:75] offset:26624
  s_waitcnt lgkmcnt(11)
  ds_write_b128 v6, v[76:79] offset:27648
  s_waitcnt lgkmcnt(10)
  ds_write_b128 v6, v[80:83] offset:28672
  s_waitcnt lgkmcnt(9)
  ds_write_b128 v6, v[84:87] offset:29696
  s_waitcnt lgkmcnt(8)
  ds_write_b128 v6, v[88:91] offset:30720
  s_waitcnt lgkmcnt(7)
  ds_write_b128 v6, v[92:95] offset:31744
  s_waitcnt lgkmcnt(0)
L_wj_5:
  s_barrier
  v_bfe_u32 v22, v0, 2, 1
  v_lshlrev_b32 v22, 4, v22
  s_mov_b32 s28, 0x3f80
  v_lshlrev_b32 v24, v22, s28
  s_mov_b32 s80, 0x11111111
  s_mov_b32 s81, 0x11111111
  s_mov_b32 s82, 0x22222222
  s_mov_b32 s83, 0x22222222
  s_mov_b32 s84, 0x11111111
  s_mov_b32 s85, 0x11111111
  s_mov_b32 s86, 0x22222222
  s_mov_b32 s87, 0x22222222
  v_cndmask_b32 v28, 0, v24, s[80:81]
  v_cndmask_b32 v29, 0, v24, s[82:83]
  v_cndmask_b32 v30, 0, v24, s[84:85]
  v_cndmask_b32 v31, 0, v24, s[86:87]
  v_lshlrev_b32 v22, 4, v0
  ds_write_b128 v22, v[28:31] offset:28672
  s_cmp_lg_u32 s93, 0
  s_cbranch_scc1 L_chain_slow
  v_lshlrev_b32 v0, 4, v0
  s_add_u32 s75, s75, 4096
  s_waitcnt vmcnt(4)
  v_cmp_gt_u32 vcc, s70, v40
  s_cbranch_vccz L_pk1_26
  s_mov_b32 s34, 0
  s_mov_b32 s35, 2
L_pk_27:
  buffer_load_dword v12, off, s[8:11], s75 sc1
  s_add_u32 s34, s34, 1
  s_cmp_gt_u32 s34, 40000
  s_cbranch_scc1 L_fail
  s_waitcnt vmcnt(0)
  v_cmp_gt_u32 vcc, s70, v12
  s_cbranch_vccnz L_pk_27
L_pk1_26:
  s_add_u32 s69, s75, 4096
  s_mov_b32 s71, 2
  s_mov_b32 s72, 1
  s_add_u32 s63, s63, 0x100000
  s_add_u32 s64, s64, 0x100000
  ds_read_b128 v[16:19], v6 offset:0
  ds_read_b128 v[20:23], v6 offset:1024
  ds_read_b128 v[24:27], v6 offset:4096
  ds_read_b128 v[28:31], v6 offset:5120
  ds_read_b128 v[32:35], v6 offset:8192
  ds_read_b128 v[36:39], v6 offset:9216
  ds_read_b128 v[40:43], v6 offset:12288
  ds_read_b128 v[44:47], v6 offset:13312
  ds_read_b128 v[76:79], v6 offset:2048
  ds_read_b128 v[80:83], v6 offset:3072
  ds_read_b128 v[84:87], v6 offset:6144
  ds_read_b128 v[88:91], v6 offset:7168
  ds_read_b128 v[92:95], v6 offset:10240
  ds_read_b128 v[96:99], v6 offset:11264
  s_waitcnt lgkmcnt(14)
  ds_read_b128 v[100:103], v6 offset:14336
  s_waitcnt lgkmcnt(14)
  ds_read_b128 v[104:107], v6 offset:15360
  v_mov_b64 v[64:65], 0
  v_mov_b64 v[66:67], 0
  v_mov_b64 v[68:69], 0
  v_mov_b64 v[70:71], 0
  v_mov_b64 v[72:73], 0
  v_mov_b64 v[74:75], 0
  v_mov_b32 v15, -1
  s_mov_b32 m0, s91
  s_mov_b32 s34, 0
  s_mov_b32 s35, 5
  s_waitcnt vmcnt(0) lgkmcnt(0)
  s_waitcnt vmcnt(0)
  s_branch L_cf_loop
.p2align 6
L_cf_loop:
L_st_28:
  v_smfmac_f32_16x16x64_bf16 v[64:67], v[48:51], v[16:23], v1
  v_bitop3_b32 v14, v48, v52, 1 bitop3:0x80
  v_cmp_eq_u32 vcc, 0, v14
  v_smfmac_f32_16x16x64_bf16 v[68:71], v[48:51], v[24:31], v1
  v_mov_b32_dpp v56, v48 row_ror:8 row_mask:0xf bank_mask:0xf
  v_smfmac_f32_16x16x64_bf16 v[72:75], v[48:51], v[32:39], v1
  s_cbranch_vccnz L_rtA_30
  ds_write_b128 v7, v[48:51]
  v_mov_b32_dpp v57, v49 row_ror:8 row_mask:0xf bank_mask:0xf
  v_smfmac_f32_16x16x64_bf16 v[64:67], v[52:55], v[40:47], v1
  v_mov_b32_dpp v58, v50 row_ror:8 row_mask:0xf bank_mask:0xf
  v_smfmac_f32_16x16x64_bf16 v[68:71], v[52:55], v[128:135], v1
  ds_write_b128 v7, v[52:55] offset:1024
  v_mov_b32_dpp v59, v51 row_ror:8 row_mask:0xf bank_mask:0xf
  v_mov_b32_dpp v60, v52 row_ror:8 row_mask:0xf bank_mask:0xf
  v_smfmac_f32_16x16x64_bf16 v[72:75], v[52:55], v[144:151], v1
  v_mov_b32_dpp v61, v53 row_ror:8 row_mask:0xf bank_mask:0xf
  v_smfmac_f32_16x16x64_bf16 v[64:67], v[56:59], v[76:83], v1
  buffer_load_dwordx4 v0, s[8:11], s63 offen offset:0 sc1 lds
  v_mov_b32_dpp v62, v54 row_ror:8 row_mask:0xf bank_mask:0xf
  v_smfmac_f32_16x16x64_bf16 v[68:71], v[56:59], v[84:91], v1
  buffer_store_dwordx4 v[124:127], v0, s[8:11], s65 offen sc1
  v_mov_b32_dpp v63, v55 row_ror:8 row_mask:0xf bank_mask:0xf
L_cm_29:
  v_smfmac_f32_16x16x64_bf16 v[72:75], v[56:59], v[92:99], v1
  s_waitcnt lgkmcnt(0)
  s_barrier
  ds_read_b128 v[16:19], v8 offset:0
  v_smfmac_f32_16x16x64_bf16 v[64:67], v[60:63], v[100:107], v1
  ds_read_b128 v[20:23], v8 offset:1024
  v_smfmac_f32_16x16x64_bf16 v[68:71], v[60:63], v[136:143], v1
  ds_read_b128 v[24:27], v9 offset:0
  buffer_load_dwordx4 v[120:123], v0, s[8:11], s64 offen offset:1024 sc1
  v_smfmac_f32_16x16x64_bf16 v[72:75], v[60:63], v[152:159], v1
  s_waitcnt lgkmcnt(2)
  ds_read_b128 v[28:31], v9 offset:1024
  v_smfmac_f32_16x16x64_bf16 v[64:67], v[16:19], v[160:167], v1
  ds_read_b128 v[32:35], v10 offset:0
  v_mov_b32_dpp v40, v16 row_ror:8 row_mask:0xf bank_mask:0xf
  v_smfmac_f32_16x16x64_bf16 v[68:71], v[16:19], v[176:183], v1
  s_waitcnt lgkmcnt(3)
  ds_read_b128 v[36:39], v10 offset:1024
  v_mov_b32_dpp v41, v17 row_ror:8 row_mask:0xf bank_mask:0xf
  v_smfmac_f32_16x16x64_bf16 v[64:67], v[20:23], v[208:215], v1
  ds_read_b128 v[56:59], v11 offset:0
  v_mov_b32_dpp v42, v18 row_ror:8 row_mask:0xf bank_mask:0xf
  v_smfmac_f32_16x16x64_bf16 v[68:71], v[20:23], v[224:231], v1
  s_waitcnt lgkmcnt(4)
  ds_read_b128 v[60:63], v11 offset:1024
  v_mov_b32_dpp v43, v19 row_ror:8 row_mask:0xf bank_mask:0xf
  v_smfmac_f32_16x16x64_bf16 v[64:67], v[24:27], a[0:7], v1
  ds_read_b128 v[76:79], v6 offset:16384
  v_mov_b32_dpp v44, v20 row_ror:8 row_mask:0xf bank_mask:0xf
  v_smfmac_f32_16x16x64_bf16 v[68:71], v[24:27], a[16:23], v1
  ds_read_b128 v[80:83], v6 offset:17408
  v_mov_b32_dpp v45, v21 row_ror:8 row_mask:0xf bank_mask:0xf
  v_smfmac_f32_16x16x64_bf16 v[64:67], v[40:43], v[168:175], v1
  ds_read_b128 v[84:87], v6 offset:18432
  v_mov_b32_dpp v46, v22 row_ror:8 row_mask:0xf bank_mask:0xf
  v_smfmac_f32_16x16x64_bf16 v[68:71], v[40:43], v[184:191], v1
  s_waitcnt lgkmcnt(7)
  v_mov_b32_dpp v47, v23 row_ror:8 row_mask:0xf bank_mask:0xf
  v_smfmac_f32_16x16x64_bf16 v[64:67], v[28:31], a[48:55], v1
  s_waitcnt vmcnt(3)
  ds_read_b128 v[88:91], v6 offset:19456
  v_mov_b32_dpp v48, v24 row_ror:8 row_mask:0xf bank_mask:0xf
  v_smfmac_f32_16x16x64_bf16 v[68:71], v[28:31], a[64:71], v1
  ds_read_b128 v[92:95], v6 offset:20480
  v_mov_b32_dpp v49, v25 row_ror:8 row_mask:0xf bank_mask:0xf
  v_smfmac_f32_16x16x64_bf16 v[64:67], v[44:47], v[216:223], v1
  ds_read_b128 v[96:99], v6 offset:21504
  v_mov_b32_dpp v50, v26 row_ror:8 row_mask:0xf bank_mask:0xf
  v_smfmac_f32_16x16x64_bf16 v[68:71], v[44:47], v[232:239], v1
  s_waitcnt lgkmcnt(4)
  v_mov_b32_dpp v51, v27 row_ror:8 row_mask:0xf bank_mask:0xf
  v_smfmac_f32_16x16x64_bf16 v[64:67], v[32:35], v[76:83], v1
  ds_read_b128 v[100:103], v6 offset:22528
  v_mov_b32_dpp v52, v28 row_ror:8 row_mask:0xf bank_mask:0xf
  v_smfmac_f32_16x16x64_bf16 v[68:71], v[32:35], a[96:103], v1
  s_waitcnt lgkmcnt(3)
  ds_read_b128 v[104:107], v6 offset:23552
  v_mov_b32_dpp v53, v29 row_ror:8 row_mask:0xf bank_mask:0xf
  v_smfmac_f32_16x16x64_bf16 v[64:67], v[56:59], v[84:91], v1
  v_mov_b32_dpp v54, v30 row_ror:8 row_mask:0xf bank_mask:0xf
  v_smfmac_f32_16x16x64_bf16 v[68:71], v[56:59], a[104:111], v1
  s_waitcnt lgkmcnt(2)
  v_mov_b32_dpp v55, v31 row_ror:8 row_mask:0xf bank_mask:0xf
  v_smfmac_f32_16x16x64_bf16 v[64:67], v[36:39], v[92:99], v1
  ds_read_b128 v[76:79], v0 offset:12288
  v_smfmac_f32_16x16x64_bf16 v[68:71], v[36:39], a[128:135], v1
  s_waitcnt lgkmcnt(1)
  buffer_load_dwordx4 v0, s[8:11], s63 offen offset:1024 sc1 lds
  ds_read_b128 v[80:83], v0 offset:16384
  v_smfmac_f32_16x16x64_bf16 v[64:67], v[60:63], v[100:107], v1
  ds_read_b128 v[84:87], v0 offset:13312
  v_mov_b64 v[124:125], s[88:89]
  v_smfmac_f32_16x16x64_bf16 v[68:71], v[60:63], a[136:143], v1
  ds_read_b128 v[88:91], v0 offset:17408
  v_mov_b64 v[126:127], s[88:89]
  v_smfmac_f32_16x16x64_bf16 v[64:67], v[48:51], a[8:15], v1
  ds_read_b128 v[92:95], v0 offset:14336
  v_smfmac_f32_16x16x64_bf16 v[64:67], v[52:55], a[56:63], v1
  ds_read_b128 v[96:99], v0 offset:18432
  v_smfmac_f32_16x16x64_bf16 v[68:71], v[48:51], a[24:31], v1
  ds_read_b128 v[100:103], v0 offset:15360
  v_smfmac_f32_16x16x64_bf16 v[68:71], v[52:55], a[72:79], v1
  ds_read_b128 v[104:107], v0 offset:19456
  v_cvt_pk_bf16_f32 v64, v64, v65
  v_cvt_pk_bf16_f32 v65, v66, v67
  v_smfmac_f32_16x16x64_bf16 v[72:75], v[16:19], v[192:199], v1
  ds_write_b64 v4, v[64:65] offset:8192
  v_smfmac_f32_16x16x64_bf16 v[72:75], v[20:23], v[240:247], v1
  v_cvt_pk_bf16_f32 v68, v68, v69
  v_cvt_pk_bf16_f32 v69, v70, v71
  v_smfmac_f32_16x16x64_bf16 v[72:75], v[24:27], a[32:39], v1
  ds_write_b64 v4, v[68:69] offset:29696
  v_smfmac_f32_16x16x64_bf16 v[72:75], v[28:31], a[80:87], v1
  v_smfmac_f32_16x16x64_bf16 v[72:75], v[32:35], a[112:119], v1
  v_smfmac_f32_16x16x64_bf16 v[72:75], v[36:39], a[144:151], v1
  buffer_load_dword v12, off, s[8:11], s69 sc1
  v_smfmac_f32_16x16x64_bf16 v[72:75], v[40:43], v[200:207], v1
  s_waitcnt lgkmcnt(0)
  s_barrier
  ds_read_b64_tr_b16 v[16:17], v5 offset:8192
  ds_read_b64_tr_b16 v[18:19], v5 offset:8512
  v_smfmac_f32_16x16x64_bf16 v[72:75], v[44:47], v[248:255], v1
  ds_read_b64_tr_b16 v[20:21], v5 offset:8832
  v_or_b32 v68, 1, v68
  v_smfmac_f32_16x16x64_bf16 v[72:75], v[48:51], a[40:47], v1
  ds_read_b64_tr_b16 v[22:23], v5 offset:9152
  v_smfmac_f32_16x16x64_bf16 v[72:75], v[52:55], a[88:95], v1
  ds_read_b64_tr_b16 v[32:33], v13 offset:29696
  v_smfmac_f32_16x16x64_bf16 v[72:75], v[56:59], a[120:127], v1
  buffer_load_dwordx4 v[116:119], v0, s[8:11], s64 offen offset:0 sc1
  ds_read_b64_tr_b16 v[34:35], v13 offset:29760
  v_smfmac_f32_16x16x64_bf16 v[72:75], v[60:63], a[152:159], v1
  s_waitcnt lgkmcnt(4)
  ds_read_b64_tr_b16 v[24:25], v5 offset:9472
  ds_read_b64_tr_b16 v[26:27], v5 offset:9792
  v_mfma_f32_16x16x32_bf16 v[64:67], v[76:79], v[16:19], 0
  ds_read_b64_tr_b16 v[28:29], v5 offset:10112
  v_mov_b64 v[44:45], 0
  v_mfma_f32_16x16x32_bf16 v[48:51], v[80:83], v[16:19], 0
  s_waitcnt lgkmcnt(5)
  ds_read_b64_tr_b16 v[30:31], v5 offset:10432
  v_mov_b64 v[46:47], 0
  v_mfma_f32_16x16x32_bf16 v[64:67], v[84:87], v[20:23], v[64:67]
  s_waitcnt lgkmcnt(4)
  ds_read_b64_tr_b16 v[36:37], v13 offset:30976
  v_cvt_pk_bf16_f32 v71, v74, v75
  v_smfmac_f32_16x16x64_bf16 v[44:47], v[32:35], v[16:23], v1
  ds_read_b64_tr_b16 v[38:39], v13 offset:31040
  v_cvt_pk_bf16_f32 v70, v72, v73
  v_mfma_f32_16x16x32_bf16 v[48:51], v[88:91], v[20:23], v[48:51]
  s_waitcnt lgkmcnt(4)
  ds_read_b128 v[76:79], v6 offset:24576
  v_mov_b64 v[56:57], 0
  v_mfma_f32_16x16x32_bf16 v[64:67], v[92:95], v[24:27], v[64:67]
  ds_read_b128 v[84:87], v6 offset:26624
  v_mfma_f32_16x16x32_bf16 v[48:51], v[96:99], v[24:27], v[48:51]
  s_waitcnt lgkmcnt(2)
  ds_read_b128 v[88:91], v6 offset:27648
  v_smfmac_f32_16x16x64_bf16 v[44:47], v[36:39], v[24:31], v1
  v_mov_b64 v[52:53], 0
  v_mfma_f32_16x16x32_bf16 v[64:67], v[100:103], v[28:31], v[64:67]
  v_mov_b64 v[60:61], 0
  v_mfma_f32_16x16x32_bf16 v[48:51], v[104:107], v[28:31], v[48:51]
  ds_read_b128 v[92:95], v6 offset:28672
  ds_read_b128 v[104:107], v6 offset:31744
  v_permlane32_swap_b32 v44, v46
  v_permlane32_swap_b32 v45, v47
  v_pk_add_f32 v[44:45], v[44:45], v[46:47]
  v_max_f32_e64 v14, v44, v45
  v_max3_f32 v14, v14, v64, v65
  v_max3_f32 v14, v14, v66, v67
  v_max3_f32 v14, v14, v48, v49
  v_max3_f32 v14, v14, v50, v51
  v_mov_b32_e64 v15, v14
  v_mov_b32_e64 v22, 0
  v_mov_b64 v[28:29], 0
  v_permlane32_swap_b32 v14, v15
  v_max_f32_e64 v14, v14, v15
  v_mov_b32 v15, v14
  v_mov_b64 v[62:63], 0
  v_mov_b32 v21, 0
  v_permlane16_swap_b32 v14, v15
  v_max_f32 v14, v14, v15
  v_mul_f32 v14, -s78, v14
  v_pk_fma_f32 v[44:45], v[44:45], s[78:79], v[14:15] op_sel_hi:[1,1,0]
  v_exp_f32 v44, v44
  v_exp_f32 v45, v45
  v_pk_fma_f32 v[64:65], v[64:65], s[78:79], v[14:15] op_sel_hi:[1,1,0]
  v_cvt_pk_bf16_f32 v20, v44, v45
  v_cvt_pk_bf16_f32 v23, v44, v45
  v_pk_fma_f32 v[66:67], v[66:67], s[78:79], v[14:15] op_sel_hi:[1,1,0]
  v_pk_fma_f32 v[48:49], v[48:49], s[78:79], v[14:15] op_sel_hi:[1,1,0]
  v_permlane32_swap_b32 v20, v21
  v_permlane32_swap_b32 v22, v23
  v_pk_fma_f32 v[50:51], v[50:51], s[78:79], v[14:15] op_sel_hi:[1,1,0]
  v_exp_f32 v64, v64
  v_mfma_f32_16x16x16_bf16 v[40:43], v[124:125], v[20:21], 0
  v_exp_f32 v65, v65
  v_exp_f32 v66, v66
  v_mfma_f32_16x16x16_bf16 v[32:35], v[70:71], v[20:21], 0
  v_exp_f32 v67, v67
  v_exp_f32 v48, v48
  v_mfma_f32_16x16x16_bf16 v[36:39], v[70:71], v[22:23], 0
  v_exp_f32 v49, v49
  v_cvt_pk_bf16_f32 v16, v64, v65
  v_exp_f32 v50, v50
  v_cvt_pk_bf16_f32 v17, v66, v67
  v_exp_f32 v51, v51
  v_cvt_pk_bf16_f32 v18, v48, v49
  v_cvt_pk_bf16_f32 v19, v50, v51
  v_mov_b64 v[54:55], 0
  s_nop 0
  v_mfma_f32_16x16x32_bf16 v[40:43], v[124:127], v[16:19], v[40:43]
  ds_read_b128 v[80:83], v6 offset:25600
  v_mov_b64 v[58:59], 0
  v_mfma_f32_16x16x32_bf16 v[32:35], v[108:111], v[16:19], v[32:35]
  v_mfma_f32_16x16x32_bf16 v[36:39], v[112:115], v[16:19], v[36:39]
  ds_read_b128 v[100:103], v6 offset:30720
  v_rcp_f32 v14, v40
  v_mov_b64 v[126:127], v[70:71]
  s_nop 0
  v_pk_mul_f32 v[32:33], v[32:33], v[14:15] op_sel_hi:[1,0]
  v_pk_mul_f32 v[34:35], v[34:35], v[14:15] op_sel_hi:[1,0]
  v_cvt_pk_bf16_f32 v24, v32, v33
  v_cvt_pk_bf16_f32 v25, v34, v35
  v_pk_mul_f32 v[36:37], v[36:37], v[14:15] op_sel_hi:[1,0]
  v_pk_mul_f32 v[38:39], v[38:39], v[14:15] op_sel_hi:[1,0]
  v_cvt_pk_bf16_f32 v26, v36, v37
  v_cvt_pk_bf16_f32 v27, v38, v39
  ds_write_b128 v7, v[24:27]
  v_mov_b64 v[30:31], 0
  v_smfmac_f32_16x16x64_bf16 v[52:55], v[24:27], a[160:167], v1
  v_smfmac_f32_16x16x64_bf16 v[56:59], v[24:27], a[176:183], v1
  ds_read_b128 v[96:99], v6 offset:29696
  v_smfmac_f32_16x16x64_bf16 v[60:63], v[24:27], a[192:199], v1
  s_waitcnt lgkmcnt(1)
  s_barrier
  ds_read_b128 v[16:19], v8
  ds_read_b128 v[20:23], v9
  ds_read_b128 v[44:47], v10
  v_mov_b64 v[124:125], v[68:69]
  v_smfmac_f32_16x16x64_bf16 v[28:31], v[24:27], a[208:215], v1
  s_waitcnt lgkmcnt(2)
  v_smfmac_f32_16x16x64_bf16 v[52:55], v[16:19], a[168:175], v1
  s_waitcnt lgkmcnt(1)
  v_smfmac_f32_16x16x64_bf16 v[52:55], v[20:23], v[76:83], v1
  s_waitcnt lgkmcnt(0)
  v_smfmac_f32_16x16x64_bf16 v[52:55], v[44:47], v[84:91], v1
  v_smfmac_f32_16x16x64_bf16 v[56:59], v[16:19], a[184:191], v1
  v_smfmac_f32_16x16x64_bf16 v[56:59], v[20:23], v[92:99], v1
  v_cvt_pk_bf16_f32 v64, v52, v53
  v_smfmac_f32_16x16x64_bf16 v[56:59], v[44:47], v[100:107], v1
  v_and_b32 v64, -2, v64
  v_smfmac_f32_16x16x64_bf16 v[60:63], v[16:19], a[200:207], v1
  v_cvt_pk_bf16_f32 v65, v54, v55
  v_smfmac_f32_16x16x64_bf16 v[28:31], v[16:19], a[216:223], v1
  v_cvt_pk_bf16_f32 v66, v56, v57
  v_smfmac_f32_16x16x64_bf16 v[60:63], v[20:23], a[224:231], v1
  v_cvt_pk_bf16_f32 v67, v58, v59
  v_smfmac_f32_16x16x64_bf16 v[60:63], v[44:47], a[232:239], v1
  buffer_store_dwordx4 v[64:67], v2, s[8:11], 0 offen
  v_smfmac_f32_16x16x64_bf16 v[28:31], v[20:23], a[240:247], v1
  v_smfmac_f32_16x16x64_bf16 v[28:31], v[44:47], a[248:255], v1
  v_cvt_pk_bf16_f32 v72, v60, v61
  v_and_b32 v72, -2, v72
  v_cvt_pk_bf16_f32 v73, v62, v63
  s_nop 4
  v_cvt_pk_bf16_f32 v74, v28, v29
  v_cvt_pk_bf16_f32 v75, v30, v31
  buffer_store_dwordx4 v[72:75], v2, s[8:11], s74 offen
  ds_read_b128 v[56:59], v0 offset:28672
  ds_read_b128 v[16:19], v6 offset:0
  ds_read_b128 v[20:23], v6 offset:1024
  ds_read_b128 v[24:27], v6 offset:4096
  ds_read_b128 v[28:31], v6 offset:5120
  ds_read_b128 v[32:35], v6 offset:8192
  ds_read_b128 v[36:39], v6 offset:9216
  ds_read_b128 v[40:43], v6 offset:12288
  ds_read_b128 v[44:47], v6 offset:13312
  v_mov_b64 v[64:65], 0
  v_mov_b64 v[66:67], 0
  v_mov_b64 v[68:69], 0
  v_mov_b64 v[70:71], 0
  v_mov_b64 v[72:73], 0
  v_mov_b64 v[74:75], 0
  s_mov_b32 s75, s69
  s_mov_b32 s70, s72
  s_add_u32 s71, s71, 1
  s_add_u32 s69, s69, 4096
  s_cmp_eq_u32 s71, 7
  s_cselect_b32 s28, 7, 0
  s_cselect_b32 s29, 1, 0
  s_sub_u32 s71, s71, s28
  s_add_u32 s72, s72, s29
  s_lshl_b32 s28, s28, 12
  s_sub_u32 s69, s69, s28
  s_add_u32 s63, s63, 0x100000
  s_add_u32 s64, s64, 0x100000
  s_add_u32 s65, s65, 0x100000
  s_add_u32 s62, s62, 1
  v_mov_b64 v[60:61], 0
  s_nop 15
  s_nop 3
  s_waitcnt lgkmcnt(0)
  s_mov_b32 s34, 0
  s_mov_b32 s35, 4
  buffer_load_dwordx4 v[48:51], v0, s[8:11], s73 offen offset:0 sc1
  buffer_load_dwordx4 v[52:55], v0, s[8:11], s73 offen offset:1024 sc1
  s_nop 15
  s_nop 15
  s_nop 7
  buffer_load_dwordx4 v[108:111], v0, s[8:11], s73 offen offset:0 sc1
  buffer_load_dwordx4 v[112:115], v0, s[8:11], s73 offen offset:1024 sc1
L_p1_37:
  s_waitcnt vmcnt(2)
  v_smfmac_f32_16x16x64_bf16 v[60:63], v[56:59], v[48:55], v1
  v_bitop3_b32 v14, v48, v52, 1 bitop3:0xa8
  v_cmp_ne_u32 vcc, 0, v14
  s_cbranch_vccnz L_p1o_38
L_p1d_39:
  s_nop 4
  v_add_f32_dpp v60, v60, v60 row_ror:8 row_mask:0xf bank_mask:0xf
  v_add_f32_dpp v61, v61, v61 row_ror:8 row_mask:0xf bank_mask:0xf
  s_nop 0
  v_add_f32_dpp v60, v60, v60 row_ror:4 row_mask:0xf bank_mask:0xf
  v_add_f32_dpp v61, v61, v61 row_ror:4 row_mask:0xf bank_mask:0xf
  v_cvt_pk_bf16_f32 v60, v60, v61
  v_and_b32_sdwa v60, v60, sext(v1) dst_sel:DWORD dst_unused:UNUSED_PAD src0_sel:DWORD src1_sel:BYTE_3
  buffer_store_dword v60, v3, s[8:11], s67 offen
  v_cmp_gt_u32 vcc, s70, v12
  s_cbranch_vccnz L_pks_35
L_pkb_36:
  ds_read_b128 v[76:79], v6 offset:2048
  ds_read_b128 v[80:83], v6 offset:3072
  ds_read_b128 v[84:87], v6 offset:6144
  ds_read_b128 v[88:91], v6 offset:7168
  ds_read_b128 v[92:95], v6 offset:10240
  ds_read_b128 v[96:99], v6 offset:11264
  ds_read_b128 v[100:103], v6 offset:14336
  ds_read_b128 v[104:107], v6 offset:15360
  s_mov_b32 m0, s90
  s_barrier
  s_nop 3
  s_mov_b32 s34, 0
  s_mov_b32 s35, 5
  buffer_load_dwordx4 v[48:51], v0, s[8:11], s66 offen offset:0 sc1
  buffer_load_dwordx4 v[52:55], v0, s[8:11], s66 offen offset:1024 sc1
  s_nop 15
  s_nop 15
  s_nop 3
  buffer_load_dwordx4 v[108:111], v0, s[8:11], s66 offen offset:0 sc1
  buffer_load_dwordx4 v[112:115], v0, s[8:11], s66 offen offset:1024 sc1
  s_waitcnt vmcnt(2) lgkmcnt(0)
  s_cmp_eq_u32 s62, 63
  s_cbranch_scc1 L_cf_fin
L_st_40:
  v_smfmac_f32_16x16x64_bf16 v[64:67], v[48:51], v[16:23], v1
  v_bitop3_b32 v14, v48, v52, 1 bitop3:0xa8
  v_cmp_ne_u32 vcc, 0, v14
  v_smfmac_f32_16x16x64_bf16 v[68:71], v[48:51], v[24:31], v1
  v_mov_b32_dpp v56, v48 row_ror:8 row_mask:0xf bank_mask:0xf
  v_smfmac_f32_16x16x64_bf16 v[72:75], v[48:51], v[32:39], v1
  s_cbranch_vccnz L_rtA_42
  ds_write_b128 v7, v[48:51]
  v_mov_b32_dpp v57, v49 row_ror:8 row_mask:0xf bank_mask:0xf
  v_smfmac_f32_16x16x64_bf16 v[64:67], v[52:55], v[40:47], v1
  v_mov_b32_dpp v58, v50 row_ror:8 row_mask:0xf bank_mask:0xf
  v_smfmac_f32_16x16x64_bf16 v[68:71], v[52:55], v[128:135], v1
  ds_write_b128 v7, v[52:55] offset:1024
  v_mov_b32_dpp v59, v51 row_ror:8 row_mask:0xf bank_mask:0xf
  v_mov_b32_dpp v60, v52 row_ror:8 row_mask:0xf bank_mask:0xf
  v_smfmac_f32_16x16x64_bf16 v[72:75], v[52:55], v[144:151], v1
  v_mov_b32_dpp v61, v53 row_ror:8 row_mask:0xf bank_mask:0xf
  v_smfmac_f32_16x16x64_bf16 v[64:67], v[56:59], v[76:83], v1
  buffer_load_dwordx4 v0, s[8:11], s63 offen offset:0 sc1 lds
  v_mov_b32_dpp v62, v54 row_ror:8 row_mask:0xf bank_mask:0xf
  v_smfmac_f32_16x16x64_bf16 v[68:71], v[56:59], v[84:91], v1
  buffer_store_dwordx4 v[124:127], v0, s[8:11], s65 offen sc1
  v_mov_b32_dpp v63, v55 row_ror:8 row_mask:0xf bank_mask:0xf
L_cm_41:
  v_smfmac_f32_16x16x64_bf16 v[72:75], v[56:59], v[92:99], v1
  s_waitcnt lgkmcnt(0)
  s_barrier
  ds_read_b128 v[16:19], v8 offset:0
  v_smfmac_f32_16x16x64_bf16 v[64:67], v[60:63], v[100:107], v1
  ds_read_b128 v[20:23], v8 offset:1024
  v_smfmac_f32_16x16x64_bf16 v[68:71], v[60:63], v[136:143], v1
  ds_read_b128 v[24:27], v9 offset:0
  buffer_load_dwordx4 v[112:115], v0, s[8:11], s64 offen offset:1024 sc1
  v_smfmac_f32_16x16x64_bf16 v[72:75], v[60:63], v[152:159], v1
  s_waitcnt lgkmcnt(2)
  ds_read_b128 v[28:31], v9 offset:1024
  v_smfmac_f32_16x16x64_bf16 v[64:67], v[16:19], v[160:167], v1
  ds_read_b128 v[32:35], v10 offset:0
  v_mov_b32_dpp v40, v16 row_ror:8 row_mask:0xf bank_mask:0xf
  v_smfmac_f32_16x16x64_bf16 v[68:71], v[16:19], v[176:183], v1
  s_waitcnt lgkmcnt(3)
  ds_read_b128 v[36:39], v10 offset:1024
  v_mov_b32_dpp v41, v17 row_ror:8 row_mask:0xf bank_mask:0xf
  v_smfmac_f32_16x16x64_bf16 v[64:67], v[20:23], v[208:215], v1
  ds_read_b128 v[56:59], v11 offset:0
  v_mov_b32_dpp v42, v18 row_ror:8 row_mask:0xf bank_mask:0xf
  v_smfmac_f32_16x16x64_bf16 v[68:71], v[20:23], v[224:231], v1
  s_waitcnt lgkmcnt(4)
  ds_read_b128 v[60:63], v11 offset:1024
  v_mov_b32_dpp v43, v19 row_ror:8 row_mask:0xf bank_mask:0xf
  v_smfmac_f32_16x16x64_bf16 v[64:67], v[24:27], a[0:7], v1
  ds_read_b128 v[76:79], v6 offset:16384
  v_mov_b32_dpp v44, v20 row_ror:8 row_mask:0xf bank_mask:0xf
  v_smfmac_f32_16x16x64_bf16 v[68:71], v[24:27], a[16:23], v1
  ds_read_b128 v[80:83], v6 offset:17408
  v_mov_b32_dpp v45, v21 row_ror:8 row_mask:0xf bank_mask:0xf
  v_smfmac_f32_16x16x64_bf16 v[64:67], v[40:43], v[168:175], v1
  ds_read_b128 v[84:87], v6 offset:18432
  v_mov_b32_dpp v46, v22 row_ror:8 row_mask:0xf bank_mask:0xf
  v_smfmac_f32_16x16x64_bf16 v[68:71], v[40:43], v[184:191], v1
  s_waitcnt lgkmcnt(7)
  v_mov_b32_dpp v47, v23 row_ror:8 row_mask:0xf bank_mask:0xf
  v_smfmac_f32_16x16x64_bf16 v[64:67], v[28:31], a[48:55], v1
  s_waitcnt vmcnt(3)
  ds_read_b128 v[88:91], v6 offset:19456
  v_mov_b32_dpp v48, v24 row_ror:8 row_mask:0xf bank_mask:0xf
  v_smfmac_f32_16x16x64_bf16 v[68:71], v[28:31], a[64:71], v1
  ds_read_b128 v[92:95], v6 offset:20480
  v_mov_b32_dpp v49, v25 row_ror:8 row_mask:0xf bank_mask:0xf
  v_smfmac_f32_16x16x64_bf16 v[64:67], v[44:47], v[216:223], v1
  ds_read_b128 v[96:99], v6 offset:21504
  v_mov_b32_dpp v50, v26 row_ror:8 row_mask:0xf bank_mask:0xf
  v_smfmac_f32_16x16x64_bf16 v[68:71], v[44:47], v[232:239], v1
  s_waitcnt lgkmcnt(4)
  v_mov_b32_dpp v51, v27 row_ror:8 row_mask:0xf bank_mask:0xf
  v_smfmac_f32_16x16x64_bf16 v[64:67], v[32:35], v[76:83], v1
  ds_read_b128 v[100:103], v6 offset:22528
  v_mov_b32_dpp v52, v28 row_ror:8 row_mask:0xf bank_mask:0xf
  v_smfmac_f32_16x16x64_bf16 v[68:71], v[32:35], a[96:103], v1
  s_waitcnt lgkmcnt(3)
  ds_read_b128 v[104:107], v6 offset:23552
  v_mov_b32_dpp v53, v29 row_ror:8 row_mask:0xf bank_mask:0xf
  v_smfmac_f32_16x16x64_bf16 v[64:67], v[56:59], v[84:91], v1
  v_mov_b32_dpp v54, v30 row_ror:8 row_mask:0xf bank_mask:0xf
  v_smfmac_f32_16x16x64_bf16 v[68:71], v[56:59], a[104:111], v1
  s_waitcnt lgkmcnt(2)
  v_mov_b32_dpp v55, v31 row_ror:8 row_mask:0xf bank_mask:0xf
  v_smfmac_f32_16x16x64_bf16 v[64:67], v[36:39], v[92:99], v1
  ds_read_b128 v[76:79], v0 offset:20480
  v_smfmac_f32_16x16x64_bf16 v[68:71], v[36:39], a[128:135], v1
  s_waitcnt lgkmcnt(1)
  buffer_load_dwordx4 v0, s[8:11], s63 offen offset:1024 sc1 lds
  ds_read_b128 v[80:83], v0 offset:24576
  v_smfmac_f32_16x16x64_bf16 v[64:67], v[60:63], v[100:107], v1
  ds_read_b128 v[84:87], v0 offset:21504
  v_mov_b64 v[124:125], s[88:89]
  v_smfmac_f32_16x16x64_bf16 v[68:71], v[60:63], a[136:143], v1
  ds_read_b128 v[88:91], v0 offset:25600
  v_mov_b64 v[126:127], s[88:89]
  v_smfmac_f32_16x16x64_bf16 v[64:67], v[48:51], a[8:15], v1
  ds_read_b128 v[92:95], v0 offset:22528
  v_smfmac_f32_16x16x64_bf16 v[64:67], v[52:55], a[56:63], v1
  ds_read_b128 v[96:99], v0 offset:26624
  v_smfmac_f32_16x16x64_bf16 v[68:71], v[48:51], a[24:31], v1
  ds_read_b128 v[100:103], v0 offset:23552
  v_smfmac_f32_16x16x64_bf16 v[68:71], v[52:55], a[72:79], v1
  ds_read_b128 v[104:107], v0 offset:27648
  v_cvt_pk_bf16_f32 v64, v64, v65
  v_cvt_pk_bf16_f32 v65, v66, v67
  v_smfmac_f32_16x16x64_bf16 v[72:75], v[16:19], v[192:199], v1
  ds_write_b64 v4, v[64:65] offset:8192
  v_smfmac_f32_16x16x64_bf16 v[72:75], v[20:23], v[240:247], v1
  v_cvt_pk_bf16_f32 v68, v68, v69
  v_cvt_pk_bf16_f32 v69, v70, v71
  v_smfmac_f32_16x16x64_bf16 v[72:75], v[24:27], a[32:39], v1
  ds_write_b64 v4, v[68:69] offset:29696
  v_smfmac_f32_16x16x64_bf16 v[72:75], v[28:31], a[80:87], v1
  v_smfmac_f32_16x16x64_bf16 v[72:75], v[32:35], a[112:119], v1
  v_smfmac_f32_16x16x64_bf16 v[72:75], v[36:39], a[144:151], v1
  buffer_load_dword v12, off, s[8:11], s69 sc1
  v_smfmac_f32_16x16x64_bf16 v[72:75], v[40:43], v[200:207], v1
  s_waitcnt lgkmcnt(0)
  s_barrier
  ds_read_b64_tr_b16 v[16:17], v5 offset:8192
  ds_read_b64_tr_b16 v[18:19], v5 offset:8512
  v_smfmac_f32_16x16x64_bf16 v[72:75], v[44:47], v[248:255], v1
  ds_read_b64_tr_b16 v[20:21], v5 offset:8832
  v_or_b32 v68, 1, v68
  v_smfmac_f32_16x16x64_bf16 v[72:75], v[48:51], a[40:47], v1
  ds_read_b64_tr_b16 v[22:23], v5 offset:9152
  v_smfmac_f32_16x16x64_bf16 v[72:75], v[52:55], a[88:95], v1
  ds_read_b64_tr_b16 v[32:33], v13 offset:29696
  v_smfmac_f32_16x16x64_bf16 v[72:75], v[56:59], a[120:127], v1
  buffer_load_dwordx4 v[108:111], v0, s[8:11], s64 offen offset:0 sc1
  ds_read_b64_tr_b16 v[34:35], v13 offset:29760
  v_smfmac_f32_16x16x64_bf16 v[72:75], v[60:63], a[152:159], v1
  s_waitcnt lgkmcnt(4)
  ds_read_b64_tr_b16 v[24:25], v5 offset:9472
  ds_read_b64_tr_b16 v[26:27], v5 offset:9792
  v_mfma_f32_16x16x32_bf16 v[64:67], v[76:79], v[16:19], 0
  ds_read_b64_tr_b16 v[28:29], v5 offset:10112
  v_mov_b64 v[44:45], 0
  v_mfma_f32_16x16x32_bf16 v[48:51], v[80:83], v[16:19], 0
  s_waitcnt lgkmcnt(5)
  ds_read_b64_tr_b16 v[30:31], v5 offset:10432
  v_mov_b64 v[46:47], 0
  v_mfma_f32_16x16x32_bf16 v[64:67], v[84:87], v[20:23], v[64:67]
  s_waitcnt lgkmcnt(4)
  ds_read_b64_tr_b16 v[36:37], v13 offset:30976
  v_cvt_pk_bf16_f32 v71, v74, v75
  v_smfmac_f32_16x16x64_bf16 v[44:47], v[32:35], v[16:23], v1
  ds_read_b64_tr_b16 v[38:39], v13 offset:31040
  v_cvt_pk_bf16_f32 v70, v72, v73
  v_mfma_f32_16x16x32_bf16 v[48:51], v[88:91], v[20:23], v[48:51]
  s_waitcnt lgkmcnt(4)
  ds_read_b128 v[76:79], v6 offset:24576
  v_mov_b64 v[56:57], 0
  v_mfma_f32_16x16x32_bf16 v[64:67], v[92:95], v[24:27], v[64:67]
  ds_read_b128 v[84:87], v6 offset:26624
  v_mfma_f32_16x16x32_bf16 v[48:51], v[96:99], v[24:27], v[48:51]
  s_waitcnt lgkmcnt(2)
  ds_read_b128 v[88:91], v6 offset:27648
  v_smfmac_f32_16x16x64_bf16 v[44:47], v[36:39], v[24:31], v1
  v_mov_b64 v[52:53], 0
  v_mfma_f32_16x16x32_bf16 v[64:67], v[100:103], v[28:31], v[64:67]
  v_mov_b64 v[60:61], 0
  v_mfma_f32_16x16x32_bf16 v[48:51], v[104:107], v[28:31], v[48:51]
  ds_read_b128 v[92:95], v6 offset:28672
  ds_read_b128 v[104:107], v6 offset:31744
  v_permlane32_swap_b32 v44, v46
  v_permlane32_swap_b32 v45, v47
  v_pk_add_f32 v[44:45], v[44:45], v[46:47]
  v_max_f32 v14, v44, v45
  v_max3_f32 v14, v14, v64, v65
  v_max3_f32 v14, v14, v66, v67
  v_max3_f32 v14, v14, v48, v49
  v_max3_f32 v14, v14, v50, v51
  v_mov_b32 v15, v14
  v_mov_b32 v22, 0
  v_mov_b64 v[28:29], 0
  v_permlane32_swap_b32 v14, v15
  v_max_f32 v14, v14, v15
  v_mov_b32 v15, v14
  v_mov_b64 v[62:63], 0
  v_mov_b32 v21, 0
  v_permlane16_swap_b32 v14, v15
  v_max_f32 v14, v14, v15
  v_mul_f32 v14, -s78, v14
  v_pk_fma_f32 v[44:45], v[44:45], s[78:79], v[14:15] op_sel_hi:[1,1,0]
  v_exp_f32 v44, v44
  v_exp_f32 v45, v45
  v_pk_fma_f32 v[64:65], v[64:65], s[78:79], v[14:15] op_sel_hi:[1,1,0]
  v_cvt_pk_bf16_f32 v20, v44, v45
  v_cvt_pk_bf16_f32 v23, v44, v45
  v_pk_fma_f32 v[66:67], v[66:67], s[78:79], v[14:15] op_sel_hi:[1,1,0]
  v_pk_fma_f32 v[48:49], v[48:49], s[78:79], v[14:15] op_sel_hi:[1,1,0]
  v_permlane32_swap_b32 v20, v21
  v_permlane32_swap_b32 v22, v23
  v_pk_fma_f32 v[50:51], v[50:51], s[78:79], v[14:15] op_sel_hi:[1,1,0]
  v_exp_f32 v64, v64
  v_mfma_f32_16x16x16_bf16 v[40:43], v[124:125], v[20:21], 0
  v_exp_f32 v65, v65
  v_exp_f32 v66, v66
  v_mfma_f32_16x16x16_bf16 v[32:35], v[70:71], v[20:21], 0
  v_exp_f32 v67, v67
  v_exp_f32 v48, v48
  v_mfma_f32_16x16x16_bf16 v[36:39], v[70:71], v[22:23], 0
  v_exp_f32 v49, v49
  v_cvt_pk_bf16_f32 v16, v64, v65
  v_exp_f32 v50, v50
  v_cvt_pk_bf16_f32 v17, v66, v67
  v_exp_f32 v51, v51
  v_cvt_pk_bf16_f32 v18, v48, v49
  v_cvt_pk_bf16_f32 v19, v50, v51
  v_mov_b64 v[54:55], 0
  s_nop 0
  v_mfma_f32_16x16x32_bf16 v[40:43], v[124:127], v[16:19], v[40:43]
  ds_read_b128 v[80:83], v6 offset:25600
  v_mov_b64 v[58:59], 0
  v_mfma_f32_16x16x32_bf16 v[32:35], v[116:119], v[16:19], v[32:35]
  v_mfma_f32_16x16x32_bf16 v[36:39], v[120:123], v[16:19], v[36:39]
  ds_read_b128 v[100:103], v6 offset:30720
  v_rcp_f32 v14, v40
  v_mov_b64 v[126:127], v[70:71]
  s_nop 0
  v_pk_mul_f32 v[32:33], v[32:33], v[14:15] op_sel_hi:[1,0]
  v_pk_mul_f32 v[34:35], v[34:35], v[14:15] op_sel_hi:[1,0]
  v_cvt_pk_bf16_f32 v24, v32, v33
  v_cvt_pk_bf16_f32 v25, v34, v35
  v_pk_mul_f32 v[36:37], v[36:37], v[14:15] op_sel_hi:[1,0]
  v_pk_mul_f32 v[38:39], v[38:39], v[14:15] op_sel_hi:[1,0]
  v_cvt_pk_bf16_f32 v26, v36, v37
  v_cvt_pk_bf16_f32 v27, v38, v39
  ds_write_b128 v7, v[24:27]
  v_mov_b64 v[30:31], 0
  v_smfmac_f32_16x16x64_bf16 v[52:55], v[24:27], a[160:167], v1
  v_smfmac_f32_16x16x64_bf16 v[56:59], v[24:27], a[176:183], v1
  ds_read_b128 v[96:99], v6 offset:29696
  v_smfmac_f32_16x16x64_bf16 v[60:63], v[24:27], a[192:199], v1
  s_waitcnt lgkmcnt(1)
  s_barrier
  ds_read_b128 v[16:19], v8
  ds_read_b128 v[20:23], v9
  ds_read_b128 v[44:47], v10
  v_mov_b64 v[124:125], v[68:69]
  v_smfmac_f32_16x16x64_bf16 v[28:31], v[24:27], a[208:215], v1
  s_waitcnt lgkmcnt(2)
  v_smfmac_f32_16x16x64_bf16 v[52:55], v[16:19], a[168:175], v1
  s_waitcnt lgkmcnt(1)
  v_smfmac_f32_16x16x64_bf16 v[52:55], v[20:23], v[76:83], v1
  s_waitcnt lgkmcnt(0)
  v_smfmac_f32_16x16x64_bf16 v[52:55], v[44:47], v[84:91], v1
  v_smfmac_f32_16x16x64_bf16 v[56:59], v[16:19], a[184:191], v1
  v_smfmac_f32_16x16x64_bf16 v[56:59], v[20:23], v[92:99], v1
  v_cvt_pk_bf16_f32 v64, v52, v53
  v_smfmac_f32_16x16x64_bf16 v[56:59], v[44:47], v[100:107], v1
  v_or_b32 v64, 1, v64
  v_smfmac_f32_16x16x64_bf16 v[60:63], v[16:19], a[200:207], v1
  v_cvt_pk_bf16_f32 v65, v54, v55
  v_smfmac_f32_16x16x64_bf16 v[28:31], v[16:19], a[216:223], v1
  v_cvt_pk_bf16_f32 v66, v56, v57
  v_smfmac_f32_16x16x64_bf16 v[60:63], v[20:23], a[224:231], v1
  v_cvt_pk_bf16_f32 v67, v58, v59
  v_smfmac_f32_16x16x64_bf16 v[60:63], v[44:47], a[232:239], v1
  buffer_store_dwordx4 v[64:67], v2, s[8:11], 0 offen
  v_smfmac_f32_16x16x64_bf16 v[28:31], v[20:23], a[240:247], v1
  v_smfmac_f32_16x16x64_bf16 v[28:31], v[44:47], a[248:255], v1
  v_cvt_pk_bf16_f32 v72, v60, v61
  v_or_b32 v72, 1, v72
  v_cvt_pk_bf16_f32 v73, v62, v63
  s_nop 4
  v_cvt_pk_bf16_f32 v74, v28, v29
  v_cvt_pk_bf16_f32 v75, v30, v31
  buffer_store_dwordx4 v[72:75], v2, s[8:11], s74 offen
  ds_read_b128 v[56:59], v0 offset:28672
  ds_read_b128 v[16:19], v6 offset:0
  ds_read_b128 v[20:23], v6 offset:1024
  ds_read_b128 v[24:27], v6 offset:4096
  ds_read_b128 v[28:31], v6 offset:5120
  ds_read_b128 v[32:35], v6 offset:8192
  ds_read_b128 v[36:39], v6 offset:9216
  ds_read_b128 v[40:43], v6 offset:12288
  ds_read_b128 v[44:47], v6 offset:13312
  v_mov_b64 v[64:65], 0
  v_mov_b64 v[66:67], 0
  v_mov_b64 v[68:69], 0
  v_mov_b64 v[70:71], 0
  v_mov_b64 v[72:73], 0
  v_mov_b64 v[74:75], 0
  s_mov_b32 s75, s69
  s_mov_b32 s70, s72
  s_add_u32 s71, s71, 1
  s_add_u32 s69, s69, 4096
  s_cmp_eq_u32 s71, 7
  s_cselect_b32 s28, 7, 0
  s_cselect_b32 s29, 1, 0
  s_sub_u32 s71, s71, s28
  s_add_u32 s72, s72, s29
  s_lshl_b32 s28, s28, 12
  s_sub_u32 s69, s69, s28
  s_add_u32 s63, s63, 0x100000
  s_add_u32 s64, s64, 0x100000
  s_add_u32 s65, s65, 0x100000
  s_add_u32 s62, s62, 1
  v_mov_b64 v[60:61], 0
  s_nop 15
  s_nop 3
  s_waitcnt lgkmcnt(0)
  s_mov_b32 s34, 0
  s_mov_b32 s35, 4
  buffer_load_dwordx4 v[48:51], v0, s[8:11], s73 offen offset:0 sc1
  buffer_load_dwordx4 v[52:55], v0, s[8:11], s73 offen offset:1024 sc1
  s_nop 15
  s_nop 15
  s_nop 7
  buffer_load_dwordx4 v[116:119], v0, s[8:11], s73 offen offset:0 sc1
  buffer_load_dwordx4 v[120:123], v0, s[8:11], s73 offen offset:1024 sc1
L_p1_49:
  s_waitcnt vmcnt(2)
  v_smfmac_f32_16x16x64_bf16 v[60:63], v[56:59], v[48:55], v1
  v_bitop3_b32 v14, v48, v52, 1 bitop3:0x80
  v_cmp_eq_u32 vcc, 0, v14
  s_cbranch_vccnz L_p1o_50
L_p1d_51:
  s_nop 4
  v_add_f32_dpp v60, v60, v60 row_ror:8 row_mask:0xf bank_mask:0xf
  v_add_f32_dpp v61, v61, v61 row_ror:8 row_mask:0xf bank_mask:0xf
  s_nop 0
  v_add_f32_dpp v60, v60, v60 row_ror:4 row_mask:0xf bank_mask:0xf
  v_add_f32_dpp v61, v61, v61 row_ror:4 row_mask:0xf bank_mask:0xf
  v_cvt_pk_bf16_f32 v60, v60, v61
  v_or_b32_sdwa v60, v60, v1 dst_sel:DWORD dst_unused:UNUSED_PAD src0_sel:DWORD src1_sel:BYTE_2
  buffer_store_dword v60, v3, s[8:11], s67 offen
  v_cmp_gt_u32 vcc, s70, v12
  s_cbranch_vccnz L_pks_47
L_pkb_48:
  ds_read_b128 v[76:79], v6 offset:2048
  ds_read_b128 v[80:83], v6 offset:3072
  ds_read_b128 v[84:87], v6 offset:6144
  ds_read_b128 v[88:91], v6 offset:7168
  ds_read_b128 v[92:95], v6 offset:10240
  ds_read_b128 v[96:99], v6 offset:11264
  ds_read_b128 v[100:103], v6 offset:14336
  ds_read_b128 v[104:107], v6 offset:15360
  s_mov_b32 m0, s91
  s_barrier
  s_nop 3
  s_mov_b32 s34, 0
  s_mov_b32 s35, 5
  buffer_load_dwordx4 v[48:51], v0, s[8:11], s66 offen offset:0 sc1
  buffer_load_dwordx4 v[52:55], v0, s[8:11], s66 offen offset:1024 sc1
  s_nop 15
  s_nop 15
  s_nop 3
  buffer_load_dwordx4 v[116:119], v0, s[8:11], s66 offen offset:0 sc1
  buffer_load_dwordx4 v[120:123], v0, s[8:11], s66 offen offset:1024 sc1
  s_waitcnt vmcnt(2) lgkmcnt(0)
  s_branch L_cf_loop
L_cf_fin:
L_st_52:
  ds_write_b128 v7, v[48:51]
  ds_write_b128 v7, v[52:55] offset:1024
  v_smfmac_f32_16x16x64_bf16 v[68:71], v[48:51], v[24:31], v1
  v_bitop3_b32 v14, v48, v52, 1 bitop3:0xa8
  v_cmp_ne_u32 vcc, 0, v14
  v_smfmac_f32_16x16x64_bf16 v[72:75], v[48:51], v[32:39], v1
  v_smfmac_f32_16x16x64_bf16 v[68:71], v[52:55], v[128:135], v1
  s_cbranch_vccnz L_rtA_54
  v_mov_b32_dpp v56, v48 row_ror:8 row_mask:0xf bank_mask:0xf
  v_mov_b32_dpp v57, v49 row_ror:8 row_mask:0xf bank_mask:0xf
  v_mov_b32_dpp v58, v50 row_ror:8 row_mask:0xf bank_mask:0xf
  v_mov_b32_dpp v59, v51 row_ror:8 row_mask:0xf bank_mask:0xf
  v_smfmac_f32_16x16x64_bf16 v[72:75], v[52:55], v[144:151], v1
  v_mov_b32_dpp v60, v52 row_ror:8 row_mask:0xf bank_mask:0xf
  v_mov_b32_dpp v61, v53 row_ror:8 row_mask:0xf bank_mask:0xf
  v_mov_b32_dpp v62, v54 row_ror:8 row_mask:0xf bank_mask:0xf
  v_mov_b32_dpp v63, v55 row_ror:8 row_mask:0xf bank_mask:0xf
L_cm_53:
  v_smfmac_f32_16x16x64_bf16 v[68:71], v[56:59], v[84:91], v1
  s_waitcnt lgkmcnt(0)
  s_barrier
  ds_read_b128 v[16:19], v8 offset:0
  ds_read_b128 v[20:23], v8 offset:1024
  v_smfmac_f32_16x16x64_bf16 v[72:75], v[56:59], v[92:99], v1
  ds_read_b128 v[24:27], v9 offset:0
  ds_read_b128 v[28:31], v9 offset:1024
  v_smfmac_f32_16x16x64_bf16 v[68:71], v[60:63], v[136:143], v1
  ds_read_b128 v[32:35], v10 offset:0
  ds_read_b128 v[36:39], v10 offset:1024
  v_smfmac_f32_16x16x64_bf16 v[72:75], v[60:63], v[152:159], v1
  s_waitcnt lgkmcnt(5)
  ds_read_b128 v[56:59], v11 offset:0
  ds_read_b128 v[60:63], v11 offset:1024
  v_smfmac_f32_16x16x64_bf16 v[68:71], v[16:19], v[176:183], v1
  buffer_store_dwordx4 v[124:127], v0, s[8:11], s65 offen sc1
  s_add_u32 s65, s65, 0x100000
  v_mov_b32_dpp v40, v16 row_ror:8 row_mask:0xf bank_mask:0xf
  v_mov_b32_dpp v41, v17 row_ror:8 row_mask:0xf bank_mask:0xf
  v_smfmac_f32_16x16x64_bf16 v[72:75], v[16:19], v[192:199], v1
  s_waitcnt lgkmcnt(6)
  v_mov_b32_dpp v42, v18 row_ror:8 row_mask:0xf bank_mask:0xf
  v_smfmac_f32_16x16x64_bf16 v[68:71], v[20:23], v[224:231], v1
  v_mov_b32_dpp v43, v19 row_ror:8 row_mask:0xf bank_mask:0xf
  v_mov_b32_dpp v44, v20 row_ror:8 row_mask:0xf bank_mask:0xf
  v_smfmac_f32_16x16x64_bf16 v[72:75], v[20:23], v[240:247], v1
  s_waitcnt lgkmcnt(5)
  v_mov_b32_dpp v45, v21 row_ror:8 row_mask:0xf bank_mask:0xf
  v_smfmac_f32_16x16x64_bf16 v[68:71], v[24:27], a[16:23], v1
  v_mov_b32_dpp v46, v22 row_ror:8 row_mask:0xf bank_mask:0xf
  v_mov_b32_dpp v47, v23 row_ror:8 row_mask:0xf bank_mask:0xf
  v_smfmac_f32_16x16x64_bf16 v[72:75], v[24:27], a[32:39], v1
  s_waitcnt vmcnt(1) lgkmcnt(4)
  v_mov_b32_dpp v48, v24 row_ror:8 row_mask:0xf bank_mask:0xf
  v_smfmac_f32_16x16x64_bf16 v[68:71], v[28:31], a[64:71], v1
  v_mov_b32_dpp v49, v25 row_ror:8 row_mask:0xf bank_mask:0xf
  v_mov_b32_dpp v50, v26 row_ror:8 row_mask:0xf bank_mask:0xf
  v_smfmac_f32_16x16x64_bf16 v[72:75], v[28:31], a[80:87], v1
  s_waitcnt lgkmcnt(3)
  v_mov_b32_dpp v51, v27 row_ror:8 row_mask:0xf bank_mask:0xf
  v_smfmac_f32_16x16x64_bf16 v[68:71], v[32:35], a[96:103], v1
  v_mov_b32_dpp v52, v28 row_ror:8 row_mask:0xf bank_mask:0xf
  v_mov_b32_dpp v53, v29 row_ror:8 row_mask:0xf bank_mask:0xf
  v_smfmac_f32_16x16x64_bf16 v[72:75], v[32:35], a[112:119], v1
  s_waitcnt lgkmcnt(2)
  v_mov_b32_dpp v54, v30 row_ror:8 row_mask:0xf bank_mask:0xf
  v_smfmac_f32_16x16x64_bf16 v[68:71], v[36:39], a[128:135], v1
  v_mov_b32_dpp v55, v31 row_ror:8 row_mask:0xf bank_mask:0xf
  v_smfmac_f32_16x16x64_bf16 v[72:75], v[36:39], a[144:151], v1
  s_waitcnt lgkmcnt(1)
  v_smfmac_f32_16x16x64_bf16 v[68:71], v[56:59], a[104:111], v1
  v_smfmac_f32_16x16x64_bf16 v[72:75], v[56:59], a[120:127], v1
  s_waitcnt lgkmcnt(0)
  v_smfmac_f32_16x16x64_bf16 v[68:71], v[60:63], a[136:143], v1
  v_smfmac_f32_16x16x64_bf16 v[72:75], v[60:63], a[152:159], v1
  v_smfmac_f32_16x16x64_bf16 v[68:71], v[40:43], v[184:191], v1
  v_smfmac_f32_16x16x64_bf16 v[72:75], v[40:43], v[200:207], v1
  v_smfmac_f32_16x16x64_bf16 v[68:71], v[44:47], v[232:239], v1
  v_smfmac_f32_16x16x64_bf16 v[72:75], v[44:47], v[248:255], v1
  v_smfmac_f32_16x16x64_bf16 v[68:71], v[48:51], a[24:31], v1
  v_smfmac_f32_16x16x64_bf16 v[72:75], v[48:51], a[40:47], v1
  v_smfmac_f32_16x16x64_bf16 v[68:71], v[52:55], a[72:79], v1
  v_smfmac_f32_16x16x64_bf16 v[72:75], v[52:55], a[88:95], v1
  s_nop 3
  v_cvt_pk_bf16_f32 v68, v68, v69
  v_cvt_pk_bf16_f32 v69, v70, v71
  s_nop 1
  v_cvt_pk_bf16_f32 v70, v72, v73
  v_cvt_pk_bf16_f32 v71, v74, v75
  v_or_b32 v68, 1, v68
  buffer_store_dwordx4 v[68:71], v0, s[8:11], s65 offen sc1
  s_waitcnt vmcnt(0)
  s_endpgm
.p2align 6
L_rtA_30:
  s_mov_b64 exec, vcc
  buffer_load_dwordx4 v[48:51], v0, s[8:11], s66 offen offset:0 sc1
  buffer_load_dwordx4 v[52:55], v0, s[8:11], s66 offen offset:1024 sc1
  s_mov_b64 exec, -1
  s_add_u32 s34, s34, 1
  s_cmp_gt_u32 s34, 40000
  s_cbranch_scc1 L_fail
  s_nop 3
  v_mov_b64 v[64:65], 0
  v_mov_b64 v[66:67], 0
  v_mov_b64 v[68:69], 0
  v_mov_b64 v[70:71], 0
  v_mov_b64 v[72:73], 0
  v_mov_b64 v[74:75], 0
  s_waitcnt vmcnt(2) lgkmcnt(0)
  v_smfmac_f32_16x16x64_bf16 v[64:67], v[116:119], v[16:23], v1
  v_bitop3_b32 v14, v116, v120, 1 bitop3:0x80
  v_cmp_eq_u32 vcc, 0, v14
  v_smfmac_f32_16x16x64_bf16 v[68:71], v[116:119], v[24:31], v1
  v_mov_b32_dpp v56, v116 row_ror:8 row_mask:0xf bank_mask:0xf
  v_smfmac_f32_16x16x64_bf16 v[72:75], v[116:119], v[32:39], v1
  s_cbranch_vccnz L_rtB_31
  ds_write_b128 v7, v[116:119]
  v_mov_b32_dpp v57, v117 row_ror:8 row_mask:0xf bank_mask:0xf
  v_smfmac_f32_16x16x64_bf16 v[64:67], v[120:123], v[40:47], v1
  v_mov_b32_dpp v58, v118 row_ror:8 row_mask:0xf bank_mask:0xf
  v_smfmac_f32_16x16x64_bf16 v[68:71], v[120:123], v[128:135], v1
  ds_write_b128 v7, v[120:123] offset:1024
  v_mov_b32_dpp v59, v119 row_ror:8 row_mask:0xf bank_mask:0xf
  v_mov_b32_dpp v60, v120 row_ror:8 row_mask:0xf bank_mask:0xf
  v_smfmac_f32_16x16x64_bf16 v[72:75], v[120:123], v[144:151], v1
  v_mov_b32_dpp v61, v121 row_ror:8 row_mask:0xf bank_mask:0xf
  v_smfmac_f32_16x16x64_bf16 v[64:67], v[56:59], v[76:83], v1
  buffer_load_dwordx4 v0, s[8:11], s63 offen offset:0 sc1 lds
  v_mov_b32_dpp v62, v122 row_ror:8 row_mask:0xf bank_mask:0xf
  v_smfmac_f32_16x16x64_bf16 v[68:71], v[56:59], v[84:91], v1
  buffer_store_dwordx4 v[124:127], v0, s[8:11], s65 offen sc1
  v_mov_b32_dpp v63, v123 row_ror:8 row_mask:0xf bank_mask:0xf
  s_branch L_cm_29
L_rtB_31:
  s_mov_b64 exec, vcc
  buffer_load_dwordx4 v[116:119], v0, s[8:11], s66 offen offset:0 sc1
  buffer_load_dwordx4 v[120:123], v0, s[8:11], s66 offen offset:1024 sc1
  s_mov_b64 exec, -1
  s_add_u32 s34, s34, 1
  s_cmp_gt_u32 s34, 40000
  s_cbranch_scc1 L_fail
  s_nop 3
  v_mov_b64 v[64:65], 0
  v_mov_b64 v[66:67], 0
  v_mov_b64 v[68:69], 0
  v_mov_b64 v[70:71], 0
  v_mov_b64 v[72:73], 0
  v_mov_b64 v[74:75], 0
  s_waitcnt vmcnt(2) lgkmcnt(0)
  s_branch L_st_28
.p2align 6
L_pks_35:
  s_waitcnt lgkmcnt(0)
  s_mov_b32 s34, 0
  s_mov_b32 s35, 3
L_pk_59:
  buffer_load_dword v12, off, s[8:11], s75 sc1
  s_add_u32 s34, s34, 1
  s_cmp_gt_u32 s34, 40000
  s_cbranch_scc1 L_fail
  s_waitcnt vmcnt(0)
  v_cmp_gt_u32 vcc, s70, v12
  s_cbranch_vccnz L_pk_59
  s_branch L_pkb_36
.p2align 6
L_p1o_38:
  s_mov_b64 exec, vcc
  buffer_load_dwordx4 v[48:51], v0, s[8:11], s73 offen offset:0 sc1
  buffer_load_dwordx4 v[52:55], v0, s[8:11], s73 offen offset:1024 sc1
  s_mov_b64 exec, -1
  s_add_u32 s34, s34, 1
  s_cmp_gt_u32 s34, 40000
  s_cbranch_scc1 L_fail
  s_nop 0
  v_mov_b64 v[60:61], 0
  s_nop 0
  s_waitcnt vmcnt(2)
  v_smfmac_f32_16x16x64_bf16 v[60:63], v[56:59], v[108:115], v1
  v_bitop3_b32 v14, v108, v112, 1 bitop3:0xa8
  v_cmp_ne_u32 vcc, 0, v14
  s_cbranch_vccz L_p1d_39
  s_mov_b64 exec, vcc
  buffer_load_dwordx4 v[108:111], v0, s[8:11], s73 offen offset:0 sc1
  buffer_load_dwordx4 v[112:115], v0, s[8:11], s73 offen offset:1024 sc1
  s_mov_b64 exec, -1
  s_add_u32 s34, s34, 1
  s_cmp_gt_u32 s34, 40000
  s_cbranch_scc1 L_fail
  s_nop 0
  v_mov_b64 v[60:61], 0
  s_nop 0
  s_branch L_p1_37
.p2align 6
L_rtA_42:
  s_mov_b64 exec, vcc
  buffer_load_dwordx4 v[48:51], v0, s[8:11], s66 offen offset:0 sc1
  buffer_load_dwordx4 v[52:55], v0, s[8:11], s66 offen offset:1024 sc1
  s_mov_b64 exec, -1
  s_add_u32 s34, s34, 1
  s_cmp_gt_u32 s34, 40000
  s_cbranch_scc1 L_fail
  s_nop 3
  v_mov_b64 v[64:65], 0
  v_mov_b64 v[66:67], 0
  v_mov_b64 v[68:69], 0
  v_mov_b64 v[70:71], 0
  v_mov_b64 v[72:73], 0
  v_mov_b64 v[74:75], 0
  s_waitcnt vmcnt(2) lgkmcnt(0)
  v_smfmac_f32_16x16x64_bf16 v[64:67], v[108:111], v[16:23], v1
  v_bitop3_b32 v14, v108, v112, 1 bitop3:0xa8
  v_cmp_ne_u32 vcc, 0, v14
  v_smfmac_f32_16x16x64_bf16 v[68:71], v[108:111], v[24:31], v1
  v_mov_b32_dpp v56, v108 row_ror:8 row_mask:0xf bank_mask:0xf
  v_smfmac_f32_16x16x64_bf16 v[72:75], v[108:111], v[32:39], v1
  s_cbranch_vccnz L_rtB_43
  ds_write_b128 v7, v[108:111]
  v_mov_b32_dpp v57, v109 row_ror:8 row_mask:0xf bank_mask:0xf
  v_smfmac_f32_16x16x64_bf16 v[64:67], v[112:115], v[40:47], v1
  v_mov_b32_dpp v58, v110 row_ror:8 row_mask:0xf bank_mask:0xf
  v_smfmac_f32_16x16x64_bf16 v[68:71], v[112:115], v[128:135], v1
  ds_write_b128 v7, v[112:115] offset:1024
  v_mov_b32_dpp v59, v111 row_ror:8 row_mask:0xf bank_mask:0xf
  v_mov_b32_dpp v60, v112 row_ror:8 row_mask:0xf bank_mask:0xf
  v_smfmac_f32_16x16x64_bf16 v[72:75], v[112:115], v[144:151], v1
  v_mov_b32_dpp v61, v113 row_ror:8 row_mask:0xf bank_mask:0xf
  v_smfmac_f32_16x16x64_bf16 v[64:67], v[56:59], v[76:83], v1
  buffer_load_dwordx4 v0, s[8:11], s63 offen offset:0 sc1 lds
  v_mov_b32_dpp v62, v114 row_ror:8 row_mask:0xf bank_mask:0xf
  v_smfmac_f32_16x16x64_bf16 v[68:71], v[56:59], v[84:91], v1
  buffer_store_dwordx4 v[124:127], v0, s[8:11], s65 offen sc1
  v_mov_b32_dpp v63, v115 row_ror:8 row_mask:0xf bank_mask:0xf
  s_branch L_cm_41
L_rtB_43:
  s_mov_b64 exec, vcc
  buffer_load_dwordx4 v[108:111], v0, s[8:11], s66 offen offset:0 sc1
  buffer_load_dwordx4 v[112:115], v0, s[8:11], s66 offen offset:1024 sc1
  s_mov_b64 exec, -1
  s_add_u32 s34, s34, 1
  s_cmp_gt_u32 s34, 40000
  s_cbranch_scc1 L_fail
  s_nop 3
  v_mov_b64 v[64:65], 0
  v_mov_b64 v[66:67], 0
  v_mov_b64 v[68:69], 0
  v_mov_b64 v[70:71], 0
  v_mov_b64 v[72:73], 0
  v_mov_b64 v[74:75], 0
  s_waitcnt vmcnt(2) lgkmcnt(0)
  s_branch L_st_40
.p2align 6
L_pks_47:
  s_waitcnt lgkmcnt(0)
  s_mov_b32 s34, 0
  s_mov_b32 s35, 3
L_pk_60:
  buffer_load_dword v12, off, s[8:11], s75 sc1
  s_add_u32 s34, s34, 1
  s_cmp_gt_u32 s34, 40000
  s_cbranch_scc1 L_fail
  s_waitcnt vmcnt(0)
  v_cmp_gt_u32 vcc, s70, v12
  s_cbranch_vccnz L_pk_60
  s_branch L_pkb_48
.p2align 6
L_p1o_50:
  s_mov_b64 exec, vcc
  buffer_load_dwordx4 v[48:51], v0, s[8:11], s73 offen offset:0 sc1
  buffer_load_dwordx4 v[52:55], v0, s[8:11], s73 offen offset:1024 sc1
  s_mov_b64 exec, -1
  s_add_u32 s34, s34, 1
  s_cmp_gt_u32 s34, 40000
  s_cbranch_scc1 L_fail
  s_nop 0
  v_mov_b64 v[60:61], 0
  s_nop 0
  s_waitcnt vmcnt(2)
  v_smfmac_f32_16x16x64_bf16 v[60:63], v[56:59], v[116:123], v1
  v_bitop3_b32 v14, v116, v120, 1 bitop3:0x80
  v_cmp_eq_u32 vcc, 0, v14
  s_cbranch_vccz L_p1d_51
  s_mov_b64 exec, vcc
  buffer_load_dwordx4 v[116:119], v0, s[8:11], s73 offen offset:0 sc1
  buffer_load_dwordx4 v[120:123], v0, s[8:11], s73 offen offset:1024 sc1
  s_mov_b64 exec, -1
  s_add_u32 s34, s34, 1
  s_cmp_gt_u32 s34, 40000
  s_cbranch_scc1 L_fail
  s_nop 0
  v_mov_b64 v[60:61], 0
  s_nop 0
  s_branch L_p1_49
.p2align 6
L_rtA_54:
  s_mov_b64 exec, vcc
  buffer_load_dwordx4 v[48:51], v0, s[8:11], s66 offen offset:0 sc1
  buffer_load_dwordx4 v[52:55], v0, s[8:11], s66 offen offset:1024 sc1
  s_mov_b64 exec, -1
  s_add_u32 s34, s34, 1
  s_cmp_gt_u32 s34, 40000
  s_cbranch_scc1 L_fail
  s_nop 3
  v_mov_b64 v[64:65], 0
  v_mov_b64 v[66:67], 0
  v_mov_b64 v[68:69], 0
  v_mov_b64 v[70:71], 0
  v_mov_b64 v[72:73], 0
  v_mov_b64 v[74:75], 0
  s_waitcnt vmcnt(2) lgkmcnt(0)
  ds_write_b128 v7, v[108:111]
  ds_write_b128 v7, v[112:115] offset:1024
  v_smfmac_f32_16x16x64_bf16 v[68:71], v[108:111], v[24:31], v1
  v_bitop3_b32 v14, v108, v112, 1 bitop3:0xa8
  v_cmp_ne_u32 vcc, 0, v14
  v_smfmac_f32_16x16x64_bf16 v[72:75], v[108:111], v[32:39], v1
  v_smfmac_f32_16x16x64_bf16 v[68:71], v[112:115], v[128:135], v1
  s_cbranch_vccnz L_rtB_55
  v_mov_b32_dpp v56, v108 row_ror:8 row_mask:0xf bank_mask:0xf
  v_mov_b32_dpp v57, v109 row_ror:8 row_mask:0xf bank_mask:0xf
  v_mov_b32_dpp v58, v110 row_ror:8 row_mask:0xf bank_mask:0xf
  v_mov_b32_dpp v59, v111 row_ror:8 row_mask:0xf bank_mask:0xf
  v_smfmac_f32_16x16x64_bf16 v[72:75], v[112:115], v[144:151], v1
  v_mov_b32_dpp v60, v112 row_ror:8 row_mask:0xf bank_mask:0xf
  v_mov_b32_dpp v61, v113 row_ror:8 row_mask:0xf bank_mask:0xf
  v_mov_b32_dpp v62, v114 row_ror:8 row_mask:0xf bank_mask:0xf
  v_mov_b32_dpp v63, v115 row_ror:8 row_mask:0xf bank_mask:0xf
  s_branch L_cm_53
L_rtB_55:
  s_mov_b64 exec, vcc
  buffer_load_dwordx4 v[108:111], v0, s[8:11], s66 offen offset:0 sc1
  buffer_load_dwordx4 v[112:115], v0, s[8:11], s66 offen offset:1024 sc1
  s_mov_b64 exec, -1
  s_add_u32 s34, s34, 1
  s_cmp_gt_u32 s34, 40000
  s_cbranch_scc1 L_fail
  s_nop 3
  v_mov_b64 v[64:65], 0
  v_mov_b64 v[66:67], 0
  v_mov_b64 v[68:69], 0
  v_mov_b64 v[70:71], 0
  v_mov_b64 v[72:73], 0
  v_mov_b64 v[74:75], 0
  s_waitcnt vmcnt(2) lgkmcnt(0)
  s_branch L_st_52
L_chain_slow:
  v_lshlrev_b32 v0, 4, v0
  s_add_u32 s75, s75, 4096
  s_waitcnt vmcnt(4)
  v_cmp_gt_u32 vcc, s70, v40
  s_cbranch_vccz L_pk1_61
  s_mov_b32 s34, 0
  s_mov_b32 s35, 2
L_pk_62:
  buffer_load_dword v12, off, s[8:11], s75 sc1
  s_add_u32 s34, s34, 1
  s_cmp_gt_u32 s34, 40000
  s_cbranch_scc1 L_fail
  s_waitcnt vmcnt(0)
  v_cmp_gt_u32 vcc, s70, v12
  s_cbranch_vccnz L_pk_62
L_pk1_61:
  s_add_u32 s69, s75, 4096
  s_mov_b32 s71, 2
  s_mov_b32 s72, 1
  s_add_u32 s63, s63, 0x100000
  s_add_u32 s64, s64, 0x100000
  ds_read_b128 v[16:19], v6 offset:0
  ds_read_b128 v[20:23], v6 offset:1024
  ds_read_b128 v[24:27], v6 offset:4096
  ds_read_b128 v[28:31], v6 offset:5120
  ds_read_b128 v[32:35], v6 offset:8192
  ds_read_b128 v[36:39], v6 offset:9216
  ds_read_b128 v[40:43], v6 offset:12288
  ds_read_b128 v[44:47], v6 offset:13312
  ds_read_b128 v[76:79], v6 offset:2048
  ds_read_b128 v[80:83], v6 offset:3072
  ds_read_b128 v[84:87], v6 offset:6144
  ds_read_b128 v[88:91], v6 offset:7168
  ds_read_b128 v[92:95], v6 offset:10240
  ds_read_b128 v[96:99], v6 offset:11264
  s_waitcnt lgkmcnt(14)
  ds_read_b128 v[100:103], v6 offset:14336
  s_waitcnt lgkmcnt(14)
  ds_read_b128 v[104:107], v6 offset:15360
  v_mov_b64 v[64:65], 0
  v_mov_b64 v[66:67], 0
  v_mov_b64 v[68:69], 0
  v_mov_b64 v[70:71], 0
  v_mov_b64 v[72:73], 0
  v_mov_b64 v[74:75], 0
  v_mov_b32 v15, -1
  s_mov_b32 m0, s91
  s_mov_b32 s34, 0
  s_mov_b32 s35, 5
  s_waitcnt vmcnt(0) lgkmcnt(0)
  s_waitcnt vmcnt(0)
  s_branch L_cs_loop
.p2align 6
L_cs_loop:
L_st_63:
  v_smfmac_f32_16x16x64_bf16 v[64:67], v[48:51], v[16:23], v1
  v_bitop3_b32 v14, v48, v52, 1 bitop3:0x80
  v_cmp_eq_u32 vcc, 0, v14
  v_smfmac_f32_16x16x64_bf16 v[68:71], v[48:51], v[24:31], v1
  v_mov_b32_dpp v56, v48 row_ror:8 row_mask:0xf bank_mask:0xf
  v_smfmac_f32_16x16x64_bf16 v[72:75], v[48:51], v[32:39], v1
  s_cbranch_vccnz L_rtA_65
  ds_write_b128 v7, v[48:51]
  v_mov_b32_dpp v57, v49 row_ror:8 row_mask:0xf bank_mask:0xf
  v_smfmac_f32_16x16x64_bf16 v[64:67], v[52:55], v[40:47], v1
  v_mov_b32_dpp v58, v50 row_ror:8 row_mask:0xf bank_mask:0xf
  v_smfmac_f32_16x16x64_bf16 v[68:71], v[52:55], v[128:135], v1
  ds_write_b128 v7, v[52:55] offset:1024
  v_mov_b32_dpp v59, v51 row_ror:8 row_mask:0xf bank_mask:0xf
  v_mov_b32_dpp v60, v52 row_ror:8 row_mask:0xf bank_mask:0xf
  v_smfmac_f32_16x16x64_bf16 v[72:75], v[52:55], v[144:151], v1
  v_mov_b32_dpp v61, v53 row_ror:8 row_mask:0xf bank_mask:0xf
  v_smfmac_f32_16x16x64_bf16 v[64:67], v[56:59], v[76:83], v1
  buffer_load_dwordx4 v0, s[8:11], s63 offen offset:0 sc1 lds
  v_mov_b32_dpp v62, v54 row_ror:8 row_mask:0xf bank_mask:0xf
  v_smfmac_f32_16x16x64_bf16 v[68:71], v[56:59], v[84:91], v1
  buffer_store_dwordx4 v[124:127], v0, s[8:11], s65 offen sc1
  v_mov_b32_dpp v63, v55 row_ror:8 row_mask:0xf bank_mask:0xf
L_cm_64:
  v_smfmac_f32_16x16x64_bf16 v[72:75], v[56:59], v[92:99], v1
  s_waitcnt lgkmcnt(0)
  s_barrier
  ds_read_b128 v[16:19], v8 offset:0
  v_smfmac_f32_16x16x64_bf16 v[64:67], v[60:63], v[100:107], v1
  ds_read_b128 v[20:23], v8 offset:1024
  v_smfmac_f32_16x16x64_bf16 v[68:71], v[60:63], v[136:143], v1
  ds_read_b128 v[24:27], v9 offset:0
  buffer_load_dwordx4 v[120:123], v0, s[8:11], s64 offen offset:1024 sc1
  v_smfmac_f32_16x16x64_bf16 v[72:75], v[60:63], v[152:159], v1
  s_waitcnt lgkmcnt(2)
  ds_read_b128 v[28:31], v9 offset:1024
  v_smfmac_f32_16x16x64_bf16 v[64:67], v[16:19], v[160:167], v1
  ds_read_b128 v[32:35], v10 offset:0
  v_mov_b32_dpp v40, v16 row_ror:8 row_mask:0xf bank_mask:0xf
  v_smfmac_f32_16x16x64_bf16 v[68:71], v[16:19], v[176:183], v1
  s_waitcnt lgkmcnt(3)
  ds_read_b128 v[36:39], v10 offset:1024
  v_mov_b32_dpp v41, v17 row_ror:8 row_mask:0xf bank_mask:0xf
  v_smfmac_f32_16x16x64_bf16 v[64:67], v[20:23], v[208:215], v1
  ds_read_b128 v[56:59], v11 offset:0
  v_mov_b32_dpp v42, v18 row_ror:8 row_mask:0xf bank_mask:0xf
  v_smfmac_f32_16x16x64_bf16 v[68:71], v[20:23], v[224:231], v1
  s_waitcnt lgkmcnt(4)
  ds_read_b128 v[60:63], v11 offset:1024
  v_mov_b32_dpp v43, v19 row_ror:8 row_mask:0xf bank_mask:0xf
  v_smfmac_f32_16x16x64_bf16 v[64:67], v[24:27], a[0:7], v1
  ds_read_b128 v[76:79], v6 offset:16384
  v_mov_b32_dpp v44, v20 row_ror:8 row_mask:0xf bank_mask:0xf
  v_smfmac_f32_16x16x64_bf16 v[68:71], v[24:27], a[16:23], v1
  ds_read_b128 v[80:83], v6 offset:17408
  v_mov_b32_dpp v45, v21 row_ror:8 row_mask:0xf bank_mask:0xf
  v_smfmac_f32_16x16x64_bf16 v[64:67], v[40:43], v[168:175], v1
  ds_read_b128 v[84:87], v6 offset:18432
  v_mov_b32_dpp v46, v22 row_ror:8 row_mask:0xf bank_mask:0xf
  v_smfmac_f32_16x16x64_bf16 v[68:71], v[40:43], v[184:191], v1
  s_waitcnt lgkmcnt(7)
  v_mov_b32_dpp v47, v23 row_ror:8 row_mask:0xf bank_mask:0xf
  v_smfmac_f32_16x16x64_bf16 v[64:67], v[28:31], a[48:55], v1
  s_waitcnt vmcnt(3)
  ds_read_b128 v[88:91], v6 offset:19456
  v_mov_b32_dpp v48, v24 row_ror:8 row_mask:0xf bank_mask:0xf
  v_smfmac_f32_16x16x64_bf16 v[68:71], v[28:31], a[64:71], v1
  ds_read_b128 v[92:95], v6 offset:20480
  v_mov_b32_dpp v49, v25 row_ror:8 row_mask:0xf bank_mask:0xf
  v_smfmac_f32_16x16x64_bf16 v[64:67], v[44:47], v[216:223], v1
  ds_read_b128 v[96:99], v6 offset:21504
  v_mov_b32_dpp v50, v26 row_ror:8 row_mask:0xf bank_mask:0xf
  v_smfmac_f32_16x16x64_bf16 v[68:71], v[44:47], v[232:239], v1
  s_waitcnt lgkmcnt(4)
  v_mov_b32_dpp v51, v27 row_ror:8 row_mask:0xf bank_mask:0xf
  v_smfmac_f32_16x16x64_bf16 v[64:67], v[32:35], v[76:83], v1
  ds_read_b128 v[100:103], v6 offset:22528
  v_mov_b32_dpp v52, v28 row_ror:8 row_mask:0xf bank_mask:0xf
  v_smfmac_f32_16x16x64_bf16 v[68:71], v[32:35], a[96:103], v1
  s_waitcnt lgkmcnt(3)
  ds_read_b128 v[104:107], v6 offset:23552
  v_mov_b32_dpp v53, v29 row_ror:8 row_mask:0xf bank_mask:0xf
  v_smfmac_f32_16x16x64_bf16 v[64:67], v[56:59], v[84:91], v1
  v_mov_b32_dpp v54, v30 row_ror:8 row_mask:0xf bank_mask:0xf
  v_smfmac_f32_16x16x64_bf16 v[68:71], v[56:59], a[104:111], v1
  s_waitcnt lgkmcnt(2)
  v_mov_b32_dpp v55, v31 row_ror:8 row_mask:0xf bank_mask:0xf
  v_smfmac_f32_16x16x64_bf16 v[64:67], v[36:39], v[92:99], v1
  ds_read_b128 v[76:79], v0 offset:12288
  v_smfmac_f32_16x16x64_bf16 v[68:71], v[36:39], a[128:135], v1
  s_waitcnt lgkmcnt(1)
  buffer_load_dwordx4 v0, s[8:11], s63 offen offset:1024 sc1 lds
  ds_read_b128 v[80:83], v0 offset:16384
  v_smfmac_f32_16x16x64_bf16 v[64:67], v[60:63], v[100:107], v1
  ds_read_b128 v[84:87], v0 offset:13312
  v_mov_b64 v[124:125], s[88:89]
  v_smfmac_f32_16x16x64_bf16 v[68:71], v[60:63], a[136:143], v1
  ds_read_b128 v[88:91], v0 offset:17408
  v_mov_b64 v[126:127], s[88:89]
  v_smfmac_f32_16x16x64_bf16 v[64:67], v[48:51], a[8:15], v1
  ds_read_b128 v[92:95], v0 offset:14336
  v_smfmac_f32_16x16x64_bf16 v[64:67], v[52:55], a[56:63], v1
  ds_read_b128 v[96:99], v0 offset:18432
  v_smfmac_f32_16x16x64_bf16 v[68:71], v[48:51], a[24:31], v1
  ds_read_b128 v[100:103], v0 offset:15360
  v_smfmac_f32_16x16x64_bf16 v[68:71], v[52:55], a[72:79], v1
  ds_read_b128 v[104:107], v0 offset:19456
  v_cvt_pk_bf16_f32 v64, v64, v65
  v_cvt_pk_bf16_f32 v65, v66, v67
  v_smfmac_f32_16x16x64_bf16 v[72:75], v[16:19], v[192:199], v1
  ds_write_b64 v4, v[64:65] offset:8192
  v_smfmac_f32_16x16x64_bf16 v[72:75], v[20:23], v[240:247], v1
  v_cvt_pk_bf16_f32 v68, v68, v69
  v_cvt_pk_bf16_f32 v69, v70, v71
  v_smfmac_f32_16x16x64_bf16 v[72:75], v[24:27], a[32:39], v1
  ds_write_b64 v4, v[68:69] offset:29696
  v_smfmac_f32_16x16x64_bf16 v[72:75], v[28:31], a[80:87], v1
  v_smfmac_f32_16x16x64_bf16 v[72:75], v[32:35], a[112:119], v1
  v_smfmac_f32_16x16x64_bf16 v[72:75], v[36:39], a[144:151], v1
  buffer_load_dword v12, off, s[8:11], s69 sc1
  v_smfmac_f32_16x16x64_bf16 v[72:75], v[40:43], v[200:207], v1
  s_waitcnt lgkmcnt(0)
  s_barrier
  ds_read_b64_tr_b16 v[16:17], v5 offset:8192
  ds_read_b64_tr_b16 v[18:19], v5 offset:8512
  v_smfmac_f32_16x16x64_bf16 v[72:75], v[44:47], v[248:255], v1
  ds_read_b64_tr_b16 v[20:21], v5 offset:8832
  v_or_b32 v68, 1, v68
  v_smfmac_f32_16x16x64_bf16 v[72:75], v[48:51], a[40:47], v1
  ds_read_b64_tr_b16 v[22:23], v5 offset:9152
  v_smfmac_f32_16x16x64_bf16 v[72:75], v[52:55], a[88:95], v1
  ds_read_b64_tr_b16 v[32:33], v13 offset:29696
  v_smfmac_f32_16x16x64_bf16 v[72:75], v[56:59], a[120:127], v1
  buffer_load_dwordx4 v[116:119], v0, s[8:11], s64 offen offset:0 sc1
  ds_read_b64_tr_b16 v[34:35], v13 offset:29760
  v_smfmac_f32_16x16x64_bf16 v[72:75], v[60:63], a[152:159], v1
  s_waitcnt lgkmcnt(4)
  ds_read_b64_tr_b16 v[24:25], v5 offset:9472
  ds_read_b64_tr_b16 v[26:27], v5 offset:9792
  v_mfma_f32_16x16x32_bf16 v[64:67], v[76:79], v[16:19], 0
  ds_read_b64_tr_b16 v[28:29], v5 offset:10112
  v_mov_b64 v[44:45], 0
  v_mfma_f32_16x16x32_bf16 v[48:51], v[80:83], v[16:19], 0
  s_waitcnt lgkmcnt(5)
  ds_read_b64_tr_b16 v[30:31], v5 offset:10432
  v_mov_b64 v[46:47], 0
  v_mfma_f32_16x16x32_bf16 v[64:67], v[84:87], v[20:23], v[64:67]
  s_waitcnt lgkmcnt(4)
  ds_read_b64_tr_b16 v[36:37], v13 offset:30976
  v_cvt_pk_bf16_f32 v71, v74, v75
  v_smfmac_f32_16x16x64_bf16 v[44:47], v[32:35], v[16:23], v1
  ds_read_b64_tr_b16 v[38:39], v13 offset:31040
  v_cvt_pk_bf16_f32 v70, v72, v73
  v_mfma_f32_16x16x32_bf16 v[48:51], v[88:91], v[20:23], v[48:51]
  s_waitcnt lgkmcnt(4)
  ds_read_b128 v[76:79], v6 offset:24576
  v_mov_b64 v[56:57], 0
  v_mfma_f32_16x16x32_bf16 v[64:67], v[92:95], v[24:27], v[64:67]
  ds_read_b128 v[84:87], v6 offset:26624
  v_mfma_f32_16x16x32_bf16 v[48:51], v[96:99], v[24:27], v[48:51]
  s_waitcnt lgkmcnt(2)
  ds_read_b128 v[88:91], v6 offset:27648
  v_smfmac_f32_16x16x64_bf16 v[44:47], v[36:39], v[24:31], v1
  v_mov_b64 v[52:53], 0
  v_mfma_f32_16x16x32_bf16 v[64:67], v[100:103], v[28:31], v[64:67]
  v_mov_b64 v[60:61], 0
  v_mfma_f32_16x16x32_bf16 v[48:51], v[104:107], v[28:31], v[48:51]
  ds_read_b128 v[92:95], v6 offset:28672
  ds_read_b128 v[104:107], v6 offset:31744
  v_permlane32_swap_b32 v44, v46
  v_permlane32_swap_b32 v45, v47
  v_pk_add_f32 v[44:45], v[44:45], v[46:47]
  v_max_f32 v14, v44, v45
  v_max3_f32 v14, v14, v64, v65
  v_max3_f32 v14, v14, v66, v67
  v_max3_f32 v14, v14, v48, v49
  v_max3_f32 v14, v14, v50, v51
  v_mov_b32 v15, v14
  v_mov_b32 v22, 0
  v_mov_b64 v[28:29], 0
  v_permlane32_swap_b32 v14, v15
  v_max_f32 v14, v14, v15
  v_mov_b32 v15, v14
  v_mov_b64 v[62:63], 0
  v_mov_b32 v21, 0
  v_permlane16_swap_b32 v14, v15
  v_max_f32 v14, v14, v15
  v_mul_f32 v14, -s78, v14
  v_pk_fma_f32 v[44:45], v[44:45], s[78:79], v[14:15] op_sel_hi:[1,1,0]
  v_exp_f32 v44, v44
  v_exp_f32 v45, v45
  v_pk_fma_f32 v[64:65], v[64:65], s[78:79], v[14:15] op_sel_hi:[1,1,0]
  v_cvt_pk_bf16_f32 v20, v44, v45
  v_cvt_pk_bf16_f32 v23, v44, v45
  v_pk_fma_f32 v[66:67], v[66:67], s[78:79], v[14:15] op_sel_hi:[1,1,0]
  v_pk_fma_f32 v[48:49], v[48:49], s[78:79], v[14:15] op_sel_hi:[1,1,0]
  v_permlane32_swap_b32 v20, v21
  v_permlane32_swap_b32 v22, v23
  v_pk_fma_f32 v[50:51], v[50:51], s[78:79], v[14:15] op_sel_hi:[1,1,0]
  v_exp_f32 v64, v64
  v_mfma_f32_16x16x16_bf16 v[40:43], v[124:125], v[20:21], 0
  v_exp_f32 v65, v65
  v_exp_f32 v66, v66
  v_mfma_f32_16x16x16_bf16 v[32:35], v[70:71], v[20:21], 0
  v_exp_f32 v67, v67
  v_exp_f32 v48, v48
  v_mfma_f32_16x16x16_bf16 v[36:39], v[70:71], v[22:23], 0
  v_exp_f32 v49, v49
  v_cvt_pk_bf16_f32 v16, v64, v65
  v_exp_f32 v50, v50
  v_cvt_pk_bf16_f32 v17, v66, v67
  v_exp_f32 v51, v51
  v_cvt_pk_bf16_f32 v18, v48, v49
  v_cvt_pk_bf16_f32 v19, v50, v51
  v_mov_b64 v[54:55], 0
  s_nop 0
  v_mfma_f32_16x16x32_bf16 v[40:43], v[124:127], v[16:19], v[40:43]
  ds_read_b128 v[80:83], v6 offset:25600
  v_mov_b64 v[58:59], 0
  v_mfma_f32_16x16x32_bf16 v[32:35], v[108:111], v[16:19], v[32:35]
  v_mfma_f32_16x16x32_bf16 v[36:39], v[112:115], v[16:19], v[36:39]
  ds_read_b128 v[100:103], v6 offset:30720
  v_rcp_f32 v14, v40
  v_mov_b64 v[126:127], v[70:71]
  s_nop 0
  v_pk_mul_f32 v[32:33], v[32:33], v[14:15] op_sel_hi:[1,0]
  v_pk_mul_f32 v[34:35], v[34:35], v[14:15] op_sel_hi:[1,0]
  v_cvt_pk_bf16_f32 v24, v32, v33
  v_cvt_pk_bf16_f32 v25, v34, v35
  v_pk_mul_f32 v[36:37], v[36:37], v[14:15] op_sel_hi:[1,0]
  v_pk_mul_f32 v[38:39], v[38:39], v[14:15] op_sel_hi:[1,0]
  v_cvt_pk_bf16_f32 v26, v36, v37
  v_cvt_pk_bf16_f32 v27, v38, v39
  ds_write_b128 v7, v[24:27]
  v_mov_b64 v[30:31], 0
  v_smfmac_f32_16x16x64_bf16 v[52:55], v[24:27], a[160:167], v1
  v_smfmac_f32_16x16x64_bf16 v[56:59], v[24:27], a[176:183], v1
  ds_read_b128 v[96:99], v6 offset:29696
  v_smfmac_f32_16x16x64_bf16 v[60:63], v[24:27], a[192:199], v1
  s_waitcnt lgkmcnt(1)
  s_barrier
  ds_read_b128 v[16:19], v8
  ds_read_b128 v[20:23], v9
  ds_read_b128 v[44:47], v10
  v_mov_b64 v[124:125], v[68:69]
  v_smfmac_f32_16x16x64_bf16 v[28:31], v[24:27], a[208:215], v1
  s_waitcnt lgkmcnt(2)
  v_smfmac_f32_16x16x64_bf16 v[52:55], v[16:19], a[168:175], v1
  s_waitcnt lgkmcnt(1)
  v_smfmac_f32_16x16x64_bf16 v[52:55], v[20:23], v[76:83], v1
  s_waitcnt lgkmcnt(0)
  v_smfmac_f32_16x16x64_bf16 v[52:55], v[44:47], v[84:91], v1
  v_smfmac_f32_16x16x64_bf16 v[56:59], v[16:19], a[184:191], v1
  v_smfmac_f32_16x16x64_bf16 v[56:59], v[20:23], v[92:99], v1
  v_cvt_pk_bf16_f32 v64, v52, v53
  v_smfmac_f32_16x16x64_bf16 v[56:59], v[44:47], v[100:107], v1
  v_and_b32 v64, -2, v64
  v_smfmac_f32_16x16x64_bf16 v[60:63], v[16:19], a[200:207], v1
  v_cvt_pk_bf16_f32 v65, v54, v55
  v_smfmac_f32_16x16x64_bf16 v[28:31], v[16:19], a[216:223], v1
  v_cvt_pk_bf16_f32 v66, v56, v57
  v_smfmac_f32_16x16x64_bf16 v[60:63], v[20:23], a[224:231], v1
  v_cvt_pk_bf16_f32 v67, v58, v59
  v_smfmac_f32_16x16x64_bf16 v[60:63], v[44:47], a[232:239], v1
  buffer_store_dwordx4 v[64:67], v2, s[8:11], 0 offen sc1
  v_smfmac_f32_16x16x64_bf16 v[28:31], v[20:23], a[240:247], v1
  v_smfmac_f32_16x16x64_bf16 v[28:31], v[44:47], a[248:255], v1
  v_cvt_pk_bf16_f32 v72, v60, v61
  v_and_b32 v72, -2, v72
  v_cvt_pk_bf16_f32 v73, v62, v63
  s_nop 4
  v_cvt_pk_bf16_f32 v74, v28, v29
  v_cvt_pk_bf16_f32 v75, v30, v31
  buffer_store_dwordx4 v[72:75], v2, s[8:11], s74 offen sc1
  ds_read_b128 v[56:59], v0 offset:28672
  ds_read_b128 v[16:19], v6 offset:0
  ds_read_b128 v[20:23], v6 offset:1024
  ds_read_b128 v[24:27], v6 offset:4096
  ds_read_b128 v[28:31], v6 offset:5120
  ds_read_b128 v[32:35], v6 offset:8192
  ds_read_b128 v[36:39], v6 offset:9216
  ds_read_b128 v[40:43], v6 offset:12288
  ds_read_b128 v[44:47], v6 offset:13312
  v_mov_b64 v[64:65], 0
  v_mov_b64 v[66:67], 0
  v_mov_b64 v[68:69], 0
  v_mov_b64 v[70:71], 0
  v_mov_b64 v[72:73], 0
  v_mov_b64 v[74:75], 0
  s_mov_b32 s75, s69
  s_mov_b32 s70, s72
  s_add_u32 s71, s71, 1
  s_add_u32 s69, s69, 4096
  s_cmp_eq_u32 s71, 7
  s_cselect_b32 s28, 7, 0
  s_cselect_b32 s29, 1, 0
  s_sub_u32 s71, s71, s28
  s_add_u32 s72, s72, s29
  s_lshl_b32 s28, s28, 12
  s_sub_u32 s69, s69, s28
  s_add_u32 s63, s63, 0x100000
  s_add_u32 s64, s64, 0x100000
  s_add_u32 s65, s65, 0x100000
  s_add_u32 s62, s62, 1
  v_mov_b64 v[60:61], 0
  s_nop 15
  s_nop 3
  s_waitcnt lgkmcnt(0)
  s_mov_b32 s34, 0
  s_mov_b32 s35, 4
  buffer_load_dwordx4 v[48:51], v0, s[8:11], s73 offen offset:0 sc1
  buffer_load_dwordx4 v[52:55], v0, s[8:11], s73 offen offset:1024 sc1
  s_nop 15
  s_nop 15
  s_nop 7
  buffer_load_dwordx4 v[108:111], v0, s[8:11], s73 offen offset:0 sc1
  buffer_load_dwordx4 v[112:115], v0, s[8:11], s73 offen offset:1024 sc1
L_p1_72:
  s_waitcnt vmcnt(2)
  v_smfmac_f32_16x16x64_bf16 v[60:63], v[56:59], v[48:55], v1
  v_bitop3_b32 v14, v48, v52, 1 bitop3:0xa8
  v_cmp_ne_u32 vcc, 0, v14
  s_cbranch_vccnz L_p1o_73
L_p1d_74:
  s_nop 4
  v_add_f32_dpp v60, v60, v60 row_ror:8 row_mask:0xf bank_mask:0xf
  v_add_f32_dpp v61, v61, v61 row_ror:8 row_mask:0xf bank_mask:0xf
  s_nop 0
  v_add_f32_dpp v60, v60, v60 row_ror:4 row_mask:0xf bank_mask:0xf
  v_add_f32_dpp v61, v61, v61 row_ror:4 row_mask:0xf bank_mask:0xf
  v_cvt_pk_bf16_f32 v60, v60, v61
  v_and_b32_sdwa v60, v60, sext(v1) dst_sel:DWORD dst_unused:UNUSED_PAD src0_sel:DWORD src1_sel:BYTE_3
  buffer_store_dword v60, v3, s[8:11], s67 offen sc1
  v_cmp_gt_u32 vcc, s70, v12
  s_cbranch_vccnz L_pks_70
L_pkb_71:
  ds_read_b128 v[76:79], v6 offset:2048
  ds_read_b128 v[80:83], v6 offset:3072
  ds_read_b128 v[84:87], v6 offset:6144
  ds_read_b128 v[88:91], v6 offset:7168
  ds_read_b128 v[92:95], v6 offset:10240
  ds_read_b128 v[96:99], v6 offset:11264
  ds_read_b128 v[100:103], v6 offset:14336
  ds_read_b128 v[104:107], v6 offset:15360
  s_mov_b32 m0, s90
  s_barrier
  s_nop 3
  s_mov_b32 s34, 0
  s_mov_b32 s35, 5
  buffer_load_dwordx4 v[48:51], v0, s[8:11], s66 offen offset:0 sc1
  buffer_load_dwordx4 v[52:55], v0, s[8:11], s66 offen offset:1024 sc1
  s_nop 15
  s_nop 15
  s_nop 3
  buffer_load_dwordx4 v[108:111], v0, s[8:11], s66 offen offset:0 sc1
  buffer_load_dwordx4 v[112:115], v0, s[8:11], s66 offen offset:1024 sc1
  s_waitcnt vmcnt(2) lgkmcnt(0)
  s_cmp_eq_u32 s62, 63
  s_cbranch_scc1 L_cs_fin
L_st_75:
  v_smfmac_f32_16x16x64_bf16 v[64:67], v[48:51], v[16:23], v1
  v_bitop3_b32 v14, v48, v52, 1 bitop3:0xa8
  v_cmp_ne_u32 vcc, 0, v14
  v_smfmac_f32_16x16x64_bf16 v[68:71], v[48:51], v[24:31], v1
  v_mov_b32_dpp v56, v48 row_ror:8 row_mask:0xf bank_mask:0xf
  v_smfmac_f32_16x16x64_bf16 v[72:75], v[48:51], v[32:39], v1
  s_cbranch_vccnz L_rtA_77
  ds_write_b128 v7, v[48:51]
  v_mov_b32_dpp v57, v49 row_ror:8 row_mask:0xf bank_mask:0xf
  v_smfmac_f32_16x16x64_bf16 v[64:67], v[52:55], v[40:47], v1
  v_mov_b32_dpp v58, v50 row_ror:8 row_mask:0xf bank_mask:0xf
  v_smfmac_f32_16x16x64_bf16 v[68:71], v[52:55], v[128:135], v1
  ds_write_b128 v7, v[52:55] offset:1024
  v_mov_b32_dpp v59, v51 row_ror:8 row_mask:0xf bank_mask:0xf
  v_mov_b32_dpp v60, v52 row_ror:8 row_mask:0xf bank_mask:0xf
  v_smfmac_f32_16x16x64_bf16 v[72:75], v[52:55], v[144:151], v1
  v_mov_b32_dpp v61, v53 row_ror:8 row_mask:0xf bank_mask:0xf
  v_smfmac_f32_16x16x64_bf16 v[64:67], v[56:59], v[76:83], v1
  buffer_load_dwordx4 v0, s[8:11], s63 offen offset:0 sc1 lds
  v_mov_b32_dpp v62, v54 row_ror:8 row_mask:0xf bank_mask:0xf
  v_smfmac_f32_16x16x64_bf16 v[68:71], v[56:59], v[84:91], v1
  buffer_store_dwordx4 v[124:127], v0, s[8:11], s65 offen sc1
  v_mov_b32_dpp v63, v55 row_ror:8 row_mask:0xf bank_mask:0xf
L_cm_76:
  v_smfmac_f32_16x16x64_bf16 v[72:75], v[56:59], v[92:99], v1
  s_waitcnt lgkmcnt(0)
  s_barrier
  ds_read_b128 v[16:19], v8 offset:0
  v_smfmac_f32_16x16x64_bf16 v[64:67], v[60:63], v[100:107], v1
  ds_read_b128 v[20:23], v8 offset:1024
  v_smfmac_f32_16x16x64_bf16 v[68:71], v[60:63], v[136:143], v1
  ds_read_b128 v[24:27], v9 offset:0
  buffer_load_dwordx4 v[112:115], v0, s[8:11], s64 offen offset:1024 sc1
  v_smfmac_f32_16x16x64_bf16 v[72:75], v[60:63], v[152:159], v1
  s_waitcnt lgkmcnt(2)
  ds_read_b128 v[28:31], v9 offset:1024
  v_smfmac_f32_16x16x64_bf16 v[64:67], v[16:19], v[160:167], v1
  ds_read_b128 v[32:35], v10 offset:0
  v_mov_b32_dpp v40, v16 row_ror:8 row_mask:0xf bank_mask:0xf
  v_smfmac_f32_16x16x64_bf16 v[68:71], v[16:19], v[176:183], v1
  s_waitcnt lgkmcnt(3)
  ds_read_b128 v[36:39], v10 offset:1024
  v_mov_b32_dpp v41, v17 row_ror:8 row_mask:0xf bank_mask:0xf
  v_smfmac_f32_16x16x64_bf16 v[64:67], v[20:23], v[208:215], v1
  ds_read_b128 v[56:59], v11 offset:0
  v_mov_b32_dpp v42, v18 row_ror:8 row_mask:0xf bank_mask:0xf
  v_smfmac_f32_16x16x64_bf16 v[68:71], v[20:23], v[224:231], v1
  s_waitcnt lgkmcnt(4)
  ds_read_b128 v[60:63], v11 offset:1024
  v_mov_b32_dpp v43, v19 row_ror:8 row_mask:0xf bank_mask:0xf
  v_smfmac_f32_16x16x64_bf16 v[64:67], v[24:27], a[0:7], v1
  ds_read_b128 v[76:79], v6 offset:16384
  v_mov_b32_dpp v44, v20 row_ror:8 row_mask:0xf bank_mask:0xf
  v_smfmac_f32_16x16x64_bf16 v[68:71], v[24:27], a[16:23], v1
  ds_read_b128 v[80:83], v6 offset:17408
  v_mov_b32_dpp v45, v21 row_ror:8 row_mask:0xf bank_mask:0xf
  v_smfmac_f32_16x16x64_bf16 v[64:67], v[40:43], v[168:175], v1
  ds_read_b128 v[84:87], v6 offset:18432
  v_mov_b32_dpp v46, v22 row_ror:8 row_mask:0xf bank_mask:0xf
  v_smfmac_f32_16x16x64_bf16 v[68:71], v[40:43], v[184:191], v1
  s_waitcnt lgkmcnt(7)
  v_mov_b32_dpp v47, v23 row_ror:8 row_mask:0xf bank_mask:0xf
  v_smfmac_f32_16x16x64_bf16 v[64:67], v[28:31], a[48:55], v1
  s_waitcnt vmcnt(3)
  ds_read_b128 v[88:91], v6 offset:19456
  v_mov_b32_dpp v48, v24 row_ror:8 row_mask:0xf bank_mask:0xf
  v_smfmac_f32_16x16x64_bf16 v[68:71], v[28:31], a[64:71], v1
  ds_read_b128 v[92:95], v6 offset:20480
  v_mov_b32_dpp v49, v25 row_ror:8 row_mask:0xf bank_mask:0xf
  v_smfmac_f32_16x16x64_bf16 v[64:67], v[44:47], v[216:223], v1
  ds_read_b128 v[96:99], v6 offset:21504
  v_mov_b32_dpp v50, v26 row_ror:8 row_mask:0xf bank_mask:0xf
  v_smfmac_f32_16x16x64_bf16 v[68:71], v[44:47], v[232:239], v1
  s_waitcnt lgkmcnt(4)
  v_mov_b32_dpp v51, v27 row_ror:8 row_mask:0xf bank_mask:0xf
  v_smfmac_f32_16x16x64_bf16 v[64:67], v[32:35], v[76:83], v1
  ds_read_b128 v[100:103], v6 offset:22528
  v_mov_b32_dpp v52, v28 row_ror:8 row_mask:0xf bank_mask:0xf
  v_smfmac_f32_16x16x64_bf16 v[68:71], v[32:35], a[96:103], v1
  s_waitcnt lgkmcnt(3)
  ds_read_b128 v[104:107], v6 offset:23552
  v_mov_b32_dpp v53, v29 row_ror:8 row_mask:0xf bank_mask:0xf
  v_smfmac_f32_16x16x64_bf16 v[64:67], v[56:59], v[84:91], v1
  v_mov_b32_dpp v54, v30 row_ror:8 row_mask:0xf bank_mask:0xf
  v_smfmac_f32_16x16x64_bf16 v[68:71], v[56:59], a[104:111], v1
  s_waitcnt lgkmcnt(2)
  v_mov_b32_dpp v55, v31 row_ror:8 row_mask:0xf bank_mask:0xf
  v_smfmac_f32_16x16x64_bf16 v[64:67], v[36:39], v[92:99], v1
  ds_read_b128 v[76:79], v0 offset:20480
  v_smfmac_f32_16x16x64_bf16 v[68:71], v[36:39], a[128:135], v1
  s_waitcnt lgkmcnt(1)
  buffer_load_dwordx4 v0, s[8:11], s63 offen offset:1024 sc1 lds
  ds_read_b128 v[80:83], v0 offset:24576
  v_smfmac_f32_16x16x64_bf16 v[64:67], v[60:63], v[100:107], v1
  ds_read_b128 v[84:87], v0 offset:21504
  v_mov_b64 v[124:125], s[88:89]
  v_smfmac_f32_16x16x64_bf16 v[68:71], v[60:63], a[136:143], v1
  ds_read_b128 v[88:91], v0 offset:25600
  v_mov_b64 v[126:127], s[88:89]
  v_smfmac_f32_16x16x64_bf16 v[64:67], v[48:51], a[8:15], v1
  ds_read_b128 v[92:95], v0 offset:22528
  v_smfmac_f32_16x16x64_bf16 v[64:67], v[52:55], a[56:63], v1
  ds_read_b128 v[96:99], v0 offset:26624
  v_smfmac_f32_16x16x64_bf16 v[68:71], v[48:51], a[24:31], v1
  ds_read_b128 v[100:103], v0 offset:23552
  v_smfmac_f32_16x16x64_bf16 v[68:71], v[52:55], a[72:79], v1
  ds_read_b128 v[104:107], v0 offset:27648
  v_cvt_pk_bf16_f32 v64, v64, v65
  v_cvt_pk_bf16_f32 v65, v66, v67
  v_smfmac_f32_16x16x64_bf16 v[72:75], v[16:19], v[192:199], v1
  ds_write_b64 v4, v[64:65] offset:8192
  v_smfmac_f32_16x16x64_bf16 v[72:75], v[20:23], v[240:247], v1
  v_cvt_pk_bf16_f32 v68, v68, v69
  v_cvt_pk_bf16_f32 v69, v70, v71
  v_smfmac_f32_16x16x64_bf16 v[72:75], v[24:27], a[32:39], v1
  ds_write_b64 v4, v[68:69] offset:29696
  v_smfmac_f32_16x16x64_bf16 v[72:75], v[28:31], a[80:87], v1
  v_smfmac_f32_16x16x64_bf16 v[72:75], v[32:35], a[112:119], v1
  v_smfmac_f32_16x16x64_bf16 v[72:75], v[36:39], a[144:151], v1
  buffer_load_dword v12, off, s[8:11], s69 sc1
  v_smfmac_f32_16x16x64_bf16 v[72:75], v[40:43], v[200:207], v1
  s_waitcnt lgkmcnt(0)
  s_barrier
  ds_read_b64_tr_b16 v[16:17], v5 offset:8192
  ds_read_b64_tr_b16 v[18:19], v5 offset:8512
  v_smfmac_f32_16x16x64_bf16 v[72:75], v[44:47], v[248:255], v1
  ds_read_b64_tr_b16 v[20:21], v5 offset:8832
  v_or_b32 v68, 1, v68
  v_smfmac_f32_16x16x64_bf16 v[72:75], v[48:51], a[40:47], v1
  ds_read_b64_tr_b16 v[22:23], v5 offset:9152
  v_smfmac_f32_16x16x64_bf16 v[72:75], v[52:55], a[88:95], v1
  ds_read_b64_tr_b16 v[32:33], v13 offset:29696
  v_smfmac_f32_16x16x64_bf16 v[72:75], v[56:59], a[120:127], v1
  buffer_load_dwordx4 v[108:111], v0, s[8:11], s64 offen offset:0 sc1
  ds_read_b64_tr_b16 v[34:35], v13 offset:29760
  v_smfmac_f32_16x16x64_bf16 v[72:75], v[60:63], a[152:159], v1
  s_waitcnt lgkmcnt(4)
  ds_read_b64_tr_b16 v[24:25], v5 offset:9472
  ds_read_b64_tr_b16 v[26:27], v5 offset:9792
  v_mfma_f32_16x16x32_bf16 v[64:67], v[76:79], v[16:19], 0
  ds_read_b64_tr_b16 v[28:29], v5 offset:10112
  v_mov_b64 v[44:45], 0
  v_mfma_f32_16x16x32_bf16 v[48:51], v[80:83], v[16:19], 0
  s_waitcnt lgkmcnt(5)
  ds_read_b64_tr_b16 v[30:31], v5 offset:10432
  v_mov_b64 v[46:47], 0
  v_mfma_f32_16x16x32_bf16 v[64:67], v[84:87], v[20:23], v[64:67]
  s_waitcnt lgkmcnt(4)
  ds_read_b64_tr_b16 v[36:37], v13 offset:30976
  v_cvt_pk_bf16_f32 v71, v74, v75
  v_smfmac_f32_16x16x64_bf16 v[44:47], v[32:35], v[16:23], v1
  ds_read_b64_tr_b16 v[38:39], v13 offset:31040
  v_cvt_pk_bf16_f32 v70, v72, v73
  v_mfma_f32_16x16x32_bf16 v[48:51], v[88:91], v[20:23], v[48:51]
  s_waitcnt lgkmcnt(4)
  ds_read_b128 v[76:79], v6 offset:24576
  v_mov_b64 v[56:57], 0
  v_mfma_f32_16x16x32_bf16 v[64:67], v[92:95], v[24:27], v[64:67]
  ds_read_b128 v[84:87], v6 offset:26624
  v_mfma_f32_16x16x32_bf16 v[48:51], v[96:99], v[24:27], v[48:51]
  s_waitcnt lgkmcnt(2)
  ds_read_b128 v[88:91], v6 offset:27648
  v_smfmac_f32_16x16x64_bf16 v[44:47], v[36:39], v[24:31], v1
  v_mov_b64 v[52:53], 0
  v_mfma_f32_16x16x32_bf16 v[64:67], v[100:103], v[28:31], v[64:67]
  v_mov_b64 v[60:61], 0
  v_mfma_f32_16x16x32_bf16 v[48:51], v[104:107], v[28:31], v[48:51]
  ds_read_b128 v[92:95], v6 offset:28672
  ds_read_b128 v[104:107], v6 offset:31744
  v_permlane32_swap_b32 v44, v46
  v_permlane32_swap_b32 v45, v47
  v_pk_add_f32 v[44:45], v[44:45], v[46:47]
  v_max_f32 v14, v44, v45
  v_max3_f32 v14, v14, v64, v65
  v_max3_f32 v14, v14, v66, v67
  v_max3_f32 v14, v14, v48, v49
  v_max3_f32 v14, v14, v50, v51
  v_mov_b32 v15, v14
  v_mov_b32 v22, 0
  v_mov_b64 v[28:29], 0
  v_permlane32_swap_b32 v14, v15
  v_max_f32 v14, v14, v15
  v_mov_b32 v15, v14
  v_mov_b64 v[62:63], 0
  v_mov_b32 v21, 0
  v_permlane16_swap_b32 v14, v15
  v_max_f32 v14, v14, v15
  v_mul_f32 v14, -s78, v14
  v_pk_fma_f32 v[44:45], v[44:45], s[78:79], v[14:15] op_sel_hi:[1,1,0]
  v_exp_f32 v44, v44
  v_exp_f32 v45, v45
  v_pk_fma_f32 v[64:65], v[64:65], s[78:79], v[14:15] op_sel_hi:[1,1,0]
  v_cvt_pk_bf16_f32 v20, v44, v45
  v_cvt_pk_bf16_f32 v23, v44, v45
  v_pk_fma_f32 v[66:67], v[66:67], s[78:79], v[14:15] op_sel_hi:[1,1,0]
  v_pk_fma_f32 v[48:49], v[48:49], s[78:79], v[14:15] op_sel_hi:[1,1,0]
  v_permlane32_swap_b32 v20, v21
  v_permlane32_swap_b32 v22, v23
  v_pk_fma_f32 v[50:51], v[50:51], s[78:79], v[14:15] op_sel_hi:[1,1,0]
  v_exp_f32 v64, v64
  v_mfma_f32_16x16x16_bf16 v[40:43], v[124:125], v[20:21], 0
  v_exp_f32 v65, v65
  v_exp_f32 v66, v66
  v_mfma_f32_16x16x16_bf16 v[32:35], v[70:71], v[20:21], 0
  v_exp_f32 v67, v67
  v_exp_f32 v48, v48
  v_mfma_f32_16x16x16_bf16 v[36:39], v[70:71], v[22:23], 0
  v_exp_f32 v49, v49
  v_cvt_pk_bf16_f32 v16, v64, v65
  v_exp_f32 v50, v50
  v_cvt_pk_bf16_f32 v17, v66, v67
  v_exp_f32 v51, v51
  v_cvt_pk_bf16_f32 v18, v48, v49
  v_cvt_pk_bf16_f32 v19, v50, v51
  v_mov_b64 v[54:55], 0
  s_nop 0
  v_mfma_f32_16x16x32_bf16 v[40:43], v[124:127], v[16:19], v[40:43]
  ds_read_b128 v[80:83], v6 offset:25600
  v_mov_b64 v[58:59], 0
  v_mfma_f32_16x16x32_bf16 v[32:35], v[116:119], v[16:19], v[32:35]
  v_mfma_f32_16x16x32_bf16 v[36:39], v[120:123], v[16:19], v[36:39]
  ds_read_b128 v[100:103], v6 offset:30720
  v_rcp_f32 v14, v40
  v_mov_b64 v[126:127], v[70:71]
  s_nop 0
  v_pk_mul_f32 v[32:33], v[32:33], v[14:15] op_sel_hi:[1,0]
  v_pk_mul_f32 v[34:35], v[34:35], v[14:15] op_sel_hi:[1,0]
  v_cvt_pk_bf16_f32 v24, v32, v33
  v_cvt_pk_bf16_f32 v25, v34, v35
  v_pk_mul_f32 v[36:37], v[36:37], v[14:15] op_sel_hi:[1,0]
  v_pk_mul_f32 v[38:39], v[38:39], v[14:15] op_sel_hi:[1,0]
  v_cvt_pk_bf16_f32 v26, v36, v37
  v_cvt_pk_bf16_f32 v27, v38, v39
  ds_write_b128 v7, v[24:27]
  v_mov_b64 v[30:31], 0
  v_smfmac_f32_16x16x64_bf16 v[52:55], v[24:27], a[160:167], v1
  v_smfmac_f32_16x16x64_bf16 v[56:59], v[24:27], a[176:183], v1
  ds_read_b128 v[96:99], v6 offset:29696
  v_smfmac_f32_16x16x64_bf16 v[60:63], v[24:27], a[192:199], v1
  s_waitcnt lgkmcnt(1)
  s_barrier
  ds_read_b128 v[16:19], v8
  ds_read_b128 v[20:23], v9
  ds_read_b128 v[44:47], v10
  v_mov_b64 v[124:125], v[68:69]
  v_smfmac_f32_16x16x64_bf16 v[28:31], v[24:27], a[208:215], v1
  s_waitcnt lgkmcnt(2)
  v_smfmac_f32_16x16x64_bf16 v[52:55], v[16:19], a[168:175], v1
  s_waitcnt lgkmcnt(1)
  v_smfmac_f32_16x16x64_bf16 v[52:55], v[20:23], v[76:83], v1
  s_waitcnt lgkmcnt(0)
  v_smfmac_f32_16x16x64_bf16 v[52:55], v[44:47], v[84:91], v1
  v_smfmac_f32_16x16x64_bf16 v[56:59], v[16:19], a[184:191], v1
  v_smfmac_f32_16x16x64_bf16 v[56:59], v[20:23], v[92:99], v1
  v_cvt_pk_bf16_f32 v64, v52, v53
  v_smfmac_f32_16x16x64_bf16 v[56:59], v[44:47], v[100:107], v1
  v_or_b32 v64, 1, v64
  v_smfmac_f32_16x16x64_bf16 v[60:63], v[16:19], a[200:207], v1
  v_cvt_pk_bf16_f32 v65, v54, v55
  v_smfmac_f32_16x16x64_bf16 v[28:31], v[16:19], a[216:223], v1
  v_cvt_pk_bf16_f32 v66, v56, v57
  v_smfmac_f32_16x16x64_bf16 v[60:63], v[20:23], a[224:231], v1
  v_cvt_pk_bf16_f32 v67, v58, v59
  v_smfmac_f32_16x16x64_bf16 v[60:63], v[44:47], a[232:239], v1
  buffer_store_dwordx4 v[64:67], v2, s[8:11], 0 offen sc1
  v_smfmac_f32_16x16x64_bf16 v[28:31], v[20:23], a[240:247], v1
  v_smfmac_f32_16x16x64_bf16 v[28:31], v[44:47], a[248:255], v1
  v_cvt_pk_bf16_f32 v72, v60, v61
  v_or_b32 v72, 1, v72
  v_cvt_pk_bf16_f32 v73, v62, v63
  s_nop 4
  v_cvt_pk_bf16_f32 v74, v28, v29
  v_cvt_pk_bf16_f32 v75, v30, v31
  buffer_store_dwordx4 v[72:75], v2, s[8:11], s74 offen sc1
  ds_read_b128 v[56:59], v0 offset:28672
  ds_read_b128 v[16:19], v6 offset:0
  ds_read_b128 v[20:23], v6 offset:1024
  ds_read_b128 v[24:27], v6 offset:4096
  ds_read_b128 v[28:31], v6 offset:5120
  ds_read_b128 v[32:35], v6 offset:8192
  ds_read_b128 v[36:39], v6 offset:9216
  ds_read_b128 v[40:43], v6 offset:12288
  ds_read_b128 v[44:47], v6 offset:13312
  v_mov_b64 v[64:65], 0
  v_mov_b64 v[66:67], 0
  v_mov_b64 v[68:69], 0
  v_mov_b64 v[70:71], 0
  v_mov_b64 v[72:73], 0
  v_mov_b64 v[74:75], 0
  s_mov_b32 s75, s69
  s_mov_b32 s70, s72
  s_add_u32 s71, s71, 1
  s_add_u32 s69, s69, 4096
  s_cmp_eq_u32 s71, 7
  s_cselect_b32 s28, 7, 0
  s_cselect_b32 s29, 1, 0
  s_sub_u32 s71, s71, s28
  s_add_u32 s72, s72, s29
  s_lshl_b32 s28, s28, 12
  s_sub_u32 s69, s69, s28
  s_add_u32 s63, s63, 0x100000
  s_add_u32 s64, s64, 0x100000
  s_add_u32 s65, s65, 0x100000
  s_add_u32 s62, s62, 1
  v_mov_b64 v[60:61], 0
  s_nop 15
  s_nop 3
  s_waitcnt lgkmcnt(0)
  s_mov_b32 s34, 0
  s_mov_b32 s35, 4
  buffer_load_dwordx4 v[48:51], v0, s[8:11], s73 offen offset:0 sc1
  buffer_load_dwordx4 v[52:55], v0, s[8:11], s73 offen offset:1024 sc1
  s_nop 15
  s_nop 15
  s_nop 7
  buffer_load_dwordx4 v[116:119], v0, s[8:11], s73 offen offset:0 sc1
  buffer_load_dwordx4 v[120:123], v0, s[8:11], s73 offen offset:1024 sc1
L_p1_84:
  s_waitcnt vmcnt(2)
  v_smfmac_f32_16x16x64_bf16 v[60:63], v[56:59], v[48:55], v1
  v_bitop3_b32 v14, v48, v52, 1 bitop3:0x80
  v_cmp_eq_u32 vcc, 0, v14
  s_cbranch_vccnz L_p1o_85
L_p1d_86:
  s_nop 4
  v_add_f32_dpp v60, v60, v60 row_ror:8 row_mask:0xf bank_mask:0xf
  v_add_f32_dpp v61, v61, v61 row_ror:8 row_mask:0xf bank_mask:0xf
  s_nop 0
  v_add_f32_dpp v60, v60, v60 row_ror:4 row_mask:0xf bank_mask:0xf
  v_add_f32_dpp v61, v61, v61 row_ror:4 row_mask:0xf bank_mask:0xf
  v_cvt_pk_bf16_f32 v60, v60, v61
  v_or_b32_sdwa v60, v60, v1 dst_sel:DWORD dst_unused:UNUSED_PAD src0_sel:DWORD src1_sel:BYTE_2
  buffer_store_dword v60, v3, s[8:11], s67 offen sc1
  v_cmp_gt_u32 vcc, s70, v12
  s_cbranch_vccnz L_pks_82
L_pkb_83:
  ds_read_b128 v[76:79], v6 offset:2048
  ds_read_b128 v[80:83], v6 offset:3072
  ds_read_b128 v[84:87], v6 offset:6144
  ds_read_b128 v[88:91], v6 offset:7168
  ds_read_b128 v[92:95], v6 offset:10240
  ds_read_b128 v[96:99], v6 offset:11264
  ds_read_b128 v[100:103], v6 offset:14336
  ds_read_b128 v[104:107], v6 offset:15360
  s_mov_b32 m0, s91
  s_barrier
  s_nop 3
  s_mov_b32 s34, 0
  s_mov_b32 s35, 5
  buffer_load_dwordx4 v[48:51], v0, s[8:11], s66 offen offset:0 sc1
  buffer_load_dwordx4 v[52:55], v0, s[8:11], s66 offen offset:1024 sc1
  s_nop 15
  s_nop 15
  s_nop 3
  buffer_load_dwordx4 v[116:119], v0, s[8:11], s66 offen offset:0 sc1
  buffer_load_dwordx4 v[120:123], v0, s[8:11], s66 offen offset:1024 sc1
  s_waitcnt vmcnt(2) lgkmcnt(0)
  s_branch L_cs_loop
L_cs_fin:
L_st_87:
  ds_write_b128 v7, v[48:51]
  ds_write_b128 v7, v[52:55] offset:1024
  v_smfmac_f32_16x16x64_bf16 v[68:71], v[48:51], v[24:31], v1
  v_bitop3_b32 v14, v48, v52, 1 bitop3:0xa8
  v_cmp_ne_u32 vcc, 0, v14
  v_smfmac_f32_16x16x64_bf16 v[72:75], v[48:51], v[32:39], v1
  v_smfmac_f32_16x16x64_bf16 v[68:71], v[52:55], v[128:135], v1
  s_cbranch_vccnz L_rtA_89
  v_mov_b32_dpp v56, v48 row_ror:8 row_mask:0xf bank_mask:0xf
  v_mov_b32_dpp v57, v49 row_ror:8 row_mask:0xf bank_mask:0xf
  v_mov_b32_dpp v58, v50 row_ror:8 row_mask:0xf bank_mask:0xf
  v_mov_b32_dpp v59, v51 row_ror:8 row_mask:0xf bank_mask:0xf
  v_smfmac_f32_16x16x64_bf16 v[72:75], v[52:55], v[144:151], v1
  v_mov_b32_dpp v60, v52 row_ror:8 row_mask:0xf bank_mask:0xf
  v_mov_b32_dpp v61, v53 row_ror:8 row_mask:0xf bank_mask:0xf
  v_mov_b32_dpp v62, v54 row_ror:8 row_mask:0xf bank_mask:0xf
  v_mov_b32_dpp v63, v55 row_ror:8 row_mask:0xf bank_mask:0xf
L_cm_88:
  v_smfmac_f32_16x16x64_bf16 v[68:71], v[56:59], v[84:91], v1
  s_waitcnt lgkmcnt(0)
  s_barrier
  ds_read_b128 v[16:19], v8 offset:0
  ds_read_b128 v[20:23], v8 offset:1024
  v_smfmac_f32_16x16x64_bf16 v[72:75], v[56:59], v[92:99], v1
  ds_read_b128 v[24:27], v9 offset:0
  ds_read_b128 v[28:31], v9 offset:1024
  v_smfmac_f32_16x16x64_bf16 v[68:71], v[60:63], v[136:143], v1
  ds_read_b128 v[32:35], v10 offset:0
  ds_read_b128 v[36:39], v10 offset:1024
  v_smfmac_f32_16x16x64_bf16 v[72:75], v[60:63], v[152:159], v1
  s_waitcnt lgkmcnt(5)
  ds_read_b128 v[56:59], v11 offset:0
  ds_read_b128 v[60:63], v11 offset:1024
  v_smfmac_f32_16x16x64_bf16 v[68:71], v[16:19], v[176:183], v1
  buffer_store_dwordx4 v[124:127], v0, s[8:11], s65 offen sc1
  s_add_u32 s65, s65, 0x100000
  v_mov_b32_dpp v40, v16 row_ror:8 row_mask:0xf bank_mask:0xf
  v_mov_b32_dpp v41, v17 row_ror:8 row_mask:0xf bank_mask:0xf
  v_smfmac_f32_16x16x64_bf16 v[72:75], v[16:19], v[192:199], v1
  s_waitcnt lgkmcnt(6)
  v_mov_b32_dpp v42, v18 row_ror:8 row_mask:0xf bank_mask:0xf
  v_smfmac_f32_16x16x64_bf16 v[68:71], v[20:23], v[224:231], v1
  v_mov_b32_dpp v43, v19 row_ror:8 row_mask:0xf bank_mask:0xf
  v_mov_b32_dpp v44, v20 row_ror:8 row_mask:0xf bank_mask:0xf
  v_smfmac_f32_16x16x64_bf16 v[72:75], v[20:23], v[240:247], v1
  s_waitcnt lgkmcnt(5)
  v_mov_b32_dpp v45, v21 row_ror:8 row_mask:0xf bank_mask:0xf
  v_smfmac_f32_16x16x64_bf16 v[68:71], v[24:27], a[16:23], v1
  v_mov_b32_dpp v46, v22 row_ror:8 row_mask:0xf bank_mask:0xf
  v_mov_b32_dpp v47, v23 row_ror:8 row_mask:0xf bank_mask:0xf
  v_smfmac_f32_16x16x64_bf16 v[72:75], v[24:27], a[32:39], v1
  s_waitcnt vmcnt(1) lgkmcnt(4)
  v_mov_b32_dpp v48, v24 row_ror:8 row_mask:0xf bank_mask:0xf
  v_smfmac_f32_16x16x64_bf16 v[68:71], v[28:31], a[64:71], v1
  v_mov_b32_dpp v49, v25 row_ror:8 row_mask:0xf bank_mask:0xf
  v_mov_b32_dpp v50, v26 row_ror:8 row_mask:0xf bank_mask:0xf
  v_smfmac_f32_16x16x64_bf16 v[72:75], v[28:31], a[80:87], v1
  s_waitcnt lgkmcnt(3)
  v_mov_b32_dpp v51, v27 row_ror:8 row_mask:0xf bank_mask:0xf
  v_smfmac_f32_16x16x64_bf16 v[68:71], v[32:35], a[96:103], v1
  v_mov_b32_dpp v52, v28 row_ror:8 row_mask:0xf bank_mask:0xf
  v_mov_b32_dpp v53, v29 row_ror:8 row_mask:0xf bank_mask:0xf
  v_smfmac_f32_16x16x64_bf16 v[72:75], v[32:35], a[112:119], v1
  s_waitcnt lgkmcnt(2)
  v_mov_b32_dpp v54, v30 row_ror:8 row_mask:0xf bank_mask:0xf
  v_smfmac_f32_16x16x64_bf16 v[68:71], v[36:39], a[128:135], v1
  v_mov_b32_dpp v55, v31 row_ror:8 row_mask:0xf bank_mask:0xf
  v_smfmac_f32_16x16x64_bf16 v[72:75], v[36:39], a[144:151], v1
  s_waitcnt lgkmcnt(1)
  v_smfmac_f32_16x16x64_bf16 v[68:71], v[56:59], a[104:111], v1
  v_smfmac_f32_16x16x64_bf16 v[72:75], v[56:59], a[120:127], v1
  s_waitcnt lgkmcnt(0)
  v_smfmac_f32_16x16x64_bf16 v[68:71], v[60:63], a[136:143], v1
  v_smfmac_f32_16x16x64_bf16 v[72:75], v[60:63], a[152:159], v1
  v_smfmac_f32_16x16x64_bf16 v[68:71], v[40:43], v[184:191], v1
  v_smfmac_f32_16x16x64_bf16 v[72:75], v[40:43], v[200:207], v1
  v_smfmac_f32_16x16x64_bf16 v[68:71], v[44:47], v[232:239], v1
  v_smfmac_f32_16x16x64_bf16 v[72:75], v[44:47], v[248:255], v1
  v_smfmac_f32_16x16x64_bf16 v[68:71], v[48:51], a[24:31], v1
  v_smfmac_f32_16x16x64_bf16 v[72:75], v[48:51], a[40:47], v1
  v_smfmac_f32_16x16x64_bf16 v[68:71], v[52:55], a[72:79], v1
  v_smfmac_f32_16x16x64_bf16 v[72:75], v[52:55], a[88:95], v1
  s_nop 3
  v_cvt_pk_bf16_f32 v68, v68, v69
  v_cvt_pk_bf16_f32 v69, v70, v71
  s_nop 1
  v_cvt_pk_bf16_f32 v70, v72, v73
  v_cvt_pk_bf16_f32 v71, v74, v75
  v_or_b32 v68, 1, v68
  buffer_store_dwordx4 v[68:71], v0, s[8:11], s65 offen sc1
  s_waitcnt vmcnt(0)
  s_endpgm
.p2align 6
L_rtA_65:
  s_mov_b64 exec, vcc
  buffer_load_dwordx4 v[48:51], v0, s[8:11], s66 offen offset:0 sc1
  buffer_load_dwordx4 v[52:55], v0, s[8:11], s66 offen offset:1024 sc1
  s_mov_b64 exec, -1
  s_add_u32 s34, s34, 1
  s_cmp_gt_u32 s34, 40000
  s_cbranch_scc1 L_fail
  s_nop 3
  v_mov_b64 v[64:65], 0
  v_mov_b64 v[66:67], 0
  v_mov_b64 v[68:69], 0
  v_mov_b64 v[70:71], 0
  v_mov_b64 v[72:73], 0
  v_mov_b64 v[74:75], 0
  s_waitcnt vmcnt(2) lgkmcnt(0)
  v_smfmac_f32_16x16x64_bf16 v[64:67], v[116:119], v[16:23], v1
  v_bitop3_b32 v14, v116, v120, 1 bitop3:0x80
  v_cmp_eq_u32 vcc, 0, v14
  v_smfmac_f32_16x16x64_bf16 v[68:71], v[116:119], v[24:31], v1
  v_mov_b32_dpp v56, v116 row_ror:8 row_mask:0xf bank_mask:0xf
  v_smfmac_f32_16x16x64_bf16 v[72:75], v[116:119], v[32:39], v1
  s_cbranch_vccnz L_rtB_66
  ds_write_b128 v7, v[116:119]
  v_mov_b32_dpp v57, v117 row_ror:8 row_mask:0xf bank_mask:0xf
  v_smfmac_f32_16x16x64_bf16 v[64:67], v[120:123], v[40:47], v1
  v_mov_b32_dpp v58, v118 row_ror:8 row_mask:0xf bank_mask:0xf
  v_smfmac_f32_16x16x64_bf16 v[68:71], v[120:123], v[128:135], v1
  ds_write_b128 v7, v[120:123] offset:1024
  v_mov_b32_dpp v59, v119 row_ror:8 row_mask:0xf bank_mask:0xf
  v_mov_b32_dpp v60, v120 row_ror:8 row_mask:0xf bank_mask:0xf
  v_smfmac_f32_16x16x64_bf16 v[72:75], v[120:123], v[144:151], v1
  v_mov_b32_dpp v61, v121 row_ror:8 row_mask:0xf bank_mask:0xf
  v_smfmac_f32_16x16x64_bf16 v[64:67], v[56:59], v[76:83], v1
  buffer_load_dwordx4 v0, s[8:11], s63 offen offset:0 sc1 lds
  v_mov_b32_dpp v62, v122 row_ror:8 row_mask:0xf bank_mask:0xf
  v_smfmac_f32_16x16x64_bf16 v[68:71], v[56:59], v[84:91], v1
  buffer_store_dwordx4 v[124:127], v0, s[8:11], s65 offen sc1
  v_mov_b32_dpp v63, v123 row_ror:8 row_mask:0xf bank_mask:0xf
  s_branch L_cm_64
L_rtB_66:
  s_mov_b64 exec, vcc
  buffer_load_dwordx4 v[116:119], v0, s[8:11], s66 offen offset:0 sc1
  buffer_load_dwordx4 v[120:123], v0, s[8:11], s66 offen offset:1024 sc1
  s_mov_b64 exec, -1
  s_add_u32 s34, s34, 1
  s_cmp_gt_u32 s34, 40000
  s_cbranch_scc1 L_fail
  s_nop 3
  v_mov_b64 v[64:65], 0
  v_mov_b64 v[66:67], 0
  v_mov_b64 v[68:69], 0
  v_mov_b64 v[70:71], 0
  v_mov_b64 v[72:73], 0
  v_mov_b64 v[74:75], 0
  s_waitcnt vmcnt(2) lgkmcnt(0)
  s_branch L_st_63
.p2align 6
L_pks_70:
  s_waitcnt lgkmcnt(0)
  s_mov_b32 s34, 0
  s_mov_b32 s35, 3
L_pk_94:
  buffer_load_dword v12, off, s[8:11], s75 sc1
  s_add_u32 s34, s34, 1
  s_cmp_gt_u32 s34, 40000
  s_cbranch_scc1 L_fail
  s_waitcnt vmcnt(0)
  v_cmp_gt_u32 vcc, s70, v12
  s_cbranch_vccnz L_pk_94
  s_branch L_pkb_71
.p2align 6
L_p1o_73:
  s_mov_b64 exec, vcc
  buffer_load_dwordx4 v[48:51], v0, s[8:11], s73 offen offset:0 sc1
  buffer_load_dwordx4 v[52:55], v0, s[8:11], s73 offen offset:1024 sc1
  s_mov_b64 exec, -1
  s_add_u32 s34, s34, 1
  s_cmp_gt_u32 s34, 40000
  s_cbranch_scc1 L_fail
  s_nop 0
  v_mov_b64 v[60:61], 0
  s_nop 0
  s_waitcnt vmcnt(2)
  v_smfmac_f32_16x16x64_bf16 v[60:63], v[56:59], v[108:115], v1
  v_bitop3_b32 v14, v108, v112, 1 bitop3:0xa8
  v_cmp_ne_u32 vcc, 0, v14
  s_cbranch_vccz L_p1d_74
  s_mov_b64 exec, vcc
  buffer_load_dwordx4 v[108:111], v0, s[8:11], s73 offen offset:0 sc1
  buffer_load_dwordx4 v[112:115], v0, s[8:11], s73 offen offset:1024 sc1
  s_mov_b64 exec, -1
  s_add_u32 s34, s34, 1
  s_cmp_gt_u32 s34, 40000
  s_cbranch_scc1 L_fail
  s_nop 0
  v_mov_b64 v[60:61], 0
  s_nop 0
  s_branch L_p1_72
.p2align 6
L_rtA_77:
  s_mov_b64 exec, vcc
  buffer_load_dwordx4 v[48:51], v0, s[8:11], s66 offen offset:0 sc1
  buffer_load_dwordx4 v[52:55], v0, s[8:11], s66 offen offset:1024 sc1
  s_mov_b64 exec, -1
  s_add_u32 s34, s34, 1
  s_cmp_gt_u32 s34, 40000
  s_cbranch_scc1 L_fail
  s_nop 3
  v_mov_b64 v[64:65], 0
  v_mov_b64 v[66:67], 0
  v_mov_b64 v[68:69], 0
  v_mov_b64 v[70:71], 0
  v_mov_b64 v[72:73], 0
  v_mov_b64 v[74:75], 0
  s_waitcnt vmcnt(2) lgkmcnt(0)
  v_smfmac_f32_16x16x64_bf16 v[64:67], v[108:111], v[16:23], v1
  v_bitop3_b32 v14, v108, v112, 1 bitop3:0xa8
  v_cmp_ne_u32 vcc, 0, v14
  v_smfmac_f32_16x16x64_bf16 v[68:71], v[108:111], v[24:31], v1
  v_mov_b32_dpp v56, v108 row_ror:8 row_mask:0xf bank_mask:0xf
  v_smfmac_f32_16x16x64_bf16 v[72:75], v[108:111], v[32:39], v1
  s_cbranch_vccnz L_rtB_78
  ds_write_b128 v7, v[108:111]
  v_mov_b32_dpp v57, v109 row_ror:8 row_mask:0xf bank_mask:0xf
  v_smfmac_f32_16x16x64_bf16 v[64:67], v[112:115], v[40:47], v1
  v_mov_b32_dpp v58, v110 row_ror:8 row_mask:0xf bank_mask:0xf
  v_smfmac_f32_16x16x64_bf16 v[68:71], v[112:115], v[128:135], v1
  ds_write_b128 v7, v[112:115] offset:1024
  v_mov_b32_dpp v59, v111 row_ror:8 row_mask:0xf bank_mask:0xf
  v_mov_b32_dpp v60, v112 row_ror:8 row_mask:0xf bank_mask:0xf
  v_smfmac_f32_16x16x64_bf16 v[72:75], v[112:115], v[144:151], v1
  v_mov_b32_dpp v61, v113 row_ror:8 row_mask:0xf bank_mask:0xf
  v_smfmac_f32_16x16x64_bf16 v[64:67], v[56:59], v[76:83], v1
  buffer_load_dwordx4 v0, s[8:11], s63 offen offset:0 sc1 lds
  v_mov_b32_dpp v62, v114 row_ror:8 row_mask:0xf bank_mask:0xf
  v_smfmac_f32_16x16x64_bf16 v[68:71], v[56:59], v[84:91], v1
  buffer_store_dwordx4 v[124:127], v0, s[8:11], s65 offen sc1
  v_mov_b32_dpp v63, v115 row_ror:8 row_mask:0xf bank_mask:0xf
  s_branch L_cm_76
L_rtB_78:
  s_mov_b64 exec, vcc
  buffer_load_dwordx4 v[108:111], v0, s[8:11], s66 offen offset:0 sc1
  buffer_load_dwordx4 v[112:115], v0, s[8:11], s66 offen offset:1024 sc1
  s_mov_b64 exec, -1
  s_add_u32 s34, s34, 1
  s_cmp_gt_u32 s34, 40000
  s_cbranch_scc1 L_fail
  s_nop 3
  v_mov_b64 v[64:65], 0
  v_mov_b64 v[66:67], 0
  v_mov_b64 v[68:69], 0
  v_mov_b64 v[70:71], 0
  v_mov_b64 v[72:73], 0
  v_mov_b64 v[74:75], 0
  s_waitcnt vmcnt(2) lgkmcnt(0)
  s_branch L_st_75
.p2align 6
L_pks_82:
  s_waitcnt lgkmcnt(0)
  s_mov_b32 s34, 0
  s_mov_b32 s35, 3
L_pk_95:
  buffer_load_dword v12, off, s[8:11], s75 sc1
  s_add_u32 s34, s34, 1
  s_cmp_gt_u32 s34, 40000
  s_cbranch_scc1 L_fail
  s_waitcnt vmcnt(0)
  v_cmp_gt_u32 vcc, s70, v12
  s_cbranch_vccnz L_pk_95
  s_branch L_pkb_83
.p2align 6
L_p1o_85:
  s_mov_b64 exec, vcc
  buffer_load_dwordx4 v[48:51], v0, s[8:11], s73 offen offset:0 sc1
  buffer_load_dwordx4 v[52:55], v0, s[8:11], s73 offen offset:1024 sc1
  s_mov_b64 exec, -1
  s_add_u32 s34, s34, 1
  s_cmp_gt_u32 s34, 40000
  s_cbranch_scc1 L_fail
  s_nop 0
  v_mov_b64 v[60:61], 0
  s_nop 0
  s_waitcnt vmcnt(2)
  v_smfmac_f32_16x16x64_bf16 v[60:63], v[56:59], v[116:123], v1
  v_bitop3_b32 v14, v116, v120, 1 bitop3:0x80
  v_cmp_eq_u32 vcc, 0, v14
  s_cbranch_vccz L_p1d_86
  s_mov_b64 exec, vcc
  buffer_load_dwordx4 v[116:119], v0, s[8:11], s73 offen offset:0 sc1
  buffer_load_dwordx4 v[120:123], v0, s[8:11], s73 offen offset:1024 sc1
  s_mov_b64 exec, -1
  s_add_u32 s34, s34, 1
  s_cmp_gt_u32 s34, 40000
  s_cbranch_scc1 L_fail
  s_nop 0
  v_mov_b64 v[60:61], 0
  s_nop 0
  s_branch L_p1_84
.p2align 6
L_rtA_89:
  s_mov_b64 exec, vcc
  buffer_load_dwordx4 v[48:51], v0, s[8:11], s66 offen offset:0 sc1
  buffer_load_dwordx4 v[52:55], v0, s[8:11], s66 offen offset:1024 sc1
  s_mov_b64 exec, -1
  s_add_u32 s34, s34, 1
  s_cmp_gt_u32 s34, 40000
  s_cbranch_scc1 L_fail
  s_nop 3
  v_mov_b64 v[64:65], 0
  v_mov_b64 v[66:67], 0
  v_mov_b64 v[68:69], 0
  v_mov_b64 v[70:71], 0
  v_mov_b64 v[72:73], 0
  v_mov_b64 v[74:75], 0
  s_waitcnt vmcnt(2) lgkmcnt(0)
  ds_write_b128 v7, v[108:111]
  ds_write_b128 v7, v[112:115] offset:1024
  v_smfmac_f32_16x16x64_bf16 v[68:71], v[108:111], v[24:31], v1
  v_bitop3_b32 v14, v108, v112, 1 bitop3:0xa8
  v_cmp_ne_u32 vcc, 0, v14
  v_smfmac_f32_16x16x64_bf16 v[72:75], v[108:111], v[32:39], v1
  v_smfmac_f32_16x16x64_bf16 v[68:71], v[112:115], v[128:135], v1
  s_cbranch_vccnz L_rtB_90
  v_mov_b32_dpp v56, v108 row_ror:8 row_mask:0xf bank_mask:0xf
  v_mov_b32_dpp v57, v109 row_ror:8 row_mask:0xf bank_mask:0xf
  v_mov_b32_dpp v58, v110 row_ror:8 row_mask:0xf bank_mask:0xf
  v_mov_b32_dpp v59, v111 row_ror:8 row_mask:0xf bank_mask:0xf
  v_smfmac_f32_16x16x64_bf16 v[72:75], v[112:115], v[144:151], v1
  v_mov_b32_dpp v60, v112 row_ror:8 row_mask:0xf bank_mask:0xf
  v_mov_b32_dpp v61, v113 row_ror:8 row_mask:0xf bank_mask:0xf
  v_mov_b32_dpp v62, v114 row_ror:8 row_mask:0xf bank_mask:0xf
  v_mov_b32_dpp v63, v115 row_ror:8 row_mask:0xf bank_mask:0xf
  s_branch L_cm_88
L_rtB_90:
  s_mov_b64 exec, vcc
  buffer_load_dwordx4 v[108:111], v0, s[8:11], s66 offen offset:0 sc1
  buffer_load_dwordx4 v[112:115], v0, s[8:11], s66 offen offset:1024 sc1
  s_mov_b64 exec, -1
  s_add_u32 s34, s34, 1
  s_cmp_gt_u32 s34, 40000
  s_cbranch_scc1 L_fail
  s_nop 3
  v_mov_b64 v[64:65], 0
  v_mov_b64 v[66:67], 0
  v_mov_b64 v[68:69], 0
  v_mov_b64 v[70:71], 0
  v_mov_b64 v[72:73], 0
  v_mov_b64 v[74:75], 0
  s_waitcnt vmcnt(2) lgkmcnt(0)
  s_branch L_st_87
L_cgs_7:
  s_mov_b32 s34, 0
  s_mov_b32 s35, 1
L_gw_96:
  buffer_load_dword v46, v44, s[24:27], 0 offen sc1
  s_add_u32 s34, s34, 1
  s_cmp_gt_u32 s34, 40000
  s_cbranch_scc1 L_fail
  s_waitcnt vmcnt(0)
  v_and_b32 v45, 63, v46
  v_cmp_ne_u32 vcc, 32, v45
  s_cbranch_vccz L_cgb_8
  s_sleep 8
  s_branch L_gw_96
L_cps_9:
  s_mov_b32 s34, 0
  s_mov_b32 s35, 2
L_pk_97:
  buffer_load_dword v12, off, s[8:11], s75 sc1
  s_add_u32 s34, s34, 1
  s_cmp_gt_u32 s34, 40000
  s_cbranch_scc1 L_fail
  s_waitcnt vmcnt(0)
  v_cmp_gt_u32 vcc, s70, v12
  s_cbranch_vccnz L_pk_97
  s_branch L_cpb_10
L_cgs_12:
  s_mov_b32 s34, 0
  s_mov_b32 s35, 1
L_gw_98:
  buffer_load_dword v46, v44, s[24:27], 0 offen sc1
  s_add_u32 s34, s34, 1
  s_cmp_gt_u32 s34, 40000
  s_cbranch_scc1 L_fail
  s_waitcnt vmcnt(0)
  v_and_b32 v45, 63, v46
  v_cmp_ne_u32 vcc, 32, v45
  s_cbranch_vccz L_cgb_13
  s_sleep 8
  s_branch L_gw_98
L_cps_14:
  s_mov_b32 s34, 0
  s_mov_b32 s35, 2
L_pk_99:
  buffer_load_dword v12, off, s[8:11], s75 sc1
  s_add_u32 s34, s34, 1
  s_cmp_gt_u32 s34, 40000
  s_cbranch_scc1 L_fail
  s_waitcnt vmcnt(0)
  v_cmp_gt_u32 vcc, s70, v12
  s_cbranch_vccnz L_pk_99
  s_branch L_cpb_15
L_cgs_17:
  s_mov_b32 s34, 0
  s_mov_b32 s35, 1
L_gw_100:
  buffer_load_dword v46, v44, s[24:27], 0 offen sc1
  s_add_u32 s34, s34, 1
  s_cmp_gt_u32 s34, 40000
  s_cbranch_scc1 L_fail
  s_waitcnt vmcnt(0)
  v_and_b32 v45, 63, v46
  v_cmp_ne_u32 vcc, 32, v45
  s_cbranch_vccz L_cgb_18
  s_sleep 8
  s_branch L_gw_100
L_cps_19:
  s_mov_b32 s34, 0
  s_mov_b32 s35, 2
L_pk_101:
  buffer_load_dword v12, off, s[8:11], s75 sc1
  s_add_u32 s34, s34, 1
  s_cmp_gt_u32 s34, 40000
  s_cbranch_scc1 L_fail
  s_waitcnt vmcnt(0)
  v_cmp_gt_u32 vcc, s70, v12
  s_cbranch_vccnz L_pk_101
  s_branch L_cpb_20
L_cgs_22:
  s_mov_b32 s34, 0
  s_mov_b32 s35, 1
L_gw_102:
  buffer_load_dword v46, v44, s[24:27], 0 offen sc1
  s_add_u32 s34, s34, 1
  s_cmp_gt_u32 s34, 40000
  s_cbranch_scc1 L_fail
  s_waitcnt vmcnt(0)
  v_and_b32 v45, 63, v46
  v_cmp_ne_u32 vcc, 32, v45
  s_cbranch_vccz L_cgb_23
  s_sleep 8
  s_branch L_gw_102
L_cps_24:
  s_mov_b32 s34, 0
  s_mov_b32 s35, 2
L_pk_103:
  buffer_load_dword v12, off, s[8:11], s75 sc1
  s_add_u32 s34, s34, 1
  s_cmp_gt_u32 s34, 40000
  s_cbranch_scc1 L_fail
  s_waitcnt vmcnt(0)
  v_cmp_gt_u32 vcc, s70, v12
  s_cbranch_vccnz L_pk_103
  s_branch L_cpb_25
L_worker:
  s_sub_u32 s62, s3, 1
  v_lshlrev_b32 v1, 4, v0
  s_lshl_b32 s28, s62, 5
  s_add_u32 s28, s28, s4
  s_mul_i32 s29, s28, 9363
  s_lshr_b32 s76, s29, 16
  s_mul_i32 s29, s76, 7
  s_sub_u32 s77, s28, s29
  s_mul_i32 s29, s4, 37
  s_lshr_b32 s29, s29, 8
  s_mul_i32 s30, s29, 7
  s_sub_u32 s77, s4, s30
  s_mul_i32 s30, s62, 5
  s_add_u32 s76, s30, s29
  s_sub_u32 s29, s28, 206
  s_mul_i32 s30, s29, 86
  s_lshr_b32 s30, s30, 8
  s_mul_i32 s31, s30, 3
  s_sub_u32 s29, s29, s31
  s_add_u32 s29, s29, 4
  s_mul_i32 s30, s30, 5
  s_add_u32 s30, s30, 4
  s_cmp_ge_u32 s28, 206
  s_cselect_b32 s77, s29, s77
  s_cselect_b32 s76, s30, s76
  s_lshr_b32 s29, 0x30000300, s76
  s_and_b32 s29, s29, 1
  s_xor_b32 s76, s76, s29
  s_cmp_eq_u32 s77, 0
  s_cselect_b32 s84, 10, 9
  s_lshl_b32 s28, s77, 12
  s_lshl_b32 s29, s76, 7
  s_add_u32 s28, s28, s29
  s_add_u32 s87, s28, 335872
  s_mul_i32 s29, s5, 7
  s_add_u32 s29, s29, s62
  s_lshl_b32 s30, s29, 15
  s_lshl_b32 s31, s4, 10
  s_add_u32 s88, s30, s31
  s_mov_b32 s89, s29
  s_add_u32 s28, s88, 0
  buffer_load_dwordx4 v[16:19], v1, s[16:19], s28 offen
  s_add_u32 s28, s88, 917504
  buffer_load_dwordx4 v[20:23], v1, s[16:19], s28 offen
  s_add_u32 s28, s88, 1835008
  buffer_load_dwordx4 v[24:27], v1, s[16:19], s28 offen
  v_mov_b32 v28, 0
  s_mov_b64 exec, 1
  buffer_store_dword v28, off, s[8:11], s87 sc1
  s_mov_b64 exec, -1
  s_mov_b32 s64, s40
  s_mov_b32 s65, s41
  s_mov_b32 s66, 0x400000
  s_mov_b32 s67, 0x20000
  s_mov_b32 s68, s42
  s_mov_b32 s69, s43
  s_mov_b32 s70, 0x400000
  s_mov_b32 s71, 0x20000
  s_mov_b32 s72, s44
  s_mov_b32 s73, s45
  s_mov_b32 s74, 0x400000
  s_mov_b32 s75, 0x20000
  v_lshrrev_b32 v8, 4, v0
  v_bfe_u32 v9, v0, 2, 2
  v_lshl_add_u32 v2, v8, 3, v9
  s_mov_b32 s28, 8192
  v_mul_lo_u32 v2, v2, s28
  v_and_b32 v8, 3, v0
  v_lshl_add_u32 v2, v8, 4, v2
  s_lshl_b32 s28, s5, 12
  s_add_u32 s28, s28, 65536
  v_lshl_add_u32 v4, v0, 3, s28
  v_bfe_u32 v8, v0, 1, 1
  v_lshlrev_b32 v3, 11, v8
  v_lshrrev_b32 v8, 2, v0
  v_lshl_add_u32 v3, v8, 5, v3
  v_and_b32 v8, 1, v0
  v_lshl_add_u32 v3, v8, 4, v3
  v_add_u32 v3, s28, v3
  s_lshl_b32 s29, s76, 8
  s_lshl_b32 s30, s5, 6
  s_add_u32 s90, s29, s30
  s_lshl_b32 s29, s77, 19
  s_add_u32 s90, s90, s29
  s_xor_b32 s29, s90, 0x0
  buffer_load_dwordx4 a[128:131], v2, s[64:67], s29 offen
  s_add_u32 s28, s29, 0x8000
  buffer_load_dwordx4 a[132:135], v2, s[64:67], s28 offen
  s_add_u32 s28, s29, 0x40000
  buffer_load_dwordx4 a[136:139], v2, s[64:67], s28 offen
  s_add_u32 s28, s29, 0x48000
  buffer_load_dwordx4 a[140:143], v2, s[64:67], s28 offen
  s_xor_b32 s29, s90, 0x80000
  buffer_load_dwordx4 a[144:147], v2, s[64:67], s29 offen
  s_add_u32 s28, s29, 0x8000
  buffer_load_dwordx4 a[148:151], v2, s[64:67], s28 offen
  s_add_u32 s28, s29, 0x40000
  buffer_load_dwordx4 a[152:155], v2, s[64:67], s28 offen
  s_add_u32 s28, s29, 0x48000
  buffer_load_dwordx4 a[156:159], v2, s[64:67], s28 offen
  s_xor_b32 s29, s90, 0x100000
  buffer_load_dwordx4 a[160:163], v2, s[64:67], s29 offen
  s_add_u32 s28, s29, 0x8000
  buffer_load_dwordx4 a[164:167], v2, s[64:67], s28 offen
  s_add_u32 s28, s29, 0x40000
  buffer_load_dwordx4 a[168:171], v2, s[64:67], s28 offen
  s_add_u32 s28, s29, 0x48000
  buffer_load_dwordx4 a[172:175], v2, s[64:67], s28 offen
  s_xor_b32 s29, s90, 0x180000
  buffer_load_dwordx4 a[176:179], v2, s[64:67], s29 offen
  s_add_u32 s28, s29, 0x8000
  buffer_load_dwordx4 a[180:183], v2, s[64:67], s28 offen
  s_add_u32 s28, s29, 0x40000
  buffer_load_dwordx4 a[184:187], v2, s[64:67], s28 offen
  s_add_u32 s28, s29, 0x48000
  buffer_load_dwordx4 a[188:191], v2, s[64:67], s28 offen
  s_xor_b32 s29, s90, 0x200000
  buffer_load_dwordx4 a[192:195], v2, s[64:67], s29 offen
  s_add_u32 s28, s29, 0x8000
  buffer_load_dwordx4 a[196:199], v2, s[64:67], s28 offen
  s_add_u32 s28, s29, 0x40000
  buffer_load_dwordx4 a[200:203], v2, s[64:67], s28 offen
  s_add_u32 s28, s29, 0x48000
  buffer_load_dwordx4 a[204:207], v2, s[64:67], s28 offen
  s_xor_b32 s29, s90, 0x280000
  buffer_load_dwordx4 a[208:211], v2, s[64:67], s29 offen
  s_add_u32 s28, s29, 0x8000
  buffer_load_dwordx4 a[212:215], v2, s[64:67], s28 offen
  s_add_u32 s28, s29, 0x40000
  buffer_load_dwordx4 a[216:219], v2, s[64:67], s28 offen
  s_add_u32 s28, s29, 0x48000
  buffer_load_dwordx4 a[220:223], v2, s[64:67], s28 offen
  s_waitcnt vmcnt(27)
  v_and_b32 v33, 0xffff0000, v16
  v_lshlrev_b32 v32, 16, v16
  v_and_b32 v35, 0xffff0000, v17
  v_lshlrev_b32 v34, 16, v17
  v_and_b32 v37, 0xffff0000, v18
  v_lshlrev_b32 v36, 16, v18
  v_and_b32 v39, 0xffff0000, v19
  v_lshlrev_b32 v38, 16, v19
  v_add_f32 v48, v32, v33
  v_add_f32 v48, v48, v34
  v_add_f32 v48, v48, v35
  v_add_f32 v48, v48, v36
  v_add_f32 v48, v48, v37
  v_add_f32 v48, v48, v38
  v_add_f32 v48, v48, v39
  s_nop 1
  v_add_f32_dpp v48, v48, v48 row_ror:8 row_mask:0xf bank_mask:0xf
  s_nop 1
  v_add_f32_dpp v48, v48, v48 row_ror:4 row_mask:0xf bank_mask:0xf
  s_nop 1
  v_add_f32_dpp v48, v48, v48 row_ror:2 row_mask:0xf bank_mask:0xf
  s_nop 1
  v_add_f32_dpp v48, v48, v48 row_ror:1 row_mask:0xf bank_mask:0xf
  v_mov_b32 v49, v48
  s_nop 1
  v_permlane16_swap_b32 v48, v49
  v_add_f32 v48, v48, v49
  v_mov_b32 v49, v48
  s_nop 1
  v_permlane32_swap_b32 v48, v49
  v_add_f32 v48, v48, v49
  v_mul_f32 v48, 0x3b000000, v48
  v_sub_f32 v40, v32, v48
  v_sub_f32 v41, v33, v48
  v_sub_f32 v42, v34, v48
  v_sub_f32 v43, v35, v48
  v_sub_f32 v44, v36, v48
  v_sub_f32 v45, v37, v48
  v_sub_f32 v46, v38, v48
  v_sub_f32 v47, v39, v48
  v_mul_f32 v50, v40, v40
  v_fmac_f32 v50, v41, v41
  v_fmac_f32 v50, v42, v42
  v_fmac_f32 v50, v43, v43
  v_fmac_f32 v50, v44, v44
  v_fmac_f32 v50, v45, v45
  v_fmac_f32 v50, v46, v46
  v_fmac_f32 v50, v47, v47
  s_nop 1
  v_add_f32_dpp v50, v50, v50 row_ror:8 row_mask:0xf bank_mask:0xf
  s_nop 1
  v_add_f32_dpp v50, v50, v50 row_ror:4 row_mask:0xf bank_mask:0xf
  s_nop 1
  v_add_f32_dpp v50, v50, v50 row_ror:2 row_mask:0xf bank_mask:0xf
  s_nop 1
  v_add_f32_dpp v50, v50, v50 row_ror:1 row_mask:0xf bank_mask:0xf
  v_mov_b32 v49, v50
  s_nop 1
  v_permlane16_swap_b32 v50, v49
  v_add_f32 v50, v50, v49
  v_mov_b32 v49, v50
  s_nop 1
  v_permlane32_swap_b32 v50, v49
  v_add_f32 v50, v50, v49
  v_mul_f32 v50, 0x3b000000, v50
  v_cvt_pk_bf16_f32 v50, v50, v50
  v_and_b32 v50, 0xffff0000, v50
  v_add_f32 v50, 0x3727c5ac, v50
  v_cvt_pk_bf16_f32 v50, v50, v50
  v_and_b32 v50, 0xffff0000, v50
  v_sqrt_f32 v50, v50
  v_cvt_pk_bf16_f32 v48, v48, v48
  v_and_b32 v48, 0xffff0000, v48
  v_cvt_pk_bf16_f32 v50, v50, v50
  v_and_b32 v50, 0xffff0000, v50
  v_rcp_f32 v50, v50
  v_sub_f32 v40, v32, v48
  v_sub_f32 v41, v33, v48
  v_sub_f32 v42, v34, v48
  v_sub_f32 v43, v35, v48
  v_sub_f32 v44, v36, v48
  v_sub_f32 v45, v37, v48
  v_sub_f32 v46, v38, v48
  v_sub_f32 v47, v39, v48
  v_cvt_pk_bf16_f32 v40, v40, v41
  v_and_b32 v41, 0xffff0000, v40
  v_lshlrev_b32 v40, 16, v40
  v_cvt_pk_bf16_f32 v42, v42, v43
  v_and_b32 v43, 0xffff0000, v42
  v_lshlrev_b32 v42, 16, v42
  v_cvt_pk_bf16_f32 v44, v44, v45
  v_and_b32 v45, 0xffff0000, v44
  v_lshlrev_b32 v44, 16, v44
  v_cvt_pk_bf16_f32 v46, v46, v47
  v_and_b32 v47, 0xffff0000, v46
  v_lshlrev_b32 v46, 16, v46
  v_mul_f32 v40, v40, v50
  v_mul_f32 v41, v41, v50
  v_mul_f32 v42, v42, v50
  v_mul_f32 v43, v43, v50
  v_mul_f32 v44, v44, v50
  v_mul_f32 v45, v45, v50
  v_mul_f32 v46, v46, v50
  v_mul_f32 v47, v47, v50
  v_cvt_pk_bf16_f32 v16, v40, v41
  v_cvt_pk_bf16_f32 v17, v42, v43
  v_cvt_pk_bf16_f32 v18, v44, v45
  v_cvt_pk_bf16_f32 v19, v46, v47
  s_add_u32 s28, s88, 1048576
  s_add_u32 s29, s89, 0
  s_cmp_lt_u32 s29, 64
  s_cselect_b32 s28, s28, 0x10000000
  buffer_store_dwordx4 v[16:19], v1, s[8:11], s28 offen sc1
  s_waitcnt vmcnt(27)
  v_and_b32 v33, 0xffff0000, v20
  v_lshlrev_b32 v32, 16, v20
  v_and_b32 v35, 0xffff0000, v21
  v_lshlrev_b32 v34, 16, v21
  v_and_b32 v37, 0xffff0000, v22
  v_lshlrev_b32 v36, 16, v22
  v_and_b32 v39, 0xffff0000, v23
  v_lshlrev_b32 v38, 16, v23
  v_add_f32 v48, v32, v33
  v_add_f32 v48, v48, v34
  v_add_f32 v48, v48, v35
  v_add_f32 v48, v48, v36
  v_add_f32 v48, v48, v37
  v_add_f32 v48, v48, v38
  v_add_f32 v48, v48, v39
  s_nop 1
  v_add_f32_dpp v48, v48, v48 row_ror:8 row_mask:0xf bank_mask:0xf
  s_nop 1
  v_add_f32_dpp v48, v48, v48 row_ror:4 row_mask:0xf bank_mask:0xf
  s_nop 1
  v_add_f32_dpp v48, v48, v48 row_ror:2 row_mask:0xf bank_mask:0xf
  s_nop 1
  v_add_f32_dpp v48, v48, v48 row_ror:1 row_mask:0xf bank_mask:0xf
  v_mov_b32 v49, v48
  s_nop 1
  v_permlane16_swap_b32 v48, v49
  v_add_f32 v48, v48, v49
  v_mov_b32 v49, v48
  s_nop 1
  v_permlane32_swap_b32 v48, v49
  v_add_f32 v48, v48, v49
  v_mul_f32 v48, 0x3b000000, v48
  v_sub_f32 v40, v32, v48
  v_sub_f32 v41, v33, v48
  v_sub_f32 v42, v34, v48
  v_sub_f32 v43, v35, v48
  v_sub_f32 v44, v36, v48
  v_sub_f32 v45, v37, v48
  v_sub_f32 v46, v38, v48
  v_sub_f32 v47, v39, v48
  v_mul_f32 v50, v40, v40
  v_fmac_f32 v50, v41, v41
  v_fmac_f32 v50, v42, v42
  v_fmac_f32 v50, v43, v43
  v_fmac_f32 v50, v44, v44
  v_fmac_f32 v50, v45, v45
  v_fmac_f32 v50, v46, v46
  v_fmac_f32 v50, v47, v47
  s_nop 1
  v_add_f32_dpp v50, v50, v50 row_ror:8 row_mask:0xf bank_mask:0xf
  s_nop 1
  v_add_f32_dpp v50, v50, v50 row_ror:4 row_mask:0xf bank_mask:0xf
  s_nop 1
  v_add_f32_dpp v50, v50, v50 row_ror:2 row_mask:0xf bank_mask:0xf
  s_nop 1
  v_add_f32_dpp v50, v50, v50 row_ror:1 row_mask:0xf bank_mask:0xf
  v_mov_b32 v49, v50
  s_nop 1
  v_permlane16_swap_b32 v50, v49
  v_add_f32 v50, v50, v49
  v_mov_b32 v49, v50
  s_nop 1
  v_permlane32_swap_b32 v50, v49
  v_add_f32 v50, v50, v49
  v_mul_f32 v50, 0x3b000000, v50
  v_cvt_pk_bf16_f32 v50, v50, v50
  v_and_b32 v50, 0xffff0000, v50
  v_add_f32 v50, 0x3727c5ac, v50
  v_cvt_pk_bf16_f32 v50, v50, v50
  v_and_b32 v50, 0xffff0000, v50
  v_sqrt_f32 v50, v50
  v_cvt_pk_bf16_f32 v48, v48, v48
  v_and_b32 v48, 0xffff0000, v48
  v_cvt_pk_bf16_f32 v50, v50, v50
  v_and_b32 v50, 0xffff0000, v50
  v_rcp_f32 v50, v50
  v_sub_f32 v40, v32, v48
  v_sub_f32 v41, v33, v48
  v_sub_f32 v42, v34, v48
  v_sub_f32 v43, v35, v48
  v_sub_f32 v44, v36, v48
  v_sub_f32 v45, v37, v48
  v_sub_f32 v46, v38, v48
  v_sub_f32 v47, v39, v48
  v_cvt_pk_bf16_f32 v40, v40, v41
  v_and_b32 v41, 0xffff0000, v40
  v_lshlrev_b32 v40, 16, v40
  v_cvt_pk_bf16_f32 v42, v42, v43
  v_and_b32 v43, 0xffff0000, v42
  v_lshlrev_b32 v42, 16, v42
  v_cvt_pk_bf16_f32 v44, v44, v45
  v_and_b32 v45, 0xffff0000, v44
  v_lshlrev_b32 v44, 16, v44
  v_cvt_pk_bf16_f32 v46, v46, v47
  v_and_b32 v47, 0xffff0000, v46
  v_lshlrev_b32 v46, 16, v46
  v_mul_f32 v40, v40, v50
  v_mul_f32 v41, v41, v50
  v_mul_f32 v42, v42, v50
  v_mul_f32 v43, v43, v50
  v_mul_f32 v44, v44, v50
  v_mul_f32 v45, v45, v50
  v_mul_f32 v46, v46, v50
  v_mul_f32 v47, v47, v50
  v_cvt_pk_bf16_f32 v20, v40, v41
  v_cvt_pk_bf16_f32 v21, v42, v43
  v_cvt_pk_bf16_f32 v22, v44, v45
  v_cvt_pk_bf16_f32 v23, v46, v47
  s_add_u32 s28, s88, 1966080
  s_add_u32 s29, s89, 28
  s_cmp_lt_u32 s29, 64
  s_cselect_b32 s28, s28, 0x10000000
  buffer_store_dwordx4 v[20:23], v1, s[8:11], s28 offen sc1
  s_waitcnt vmcnt(27)
  v_and_b32 v33, 0xffff0000, v24
  v_lshlrev_b32 v32, 16, v24
  v_and_b32 v35, 0xffff0000, v25
  v_lshlrev_b32 v34, 16, v25
  v_and_b32 v37, 0xffff0000, v26
  v_lshlrev_b32 v36, 16, v26
  v_and_b32 v39, 0xffff0000, v27
  v_lshlrev_b32 v38, 16, v27
  v_add_f32 v48, v32, v33
  v_add_f32 v48, v48, v34
  v_add_f32 v48, v48, v35
  v_add_f32 v48, v48, v36
  v_add_f32 v48, v48, v37
  v_add_f32 v48, v48, v38
  v_add_f32 v48, v48, v39
  s_nop 1
  v_add_f32_dpp v48, v48, v48 row_ror:8 row_mask:0xf bank_mask:0xf
  s_nop 1
  v_add_f32_dpp v48, v48, v48 row_ror:4 row_mask:0xf bank_mask:0xf
  s_nop 1
  v_add_f32_dpp v48, v48, v48 row_ror:2 row_mask:0xf bank_mask:0xf
  s_nop 1
  v_add_f32_dpp v48, v48, v48 row_ror:1 row_mask:0xf bank_mask:0xf
  v_mov_b32 v49, v48
  s_nop 1
  v_permlane16_swap_b32 v48, v49
  v_add_f32 v48, v48, v49
  v_mov_b32 v49, v48
  s_nop 1
  v_permlane32_swap_b32 v48, v49
  v_add_f32 v48, v48, v49
  v_mul_f32 v48, 0x3b000000, v48
  v_sub_f32 v40, v32, v48
  v_sub_f32 v41, v33, v48
  v_sub_f32 v42, v34, v48
  v_sub_f32 v43, v35, v48
  v_sub_f32 v44, v36, v48
  v_sub_f32 v45, v37, v48
  v_sub_f32 v46, v38, v48
  v_sub_f32 v47, v39, v48
  v_mul_f32 v50, v40, v40
  v_fmac_f32 v50, v41, v41
  v_fmac_f32 v50, v42, v42
  v_fmac_f32 v50, v43, v43
  v_fmac_f32 v50, v44, v44
  v_fmac_f32 v50, v45, v45
  v_fmac_f32 v50, v46, v46
  v_fmac_f32 v50, v47, v47
  s_nop 1
  v_add_f32_dpp v50, v50, v50 row_ror:8 row_mask:0xf bank_mask:0xf
  s_nop 1
  v_add_f32_dpp v50, v50, v50 row_ror:4 row_mask:0xf bank_mask:0xf
  s_nop 1
  v_add_f32_dpp v50, v50, v50 row_ror:2 row_mask:0xf bank_mask:0xf
  s_nop 1
  v_add_f32_dpp v50, v50, v50 row_ror:1 row_mask:0xf bank_mask:0xf
  v_mov_b32 v49, v50
  s_nop 1
  v_permlane16_swap_b32 v50, v49
  v_add_f32 v50, v50, v49
  v_mov_b32 v49, v50
  s_nop 1
  v_permlane32_swap_b32 v50, v49
  v_add_f32 v50, v50, v49
  v_mul_f32 v50, 0x3b000000, v50
  v_cvt_pk_bf16_f32 v50, v50, v50
  v_and_b32 v50, 0xffff0000, v50
  v_add_f32 v50, 0x3727c5ac, v50
  v_cvt_pk_bf16_f32 v50, v50, v50
  v_and_b32 v50, 0xffff0000, v50
  v_sqrt_f32 v50, v50
  v_cvt_pk_bf16_f32 v48, v48, v48
  v_and_b32 v48, 0xffff0000, v48
  v_cvt_pk_bf16_f32 v50, v50, v50
  v_and_b32 v50, 0xffff0000, v50
  v_rcp_f32 v50, v50
  v_sub_f32 v40, v32, v48
  v_sub_f32 v41, v33, v48
  v_sub_f32 v42, v34, v48
  v_sub_f32 v43, v35, v48
  v_sub_f32 v44, v36, v48
  v_sub_f32 v45, v37, v48
  v_sub_f32 v46, v38, v48
  v_sub_f32 v47, v39, v48
  v_cvt_pk_bf16_f32 v40, v40, v41
  v_and_b32 v41, 0xffff0000, v40
  v_lshlrev_b32 v40, 16, v40
  v_cvt_pk_bf16_f32 v42, v42, v43
  v_and_b32 v43, 0xffff0000, v42
  v_lshlrev_b32 v42, 16, v42
  v_cvt_pk_bf16_f32 v44, v44, v45
  v_and_b32 v45, 0xffff0000, v44
  v_lshlrev_b32 v44, 16, v44
  v_cvt_pk_bf16_f32 v46, v46, v47
  v_and_b32 v47, 0xffff0000, v46
  v_lshlrev_b32 v46, 16, v46
  v_mul_f32 v40, v40, v50
  v_mul_f32 v41, v41, v50
  v_mul_f32 v42, v42, v50
  v_mul_f32 v43, v43, v50
  v_mul_f32 v44, v44, v50
  v_mul_f32 v45, v45, v50
  v_mul_f32 v46, v46, v50
  v_mul_f32 v47, v47, v50
  v_cvt_pk_bf16_f32 v24, v40, v41
  v_cvt_pk_bf16_f32 v25, v42, v43
  v_cvt_pk_bf16_f32 v26, v44, v45
  v_cvt_pk_bf16_f32 v27, v46, v47
  s_add_u32 s28, s88, 2883584
  s_add_u32 s29, s89, 56
  s_cmp_lt_u32 s29, 64
  s_cselect_b32 s28, s28, 0x10000000
  buffer_store_dwordx4 v[24:27], v1, s[8:11], s28 offen sc1
  s_waitcnt vmcnt(26)
  ds_write_b128 v3, a[128:131] offset:0
  s_waitcnt vmcnt(25)
  ds_write_b128 v3, a[132:135] offset:512
  s_waitcnt vmcnt(24)
  ds_write_b128 v3, a[136:139] offset:1024
  s_waitcnt vmcnt(23)
  ds_write_b128 v3, a[140:143] offset:1536
  ds_read_b64_tr_b16 a[128:129], v4 offset:0
  ds_read_b64_tr_b16 a[130:131], v4 offset:512
  ds_read_b64_tr_b16 a[132:133], v4 offset:1024
  ds_read_b64_tr_b16 a[134:135], v4 offset:1536
  ds_read_b64_tr_b16 a[136:137], v4 offset:2048
  ds_read_b64_tr_b16 a[138:139], v4 offset:2560
  ds_read_b64_tr_b16 a[140:141], v4 offset:3072
  ds_read_b64_tr_b16 a[142:143], v4 offset:3584
  s_xor_b32 s29, s90, 0x300000
  buffer_load_dwordx4 a[224:227], v2, s[64:67], s29 offen
  s_add_u32 s28, s29, 0x8000
  buffer_load_dwordx4 a[228:231], v2, s[64:67], s28 offen
  s_add_u32 s28, s29, 0x40000
  buffer_load_dwordx4 a[232:235], v2, s[64:67], s28 offen
  s_add_u32 s28, s29, 0x48000
  buffer_load_dwordx4 a[236:239], v2, s[64:67], s28 offen
  s_waitcnt vmcnt(26)
  ds_write_b128 v3, a[144:147] offset:0
  s_waitcnt vmcnt(25)
  ds_write_b128 v3, a[148:151] offset:512
  s_waitcnt vmcnt(24)
  ds_write_b128 v3, a[152:155] offset:1024
  s_waitcnt vmcnt(23)
  s_waitcnt lgkmcnt(14)
  ds_write_b128 v3, a[156:159] offset:1536
  s_waitcnt lgkmcnt(14)
  ds_read_b64_tr_b16 a[144:145], v4 offset:0
  s_waitcnt lgkmcnt(14)
  ds_read_b64_tr_b16 a[146:147], v4 offset:512
  s_waitcnt lgkmcnt(14)
  ds_read_b64_tr_b16 a[148:149], v4 offset:1024
  s_waitcnt lgkmcnt(14)
  ds_read_b64_tr_b16 a[150:151], v4 offset:1536
  s_waitcnt lgkmcnt(14)
  ds_read_b64_tr_b16 a[152:153], v4 offset:2048
  s_waitcnt lgkmcnt(14)
  ds_read_b64_tr_b16 a[154:155], v4 offset:2560
  s_waitcnt lgkmcnt(14)
  ds_read_b64_tr_b16 a[156:157], v4 offset:3072
  s_waitcnt lgkmcnt(14)
  ds_read_b64_tr_b16 a[158:159], v4 offset:3584
  s_xor_b32 s29, s90, 0x380000
  buffer_load_dwordx4 a[240:243], v2, s[64:67], s29 offen
  s_add_u32 s28, s29, 0x8000
  buffer_load_dwordx4 a[244:247], v2, s[64:67], s28 offen
  s_add_u32 s28, s29, 0x40000
  buffer_load_dwordx4 a[248:251], v2, s[64:67], s28 offen
  s_add_u32 s28, s29, 0x48000
  buffer_load_dwordx4 a[252:255], v2, s[64:67], s28 offen
  s_waitcnt vmcnt(26)
  s_waitcnt lgkmcnt(14)
  ds_write_b128 v3, a[160:163] offset:0
  s_waitcnt vmcnt(25)
  s_waitcnt lgkmcnt(14)
  ds_write_b128 v3, a[164:167] offset:512
  s_waitcnt vmcnt(24)
  s_waitcnt lgkmcnt(14)
  ds_write_b128 v3, a[168:171] offset:1024
  s_waitcnt vmcnt(23)
  s_waitcnt lgkmcnt(14)
  ds_write_b128 v3, a[172:175] offset:1536
  s_waitcnt lgkmcnt(14)
  ds_read_b64_tr_b16 a[160:161], v4 offset:0
  s_waitcnt lgkmcnt(14)
  ds_read_b64_tr_b16 a[162:163], v4 offset:512
  s_waitcnt lgkmcnt(14)
  ds_read_b64_tr_b16 a[164:165], v4 offset:1024
  s_waitcnt lgkmcnt(14)
  ds_read_b64_tr_b16 a[166:167], v4 offset:1536
  s_waitcnt lgkmcnt(14)
  ds_read_b64_tr_b16 a[168:169], v4 offset:2048
  s_waitcnt lgkmcnt(14)
  ds_read_b64_tr_b16 a[170:171], v4 offset:2560
  s_waitcnt lgkmcnt(14)
  ds_read_b64_tr_b16 a[172:173], v4 offset:3072
  s_waitcnt lgkmcnt(14)
  ds_read_b64_tr_b16 a[174:175], v4 offset:3584
  s_xor_b32 s29, s90, 0x0
  buffer_load_dwordx4 a[0:3], v2, s[68:71], s29 offen
  s_add_u32 s28, s29, 0x8000
  buffer_load_dwordx4 a[4:7], v2, s[68:71], s28 offen
  s_add_u32 s28, s29, 0x40000
  buffer_load_dwordx4 a[8:11], v2, s[68:71], s28 offen
  s_add_u32 s28, s29, 0x48000
  buffer_load_dwordx4 a[12:15], v2, s[68:71], s28 offen
  s_waitcnt vmcnt(26)
  s_waitcnt lgkmcnt(14)
  ds_write_b128 v3, a[176:179] offset:0
  s_waitcnt vmcnt(25)
  s_waitcnt lgkmcnt(14)
  ds_write_b128 v3, a[180:183] offset:512
  s_waitcnt vmcnt(24)
  s_waitcnt lgkmcnt(14)
  ds_write_b128 v3, a[184:187] offset:1024
  s_waitcnt vmcnt(23)
  s_waitcnt lgkmcnt(14)
  ds_write_b128 v3, a[188:191] offset:1536
  s_waitcnt lgkmcnt(14)
  ds_read_b64_tr_b16 a[176:177], v4 offset:0
  s_waitcnt lgkmcnt(14)
  ds_read_b64_tr_b16 a[178:179], v4 offset:512
  s_waitcnt lgkmcnt(14)
  ds_read_b64_tr_b16 a[180:181], v4 offset:1024
  s_waitcnt lgkmcnt(14)
  ds_read_b64_tr_b16 a[182:183], v4 offset:1536
  s_waitcnt lgkmcnt(14)
  ds_read_b64_tr_b16 a[184:185], v4 offset:2048
  s_waitcnt lgkmcnt(14)
  ds_read_b64_tr_b16 a[186:187], v4 offset:2560
  s_waitcnt lgkmcnt(14)
  ds_read_b64_tr_b16 a[188:189], v4 offset:3072
  s_waitcnt lgkmcnt(14)
  ds_read_b64_tr_b16 a[190:191], v4 offset:3584
  s_xor_b32 s29, s90, 0x0
  buffer_load_dwordx4 v[128:131], v2, s[72:75], s29 offen
  s_add_u32 s28, s29, 0x8000
  buffer_load_dwordx4 v[132:135], v2, s[72:75], s28 offen
  s_add_u32 s28, s29, 0x40000
  buffer_load_dwordx4 v[136:139], v2, s[72:75], s28 offen
  s_add_u32 s28, s29, 0x48000
  buffer_load_dwordx4 v[140:143], v2, s[72:75], s28 offen
  s_waitcnt vmcnt(26)
  s_waitcnt lgkmcnt(14)
  ds_write_b128 v3, a[192:195] offset:0
  s_waitcnt vmcnt(25)
  s_waitcnt lgkmcnt(14)
  ds_write_b128 v3, a[196:199] offset:512
  s_waitcnt vmcnt(24)
  s_waitcnt lgkmcnt(14)
  ds_write_b128 v3, a[200:203] offset:1024
  s_waitcnt vmcnt(23)
  s_waitcnt lgkmcnt(14)
  ds_write_b128 v3, a[204:207] offset:1536
  s_waitcnt lgkmcnt(14)
  ds_read_b64_tr_b16 a[192:193], v4 offset:0
  s_waitcnt lgkmcnt(14)
  ds_read_b64_tr_b16 a[194:195], v4 offset:512
  s_waitcnt lgkmcnt(14)
  ds_read_b64_tr_b16 a[196:197], v4 offset:1024
  s_waitcnt lgkmcnt(14)
  ds_read_b64_tr_b16 a[198:199], v4 offset:1536
  s_waitcnt lgkmcnt(14)
  ds_read_b64_tr_b16 a[200:201], v4 offset:2048
  s_waitcnt lgkmcnt(14)
  ds_read_b64_tr_b16 a[202:203], v4 offset:2560
  s_waitcnt lgkmcnt(14)
  ds_read_b64_tr_b16 a[204:205], v4 offset:3072
  s_waitcnt lgkmcnt(14)
  ds_read_b64_tr_b16 a[206:207], v4 offset:3584
  s_xor_b32 s29, s90, 0x80000
  buffer_load_dwordx4 a[16:19], v2, s[68:71], s29 offen
  s_add_u32 s28, s29, 0x8000
  buffer_load_dwordx4 a[20:23], v2, s[68:71], s28 offen
  s_add_u32 s28, s29, 0x40000
  buffer_load_dwordx4 a[24:27], v2, s[68:71], s28 offen
  s_add_u32 s28, s29, 0x48000
  buffer_load_dwordx4 a[28:31], v2, s[68:71], s28 offen
  s_waitcnt vmcnt(26)
  s_waitcnt lgkmcnt(14)
  ds_write_b128 v3, a[208:211] offset:0
  s_waitcnt vmcnt(25)
  s_waitcnt lgkmcnt(14)
  ds_write_b128 v3, a[212:215] offset:512
  s_waitcnt vmcnt(24)
  s_waitcnt lgkmcnt(14)
  ds_write_b128 v3, a[216:219] offset:1024
  s_waitcnt vmcnt(23)
  s_waitcnt lgkmcnt(14)
  ds_write_b128 v3, a[220:223] offset:1536
  s_waitcnt lgkmcnt(14)
  ds_read_b64_tr_b16 a[208:209], v4 offset:0
  s_waitcnt lgkmcnt(14)
  ds_read_b64_tr_b16 a[210:211], v4 offset:512
  s_waitcnt lgkmcnt(14)
  ds_read_b64_tr_b16 a[212:213], v4 offset:1024
  s_waitcnt lgkmcnt(14)
  ds_read_b64_tr_b16 a[214:215], v4 offset:1536
  s_waitcnt lgkmcnt(14)
  ds_read_b64_tr_b16 a[216:217], v4 offset:2048
  s_waitcnt lgkmcnt(14)
  ds_read_b64_tr_b16 a[218:219], v4 offset:2560
  s_waitcnt lgkmcnt(14)
  ds_read_b64_tr_b16 a[220:221], v4 offset:3072
  s_waitcnt lgkmcnt(14)
  ds_read_b64_tr_b16 a[222:223], v4 offset:3584
  s_xor_b32 s29, s90, 0x80000
  buffer_load_dwordx4 v[144:147], v2, s[72:75], s29 offen
  s_add_u32 s28, s29, 0x8000
  buffer_load_dwordx4 v[148:151], v2, s[72:75], s28 offen
  s_add_u32 s28, s29, 0x40000
  buffer_load_dwordx4 v[152:155], v2, s[72:75], s28 offen
  s_add_u32 s28, s29, 0x48000
  buffer_load_dwordx4 v[156:159], v2, s[72:75], s28 offen
  s_waitcnt vmcnt(24)
  s_waitcnt lgkmcnt(8)
  s_barrier
  s_cmp_lg_u32 s5, 0
  s_cbranch_scc1 L_arr_106
  s_lshl_b32 s28, s3, 5
  v_mov_b32 v8, s7
  s_mov_b64 exec, 1
  buffer_atomic_add v8, off, s[24:27], s28 offset:0 sc1
  s_mov_b64 exec, -1
L_arr_106:
  s_waitcnt vmcnt(23)
  ds_write_b128 v3, a[224:227] offset:0
  s_waitcnt vmcnt(22)
  ds_write_b128 v3, a[228:231] offset:512
  s_waitcnt vmcnt(21)
  ds_write_b128 v3, a[232:235] offset:1024
  s_waitcnt vmcnt(20)
  ds_write_b128 v3, a[236:239] offset:1536
  ds_read_b64_tr_b16 a[224:225], v4 offset:0
  ds_read_b64_tr_b16 a[226:227], v4 offset:512
  ds_read_b64_tr_b16 a[228:229], v4 offset:1024
  s_waitcnt lgkmcnt(14)
  ds_read_b64_tr_b16 a[230:231], v4 offset:1536
  s_waitcnt lgkmcnt(14)
  ds_read_b64_tr_b16 a[232:233], v4 offset:2048
  s_waitcnt lgkmcnt(14)
  ds_read_b64_tr_b16 a[234:235], v4 offset:2560
  s_waitcnt lgkmcnt(14)
  ds_read_b64_tr_b16 a[236:237], v4 offset:3072
  s_waitcnt lgkmcnt(14)
  ds_read_b64_tr_b16 a[238:239], v4 offset:3584
  s_xor_b32 s29, s90, 0x100000
  buffer_load_dwordx4 a[32:35], v2, s[68:71], s29 offen
  s_add_u32 s28, s29, 0x8000
  buffer_load_dwordx4 a[36:39], v2, s[68:71], s28 offen
  s_add_u32 s28, s29, 0x40000
  buffer_load_dwordx4 a[40:43], v2, s[68:71], s28 offen
  s_add_u32 s28, s29, 0x48000
  buffer_load_dwordx4 a[44:47], v2, s[68:71], s28 offen
  s_waitcnt vmcnt(23)
  s_waitcnt lgkmcnt(14)
  ds_write_b128 v3, a[240:243] offset:0
  s_waitcnt vmcnt(22)
  s_waitcnt lgkmcnt(14)
  ds_write_b128 v3, a[244:247] offset:512
  s_waitcnt vmcnt(21)
  s_waitcnt lgkmcnt(14)
  ds_write_b128 v3, a[248:251] offset:1024
  s_waitcnt vmcnt(20)
  s_waitcnt lgkmcnt(14)
  ds_write_b128 v3, a[252:255] offset:1536
  s_waitcnt lgkmcnt(14)
  ds_read_b64_tr_b16 a[240:241], v4 offset:0
  s_waitcnt lgkmcnt(14)
  ds_read_b64_tr_b16 a[242:243], v4 offset:512
  s_waitcnt lgkmcnt(14)
  ds_read_b64_tr_b16 a[244:245], v4 offset:1024
  s_waitcnt lgkmcnt(14)
  ds_read_b64_tr_b16 a[246:247], v4 offset:1536
  s_waitcnt lgkmcnt(14)
  ds_read_b64_tr_b16 a[248:249], v4 offset:2048
  s_waitcnt lgkmcnt(14)
  ds_read_b64_tr_b16 a[250:251], v4 offset:2560
  s_waitcnt lgkmcnt(14)
  ds_read_b64_tr_b16 a[252:253], v4 offset:3072
  s_waitcnt lgkmcnt(14)
  ds_read_b64_tr_b16 a[254:255], v4 offset:3584
  s_xor_b32 s29, s90, 0x100000
  buffer_load_dwordx4 v[160:163], v2, s[72:75], s29 offen
  s_add_u32 s28, s29, 0x8000
  buffer_load_dwordx4 v[164:167], v2, s[72:75], s28 offen
  s_add_u32 s28, s29, 0x40000
  buffer_load_dwordx4 v[168:171], v2, s[72:75], s28 offen
  s_add_u32 s28, s29, 0x48000
  buffer_load_dwordx4 v[172:175], v2, s[72:75], s28 offen
  s_waitcnt vmcnt(23)
  s_waitcnt lgkmcnt(14)
  ds_write_b128 v3, a[0:3] offset:0
  s_waitcnt vmcnt(22)
  s_waitcnt lgkmcnt(14)
  ds_write_b128 v3, a[4:7] offset:512
  s_waitcnt vmcnt(21)
  s_waitcnt lgkmcnt(14)
  ds_write_b128 v3, a[8:11] offset:1024
  s_waitcnt vmcnt(20)
  s_waitcnt lgkmcnt(14)
  ds_write_b128 v3, a[12:15] offset:1536
  s_waitcnt lgkmcnt(14)
  ds_read_b64_tr_b16 a[0:1], v4 offset:0
  s_waitcnt lgkmcnt(14)
  ds_read_b64_tr_b16 a[2:3], v4 offset:512
  s_waitcnt lgkmcnt(14)
  ds_read_b64_tr_b16 a[4:5], v4 offset:1024
  s_waitcnt lgkmcnt(14)
  ds_read_b64_tr_b16 a[6:7], v4 offset:1536
  s_waitcnt lgkmcnt(14)
  ds_read_b64_tr_b16 a[8:9], v4 offset:2048
  s_waitcnt lgkmcnt(14)
  ds_read_b64_tr_b16 a[10:11], v4 offset:2560
  s_waitcnt lgkmcnt(14)
  ds_read_b64_tr_b16 a[12:13], v4 offset:3072
  s_waitcnt lgkmcnt(14)
  ds_read_b64_tr_b16 a[14:15], v4 offset:3584
  s_xor_b32 s29, s90, 0x180000
  buffer_load_dwordx4 a[48:51], v2, s[68:71], s29 offen
  s_add_u32 s28, s29, 0x8000
  buffer_load_dwordx4 a[52:55], v2, s[68:71], s28 offen
  s_add_u32 s28, s29, 0x40000
  buffer_load_dwordx4 a[56:59], v2, s[68:71], s28 offen
  s_add_u32 s28, s29, 0x48000
  buffer_load_dwordx4 a[60:63], v2, s[68:71], s28 offen
  s_waitcnt vmcnt(23)
  s_waitcnt lgkmcnt(14)
  ds_write_b128 v3, v[128:131] offset:0
  s_waitcnt vmcnt(22)
  s_waitcnt lgkmcnt(14)
  ds_write_b128 v3, v[132:135] offset:512
  s_waitcnt vmcnt(21)
  s_waitcnt lgkmcnt(14)
  ds_write_b128 v3, v[136:139] offset:1024
  s_waitcnt vmcnt(20)
  s_waitcnt lgkmcnt(14)
  ds_write_b128 v3, v[140:143] offset:1536
  s_waitcnt lgkmcnt(14)
  ds_read_b64_tr_b16 v[128:129], v4 offset:0
  s_waitcnt lgkmcnt(14)
  ds_read_b64_tr_b16 v[130:131], v4 offset:512
  s_waitcnt lgkmcnt(14)
  ds_read_b64_tr_b16 v[132:133], v4 offset:1024
  s_waitcnt lgkmcnt(14)
  ds_read_b64_tr_b16 v[134:135], v4 offset:1536
  s_waitcnt lgkmcnt(14)
  ds_read_b64_tr_b16 v[136:137], v4 offset:2048
  s_waitcnt lgkmcnt(14)
  ds_read_b64_tr_b16 v[138:139], v4 offset:2560
  s_waitcnt lgkmcnt(14)
  ds_read_b64_tr_b16 v[140:141], v4 offset:3072
  s_waitcnt lgkmcnt(14)
  ds_read_b64_tr_b16 v[142:143], v4 offset:3584
  s_xor_b32 s29, s90, 0x180000
  buffer_load_dwordx4 v[176:179], v2, s[72:75], s29 offen
  s_add_u32 s28, s29, 0x8000
  buffer_load_dwordx4 v[180:183], v2, s[72:75], s28 offen
  s_add_u32 s28, s29, 0x40000
  buffer_load_dwordx4 v[184:187], v2, s[72:75], s28 offen
  s_add_u32 s28, s29, 0x48000
  buffer_load_dwordx4 v[188:191], v2, s[72:75], s28 offen
  s_waitcnt vmcnt(23)
  s_waitcnt lgkmcnt(14)
  ds_write_b128 v3, a[16:19] offset:0
  s_waitcnt vmcnt(22)
  s_waitcnt lgkmcnt(14)
  ds_write_b128 v3, a[20:23] offset:512
  s_waitcnt vmcnt(21)
  s_waitcnt lgkmcnt(14)
  ds_write_b128 v3, a[24:27] offset:1024
  s_waitcnt vmcnt(20)
  s_waitcnt lgkmcnt(14)
  ds_write_b128 v3, a[28:31] offset:1536
  s_waitcnt lgkmcnt(14)
  ds_read_b64_tr_b16 a[16:17], v4 offset:0
  s_waitcnt lgkmcnt(14)
  ds_read_b64_tr_b16 a[18:19], v4 offset:512
  s_waitcnt lgkmcnt(14)
  ds_read_b64_tr_b16 a[20:21], v4 offset:1024
  s_waitcnt lgkmcnt(14)
  ds_read_b64_tr_b16 a[22:23], v4 offset:1536
  s_waitcnt lgkmcnt(14)
  ds_read_b64_tr_b16 a[24:25], v4 offset:2048
  s_waitcnt lgkmcnt(14)
  ds_read_b64_tr_b16 a[26:27], v4 offset:2560
  s_waitcnt lgkmcnt(14)
  ds_read_b64_tr_b16 a[28:29], v4 offset:3072
  s_waitcnt lgkmcnt(14)
  ds_read_b64_tr_b16 a[30:31], v4 offset:3584
  s_xor_b32 s29, s90, 0x200000
  buffer_load_dwordx4 a[64:67], v2, s[68:71], s29 offen
  s_add_u32 s28, s29, 0x8000
  buffer_load_dwordx4 a[68:71], v2, s[68:71], s28 offen
  s_add_u32 s28, s29, 0x40000
  buffer_load_dwordx4 a[72:75], v2, s[68:71], s28 offen
  s_add_u32 s28, s29, 0x48000
  buffer_load_dwordx4 a[76:79], v2, s[68:71], s28 offen
  s_waitcnt vmcnt(23)
  s_waitcnt lgkmcnt(14)
  ds_write_b128 v3, v[144:147] offset:0
  s_waitcnt vmcnt(22)
  s_waitcnt lgkmcnt(14)
  ds_write_b128 v3, v[148:151] offset:512
  s_waitcnt vmcnt(21)
  s_waitcnt lgkmcnt(14)
  ds_write_b128 v3, v[152:155] offset:1024
  s_waitcnt vmcnt(20)
  s_waitcnt lgkmcnt(14)
  ds_write_b128 v3, v[156:159] offset:1536
  s_waitcnt lgkmcnt(14)
  ds_read_b64_tr_b16 v[144:145], v4 offset:0
  s_waitcnt lgkmcnt(14)
  ds_read_b64_tr_b16 v[146:147], v4 offset:512
  s_waitcnt lgkmcnt(14)
  ds_read_b64_tr_b16 v[148:149], v4 offset:1024
  s_waitcnt lgkmcnt(14)
  ds_read_b64_tr_b16 v[150:151], v4 offset:1536
  s_waitcnt lgkmcnt(14)
  ds_read_b64_tr_b16 v[152:153], v4 offset:2048
  s_waitcnt lgkmcnt(14)
  ds_read_b64_tr_b16 v[154:155], v4 offset:2560
  s_waitcnt lgkmcnt(14)
  ds_read_b64_tr_b16 v[156:157], v4 offset:3072
  s_waitcnt lgkmcnt(14)
  ds_read_b64_tr_b16 v[158:159], v4 offset:3584
  s_xor_b32 s29, s90, 0x200000
  buffer_load_dwordx4 v[192:195], v2, s[72:75], s29 offen
  s_add_u32 s28, s29, 0x8000
  buffer_load_dwordx4 v[196:199], v2, s[72:75], s28 offen
  s_add_u32 s28, s29, 0x40000
  buffer_load_dwordx4 v[200:203], v2, s[72:75], s28 offen
  s_add_u32 s28, s29, 0x48000
  buffer_load_dwordx4 v[204:207], v2, s[72:75], s28 offen
  s_waitcnt vmcnt(23)
  s_waitcnt lgkmcnt(14)
  ds_write_b128 v3, a[32:35] offset:0
  s_waitcnt vmcnt(22)
  s_waitcnt lgkmcnt(14)
  ds_write_b128 v3, a[36:39] offset:512
  s_waitcnt vmcnt(21)
  s_waitcnt lgkmcnt(14)
  ds_write_b128 v3, a[40:43] offset:1024
  s_waitcnt vmcnt(20)
  s_waitcnt lgkmcnt(14)
  ds_write_b128 v3, a[44:47] offset:1536
  s_waitcnt lgkmcnt(14)
  ds_read_b64_tr_b16 a[32:33], v4 offset:0
  s_waitcnt lgkmcnt(14)
  ds_read_b64_tr_b16 a[34:35], v4 offset:512
  s_waitcnt lgkmcnt(14)
  ds_read_b64_tr_b16 a[36:37], v4 offset:1024
  s_waitcnt lgkmcnt(14)
  ds_read_b64_tr_b16 a[38:39], v4 offset:1536
  s_waitcnt lgkmcnt(14)
  ds_read_b64_tr_b16 a[40:41], v4 offset:2048
  s_waitcnt lgkmcnt(14)
  ds_read_b64_tr_b16 a[42:43], v4 offset:2560
  s_waitcnt lgkmcnt(14)
  ds_read_b64_tr_b16 a[44:45], v4 offset:3072
  s_waitcnt lgkmcnt(14)
  ds_read_b64_tr_b16 a[46:47], v4 offset:3584
  s_xor_b32 s29, s90, 0x280000
  buffer_load_dwordx4 a[80:83], v2, s[68:71], s29 offen
  s_add_u32 s28, s29, 0x8000
  buffer_load_dwordx4 a[84:87], v2, s[68:71], s28 offen
  s_add_u32 s28, s29, 0x40000
  buffer_load_dwordx4 a[88:91], v2, s[68:71], s28 offen
  s_add_u32 s28, s29, 0x48000
  buffer_load_dwordx4 a[92:95], v2, s[68:71], s28 offen
  s_waitcnt vmcnt(23)
  s_waitcnt lgkmcnt(14)
  ds_write_b128 v3, v[160:163] offset:0
  s_waitcnt vmcnt(22)
  s_waitcnt lgkmcnt(14)
  ds_write_b128 v3, v[164:167] offset:512
  s_waitcnt vmcnt(21)
  s_waitcnt lgkmcnt(14)
  ds_write_b128 v3, v[168:171] offset:1024
  s_waitcnt vmcnt(20)
  s_waitcnt lgkmcnt(14)
  ds_write_b128 v3, v[172:175] offset:1536
  s_waitcnt lgkmcnt(14)
  ds_read_b64_tr_b16 v[160:161], v4 offset:0
  s_waitcnt lgkmcnt(14)
  ds_read_b64_tr_b16 v[162:163], v4 offset:512
  s_waitcnt lgkmcnt(14)
  ds_read_b64_tr_b16 v[164:165], v4 offset:1024
  s_waitcnt lgkmcnt(14)
  ds_read_b64_tr_b16 v[166:167], v4 offset:1536
  s_waitcnt lgkmcnt(14)
  ds_read_b64_tr_b16 v[168:169], v4 offset:2048
  s_waitcnt lgkmcnt(14)
  ds_read_b64_tr_b16 v[170:171], v4 offset:2560
  s_waitcnt lgkmcnt(14)
  ds_read_b64_tr_b16 v[172:173], v4 offset:3072
  s_waitcnt lgkmcnt(14)
  ds_read_b64_tr_b16 v[174:175], v4 offset:3584
  s_xor_b32 s29, s90, 0x280000
  buffer_load_dwordx4 v[208:211], v2, s[72:75], s29 offen
  s_add_u32 s28, s29, 0x8000
  buffer_load_dwordx4 v[212:215], v2, s[72:75], s28 offen
  s_add_u32 s28, s29, 0x40000
  buffer_load_dwordx4 v[216:219], v2, s[72:75], s28 offen
  s_add_u32 s28, s29, 0x48000
  buffer_load_dwordx4 v[220:223], v2, s[72:75], s28 offen
  v_lshlrev_b32 v9, 6, v0
  s_lshl_b32 s28, s62, 5
  s_add_u32 s28, s28, s4
  s_lshl_b32 s28, s28, 2
  s_add_u32 s28, s28, s5
  s_lshl_b32 s28, s28, 12
  s_add_u32 s29, s28, 3670016
  s_mov_b32 s12, s46
  s_mov_b32 s13, s47
  s_mov_b32 s14, 0x400000
  s_mov_b32 s15, 0x20000
  buffer_load_dword v116, v9, s[12:15], s28 offen
  buffer_load_dword v117, v9, s[12:15], s29 offen
  s_waitcnt vmcnt(25)
  s_waitcnt lgkmcnt(14)
  ds_write_b128 v3, a[48:51] offset:0
  s_waitcnt vmcnt(24)
  s_waitcnt lgkmcnt(14)
  ds_write_b128 v3, a[52:55] offset:512
  s_waitcnt vmcnt(23)
  s_waitcnt lgkmcnt(14)
  ds_write_b128 v3, a[56:59] offset:1024
  s_waitcnt vmcnt(22)
  s_waitcnt lgkmcnt(14)
  ds_write_b128 v3, a[60:63] offset:1536
  s_waitcnt lgkmcnt(14)
  ds_read_b64_tr_b16 a[48:49], v4 offset:0
  s_waitcnt lgkmcnt(14)
  ds_read_b64_tr_b16 a[50:51], v4 offset:512
  s_waitcnt lgkmcnt(14)
  ds_read_b64_tr_b16 a[52:53], v4 offset:1024
  s_waitcnt lgkmcnt(14)
  ds_read_b64_tr_b16 a[54:55], v4 offset:1536
  s_waitcnt lgkmcnt(14)
  ds_read_b64_tr_b16 a[56:57], v4 offset:2048
  s_waitcnt lgkmcnt(14)
  ds_read_b64_tr_b16 a[58:59], v4 offset:2560
  s_waitcnt lgkmcnt(14)
  ds_read_b64_tr_b16 a[60:61], v4 offset:3072
  s_waitcnt lgkmcnt(14)
  ds_read_b64_tr_b16 a[62:63], v4 offset:3584
  s_xor_b32 s29, s90, 0x300000
  buffer_load_dwordx4 a[96:99], v2, s[68:71], s29 offen
  s_add_u32 s28, s29, 0x8000
  buffer_load_dwordx4 a[100:103], v2, s[68:71], s28 offen
  s_add_u32 s28, s29, 0x40000
  buffer_load_dwordx4 a[104:107], v2, s[68:71], s28 offen
  s_add_u32 s28, s29, 0x48000
  buffer_load_dwordx4 a[108:111], v2, s[68:71], s28 offen
  s_waitcnt vmcnt(25)
  s_waitcnt lgkmcnt(14)
  ds_write_b128 v3, v[176:179] offset:0
  s_waitcnt vmcnt(24)
  s_waitcnt lgkmcnt(14)
  ds_write_b128 v3, v[180:183] offset:512
  s_waitcnt vmcnt(23)
  s_waitcnt lgkmcnt(14)
  ds_write_b128 v3, v[184:187] offset:1024
  s_waitcnt vmcnt(22)
  s_waitcnt lgkmcnt(14)
  ds_write_b128 v3, v[188:191] offset:1536
  s_waitcnt lgkmcnt(14)
  ds_read_b64_tr_b16 v[176:177], v4 offset:0
  s_waitcnt lgkmcnt(14)
  ds_read_b64_tr_b16 v[178:179], v4 offset:512
  s_waitcnt lgkmcnt(14)
  ds_read_b64_tr_b16 v[180:181], v4 offset:1024
  s_waitcnt lgkmcnt(14)
  ds_read_b64_tr_b16 v[182:183], v4 offset:1536
  s_waitcnt lgkmcnt(14)
  ds_read_b64_tr_b16 v[184:185], v4 offset:2048
  s_waitcnt lgkmcnt(14)
  ds_read_b64_tr_b16 v[186:187], v4 offset:2560
  s_waitcnt lgkmcnt(14)
  ds_read_b64_tr_b16 v[188:189], v4 offset:3072
  s_waitcnt lgkmcnt(14)
  ds_read_b64_tr_b16 v[190:191], v4 offset:3584
  s_xor_b32 s29, s90, 0x300000
  buffer_load_dwordx4 v[224:227], v2, s[72:75], s29 offen
  s_add_u32 s28, s29, 0x8000
  buffer_load_dwordx4 v[228:231], v2, s[72:75], s28 offen
  s_add_u32 s28, s29, 0x40000
  buffer_load_dwordx4 v[232:235], v2, s[72:75], s28 offen
  s_add_u32 s28, s29, 0x48000
  buffer_load_dwordx4 v[236:239], v2, s[72:75], s28 offen
  s_waitcnt vmcnt(25)
  s_waitcnt lgkmcnt(14)
  ds_write_b128 v3, a[64:67] offset:0
  s_waitcnt vmcnt(24)
  s_waitcnt lgkmcnt(14)
  ds_write_b128 v3, a[68:71] offset:512
  s_waitcnt vmcnt(23)
  s_waitcnt lgkmcnt(14)
  ds_write_b128 v3, a[72:75] offset:1024
  s_waitcnt vmcnt(22)
  s_waitcnt lgkmcnt(14)
  ds_write_b128 v3, a[76:79] offset:1536
  s_waitcnt lgkmcnt(14)
  ds_read_b64_tr_b16 a[64:65], v4 offset:0
  s_waitcnt lgkmcnt(14)
  ds_read_b64_tr_b16 a[66:67], v4 offset:512
  s_waitcnt lgkmcnt(14)
  ds_read_b64_tr_b16 a[68:69], v4 offset:1024
  s_waitcnt lgkmcnt(14)
  ds_read_b64_tr_b16 a[70:71], v4 offset:1536
  s_waitcnt lgkmcnt(14)
  ds_read_b64_tr_b16 a[72:73], v4 offset:2048
  s_waitcnt lgkmcnt(14)
  ds_read_b64_tr_b16 a[74:75], v4 offset:2560
  s_waitcnt lgkmcnt(14)
  ds_read_b64_tr_b16 a[76:77], v4 offset:3072
  s_waitcnt lgkmcnt(14)
  ds_read_b64_tr_b16 a[78:79], v4 offset:3584
  s_xor_b32 s29, s90, 0x380000
  buffer_load_dwordx4 a[112:115], v2, s[68:71], s29 offen
  s_add_u32 s28, s29, 0x8000
  buffer_load_dwordx4 a[116:119], v2, s[68:71], s28 offen
  s_add_u32 s28, s29, 0x40000
  buffer_load_dwordx4 a[120:123], v2, s[68:71], s28 offen
  s_add_u32 s28, s29, 0x48000
  buffer_load_dwordx4 a[124:127], v2, s[68:71], s28 offen
  s_waitcnt vmcnt(25)
  s_waitcnt lgkmcnt(14)
  ds_write_b128 v3, v[192:195] offset:0
  s_waitcnt vmcnt(24)
  s_waitcnt lgkmcnt(14)
  ds_write_b128 v3, v[196:199] offset:512
  s_waitcnt vmcnt(23)
  s_waitcnt lgkmcnt(14)
  ds_write_b128 v3, v[200:203] offset:1024
  s_waitcnt vmcnt(22)
  s_waitcnt lgkmcnt(14)
  ds_write_b128 v3, v[204:207] offset:1536
  s_waitcnt lgkmcnt(14)
  ds_read_b64_tr_b16 v[192:193], v4 offset:0
  s_waitcnt lgkmcnt(14)
  ds_read_b64_tr_b16 v[194:195], v4 offset:512
  s_waitcnt lgkmcnt(14)
  ds_read_b64_tr_b16 v[196:197], v4 offset:1024
  s_waitcnt lgkmcnt(14)
  ds_read_b64_tr_b16 v[198:199], v4 offset:1536
  s_waitcnt lgkmcnt(14)
  ds_read_b64_tr_b16 v[200:201], v4 offset:2048
  s_waitcnt lgkmcnt(14)
  ds_read_b64_tr_b16 v[202:203], v4 offset:2560
  s_waitcnt lgkmcnt(14)
  ds_read_b64_tr_b16 v[204:205], v4 offset:3072
  s_waitcnt lgkmcnt(14)
  ds_read_b64_tr_b16 v[206:207], v4 offset:3584
  s_xor_b32 s29, s90, 0x380000
  buffer_load_dwordx4 v[240:243], v2, s[72:75], s29 offen
  s_add_u32 s28, s29, 0x8000
  buffer_load_dwordx4 v[244:247], v2, s[72:75], s28 offen
  s_add_u32 s28, s29, 0x40000
  buffer_load_dwordx4 v[248:251], v2, s[72:75], s28 offen
  s_add_u32 s28, s29, 0x48000
  buffer_load_dwordx4 v[252:255], v2, s[72:75], s28 offen
  v_and_b32 v12, 7, v0
  v_max_u32 v12, 1, v12
  v_lshlrev_b32 v12, 5, v12
  buffer_load_dword v14, v12, s[24:27], 0 offen sc1
  v_and_b32 v8, 15, v0
  v_lshlrev_b32 v8, 10, v8
  v_lshrrev_b32 v9, 4, v0
  v_lshl_add_u32 v8, v9, 4, v8
  s_lshr_b32 s28, s5, 1
  s_lshl_b32 s28, s28, 14
  s_and_b32 s29, s5, 1
  s_lshr_b32 s30, s77, 2
  s_xor_b32 s29, s29, s30
  s_lshl_b32 s29, s29, 9
  s_add_u32 s28, s28, s29
  v_add_u32 v5, s28, v8
  s_mov_b32 s85, s77
  s_mov_b32 s63, 0
  s_lshl_b32 s28, s77, 20
  s_mul_i32 s29, s76, 29696
  s_add_u32 s28, s28, s29
  s_add_u32 s86, s28, 0x1800000
  s_lshl_b32 s91, s5, 13
  s_and_b32 s28, s77, 3
  s_lshl_b32 s28, s28, 11
  s_add_u32 s91, s91, s28
  s_waitcnt vmcnt(26)
  s_waitcnt lgkmcnt(14)
  ds_write_b128 v3, a[80:83] offset:0
  s_waitcnt vmcnt(25)
  s_waitcnt lgkmcnt(14)
  ds_write_b128 v3, a[84:87] offset:512
  s_waitcnt vmcnt(24)
  s_waitcnt lgkmcnt(14)
  ds_write_b128 v3, a[88:91] offset:1024
  s_waitcnt vmcnt(23)
  s_waitcnt lgkmcnt(14)
  ds_write_b128 v3, a[92:95] offset:1536
  s_waitcnt lgkmcnt(14)
  ds_read_b64_tr_b16 a[80:81], v4 offset:0
  s_waitcnt lgkmcnt(14)
  ds_read_b64_tr_b16 a[82:83], v4 offset:512
  s_waitcnt lgkmcnt(14)
  ds_read_b64_tr_b16 a[84:85], v4 offset:1024
  s_waitcnt lgkmcnt(14)
  ds_read_b64_tr_b16 a[86:87], v4 offset:1536
  s_waitcnt lgkmcnt(14)
  ds_read_b64_tr_b16 a[88:89], v4 offset:2048
  s_waitcnt lgkmcnt(14)
  ds_read_b64_tr_b16 a[90:91], v4 offset:2560
  s_waitcnt lgkmcnt(14)
  ds_read_b64_tr_b16 a[92:93], v4 offset:3072
  s_waitcnt lgkmcnt(14)
  ds_read_b64_tr_b16 a[94:95], v4 offset:3584
  s_waitcnt vmcnt(22)
  s_waitcnt lgkmcnt(14)
  ds_write_b128 v3, v[208:211] offset:0
  s_waitcnt vmcnt(21)
  s_waitcnt lgkmcnt(14)
  ds_write_b128 v3, v[212:215] offset:512
  s_waitcnt vmcnt(20)
  s_waitcnt lgkmcnt(14)
  ds_write_b128 v3, v[216:219] offset:1024
  s_waitcnt vmcnt(19)
  s_waitcnt lgkmcnt(14)
  ds_write_b128 v3, v[220:223] offset:1536
  s_waitcnt lgkmcnt(14)
  ds_read_b64_tr_b16 v[208:209], v4 offset:0
  s_waitcnt lgkmcnt(14)
  ds_read_b64_tr_b16 v[210:211], v4 offset:512
  s_waitcnt lgkmcnt(14)
  ds_read_b64_tr_b16 v[212:213], v4 offset:1024
  s_waitcnt lgkmcnt(14)
  ds_read_b64_tr_b16 v[214:215], v4 offset:1536
  s_waitcnt lgkmcnt(14)
  ds_read_b64_tr_b16 v[216:217], v4 offset:2048
  s_waitcnt lgkmcnt(14)
  ds_read_b64_tr_b16 v[218:219], v4 offset:2560
  s_waitcnt lgkmcnt(14)
  ds_read_b64_tr_b16 v[220:221], v4 offset:3072
  s_waitcnt lgkmcnt(14)
  ds_read_b64_tr_b16 v[222:223], v4 offset:3584
  s_waitcnt vmcnt(16)
  s_waitcnt lgkmcnt(14)
  ds_write_b128 v3, a[96:99] offset:0
  s_waitcnt vmcnt(15)
  s_waitcnt lgkmcnt(14)
  ds_write_b128 v3, a[100:103] offset:512
  s_waitcnt vmcnt(14)
  s_waitcnt lgkmcnt(14)
  ds_write_b128 v3, a[104:107] offset:1024
  s_waitcnt vmcnt(13)
  s_waitcnt lgkmcnt(14)
  ds_write_b128 v3, a[108:111] offset:1536
  s_waitcnt lgkmcnt(14)
  ds_read_b64_tr_b16 a[96:97], v4 offset:0
  s_waitcnt lgkmcnt(14)
  ds_read_b64_tr_b16 a[98:99], v4 offset:512
  s_waitcnt lgkmcnt(14)
  ds_read_b64_tr_b16 a[100:101], v4 offset:1024
  s_waitcnt lgkmcnt(14)
  ds_read_b64_tr_b16 a[102:103], v4 offset:1536
  s_waitcnt lgkmcnt(14)
  ds_read_b64_tr_b16 a[104:105], v4 offset:2048
  s_waitcnt lgkmcnt(14)
  ds_read_b64_tr_b16 a[106:107], v4 offset:2560
  s_waitcnt lgkmcnt(14)
  ds_read_b64_tr_b16 a[108:109], v4 offset:3072
  s_waitcnt lgkmcnt(14)
  ds_read_b64_tr_b16 a[110:111], v4 offset:3584
  s_waitcnt vmcnt(0)
  v_and_b32 v13, 63, v14
  v_cmp_ne_u32 vcc, 32, v13
  s_cbranch_vccnz L_gs_104
L_gb_105:
  v_readlane_b32 s28, v14, s3
  s_lshl_b32 s29, s7, 5
  s_nop 1
  s_cmp_lg_u32 s28, s29
  s_cselect_b32 s92, 1, 0
  s_add_u32 s29, s85, 0
  s_lshl_b32 s29, s29, 15
  s_add_u32 s29, s29, 0x100000
  s_xor_b32 m0, s91, 0
  s_nop 0
  buffer_load_dwordx4 v5, s[8:11], s29 offen sc1 lds
  s_xor_b32 m0, s91, 1024
  s_add_u32 s29, s29, 64
  buffer_load_dwordx4 v5, s[8:11], s29 offen sc1 lds
  s_xor_b32 m0, s91, 2048
  s_add_u32 s29, s29, 64
  buffer_load_dwordx4 v5, s[8:11], s29 offen sc1 lds
  s_xor_b32 m0, s91, 3072
  s_add_u32 s29, s29, 64
  buffer_load_dwordx4 v5, s[8:11], s29 offen sc1 lds
  s_xor_b32 m0, s91, 4096
  s_add_u32 s29, s29, 64
  buffer_load_dwordx4 v5, s[8:11], s29 offen sc1 lds
  s_xor_b32 m0, s91, 5120
  s_add_u32 s29, s29, 64
  buffer_load_dwordx4 v5, s[8:11], s29 offen sc1 lds
  s_xor_b32 m0, s91, 6144
  s_add_u32 s29, s29, 64
  buffer_load_dwordx4 v5, s[8:11], s29 offen sc1 lds
  s_xor_b32 m0, s91, 7168
  s_add_u32 s29, s29, 64
  buffer_load_dwordx4 v5, s[8:11], s29 offen sc1 lds
  s_waitcnt lgkmcnt(14)
  ds_write_b128 v3, v[224:227] offset:0
  s_waitcnt lgkmcnt(14)
  ds_write_b128 v3, v[228:231] offset:512
  s_waitcnt lgkmcnt(14)
  ds_write_b128 v3, v[232:235] offset:1024
  s_waitcnt lgkmcnt(14)
  ds_write_b128 v3, v[236:239] offset:1536
  s_waitcnt lgkmcnt(14)
  ds_read_b64_tr_b16 v[224:225], v4 offset:0
  s_waitcnt lgkmcnt(14)
  ds_read_b64_tr_b16 v[226:227], v4 offset:512
  s_waitcnt lgkmcnt(14)
  ds_read_b64_tr_b16 v[228:229], v4 offset:1024
  s_waitcnt lgkmcnt(14)
  ds_read_b64_tr_b16 v[230:231], v4 offset:1536
  s_waitcnt lgkmcnt(14)
  ds_read_b64_tr_b16 v[232:233], v4 offset:2048
  s_waitcnt lgkmcnt(14)
  ds_read_b64_tr_b16 v[234:235], v4 offset:2560
  s_waitcnt lgkmcnt(14)
  ds_read_b64_tr_b16 v[236:237], v4 offset:3072
  s_waitcnt lgkmcnt(14)
  ds_read_b64_tr_b16 v[238:239], v4 offset:3584
  s_waitcnt lgkmcnt(14)
  ds_write_b128 v3, a[112:115] offset:0
  s_waitcnt lgkmcnt(14)
  ds_write_b128 v3, a[116:119] offset:512
  s_waitcnt lgkmcnt(14)
  ds_write_b128 v3, a[120:123] offset:1024
  s_waitcnt lgkmcnt(14)
  ds_write_b128 v3, a[124:127] offset:1536
  s_waitcnt lgkmcnt(14)
  ds_read_b64_tr_b16 a[112:113], v4 offset:0
  s_waitcnt lgkmcnt(14)
  ds_read_b64_tr_b16 a[114:115], v4 offset:512
  s_waitcnt lgkmcnt(14)
  ds_read_b64_tr_b16 a[116:117], v4 offset:1024
  s_waitcnt lgkmcnt(14)
  ds_read_b64_tr_b16 a[118:119], v4 offset:1536
  s_waitcnt lgkmcnt(14)
  ds_read_b64_tr_b16 a[120:121], v4 offset:2048
  s_waitcnt lgkmcnt(14)
  ds_read_b64_tr_b16 a[122:123], v4 offset:2560
  s_waitcnt lgkmcnt(14)
  ds_read_b64_tr_b16 a[124:125], v4 offset:3072
  s_waitcnt lgkmcnt(14)
  ds_read_b64_tr_b16 a[126:127], v4 offset:3584
  s_waitcnt lgkmcnt(14)
  ds_write_b128 v3, v[240:243] offset:0
  s_waitcnt lgkmcnt(14)
  ds_write_b128 v3, v[244:247] offset:512
  s_waitcnt lgkmcnt(14)
  ds_write_b128 v3, v[248:251] offset:1024
  s_waitcnt lgkmcnt(14)
  ds_write_b128 v3, v[252:255] offset:1536
  s_waitcnt lgkmcnt(14)
  ds_read_b64_tr_b16 v[240:241], v4 offset:0
  s_waitcnt lgkmcnt(14)
  ds_read_b64_tr_b16 v[242:243], v4 offset:512
  s_waitcnt lgkmcnt(14)
  ds_read_b64_tr_b16 v[244:245], v4 offset:1024
  s_waitcnt lgkmcnt(14)
  ds_read_b64_tr_b16 v[246:247], v4 offset:1536
  s_waitcnt lgkmcnt(14)
  ds_read_b64_tr_b16 v[248:249], v4 offset:2048
  s_waitcnt lgkmcnt(14)
  ds_read_b64_tr_b16 v[250:251], v4 offset:2560
  s_waitcnt lgkmcnt(14)
  ds_read_b64_tr_b16 v[252:253], v4 offset:3072
  s_waitcnt lgkmcnt(14)
  ds_read_b64_tr_b16 v[254:255], v4 offset:3584
  v_mov_b32 v6, v1
  v_mov_b32 v120, 0
  v_mov_b32 v121, 0
  v_mov_b32 v122, 0
  v_mov_b32 v123, 0
  s_waitcnt vmcnt(0) lgkmcnt(0)
  v_lshlrev_b32 v9, 6, v0
  s_lshl_b32 s28, s62, 5
  s_add_u32 s28, s28, s4
  s_lshl_b32 s28, s28, 2
  s_add_u32 s28, s28, s5
  s_lshl_b32 s28, s28, 12
  s_mov_b32 s12, s52
  s_mov_b32 s13, s53
  s_mov_b32 s14, 0x158000
  s_mov_b32 s15, 0x20000
  buffer_load_dword v118, v9, s[12:15], s28 offen
  s_mov_b32 s12, s54
  s_mov_b32 s13, s55
  s_mov_b32 s14, 0x158000
  s_mov_b32 s15, 0x20000
  buffer_load_dword v119, v9, s[12:15], s28 offen
  s_barrier
L_w1_loop:
  s_xor_b32 s91, s91, 0x8000
  s_add_u32 s29, s85, 7
  s_lshl_b32 s29, s29, 15
  s_add_u32 s29, s29, 0x100000
  s_xor_b32 m0, s91, 0
  s_nop 0
  buffer_load_dwordx4 v5, s[8:11], s29 offen sc1 lds
  s_xor_b32 m0, s91, 1024
  s_add_u32 s29, s29, 64
  buffer_load_dwordx4 v5, s[8:11], s29 offen sc1 lds
  s_xor_b32 m0, s91, 2048
  s_add_u32 s29, s29, 64
  buffer_load_dwordx4 v5, s[8:11], s29 offen sc1 lds
  s_xor_b32 m0, s91, 3072
  s_add_u32 s29, s29, 64
  buffer_load_dwordx4 v5, s[8:11], s29 offen sc1 lds
  s_xor_b32 m0, s91, 4096
  s_add_u32 s29, s29, 64
  buffer_load_dwordx4 v5, s[8:11], s29 offen sc1 lds
  s_xor_b32 m0, s91, 5120
  s_add_u32 s29, s29, 64
  buffer_load_dwordx4 v5, s[8:11], s29 offen sc1 lds
  s_xor_b32 m0, s91, 6144
  s_add_u32 s29, s29, 64
  buffer_load_dwordx4 v5, s[8:11], s29 offen sc1 lds
  s_xor_b32 m0, s91, 7168
  s_add_u32 s29, s29, 64
  buffer_load_dwordx4 v5, s[8:11], s29 offen sc1 lds
  ds_read_b128 v[64:67], v6 offset:0
  ds_read_b128 v[68:71], v6 offset:16384
  ds_read_b128 v[72:75], v6 offset:1024
  ds_read_b128 v[76:79], v6 offset:17408
  s_waitcnt lgkmcnt(3)
  v_mfma_f32_16x16x32_bf16 v[16:19], a[0:3], v[64:67], 0
  s_waitcnt lgkmcnt(2)
  v_mfma_f32_16x16x32_bf16 v[24:27], a[0:3], v[68:71], 0
  ds_read_b128 v[80:83], v6 offset:2048
  ds_read_b128 v[84:87], v6 offset:18432
  v_mfma_f32_16x16x32_bf16 v[20:23], a[8:11], v[64:67], 0
  v_mfma_f32_16x16x32_bf16 v[28:31], a[8:11], v[68:71], 0
  v_mfma_f32_16x16x32_bf16 v[32:35], v[64:67], v[128:131], 0
  v_mfma_f32_16x16x32_bf16 v[36:39], v[68:71], v[128:131], 0
  v_mfma_f32_16x16x32_bf16 v[40:43], v[64:67], v[136:139], 0
  v_mfma_f32_16x16x32_bf16 v[44:47], v[68:71], v[136:139], 0
  s_waitcnt lgkmcnt(3)
  v_mfma_f32_16x16x32_bf16 v[16:19], a[4:7], v[72:75], v[16:19]
  s_waitcnt lgkmcnt(2)
  v_mfma_f32_16x16x32_bf16 v[24:27], a[4:7], v[76:79], v[24:27]
  ds_read_b128 v[64:67], v6 offset:3072
  ds_read_b128 v[68:71], v6 offset:19456
  v_mfma_f32_16x16x32_bf16 v[20:23], a[12:15], v[72:75], v[20:23]
  v_mfma_f32_16x16x32_bf16 v[28:31], a[12:15], v[76:79], v[28:31]
  v_mfma_f32_16x16x32_bf16 v[32:35], v[72:75], v[132:135], v[32:35]
  v_mfma_f32_16x16x32_bf16 v[36:39], v[76:79], v[132:135], v[36:39]
  v_mfma_f32_16x16x32_bf16 v[40:43], v[72:75], v[140:143], v[40:43]
  v_mfma_f32_16x16x32_bf16 v[44:47], v[76:79], v[140:143], v[44:47]
  s_waitcnt lgkmcnt(3)
  v_mfma_f32_16x16x32_bf16 v[16:19], a[16:19], v[80:83], v[16:19]
  s_waitcnt lgkmcnt(2)
  v_mfma_f32_16x16x32_bf16 v[24:27], a[16:19], v[84:87], v[24:27]
  ds_read_b128 v[72:75], v6 offset:4096
  ds_read_b128 v[76:79], v6 offset:20480
  v_mfma_f32_16x16x32_bf16 v[20:23], a[24:27], v[80:83], v[20:23]
  v_mfma_f32_16x16x32_bf16 v[28:31], a[24:27], v[84:87], v[28:31]
  v_mfma_f32_16x16x32_bf16 v[32:35], v[80:83], v[144:147], v[32:35]
  v_mfma_f32_16x16x32_bf16 v[36:39], v[84:87], v[144:147], v[36:39]
  v_mfma_f32_16x16x32_bf16 v[40:43], v[80:83], v[152:155], v[40:43]
  v_mfma_f32_16x16x32_bf16 v[44:47], v[84:87], v[152:155], v[44:47]
  s_waitcnt lgkmcnt(3)
  v_mfma_f32_16x16x32_bf16 v[16:19], a[20:23], v[64:67], v[16:19]
  s_waitcnt lgkmcnt(2)
  v_mfma_f32_16x16x32_bf16 v[24:27], a[20:23], v[68:71], v[24:27]
  ds_read_b128 v[80:83], v6 offset:5120
  ds_read_b128 v[84:87], v6 offset:21504
  v_mfma_f32_16x16x32_bf16 v[20:23], a[28:31], v[64:67], v[20:23]
  v_mfma_f32_16x16x32_bf16 v[28:31], a[28:31], v[68:71], v[28:31]
  v_mfma_f32_16x16x32_bf16 v[32:35], v[64:67], v[148:151], v[32:35]
  v_mfma_f32_16x16x32_bf16 v[36:39], v[68:71], v[148:151], v[36:39]
  v_mfma_f32_16x16x32_bf16 v[40:43], v[64:67], v[156:159], v[40:43]
  v_mfma_f32_16x16x32_bf16 v[44:47], v[68:71], v[156:159], v[44:47]
  s_waitcnt lgkmcnt(3)
  v_mfma_f32_16x16x32_bf16 v[16:19], a[32:35], v[72:75], v[16:19]
  s_waitcnt lgkmcnt(2)
  v_mfma_f32_16x16x32_bf16 v[24:27], a[32:35], v[76:79], v[24:27]
  ds_read_b128 v[64:67], v6 offset:6144
  ds_read_b128 v[68:71], v6 offset:22528
  v_mfma_f32_16x16x32_bf16 v[20:23], a[40:43], v[72:75], v[20:23]
  v_mfma_f32_16x16x32_bf16 v[28:31], a[40:43], v[76:79], v[28:31]
  v_mfma_f32_16x16x32_bf16 v[32:35], v[72:75], v[160:163], v[32:35]
  v_mfma_f32_16x16x32_bf16 v[36:39], v[76:79], v[160:163], v[36:39]
  v_mfma_f32_16x16x32_bf16 v[40:43], v[72:75], v[168:171], v[40:43]
  v_mfma_f32_16x16x32_bf16 v[44:47], v[76:79], v[168:171], v[44:47]
  s_waitcnt lgkmcnt(3)
  v_mfma_f32_16x16x32_bf16 v[16:19], a[36:39], v[80:83], v[16:19]
  s_waitcnt lgkmcnt(2)
  v_mfma_f32_16x16x32_bf16 v[24:27], a[36:39], v[84:87], v[24:27]
  ds_read_b128 v[72:75], v6 offset:7168
  ds_read_b128 v[76:79], v6 offset:23552
  v_mfma_f32_16x16x32_bf16 v[20:23], a[44:47], v[80:83], v[20:23]
  v_mfma_f32_16x16x32_bf16 v[28:31], a[44:47], v[84:87], v[28:31]
  v_mfma_f32_16x16x32_bf16 v[32:35], v[80:83], v[164:167], v[32:35]
  v_mfma_f32_16x16x32_bf16 v[36:39], v[84:87], v[164:167], v[36:39]
  v_mfma_f32_16x16x32_bf16 v[40:43], v[80:83], v[172:175], v[40:43]
  v_mfma_f32_16x16x32_bf16 v[44:47], v[84:87], v[172:175], v[44:47]
  s_waitcnt lgkmcnt(3)
  v_mfma_f32_16x16x32_bf16 v[16:19], a[48:51], v[64:67], v[16:19]
  s_waitcnt lgkmcnt(2)
  v_mfma_f32_16x16x32_bf16 v[24:27], a[48:51], v[68:71], v[24:27]
  ds_read_b128 v[80:83], v6 offset:8192
  ds_read_b128 v[84:87], v6 offset:24576
  v_mfma_f32_16x16x32_bf16 v[20:23], a[56:59], v[64:67], v[20:23]
  v_mfma_f32_16x16x32_bf16 v[28:31], a[56:59], v[68:71], v[28:31]
  v_mfma_f32_16x16x32_bf16 v[32:35], v[64:67], v[176:179], v[32:35]
  v_mfma_f32_16x16x32_bf16 v[36:39], v[68:71], v[176:179], v[36:39]
  v_mfma_f32_16x16x32_bf16 v[40:43], v[64:67], v[184:187], v[40:43]
  v_mfma_f32_16x16x32_bf16 v[44:47], v[68:71], v[184:187], v[44:47]
  s_waitcnt lgkmcnt(3)
  v_mfma_f32_16x16x32_bf16 v[16:19], a[52:55], v[72:75], v[16:19]
  s_waitcnt lgkmcnt(2)
  v_mfma_f32_16x16x32_bf16 v[24:27], a[52:55], v[76:79], v[24:27]
  ds_read_b128 v[64:67], v6 offset:9216
  ds_read_b128 v[68:71], v6 offset:25600
  v_mfma_f32_16x16x32_bf16 v[20:23], a[60:63], v[72:75], v[20:23]
  v_mfma_f32_16x16x32_bf16 v[28:31], a[60:63], v[76:79], v[28:31]
  v_mfma_f32_16x16x32_bf16 v[32:35], v[72:75], v[180:183], v[32:35]
  v_mfma_f32_16x16x32_bf16 v[36:39], v[76:79], v[180:183], v[36:39]
  v_mfma_f32_16x16x32_bf16 v[40:43], v[72:75], v[188:191], v[40:43]
  v_mfma_f32_16x16x32_bf16 v[44:47], v[76:79], v[188:191], v[44:47]
  s_waitcnt lgkmcnt(3)
  v_mfma_f32_16x16x32_bf16 v[16:19], a[64:67], v[80:83], v[16:19]
  s_waitcnt lgkmcnt(2)
  v_mfma_f32_16x16x32_bf16 v[24:27], a[64:67], v[84:87], v[24:27]
  ds_read_b128 v[72:75], v6 offset:10240
  ds_read_b128 v[76:79], v6 offset:26624
  v_mfma_f32_16x16x32_bf16 v[20:23], a[72:75], v[80:83], v[20:23]
  v_mfma_f32_16x16x32_bf16 v[28:31], a[72:75], v[84:87], v[28:31]
  v_mfma_f32_16x16x32_bf16 v[32:35], v[80:83], v[192:195], v[32:35]
  v_mfma_f32_16x16x32_bf16 v[36:39], v[84:87], v[192:195], v[36:39]
  v_mfma_f32_16x16x32_bf16 v[40:43], v[80:83], v[200:203], v[40:43]
  v_mfma_f32_16x16x32_bf16 v[44:47], v[84:87], v[200:203], v[44:47]
  s_waitcnt lgkmcnt(3)
  v_mfma_f32_16x16x32_bf16 v[16:19], a[68:71], v[64:67], v[16:19]
  s_waitcnt lgkmcnt(2)
  v_mfma_f32_16x16x32_bf16 v[24:27], a[68:71], v[68:71], v[24:27]
  ds_read_b128 v[80:83], v6 offset:11264
  ds_read_b128 v[84:87], v6 offset:27648
  v_mfma_f32_16x16x32_bf16 v[20:23], a[76:79], v[64:67], v[20:23]
  v_mfma_f32_16x16x32_bf16 v[28:31], a[76:79], v[68:71], v[28:31]
  v_mfma_f32_16x16x32_bf16 v[32:35], v[64:67], v[196:199], v[32:35]
  v_mfma_f32_16x16x32_bf16 v[36:39], v[68:71], v[196:199], v[36:39]
  v_mfma_f32_16x16x32_bf16 v[40:43], v[64:67], v[204:207], v[40:43]
  v_mfma_f32_16x16x32_bf16 v[44:47], v[68:71], v[204:207], v[44:47]
  s_waitcnt lgkmcnt(3)
  v_mfma_f32_16x16x32_bf16 v[16:19], a[80:83], v[72:75], v[16:19]
  s_waitcnt lgkmcnt(2)
  v_mfma_f32_16x16x32_bf16 v[24:27], a[80:83], v[76:79], v[24:27]
  ds_read_b128 v[64:67], v6 offset:12288
  ds_read_b128 v[68:71], v6 offset:28672
  v_mfma_f32_16x16x32_bf16 v[20:23], a[88:91], v[72:75], v[20:23]
  v_mfma_f32_16x16x32_bf16 v[28:31], a[88:91], v[76:79], v[28:31]
  v_mfma_f32_16x16x32_bf16 v[32:35], v[72:75], v[208:211], v[32:35]
  v_mfma_f32_16x16x32_bf16 v[36:39], v[76:79], v[208:211], v[36:39]
  v_mfma_f32_16x16x32_bf16 v[40:43], v[72:75], v[216:219], v[40:43]
  v_mfma_f32_16x16x32_bf16 v[44:47], v[76:79], v[216:219], v[44:47]
  s_waitcnt lgkmcnt(3)
  v_mfma_f32_16x16x32_bf16 v[16:19], a[84:87], v[80:83], v[16:19]
  s_waitcnt lgkmcnt(2)
  v_mfma_f32_16x16x32_bf16 v[24:27], a[84:87], v[84:87], v[24:27]
  ds_read_b128 v[72:75], v6 offset:13312
  ds_read_b128 v[76:79], v6 offset:29696
  v_mfma_f32_16x16x32_bf16 v[20:23], a[92:95], v[80:83], v[20:23]
  v_mfma_f32_16x16x32_bf16 v[28:31], a[92:95], v[84:87], v[28:31]
  v_mfma_f32_16x16x32_bf16 v[32:35], v[80:83], v[212:215], v[32:35]
  v_mfma_f32_16x16x32_bf16 v[36:39], v[84:87], v[212:215], v[36:39]
  v_mfma_f32_16x16x32_bf16 v[40:43], v[80:83], v[220:223], v[40:43]
  v_mfma_f32_16x16x32_bf16 v[44:47], v[84:87], v[220:223], v[44:47]
  s_waitcnt lgkmcnt(3)
  v_mfma_f32_16x16x32_bf16 v[16:19], a[96:99], v[64:67], v[16:19]
  s_waitcnt lgkmcnt(2)
  v_mfma_f32_16x16x32_bf16 v[24:27], a[96:99], v[68:71], v[24:27]
  ds_read_b128 v[80:83], v6 offset:14336
  ds_read_b128 v[84:87], v6 offset:30720
  v_mfma_f32_16x16x32_bf16 v[20:23], a[104:107], v[64:67], v[20:23]
  v_mfma_f32_16x16x32_bf16 v[28:31], a[104:107], v[68:71], v[28:31]
  v_mfma_f32_16x16x32_bf16 v[32:35], v[64:67], v[224:227], v[32:35]
  v_mfma_f32_16x16x32_bf16 v[36:39], v[68:71], v[224:227], v[36:39]
  v_mfma_f32_16x16x32_bf16 v[40:43], v[64:67], v[232:235], v[40:43]
  v_mfma_f32_16x16x32_bf16 v[44:47], v[68:71], v[232:235], v[44:47]
  s_waitcnt lgkmcnt(3)
  v_mfma_f32_16x16x32_bf16 v[16:19], a[100:103], v[72:75], v[16:19]
  s_waitcnt lgkmcnt(2)
  v_mfma_f32_16x16x32_bf16 v[24:27], a[100:103], v[76:79], v[24:27]
  ds_read_b128 v[64:67], v6 offset:15360
  ds_read_b128 v[68:71], v6 offset:31744
  v_mfma_f32_16x16x32_bf16 v[20:23], a[108:111], v[72:75], v[20:23]
  v_mfma_f32_16x16x32_bf16 v[28:31], a[108:111], v[76:79], v[28:31]
  v_mfma_f32_16x16x32_bf16 v[32:35], v[72:75], v[228:231], v[32:35]
  v_mfma_f32_16x16x32_bf16 v[36:39], v[76:79], v[228:231], v[36:39]
  v_mfma_f32_16x16x32_bf16 v[40:43], v[72:75], v[236:239], v[40:43]
  v_mfma_f32_16x16x32_bf16 v[44:47], v[76:79], v[236:239], v[44:47]
  s_waitcnt lgkmcnt(3)
  v_mfma_f32_16x16x32_bf16 v[16:19], a[112:115], v[80:83], v[16:19]
  s_waitcnt lgkmcnt(2)
  v_mfma_f32_16x16x32_bf16 v[24:27], a[112:115], v[84:87], v[24:27]
  v_mfma_f32_16x16x32_bf16 v[20:23], a[120:123], v[80:83], v[20:23]
  v_mfma_f32_16x16x32_bf16 v[28:31], a[120:123], v[84:87], v[28:31]
  v_mfma_f32_16x16x32_bf16 v[32:35], v[80:83], v[240:243], v[32:35]
  v_mfma_f32_16x16x32_bf16 v[36:39], v[84:87], v[240:243], v[36:39]
  v_mfma_f32_16x16x32_bf16 v[40:43], v[80:83], v[248:251], v[40:43]
  v_mfma_f32_16x16x32_bf16 v[44:47], v[84:87], v[248:251], v[44:47]
  s_waitcnt lgkmcnt(1)
  v_mfma_f32_16x16x32_bf16 v[16:19], a[116:119], v[64:67], v[16:19]
  s_waitcnt lgkmcnt(0)
  v_mfma_f32_16x16x32_bf16 v[24:27], a[116:119], v[68:71], v[24:27]
  v_mfma_f32_16x16x32_bf16 v[20:23], a[124:127], v[64:67], v[20:23]
  v_mfma_f32_16x16x32_bf16 v[28:31], a[124:127], v[68:71], v[28:31]
  v_mfma_f32_16x16x32_bf16 v[32:35], v[64:67], v[244:247], v[32:35]
  v_mfma_f32_16x16x32_bf16 v[36:39], v[68:71], v[244:247], v[36:39]
  v_mfma_f32_16x16x32_bf16 v[40:43], v[64:67], v[252:255], v[40:43]
  v_mfma_f32_16x16x32_bf16 v[44:47], v[68:71], v[252:255], v[44:47]
  ds_read_b128 v[64:67], v6 offset:0
  ds_read_b128 v[68:71], v6 offset:16384
  ds_read_b128 v[72:75], v6 offset:1024
  ds_read_b128 v[76:79], v6 offset:17408
  s_lshl_b32 s28, s5, 10
  s_add_u32 s30, s86, s28
  s_add_u32 s31, s30, 4096
  s_add_u32 s32, s30, s28
  s_add_u32 s32, s32, 8192
  s_add_u32 s33, s30, 24576
  s_waitcnt lgkmcnt(3)
  v_mfma_f32_16x16x32_bf16 v[48:51], a[128:131], v[64:67], 0
  s_waitcnt lgkmcnt(2)
  v_mfma_f32_16x16x32_bf16 v[56:59], a[128:131], v[68:71], 0
  ds_read_b128 v[80:83], v6 offset:2048
  ds_read_b128 v[84:87], v6 offset:18432
  v_mfma_f32_16x16x32_bf16 v[52:55], a[136:139], v[64:67], 0
  v_mfma_f32_16x16x32_bf16 v[60:63], a[136:139], v[68:71], 0
  s_waitcnt lgkmcnt(3)
  v_mfma_f32_16x16x32_bf16 v[48:51], a[132:135], v[72:75], v[48:51]
  buffer_store_dwordx4 v[120:123], v1, s[8:11], s33 offen sc1
  s_waitcnt lgkmcnt(2)
  v_mfma_f32_16x16x32_bf16 v[56:59], a[132:135], v[76:79], v[56:59]
  ds_read_b128 v[64:67], v6 offset:3072
  ds_read_b128 v[68:71], v6 offset:19456
  v_mfma_f32_16x16x32_bf16 v[52:55], a[140:143], v[72:75], v[52:55]
  v_cvt_pk_bf16_f32 v88, v16, v17
  v_mfma_f32_16x16x32_bf16 v[60:63], a[140:143], v[76:79], v[60:63]
  v_cvt_pk_bf16_f32 v89, v18, v19
  s_waitcnt lgkmcnt(3)
  v_mfma_f32_16x16x32_bf16 v[48:51], a[144:147], v[80:83], v[48:51]
  v_cvt_pk_bf16_f32 v90, v20, v21
  s_waitcnt lgkmcnt(2)
  v_mfma_f32_16x16x32_bf16 v[56:59], a[144:147], v[84:87], v[56:59]
  ds_read_b128 v[72:75], v6 offset:4096
  ds_read_b128 v[76:79], v6 offset:20480
  v_mfma_f32_16x16x32_bf16 v[52:55], a[152:155], v[80:83], v[52:55]
  v_cvt_pk_bf16_f32 v91, v22, v23
  v_mfma_f32_16x16x32_bf16 v[60:63], a[152:155], v[84:87], v[60:63]
  v_cvt_pk_bf16_f32 v92, v24, v25
  s_waitcnt lgkmcnt(3)
  v_mfma_f32_16x16x32_bf16 v[48:51], a[148:151], v[64:67], v[48:51]
  v_cvt_pk_bf16_f32 v93, v26, v27
  s_waitcnt lgkmcnt(2)
  v_mfma_f32_16x16x32_bf16 v[56:59], a[148:151], v[68:71], v[56:59]
  ds_read_b128 v[80:83], v6 offset:5120
  ds_read_b128 v[84:87], v6 offset:21504
  v_mfma_f32_16x16x32_bf16 v[52:55], a[156:159], v[64:67], v[52:55]
  v_cvt_pk_bf16_f32 v94, v28, v29
  v_mfma_f32_16x16x32_bf16 v[60:63], a[156:159], v[68:71], v[60:63]
  v_cvt_pk_bf16_f32 v95, v30, v31
  s_waitcnt lgkmcnt(3)
  v_mfma_f32_16x16x32_bf16 v[48:51], a[160:163], v[72:75], v[48:51]
  buffer_store_dwordx4 v[88:91], v1, s[8:11], s30 offen sc1
  s_waitcnt lgkmcnt(2)
  v_mfma_f32_16x16x32_bf16 v[56:59], a[160:163], v[76:79], v[56:59]
  ds_read_b128 v[64:67], v6 offset:6144
  ds_read_b128 v[68:71], v6 offset:22528
  v_mfma_f32_16x16x32_bf16 v[52:55], a[168:171], v[72:75], v[52:55]
  buffer_store_dwordx4 v[92:95], v1, s[8:11], s31 offen sc1
  v_mfma_f32_16x16x32_bf16 v[60:63], a[168:171], v[76:79], v[60:63]
  v_cvt_pk_bf16_f32 v96, v32, v33
  s_waitcnt lgkmcnt(3)
  v_mfma_f32_16x16x32_bf16 v[48:51], a[164:167], v[80:83], v[48:51]
  v_cvt_pk_bf16_f32 v97, v34, v35
  s_waitcnt lgkmcnt(2)
  v_mfma_f32_16x16x32_bf16 v[56:59], a[164:167], v[84:87], v[56:59]
  ds_read_b128 v[72:75], v6 offset:7168
  ds_read_b128 v[76:79], v6 offset:23552
  v_mfma_f32_16x16x32_bf16 v[52:55], a[172:175], v[80:83], v[52:55]
  v_cvt_pk_bf16_f32 v98, v36, v37
  v_mfma_f32_16x16x32_bf16 v[60:63], a[172:175], v[84:87], v[60:63]
  v_cvt_pk_bf16_f32 v99, v38, v39
  s_waitcnt lgkmcnt(3)
  v_mfma_f32_16x16x32_bf16 v[48:51], a[176:179], v[64:67], v[48:51]
  v_cvt_pk_bf16_f32 v100, v40, v41
  s_waitcnt lgkmcnt(2)
  v_mfma_f32_16x16x32_bf16 v[56:59], a[176:179], v[68:71], v[56:59]
  ds_read_b128 v[80:83], v6 offset:8192
  ds_read_b128 v[84:87], v6 offset:24576
  v_mfma_f32_16x16x32_bf16 v[52:55], a[184:187], v[64:67], v[52:55]
  v_cvt_pk_bf16_f32 v101, v42, v43
  v_mfma_f32_16x16x32_bf16 v[60:63], a[184:187], v[68:71], v[60:63]
  v_cvt_pk_bf16_f32 v102, v44, v45
  s_waitcnt lgkmcnt(3)
  v_mfma_f32_16x16x32_bf16 v[48:51], a[180:183], v[72:75], v[48:51]
  v_cvt_pk_bf16_f32 v103, v46, v47
  s_waitcnt lgkmcnt(2)
  v_mfma_f32_16x16x32_bf16 v[56:59], a[180:183], v[76:79], v[56:59]
  ds_read_b128 v[64:67], v6 offset:9216
  ds_read_b128 v[68:71], v6 offset:25600
  v_mfma_f32_16x16x32_bf16 v[52:55], a[188:191], v[72:75], v[52:55]
  buffer_store_dwordx4 v[96:99], v1, s[8:11], s32 offen sc1
  v_mfma_f32_16x16x32_bf16 v[60:63], a[188:191], v[76:79], v[60:63]
  buffer_store_dwordx4 v[100:103], v1, s[8:11], s32 offen offset:1024 sc1
  s_waitcnt lgkmcnt(3)
  v_mfma_f32_16x16x32_bf16 v[48:51], a[192:195], v[80:83], v[48:51]
  s_waitcnt lgkmcnt(2)
  v_mfma_f32_16x16x32_bf16 v[56:59], a[192:195], v[84:87], v[56:59]
  ds_read_b128 v[72:75], v6 offset:10240
  ds_read_b128 v[76:79], v6 offset:26624
  v_mfma_f32_16x16x32_bf16 v[52:55], a[200:203], v[80:83], v[52:55]
  v_mfma_f32_16x16x32_bf16 v[60:63], a[200:203], v[84:87], v[60:63]
  s_waitcnt lgkmcnt(3)
  v_mfma_f32_16x16x32_bf16 v[48:51], a[196:199], v[64:67], v[48:51]
  s_waitcnt lgkmcnt(2)
  v_mfma_f32_16x16x32_bf16 v[56:59], a[196:199], v[68:71], v[56:59]
  ds_read_b128 v[80:83], v6 offset:11264
  ds_read_b128 v[84:87], v6 offset:27648
  v_mfma_f32_16x16x32_bf16 v[52:55], a[204:207], v[64:67], v[52:55]
  v_mfma_f32_16x16x32_bf16 v[60:63], a[204:207], v[68:71], v[60:63]
  s_waitcnt lgkmcnt(3)
  v_mfma_f32_16x16x32_bf16 v[48:51], a[208:211], v[72:75], v[48:51]
  s_waitcnt lgkmcnt(2)
  v_mfma_f32_16x16x32_bf16 v[56:59], a[208:211], v[76:79], v[56:59]
  ds_read_b128 v[64:67], v6 offset:12288
  ds_read_b128 v[68:71], v6 offset:28672
  v_mfma_f32_16x16x32_bf16 v[52:55], a[216:219], v[72:75], v[52:55]
  v_mfma_f32_16x16x32_bf16 v[60:63], a[216:219], v[76:79], v[60:63]
  s_waitcnt lgkmcnt(3)
  v_mfma_f32_16x16x32_bf16 v[48:51], a[212:215], v[80:83], v[48:51]
  s_waitcnt lgkmcnt(2)
  v_mfma_f32_16x16x32_bf16 v[56:59], a[212:215], v[84:87], v[56:59]
  ds_read_b128 v[72:75], v6 offset:13312
  ds_read_b128 v[76:79], v6 offset:29696
  v_mfma_f32_16x16x32_bf16 v[52:55], a[220:223], v[80:83], v[52:55]
  v_mfma_f32_16x16x32_bf16 v[60:63], a[220:223], v[84:87], v[60:63]
  s_waitcnt lgkmcnt(3)
  v_mfma_f32_16x16x32_bf16 v[48:51], a[224:227], v[64:67], v[48:51]
  s_waitcnt lgkmcnt(2)
  v_mfma_f32_16x16x32_bf16 v[56:59], a[224:227], v[68:71], v[56:59]
  ds_read_b128 v[80:83], v6 offset:14336
  ds_read_b128 v[84:87], v6 offset:30720
  v_mfma_f32_16x16x32_bf16 v[52:55], a[232:235], v[64:67], v[52:55]
  v_mfma_f32_16x16x32_bf16 v[60:63], a[232:235], v[68:71], v[60:63]
  s_waitcnt lgkmcnt(3)
  v_mfma_f32_16x16x32_bf16 v[48:51], a[228:231], v[72:75], v[48:51]
  s_waitcnt lgkmcnt(2)
  v_mfma_f32_16x16x32_bf16 v[56:59], a[228:231], v[76:79], v[56:59]
  ds_read_b128 v[64:67], v6 offset:15360
  ds_read_b128 v[68:71], v6 offset:31744
  v_mfma_f32_16x16x32_bf16 v[52:55], a[236:239], v[72:75], v[52:55]
  v_mfma_f32_16x16x32_bf16 v[60:63], a[236:239], v[76:79], v[60:63]
  s_waitcnt lgkmcnt(3)
  v_mfma_f32_16x16x32_bf16 v[48:51], a[240:243], v[80:83], v[48:51]
  s_waitcnt lgkmcnt(2)
  v_mfma_f32_16x16x32_bf16 v[56:59], a[240:243], v[84:87], v[56:59]
  v_mfma_f32_16x16x32_bf16 v[52:55], a[248:251], v[80:83], v[52:55]
  v_mfma_f32_16x16x32_bf16 v[60:63], a[248:251], v[84:87], v[60:63]
  s_waitcnt lgkmcnt(1)
  v_mfma_f32_16x16x32_bf16 v[48:51], a[244:247], v[64:67], v[48:51]
  s_waitcnt lgkmcnt(0)
  v_mfma_f32_16x16x32_bf16 v[56:59], a[244:247], v[68:71], v[56:59]
  v_mfma_f32_16x16x32_bf16 v[52:55], a[252:255], v[64:67], v[52:55]
  v_mfma_f32_16x16x32_bf16 v[60:63], a[252:255], v[68:71], v[60:63]
  s_add_u32 s30, s30, 16384
  s_add_u32 s31, s31, 16384
  s_add_u32 s63, s63, 1
  v_mov_b32 v8, s63
  v_xor_b32 v6, 0x8000, v6
  v_cvt_pk_bf16_f32 v104, v48, v49
  v_cvt_pk_bf16_f32 v105, v50, v51
  v_cvt_pk_bf16_f32 v106, v52, v53
  v_cvt_pk_bf16_f32 v107, v54, v55
  v_cvt_pk_bf16_f32 v108, v56, v57
  v_cvt_pk_bf16_f32 v109, v58, v59
  v_cvt_pk_bf16_f32 v110, v60, v61
  v_cvt_pk_bf16_f32 v111, v62, v63
  s_waitcnt vmcnt(0)
  buffer_store_dwordx4 v[104:107], v1, s[8:11], s30 offen sc1
  buffer_store_dwordx4 v[108:111], v1, s[8:11], s31 offen sc1
  s_barrier
  s_cmp_lg_u32 s5, 0
  s_cbranch_scc1 L_nf_107
  s_mov_b64 exec, 1
  buffer_store_dword v8, off, s[8:11], s87 sc1
  s_mov_b64 exec, -1
L_nf_107:
  s_add_u32 s85, s85, 7
  s_add_u32 s86, s86, 0x700000
  s_cmp_lt_u32 s63, s84
  s_cbranch_scc1 L_w1_loop
  s_waitcnt vmcnt(0) lgkmcnt(0)
  s_add_u32 s63, s63, 1
  v_mov_b32 v8, s63
  s_barrier
  s_cmp_lg_u32 s5, 0
  s_cbranch_scc1 L_nf_108
  s_mov_b64 exec, 1
  buffer_store_dword v8, off, s[8:11], s87 sc1
  s_mov_b64 exec, -1
L_nf_108:
  s_cmp_lg_u32 s92, 0
  s_cbranch_scc1 L_w2_slow
  s_mov_b32 s64, s46
  s_mov_b32 s65, s47
  s_mov_b32 s66, 0x400000
  s_mov_b32 s67, 0x20000
  s_mov_b32 s68, s52
  s_mov_b32 s69, s53
  s_mov_b32 s70, 0x158000
  s_mov_b32 s71, 0x20000
  s_mov_b32 s72, s54
  s_mov_b32 s73, s55
  s_mov_b32 s74, 0x158000
  s_mov_b32 s75, 0x20000
  s_lshl_b32 s28, s4, 1
  s_and_b32 s29, s5, 1
  s_add_u32 s28, s28, s29
  s_cmp_lt_u32 s28, 43
  s_cselect_b32 s70, s70, 0
  s_lshl_b32 s88, s28, 6
  s_lshl_b32 s28, s4, 17
  s_lshl_b32 s29, s5, 8
  s_add_u32 s89, s28, s29
  s_lshl_b32 s28, s4, 16
  s_add_u32 s90, s28, s29
  v_lshrrev_b32 v13, 4, v0
  v_and_b32 v14, 15, v0
  v_lshlrev_b32 v2, 4, v14
  s_mul_i32 s28, s5, 8704
  s_add_u32 s28, s28, 24576
  s_mov_b32 s29, 272
  v_mad_u32_u24 v179, v13, s29, v2
  v_add_u32 v179, s28, v179
  v_lshl_add_u32 v2, v13, 10, v2
  v_lshrrev_b32 v13, 2, v0
  v_and_b32 v14, 3, v0
  v_lshlrev_b32 v14, 5, v14
  v_mad_u32_u24 v191, v13, s29, v14
  v_add_u32 v191, s28, v191
  v_lshrrev_b32 v13, 4, v0
  v_bfe_u32 v14, v0, 2, 2
  v_lshl_add_u32 v3, v13, 3, v14
  s_mov_b32 s28, 2752
  v_mul_lo_u32 v3, v3, s28
  v_and_b32 v13, 3, v0
  v_lshl_add_u32 v3, v13, 4, v3
  s_lshl_b32 s28, s5, 12
  s_add_u32 s28, s28, 65536
  v_lshl_add_u32 v5, v0, 3, s28
  v_bfe_u32 v13, v0, 1, 1
  v_lshlrev_b32 v4, 11, v13
  v_lshrrev_b32 v13, 2, v0
  v_lshl_add_u32 v4, v13, 5, v4
  v_and_b32 v13, 1, v0
  v_lshl_add_u32 v4, v13, 4, v4
  v_add_u32 v4, s28, v4
  s_and_b32 s28, s5, 1
  s_lshl_b32 s28, s28, 16
  s_xor_b32 s29, s28, 0x10000
  s_add_u32 s12, s89, s29
  s_add_u32 s89, s89, s28
  s_lshr_b32 s28, s28, 1
  s_lshr_b32 s29, s29, 1
  s_add_u32 s13, s90, s29
  s_add_u32 s90, s90, s28
  v_and_b32 v13, 15, v0
  v_lshrrev_b32 v14, 4, v0
  s_lshl_b32 s29, s5, 8
  v_lshlrev_b32 v15, 4, v13
  v_lshl_add_u32 v15, v14, 10, v15
  v_add_u32 v6, s29, v15
  v_mov_b32 v15, 0x10000000
  v_cmp_gt_u32 vcc, 2, v14
  s_nop 1
  v_cndmask_b32 v7, v15, v6, vcc
  s_lshl_b32 s28, s4, 10
  s_add_u32 s28, s28, s29
  v_lshlrev_b32 v15, 4, v13
  v_add_u32 v15, s28, v15
  v_lshl_add_u32 v8, v14, 17, v15
  s_mov_b32 s30, 98304
  v_mad_u32_u24 v9, v14, s30, v15
  v_and_b32 v15, 7, v13
  v_lshlrev_b32 v15, 3, v15
  v_lshl_add_u32 v15, v14, 6, v15
  v_add_u32 v10, s29, v15
  v_lshlrev_b32 v15, 10, v13
  v_lshl_add_u32 v15, v14, 4, v15
  s_lshr_b32 s30, s5, 1
  s_lshl_b32 s31, s30, 14
  s_and_b32 s32, s5, 1
  s_lshl_b32 s33, s32, 9
  s_add_u32 s33, s33, s31
  s_mul_i32 s33, s5, 8320
  s_add_u32 s33, s33, 32768
  v_add_u32 v11, s33, v1
  s_mul_i32 s33, s30, 16640
  s_add_u32 s33, s33, 32768
  s_mov_b32 s31, 1040
  v_lshlrev_b32 v15, 4, v14
  v_mad_u32_u24 v15, v13, s31, v15
  v_add_u32 v12, s33, v15
  s_lshl_b32 s31, s5, 11
  v_add_u32 v176, s31, v1
  s_lshl_b32 s31, s5, 10
  s_add_u32 s31, s31, 8192
  v_add_u32 v177, s31, v1
  s_lshl_b32 s31, s5, 2
  s_add_u32 s31, s31, 12288
  v_bfe_u32 v178, v0, 4, 1
  v_lshlrev_b32 v178, 4, v178
  v_add_u32 v178, s31, v178
  s_lshl_b32 s28, s62, 20
  s_add_u32 s80, s28, 0x800000
  v_mov_b32 v16, 1
  v_mov_b32 v20, -1
  v_mov_b32 v17, 1
  v_mov_b32 v21, -1
  v_mov_b32 v18, 1
  v_mov_b32 v22, -1
  v_mov_b32 v19, 1
  v_mov_b32 v23, -1
  s_add_u32 s28, s80, 0
  s_xor_b32 s29, s28, 0x1800000
  buffer_store_dwordx4 v[16:19], v8, s[8:11], s28 offen
  buffer_store_dwordx4 v[16:19], v8, s[8:11], s29 offen
  s_add_u32 s28, s28, 32768
  s_xor_b32 s29, s28, 0x1800000
  buffer_store_dwordx4 v[16:19], v8, s[8:11], s28 offen
  buffer_store_dwordx4 v[16:19], v8, s[8:11], s29 offen
  s_add_u32 s28, s28, 32768
  s_xor_b32 s29, s28, 0x1800000
  buffer_store_dwordx4 v[16:19], v8, s[8:11], s28 offen
  buffer_store_dwordx4 v[16:19], v8, s[8:11], s29 offen
  s_add_u32 s28, s28, 32768
  s_xor_b32 s29, s28, 0x1800000
  buffer_store_dwordx4 v[16:19], v8, s[8:11], s28 offen
  buffer_store_dwordx4 v[16:19], v8, s[8:11], s29 offen
  s_add_u32 s28, s80, 524288
  s_xor_b32 s29, s28, 0x1800000
  buffer_store_dwordx4 v[16:19], v8, s[8:11], s28 offen
  buffer_store_dwordx4 v[16:19], v8, s[8:11], s29 offen
  s_add_u32 s28, s28, 32768
  s_xor_b32 s29, s28, 0x1800000
  buffer_store_dwordx4 v[16:19], v8, s[8:11], s28 offen
  buffer_store_dwordx4 v[16:19], v8, s[8:11], s29 offen
  s_add_u32 s28, s28, 32768
  s_xor_b32 s29, s28, 0x1800000
  buffer_store_dwordx4 v[16:19], v8, s[8:11], s28 offen
  buffer_store_dwordx4 v[16:19], v8, s[8:11], s29 offen
  s_add_u32 s28, s28, 32768
  s_xor_b32 s29, s28, 0x1800000
  buffer_store_dwordx4 v[16:19], v8, s[8:11], s28 offen
  buffer_store_dwordx4 v[16:19], v8, s[8:11], s29 offen
  v_lshlrev_b32 v15, 4, v13
  v_sub_u32 v8, v8, v15
  v_lshrrev_b32 v15, 3, v13
  v_lshl_add_u32 v8, v15, 6, v8
  v_and_b32 v15, 3, v13
  v_lshl_add_u32 v8, v15, 4, v8
  v_bfe_u32 v15, v13, 2, 1
  v_lshl_add_u32 v8, v15, 3, v8
  v_xor_b32 v9, 1, v15
  s_mul_i32 s29, s5, 7
  s_add_u32 s29, s29, s62
  s_add_u32 s30, s29, 0
  s_lshl_b32 s28, s30, 15
  s_lshl_b32 s31, s4, 10
  s_add_u32 s28, s28, s31
  s_add_u32 s28, s28, 0x300000
  s_cmp_lt_u32 s30, 64
  s_cselect_b32 s28, s28, 0x10000000
  buffer_store_dwordx4 v[20:23], v1, s[8:11], s28 offen
  s_add_u32 s30, s29, 28
  s_lshl_b32 s28, s30, 15
  s_lshl_b32 s31, s4, 10
  s_add_u32 s28, s28, s31
  s_add_u32 s28, s28, 0x300000
  s_cmp_lt_u32 s30, 64
  s_cselect_b32 s28, s28, 0x10000000
  buffer_store_dwordx4 v[20:23], v1, s[8:11], s28 offen
  s_add_u32 s30, s29, 56
  s_lshl_b32 s28, s30, 15
  s_lshl_b32 s31, s4, 10
  s_add_u32 s28, s28, s31
  s_add_u32 s28, s28, 0x300000
  s_cmp_ge_u32 s4, 16
  s_cselect_b32 s31, 62, 64
  s_cmp_lt_u32 s30, s31
  s_cselect_b32 s28, s28, 0x10000000
  buffer_store_dwordx4 v[20:23], v1, s[8:11], s28 offen
  s_add_u32 s30, s62, 61
  s_lshl_b32 s28, s30, 15
  s_lshl_b32 s31, s4, 10
  s_add_u32 s28, s28, s31
  s_add_u32 s28, s28, 0x300000
  s_sub_u32 s30, s62, 1
  s_cmp_lt_u32 s30, 2
  s_cselect_b32 s28, s28, 0x10000000
  s_cmp_ge_u32 s4, 16
  s_cselect_b32 s28, s28, 0x10000000
  s_cmp_eq_u32 s5, 3
  s_cselect_b32 s28, s28, 0x10000000
  buffer_store_dwordx4 v[20:23], v1, s[8:11], s28 offen
  s_add_u32 s28, s89, 0x0
  buffer_load_dwordx4 a[0:3], v2, s[64:67], s28 offen
  s_add_u32 s28, s89, 0x1000
  buffer_load_dwordx4 a[4:7], v2, s[64:67], s28 offen
  s_add_u32 s28, s89, 0x2000
  buffer_load_dwordx4 a[8:11], v2, s[64:67], s28 offen
  s_add_u32 s28, s89, 0x3000
  buffer_load_dwordx4 a[12:15], v2, s[64:67], s28 offen
  s_add_u32 s28, s89, 0x4000
  buffer_load_dwordx4 a[16:19], v2, s[64:67], s28 offen
  s_add_u32 s28, s89, 0x5000
  buffer_load_dwordx4 a[20:23], v2, s[64:67], s28 offen
  s_add_u32 s28, s89, 0x6000
  buffer_load_dwordx4 a[24:27], v2, s[64:67], s28 offen
  s_add_u32 s28, s89, 0x7000
  buffer_load_dwordx4 a[28:31], v2, s[64:67], s28 offen
  s_add_u32 s28, s89, 0x8000
  buffer_load_dwordx4 a[32:35], v2, s[64:67], s28 offen
  s_add_u32 s28, s89, 0x9000
  buffer_load_dwordx4 a[36:39], v2, s[64:67], s28 offen
  s_add_u32 s28, s89, 0xa000
  buffer_load_dwordx4 a[40:43], v2, s[64:67], s28 offen
  s_add_u32 s28, s89, 0xb000
  buffer_load_dwordx4 a[44:47], v2, s[64:67], s28 offen
  s_add_u32 s28, s89, 0xc000
  buffer_load_dwordx4 a[48:51], v2, s[64:67], s28 offen
  s_add_u32 s28, s89, 0xd000
  buffer_load_dwordx4 a[52:55], v2, s[64:67], s28 offen
  s_add_u32 s28, s89, 0xe000
  buffer_load_dwordx4 a[56:59], v2, s[64:67], s28 offen
  s_add_u32 s28, s89, 0xf000
  buffer_load_dwordx4 a[60:63], v2, s[64:67], s28 offen
  s_add_u32 s28, s12, 0x0
  buffer_load_dwordx4 a[64:67], v2, s[64:67], s28 offen
  s_add_u32 s28, s12, 0x1000
  buffer_load_dwordx4 a[68:71], v2, s[64:67], s28 offen
  s_add_u32 s28, s12, 0x2000
  buffer_load_dwordx4 a[72:75], v2, s[64:67], s28 offen
  s_add_u32 s28, s12, 0x3000
  buffer_load_dwordx4 a[76:79], v2, s[64:67], s28 offen
  s_add_u32 s28, s12, 0x4000
  buffer_load_dwordx4 a[80:83], v2, s[64:67], s28 offen
  s_add_u32 s28, s12, 0x5000
  buffer_load_dwordx4 a[84:87], v2, s[64:67], s28 offen
  s_add_u32 s28, s12, 0x6000
  buffer_load_dwordx4 a[88:91], v2, s[64:67], s28 offen
  s_add_u32 s28, s12, 0x7000
  buffer_load_dwordx4 a[92:95], v2, s[64:67], s28 offen
  s_add_u32 s28, s12, 0x8000
  buffer_load_dwordx4 a[96:99], v2, s[64:67], s28 offen
  s_add_u32 s28, s12, 0x9000
  buffer_load_dwordx4 a[100:103], v2, s[64:67], s28 offen
  s_add_u32 s28, s12, 0xa000
  buffer_load_dwordx4 a[104:107], v2, s[64:67], s28 offen
  s_add_u32 s28, s12, 0xb000
  buffer_load_dwordx4 a[108:111], v2, s[64:67], s28 offen
  s_add_u32 s28, s12, 0xc000
  buffer_load_dwordx4 a[112:115], v2, s[64:67], s28 offen
  s_add_u32 s28, s12, 0xd000
  buffer_load_dwordx4 a[116:119], v2, s[64:67], s28 offen
  s_add_u32 s28, s12, 0xe000
  buffer_load_dwordx4 a[120:123], v2, s[64:67], s28 offen
  s_add_u32 s28, s12, 0xf000
  buffer_load_dwordx4 a[124:127], v2, s[64:67], s28 offen
  s_add_u32 s28, s88, 0x0
  buffer_load_dwordx4 a[128:131], v3, s[68:71], s28 offen
  s_add_u32 s28, s88, 0x2b00
  buffer_load_dwordx4 a[132:135], v3, s[68:71], s28 offen
  s_add_u32 s28, s88, 0x15800
  buffer_load_dwordx4 a[136:139], v3, s[68:71], s28 offen
  s_add_u32 s28, s88, 0x18300
  buffer_load_dwordx4 a[140:143], v3, s[68:71], s28 offen
  s_add_u32 s28, s88, 0x2b000
  buffer_load_dwordx4 a[144:147], v3, s[68:71], s28 offen
  s_add_u32 s28, s88, 0x2db00
  buffer_load_dwordx4 a[148:151], v3, s[68:71], s28 offen
  s_add_u32 s28, s88, 0x40800
  buffer_load_dwordx4 a[152:155], v3, s[68:71], s28 offen
  s_add_u32 s28, s88, 0x43300
  buffer_load_dwordx4 a[156:159], v3, s[68:71], s28 offen
  s_waitcnt vmcnt(39)
  ds_write_b128 v179, a[0:3] offset:0
  s_waitcnt vmcnt(38)
  ds_write_b128 v179, a[4:7] offset:1088
  s_waitcnt vmcnt(37)
  ds_write_b128 v179, a[8:11] offset:2176
  s_waitcnt vmcnt(36)
  ds_write_b128 v179, a[12:15] offset:3264
  s_waitcnt vmcnt(35)
  ds_write_b128 v179, a[16:19] offset:4352
  s_waitcnt vmcnt(34)
  ds_write_b128 v179, a[20:23] offset:5440
  s_waitcnt vmcnt(33)
  ds_write_b128 v179, a[24:27] offset:6528
  s_waitcnt vmcnt(32)
  ds_write_b128 v179, a[28:31] offset:7616
  ds_read_b64_tr_b16 a[0:1], v191 offset:0
  ds_read_b64_tr_b16 a[2:3], v191 offset:4352
  ds_read_b64_tr_b16 a[4:5], v191 offset:8
  ds_read_b64_tr_b16 a[6:7], v191 offset:4360
  ds_read_b64_tr_b16 a[8:9], v191 offset:16
  ds_read_b64_tr_b16 a[10:11], v191 offset:4368
  ds_read_b64_tr_b16 a[12:13], v191 offset:24
  s_waitcnt lgkmcnt(14)
  ds_read_b64_tr_b16 a[14:15], v191 offset:4376
  s_waitcnt lgkmcnt(14)
  ds_read_b64_tr_b16 a[16:17], v191 offset:128
  s_waitcnt lgkmcnt(14)
  ds_read_b64_tr_b16 a[18:19], v191 offset:4480
  s_waitcnt lgkmcnt(14)
  ds_read_b64_tr_b16 a[20:21], v191 offset:136
  s_waitcnt lgkmcnt(14)
  ds_read_b64_tr_b16 a[22:23], v191 offset:4488
  s_waitcnt lgkmcnt(14)
  ds_read_b64_tr_b16 a[24:25], v191 offset:144
  s_waitcnt lgkmcnt(14)
  ds_read_b64_tr_b16 a[26:27], v191 offset:4496
  s_waitcnt lgkmcnt(14)
  ds_read_b64_tr_b16 a[28:29], v191 offset:152
  s_waitcnt lgkmcnt(14)
  ds_read_b64_tr_b16 a[30:31], v191 offset:4504
  s_add_u32 s28, s88, 0x56000
  buffer_load_dwordx4 a[160:163], v3, s[68:71], s28 offen
  s_add_u32 s28, s88, 0x58b00
  buffer_load_dwordx4 a[164:167], v3, s[68:71], s28 offen
  s_add_u32 s28, s88, 0x6b800
  buffer_load_dwordx4 a[168:171], v3, s[68:71], s28 offen
  s_add_u32 s28, s88, 0x6e300
  buffer_load_dwordx4 a[172:175], v3, s[68:71], s28 offen
  s_add_u32 s28, s88, 0x81000
  buffer_load_dwordx4 a[176:179], v3, s[68:71], s28 offen
  s_add_u32 s28, s88, 0x83b00
  buffer_load_dwordx4 a[180:183], v3, s[68:71], s28 offen
  s_add_u32 s28, s88, 0x96800
  buffer_load_dwordx4 a[184:187], v3, s[68:71], s28 offen
  s_add_u32 s28, s88, 0x99300
  buffer_load_dwordx4 a[188:191], v3, s[68:71], s28 offen
  s_barrier
  s_cmp_lg_u32 s5, 0
  s_cbranch_scc1 L_arr_109
  s_lshl_b32 s28, s3, 5
  v_mov_b32 v24, 1
  s_mov_b64 exec, 1
  buffer_atomic_add v24, off, s[24:27], s28 offset:4 sc1
  s_mov_b64 exec, -1
L_arr_109:
  s_waitcnt vmcnt(39)
  s_waitcnt lgkmcnt(14)
  ds_write_b128 v179, a[32:35] offset:0
  s_waitcnt vmcnt(38)
  s_waitcnt lgkmcnt(14)
  ds_write_b128 v179, a[36:39] offset:1088
  s_waitcnt vmcnt(37)
  s_waitcnt lgkmcnt(14)
  ds_write_b128 v179, a[40:43] offset:2176
  s_waitcnt vmcnt(36)
  s_waitcnt lgkmcnt(14)
  ds_write_b128 v179, a[44:47] offset:3264
  s_waitcnt vmcnt(35)
  s_waitcnt lgkmcnt(14)
  ds_write_b128 v179, a[48:51] offset:4352
  s_waitcnt vmcnt(34)
  s_waitcnt lgkmcnt(14)
  ds_write_b128 v179, a[52:55] offset:5440
  s_waitcnt vmcnt(33)
  s_waitcnt lgkmcnt(14)
  ds_write_b128 v179, a[56:59] offset:6528
  s_waitcnt vmcnt(32)
  s_waitcnt lgkmcnt(14)
  ds_write_b128 v179, a[60:63] offset:7616
  s_waitcnt lgkmcnt(14)
  ds_read_b64_tr_b16 a[32:33], v191 offset:0
  s_waitcnt lgkmcnt(14)
  ds_read_b64_tr_b16 a[34:35], v191 offset:4352
  s_waitcnt lgkmcnt(14)
  ds_read_b64_tr_b16 a[36:37], v191 offset:8
  s_waitcnt lgkmcnt(14)
  ds_read_b64_tr_b16 a[38:39], v191 offset:4360
  s_waitcnt lgkmcnt(14)
  ds_read_b64_tr_b16 a[40:41], v191 offset:16
  s_waitcnt lgkmcnt(14)
  ds_read_b64_tr_b16 a[42:43], v191 offset:4368
  s_waitcnt lgkmcnt(14)
  ds_read_b64_tr_b16 a[44:45], v191 offset:24
  s_waitcnt lgkmcnt(14)
  ds_read_b64_tr_b16 a[46:47], v191 offset:4376
  s_waitcnt lgkmcnt(14)
  ds_read_b64_tr_b16 a[48:49], v191 offset:128
  s_waitcnt lgkmcnt(14)
  ds_read_b64_tr_b16 a[50:51], v191 offset:4480
  s_waitcnt lgkmcnt(14)
  ds_read_b64_tr_b16 a[52:53], v191 offset:136
  s_waitcnt lgkmcnt(14)
  ds_read_b64_tr_b16 a[54:55], v191 offset:4488
  s_waitcnt lgkmcnt(14)
  ds_read_b64_tr_b16 a[56:57], v191 offset:144
  s_waitcnt lgkmcnt(14)
  ds_read_b64_tr_b16 a[58:59], v191 offset:4496
  s_waitcnt lgkmcnt(14)
  ds_read_b64_tr_b16 a[60:61], v191 offset:152
  s_waitcnt lgkmcnt(14)
  ds_read_b64_tr_b16 a[62:63], v191 offset:4504
  s_add_u32 s28, s88, 0xac000
  buffer_load_dwordx4 a[192:195], v3, s[68:71], s28 offen
  s_add_u32 s28, s88, 0xaeb00
  buffer_load_dwordx4 a[196:199], v3, s[68:71], s28 offen
  s_add_u32 s28, s88, 0xc1800
  buffer_load_dwordx4 a[200:203], v3, s[68:71], s28 offen
  s_add_u32 s28, s88, 0xc4300
  buffer_load_dwordx4 a[204:207], v3, s[68:71], s28 offen
  s_add_u32 s28, s88, 0xd7000
  buffer_load_dwordx4 a[208:211], v3, s[68:71], s28 offen
  s_add_u32 s28, s88, 0xd9b00
  buffer_load_dwordx4 a[212:215], v3, s[68:71], s28 offen
  s_add_u32 s28, s88, 0xec800
  buffer_load_dwordx4 a[216:219], v3, s[68:71], s28 offen
  s_add_u32 s28, s88, 0xef300
  buffer_load_dwordx4 a[220:223], v3, s[68:71], s28 offen
  s_waitcnt vmcnt(39)
  s_waitcnt lgkmcnt(14)
  ds_write_b128 v179, a[64:67] offset:0
  s_waitcnt vmcnt(38)
  s_waitcnt lgkmcnt(14)
  ds_write_b128 v179, a[68:71] offset:1088
  s_waitcnt vmcnt(37)
  s_waitcnt lgkmcnt(14)
  ds_write_b128 v179, a[72:75] offset:2176
  s_waitcnt vmcnt(36)
  s_waitcnt lgkmcnt(14)
  ds_write_b128 v179, a[76:79] offset:3264
  s_waitcnt vmcnt(35)
  s_waitcnt lgkmcnt(14)
  ds_write_b128 v179, a[80:83] offset:4352
  s_waitcnt vmcnt(34)
  s_waitcnt lgkmcnt(14)
  ds_write_b128 v179, a[84:87] offset:5440
  s_waitcnt vmcnt(33)
  s_waitcnt lgkmcnt(14)
  ds_write_b128 v179, a[88:91] offset:6528
  s_waitcnt vmcnt(32)
  s_waitcnt lgkmcnt(14)
  ds_write_b128 v179, a[92:95] offset:7616
  s_waitcnt lgkmcnt(14)
  ds_read_b64_tr_b16 a[64:65], v191 offset:0
  s_waitcnt lgkmcnt(14)
  ds_read_b64_tr_b16 a[66:67], v191 offset:4352
  s_waitcnt lgkmcnt(14)
  ds_read_b64_tr_b16 a[68:69], v191 offset:8
  s_waitcnt lgkmcnt(14)
  ds_read_b64_tr_b16 a[70:71], v191 offset:4360
  s_waitcnt lgkmcnt(14)
  ds_read_b64_tr_b16 a[72:73], v191 offset:16
  s_waitcnt lgkmcnt(14)
  ds_read_b64_tr_b16 a[74:75], v191 offset:4368
  s_waitcnt lgkmcnt(14)
  ds_read_b64_tr_b16 a[76:77], v191 offset:24
  s_waitcnt lgkmcnt(14)
  ds_read_b64_tr_b16 a[78:79], v191 offset:4376
  s_waitcnt lgkmcnt(14)
  ds_read_b64_tr_b16 a[80:81], v191 offset:128
  s_waitcnt lgkmcnt(14)
  ds_read_b64_tr_b16 a[82:83], v191 offset:4480
  s_waitcnt lgkmcnt(14)
  ds_read_b64_tr_b16 a[84:85], v191 offset:136
  s_waitcnt lgkmcnt(14)
  ds_read_b64_tr_b16 a[86:87], v191 offset:4488
  s_waitcnt lgkmcnt(14)
  ds_read_b64_tr_b16 a[88:89], v191 offset:144
  s_waitcnt lgkmcnt(14)
  ds_read_b64_tr_b16 a[90:91], v191 offset:4496
  s_waitcnt lgkmcnt(14)
  ds_read_b64_tr_b16 a[92:93], v191 offset:152
  s_waitcnt lgkmcnt(14)
  ds_read_b64_tr_b16 a[94:95], v191 offset:4504
  s_add_u32 s28, s88, 0x102000
  buffer_load_dwordx4 a[224:227], v3, s[68:71], s28 offen
  s_add_u32 s28, s88, 0x104b00
  buffer_load_dwordx4 a[228:231], v3, s[68:71], s28 offen
  s_add_u32 s28, s88, 0x117800
  buffer_load_dwordx4 a[232:235], v3, s[68:71], s28 offen
  s_add_u32 s28, s88, 0x11a300
  buffer_load_dwordx4 a[236:239], v3, s[68:71], s28 offen
  s_add_u32 s28, s88, 0x12d000
  buffer_load_dwordx4 a[240:243], v3, s[68:71], s28 offen
  s_add_u32 s28, s88, 0x12fb00
  buffer_load_dwordx4 a[244:247], v3, s[68:71], s28 offen
  s_add_u32 s28, s88, 0x142800
  buffer_load_dwordx4 a[248:251], v3, s[68:71], s28 offen
  s_add_u32 s28, s88, 0x145300
  buffer_load_dwordx4 a[252:255], v3, s[68:71], s28 offen
  s_waitcnt vmcnt(39)
  s_waitcnt lgkmcnt(14)
  ds_write_b128 v179, a[96:99] offset:0
  s_waitcnt vmcnt(38)
  s_waitcnt lgkmcnt(14)
  ds_write_b128 v179, a[100:103] offset:1088
  s_waitcnt vmcnt(37)
  s_waitcnt lgkmcnt(14)
  ds_write_b128 v179, a[104:107] offset:2176
  s_waitcnt vmcnt(36)
  s_waitcnt lgkmcnt(14)
  ds_write_b128 v179, a[108:111] offset:3264
  s_waitcnt vmcnt(35)
  s_waitcnt lgkmcnt(14)
  ds_write_b128 v179, a[112:115] offset:4352
  s_waitcnt vmcnt(34)
  s_waitcnt lgkmcnt(14)
  ds_write_b128 v179, a[116:119] offset:5440
  s_waitcnt vmcnt(33)
  s_waitcnt lgkmcnt(14)
  ds_write_b128 v179, a[120:123] offset:6528
  s_waitcnt vmcnt(32)
  s_waitcnt lgkmcnt(14)
  ds_write_b128 v179, a[124:127] offset:7616
  s_waitcnt lgkmcnt(14)
  ds_read_b64_tr_b16 a[96:97], v191 offset:0
  s_waitcnt lgkmcnt(14)
  ds_read_b64_tr_b16 a[98:99], v191 offset:4352
  s_waitcnt lgkmcnt(14)
  ds_read_b64_tr_b16 a[100:101], v191 offset:8
  s_waitcnt lgkmcnt(14)
  ds_read_b64_tr_b16 a[102:103], v191 offset:4360
  s_waitcnt lgkmcnt(14)
  ds_read_b64_tr_b16 a[104:105], v191 offset:16
  s_waitcnt lgkmcnt(14)
  ds_read_b64_tr_b16 a[106:107], v191 offset:4368
  s_waitcnt lgkmcnt(14)
  ds_read_b64_tr_b16 a[108:109], v191 offset:24
  s_waitcnt lgkmcnt(14)
  ds_read_b64_tr_b16 a[110:111], v191 offset:4376
  s_waitcnt lgkmcnt(14)
  ds_read_b64_tr_b16 a[112:113], v191 offset:128
  s_waitcnt lgkmcnt(14)
  ds_read_b64_tr_b16 a[114:115], v191 offset:4480
  s_waitcnt lgkmcnt(14)
  ds_read_b64_tr_b16 a[116:117], v191 offset:136
  s_waitcnt lgkmcnt(14)
  ds_read_b64_tr_b16 a[118:119], v191 offset:4488
  s_waitcnt lgkmcnt(14)
  ds_read_b64_tr_b16 a[120:121], v191 offset:144
  s_waitcnt lgkmcnt(14)
  ds_read_b64_tr_b16 a[122:123], v191 offset:4496
  s_waitcnt lgkmcnt(14)
  ds_read_b64_tr_b16 a[124:125], v191 offset:152
  s_waitcnt lgkmcnt(14)
  ds_read_b64_tr_b16 a[126:127], v191 offset:4504
  s_add_u32 s28, s90, 0x0
  buffer_load_dwordx4 v[192:195], v2, s[72:75], s28 offen
  s_add_u32 s28, s90, 0x1000
  buffer_load_dwordx4 v[196:199], v2, s[72:75], s28 offen
  s_add_u32 s28, s90, 0x2000
  buffer_load_dwordx4 v[200:203], v2, s[72:75], s28 offen
  s_add_u32 s28, s90, 0x3000
  buffer_load_dwordx4 v[204:207], v2, s[72:75], s28 offen
  s_add_u32 s28, s90, 0x4000
  buffer_load_dwordx4 v[208:211], v2, s[72:75], s28 offen
  s_add_u32 s28, s90, 0x5000
  buffer_load_dwordx4 v[212:215], v2, s[72:75], s28 offen
  s_add_u32 s28, s90, 0x6000
  buffer_load_dwordx4 v[216:219], v2, s[72:75], s28 offen
  s_add_u32 s28, s90, 0x7000
  buffer_load_dwordx4 v[220:223], v2, s[72:75], s28 offen
  s_waitcnt vmcnt(39)
  s_waitcnt lgkmcnt(14)
  ds_write_b128 v4, a[128:131] offset:0
  s_waitcnt vmcnt(38)
  s_waitcnt lgkmcnt(14)
  ds_write_b128 v4, a[132:135] offset:512
  s_waitcnt vmcnt(37)
  s_waitcnt lgkmcnt(14)
  ds_write_b128 v4, a[136:139] offset:1024
  s_waitcnt vmcnt(36)
  s_waitcnt lgkmcnt(14)
  ds_write_b128 v4, a[140:143] offset:1536
  s_waitcnt lgkmcnt(14)
  ds_read_b64_tr_b16 a[128:129], v5 offset:0
  s_waitcnt lgkmcnt(14)
  ds_read_b64_tr_b16 a[130:131], v5 offset:512
  s_waitcnt lgkmcnt(14)
  ds_read_b64_tr_b16 a[132:133], v5 offset:1024
  s_waitcnt lgkmcnt(14)
  ds_read_b64_tr_b16 a[134:135], v5 offset:1536
  s_waitcnt lgkmcnt(14)
  ds_read_b64_tr_b16 a[136:137], v5 offset:2048
  s_waitcnt lgkmcnt(14)
  ds_read_b64_tr_b16 a[138:139], v5 offset:2560
  s_waitcnt lgkmcnt(14)
  ds_read_b64_tr_b16 a[140:141], v5 offset:3072
  s_waitcnt lgkmcnt(14)
  ds_read_b64_tr_b16 a[142:143], v5 offset:3584
  s_waitcnt vmcnt(35)
  s_waitcnt lgkmcnt(14)
  ds_write_b128 v4, a[144:147] offset:0
  s_waitcnt vmcnt(34)
  s_waitcnt lgkmcnt(14)
  ds_write_b128 v4, a[148:151] offset:512
  s_waitcnt vmcnt(33)
  s_waitcnt lgkmcnt(14)
  ds_write_b128 v4, a[152:155] offset:1024
  s_waitcnt vmcnt(32)
  s_waitcnt lgkmcnt(14)
  ds_write_b128 v4, a[156:159] offset:1536
  s_waitcnt lgkmcnt(14)
  ds_read_b64_tr_b16 a[144:145], v5 offset:0
  s_waitcnt lgkmcnt(14)
  ds_read_b64_tr_b16 a[146:147], v5 offset:512
  s_waitcnt lgkmcnt(14)
  ds_read_b64_tr_b16 a[148:149], v5 offset:1024
  s_waitcnt lgkmcnt(14)
  ds_read_b64_tr_b16 a[150:151], v5 offset:1536
  s_waitcnt lgkmcnt(14)
  ds_read_b64_tr_b16 a[152:153], v5 offset:2048
  s_waitcnt lgkmcnt(14)
  ds_read_b64_tr_b16 a[154:155], v5 offset:2560
  s_waitcnt lgkmcnt(14)
  ds_read_b64_tr_b16 a[156:157], v5 offset:3072
  s_waitcnt lgkmcnt(14)
  ds_read_b64_tr_b16 a[158:159], v5 offset:3584
  s_add_u32 s28, s13, 0x0
  buffer_load_dwordx4 v[224:227], v2, s[72:75], s28 offen
  s_add_u32 s28, s13, 0x1000
  buffer_load_dwordx4 v[228:231], v2, s[72:75], s28 offen
  s_add_u32 s28, s13, 0x2000
  buffer_load_dwordx4 v[232:235], v2, s[72:75], s28 offen
  s_add_u32 s28, s13, 0x3000
  buffer_load_dwordx4 v[236:239], v2, s[72:75], s28 offen
  s_add_u32 s28, s13, 0x4000
  buffer_load_dwordx4 v[240:243], v2, s[72:75], s28 offen
  s_add_u32 s28, s13, 0x5000
  buffer_load_dwordx4 v[244:247], v2, s[72:75], s28 offen
  s_add_u32 s28, s13, 0x6000
  buffer_load_dwordx4 v[248:251], v2, s[72:75], s28 offen
  s_add_u32 s28, s13, 0x7000
  buffer_load_dwordx4 v[252:255], v2, s[72:75], s28 offen
  s_waitcnt vmcnt(39)
  s_waitcnt lgkmcnt(14)
  ds_write_b128 v4, a[160:163] offset:0
  s_waitcnt vmcnt(38)
  s_waitcnt lgkmcnt(14)
  ds_write_b128 v4, a[164:167] offset:512
  s_waitcnt vmcnt(37)
  s_waitcnt lgkmcnt(14)
  ds_write_b128 v4, a[168:171] offset:1024
  s_waitcnt vmcnt(36)
  s_waitcnt lgkmcnt(14)
  ds_write_b128 v4, a[172:175] offset:1536
  s_waitcnt lgkmcnt(14)
  ds_read_b64_tr_b16 a[160:161], v5 offset:0
  s_waitcnt lgkmcnt(14)
  ds_read_b64_tr_b16 a[162:163], v5 offset:512
  s_waitcnt lgkmcnt(14)
  ds_read_b64_tr_b16 a[164:165], v5 offset:1024
  s_waitcnt lgkmcnt(14)
  ds_read_b64_tr_b16 a[166:167], v5 offset:1536
  s_waitcnt lgkmcnt(14)
  ds_read_b64_tr_b16 a[168:169], v5 offset:2048
  s_waitcnt lgkmcnt(14)
  ds_read_b64_tr_b16 a[170:171], v5 offset:2560
  s_waitcnt lgkmcnt(14)
  ds_read_b64_tr_b16 a[172:173], v5 offset:3072
  s_waitcnt lgkmcnt(14)
  ds_read_b64_tr_b16 a[174:175], v5 offset:3584
  s_waitcnt vmcnt(35)
  s_waitcnt lgkmcnt(14)
  ds_write_b128 v4, a[176:179] offset:0
  s_waitcnt vmcnt(34)
  s_waitcnt lgkmcnt(14)
  ds_write_b128 v4, a[180:183] offset:512
  s_waitcnt vmcnt(33)
  s_waitcnt lgkmcnt(14)
  ds_write_b128 v4, a[184:187] offset:1024
  s_waitcnt vmcnt(32)
  s_waitcnt lgkmcnt(14)
  ds_write_b128 v4, a[188:191] offset:1536
  s_waitcnt lgkmcnt(14)
  ds_read_b64_tr_b16 a[176:177], v5 offset:0
  s_waitcnt lgkmcnt(14)
  ds_read_b64_tr_b16 a[178:179], v5 offset:512
  s_waitcnt lgkmcnt(14)
  ds_read_b64_tr_b16 a[180:181], v5 offset:1024
  s_waitcnt lgkmcnt(14)
  ds_read_b64_tr_b16 a[182:183], v5 offset:1536
  s_waitcnt lgkmcnt(14)
  ds_read_b64_tr_b16 a[184:185], v5 offset:2048
  s_waitcnt lgkmcnt(14)
  ds_read_b64_tr_b16 a[186:187], v5 offset:2560
  s_waitcnt lgkmcnt(14)
  ds_read_b64_tr_b16 a[188:189], v5 offset:3072
  s_waitcnt lgkmcnt(14)
  ds_read_b64_tr_b16 a[190:191], v5 offset:3584
  s_waitcnt vmcnt(31)
  s_waitcnt lgkmcnt(14)
  ds_write_b128 v4, a[192:195] offset:0
  s_waitcnt vmcnt(30)
  s_waitcnt lgkmcnt(14)
  ds_write_b128 v4, a[196:199] offset:512
  s_waitcnt vmcnt(29)
  s_waitcnt lgkmcnt(14)
  ds_write_b128 v4, a[200:203] offset:1024
  s_waitcnt vmcnt(28)
  s_waitcnt lgkmcnt(14)
  ds_write_b128 v4, a[204:207] offset:1536
  s_waitcnt lgkmcnt(14)
  ds_read_b64_tr_b16 a[192:193], v5 offset:0
  s_waitcnt lgkmcnt(14)
  ds_read_b64_tr_b16 a[194:195], v5 offset:512
  s_waitcnt lgkmcnt(14)
  ds_read_b64_tr_b16 a[196:197], v5 offset:1024
  s_waitcnt lgkmcnt(14)
  ds_read_b64_tr_b16 a[198:199], v5 offset:1536
  s_waitcnt lgkmcnt(14)
  ds_read_b64_tr_b16 a[200:201], v5 offset:2048
  s_waitcnt lgkmcnt(14)
  ds_read_b64_tr_b16 a[202:203], v5 offset:2560
  s_waitcnt lgkmcnt(14)
  ds_read_b64_tr_b16 a[204:205], v5 offset:3072
  s_waitcnt lgkmcnt(14)
  ds_read_b64_tr_b16 a[206:207], v5 offset:3584
  s_waitcnt vmcnt(27)
  s_waitcnt lgkmcnt(14)
  ds_write_b128 v4, a[208:211] offset:0
  s_waitcnt vmcnt(26)
  s_waitcnt lgkmcnt(14)
  ds_write_b128 v4, a[212:215] offset:512
  s_waitcnt vmcnt(25)
  s_waitcnt lgkmcnt(14)
  ds_write_b128 v4, a[216:219] offset:1024
  s_waitcnt vmcnt(24)
  s_waitcnt lgkmcnt(14)
  ds_write_b128 v4, a[220:223] offset:1536
  s_waitcnt lgkmcnt(14)
  ds_read_b64_tr_b16 a[208:209], v5 offset:0
  s_waitcnt lgkmcnt(14)
  ds_read_b64_tr_b16 a[210:211], v5 offset:512
  s_waitcnt lgkmcnt(14)
  ds_read_b64_tr_b16 a[212:213], v5 offset:1024
  s_waitcnt lgkmcnt(14)
  ds_read_b64_tr_b16 a[214:215], v5 offset:1536
  s_waitcnt lgkmcnt(14)
  ds_read_b64_tr_b16 a[216:217], v5 offset:2048
  s_waitcnt lgkmcnt(14)
  ds_read_b64_tr_b16 a[218:219], v5 offset:2560
  s_waitcnt lgkmcnt(14)
  ds_read_b64_tr_b16 a[220:221], v5 offset:3072
  s_waitcnt lgkmcnt(14)
  ds_read_b64_tr_b16 a[222:223], v5 offset:3584
  s_waitcnt vmcnt(23)
  s_waitcnt lgkmcnt(14)
  ds_write_b128 v4, a[224:227] offset:0
  s_waitcnt vmcnt(22)
  s_waitcnt lgkmcnt(14)
  ds_write_b128 v4, a[228:231] offset:512
  s_waitcnt vmcnt(21)
  s_waitcnt lgkmcnt(14)
  ds_write_b128 v4, a[232:235] offset:1024
  s_waitcnt vmcnt(20)
  s_waitcnt lgkmcnt(14)
  ds_write_b128 v4, a[236:239] offset:1536
  s_waitcnt lgkmcnt(14)
  ds_read_b64_tr_b16 a[224:225], v5 offset:0
  s_waitcnt lgkmcnt(14)
  ds_read_b64_tr_b16 a[226:227], v5 offset:512
  s_waitcnt lgkmcnt(14)
  ds_read_b64_tr_b16 a[228:229], v5 offset:1024
  s_waitcnt lgkmcnt(14)
  ds_read_b64_tr_b16 a[230:231], v5 offset:1536
  s_waitcnt lgkmcnt(14)
  ds_read_b64_tr_b16 a[232:233], v5 offset:2048
  s_waitcnt lgkmcnt(14)
  ds_read_b64_tr_b16 a[234:235], v5 offset:2560
  s_waitcnt lgkmcnt(14)
  ds_read_b64_tr_b16 a[236:237], v5 offset:3072
  s_waitcnt lgkmcnt(14)
  ds_read_b64_tr_b16 a[238:239], v5 offset:3584
  s_waitcnt vmcnt(19)
  s_waitcnt lgkmcnt(14)
  ds_write_b128 v4, a[240:243] offset:0
  s_waitcnt vmcnt(18)
  s_waitcnt lgkmcnt(14)
  ds_write_b128 v4, a[244:247] offset:512
  s_waitcnt vmcnt(17)
  s_waitcnt lgkmcnt(14)
  ds_write_b128 v4, a[248:251] offset:1024
  s_waitcnt vmcnt(16)
  s_waitcnt lgkmcnt(14)
  ds_write_b128 v4, a[252:255] offset:1536
  s_waitcnt lgkmcnt(14)
  ds_read_b64_tr_b16 a[240:241], v5 offset:0
  s_waitcnt lgkmcnt(14)
  ds_read_b64_tr_b16 a[242:243], v5 offset:512
  s_waitcnt lgkmcnt(14)
  ds_read_b64_tr_b16 a[244:245], v5 offset:1024
  s_waitcnt lgkmcnt(14)
  ds_read_b64_tr_b16 a[246:247], v5 offset:1536
  s_waitcnt lgkmcnt(14)
  ds_read_b64_tr_b16 a[248:249], v5 offset:2048
  s_waitcnt lgkmcnt(14)
  ds_read_b64_tr_b16 a[250:251], v5 offset:2560
  s_waitcnt lgkmcnt(14)
  ds_read_b64_tr_b16 a[252:253], v5 offset:3072
  s_waitcnt lgkmcnt(14)
  ds_read_b64_tr_b16 a[254:255], v5 offset:3584
  s_waitcnt vmcnt(15)
  s_waitcnt lgkmcnt(14)
  ds_write_b128 v179, v[192:195] offset:0
  s_waitcnt vmcnt(14)
  s_waitcnt lgkmcnt(14)
  ds_write_b128 v179, v[196:199] offset:1088
  s_waitcnt vmcnt(13)
  s_waitcnt lgkmcnt(14)
  ds_write_b128 v179, v[200:203] offset:2176
  s_waitcnt vmcnt(12)
  s_waitcnt lgkmcnt(14)
  ds_write_b128 v179, v[204:207] offset:3264
  s_waitcnt vmcnt(11)
  s_waitcnt lgkmcnt(14)
  ds_write_b128 v179, v[208:211] offset:4352
  s_waitcnt vmcnt(10)
  s_waitcnt lgkmcnt(14)
  ds_write_b128 v179, v[212:215] offset:5440
  s_waitcnt vmcnt(9)
  s_waitcnt lgkmcnt(14)
  ds_write_b128 v179, v[216:219] offset:6528
  s_waitcnt vmcnt(8)
  s_waitcnt lgkmcnt(14)
  ds_write_b128 v179, v[220:223] offset:7616
  s_waitcnt lgkmcnt(14)
  ds_read_b64_tr_b16 v[192:193], v191 offset:0
  s_waitcnt lgkmcnt(14)
  ds_read_b64_tr_b16 v[194:195], v191 offset:4352
  s_waitcnt lgkmcnt(14)
  ds_read_b64_tr_b16 v[196:197], v191 offset:8
  s_waitcnt lgkmcnt(14)
  ds_read_b64_tr_b16 v[198:199], v191 offset:4360
  s_waitcnt lgkmcnt(14)
  ds_read_b64_tr_b16 v[200:201], v191 offset:16
  s_waitcnt lgkmcnt(14)
  ds_read_b64_tr_b16 v[202:203], v191 offset:4368
  s_waitcnt lgkmcnt(14)
  ds_read_b64_tr_b16 v[204:205], v191 offset:24
  s_waitcnt lgkmcnt(14)
  ds_read_b64_tr_b16 v[206:207], v191 offset:4376
  s_waitcnt lgkmcnt(14)
  ds_read_b64_tr_b16 v[208:209], v191 offset:128
  s_waitcnt lgkmcnt(14)
  ds_read_b64_tr_b16 v[210:211], v191 offset:4480
  s_waitcnt lgkmcnt(14)
  ds_read_b64_tr_b16 v[212:213], v191 offset:136
  s_waitcnt lgkmcnt(14)
  ds_read_b64_tr_b16 v[214:215], v191 offset:4488
  s_waitcnt lgkmcnt(14)
  ds_read_b64_tr_b16 v[216:217], v191 offset:144
  s_waitcnt lgkmcnt(14)
  ds_read_b64_tr_b16 v[218:219], v191 offset:4496
  s_waitcnt lgkmcnt(14)
  ds_read_b64_tr_b16 v[220:221], v191 offset:152
  s_waitcnt lgkmcnt(14)
  ds_read_b64_tr_b16 v[222:223], v191 offset:4504
  s_waitcnt vmcnt(7)
  s_waitcnt lgkmcnt(14)
  ds_write_b128 v179, v[224:227] offset:0
  s_waitcnt vmcnt(6)
  s_waitcnt lgkmcnt(14)
  ds_write_b128 v179, v[228:231] offset:1088
  s_waitcnt vmcnt(5)
  s_waitcnt lgkmcnt(14)
  ds_write_b128 v179, v[232:235] offset:2176
  s_waitcnt vmcnt(4)
  s_waitcnt lgkmcnt(14)
  ds_write_b128 v179, v[236:239] offset:3264
  s_waitcnt vmcnt(3)
  s_waitcnt lgkmcnt(14)
  ds_write_b128 v179, v[240:243] offset:4352
  s_waitcnt vmcnt(2)
  s_waitcnt lgkmcnt(14)
  ds_write_b128 v179, v[244:247] offset:5440
  s_waitcnt vmcnt(1)
  s_waitcnt lgkmcnt(14)
  ds_write_b128 v179, v[248:251] offset:6528
  s_waitcnt vmcnt(0)
  s_waitcnt lgkmcnt(14)
  ds_write_b128 v179, v[252:255] offset:7616
  s_waitcnt lgkmcnt(14)
  ds_read_b64_tr_b16 v[224:225], v191 offset:0
  s_waitcnt lgkmcnt(14)
  ds_read_b64_tr_b16 v[226:227], v191 offset:4352
  s_waitcnt lgkmcnt(14)
  ds_read_b64_tr_b16 v[228:229], v191 offset:8
  s_waitcnt lgkmcnt(14)
  ds_read_b64_tr_b16 v[230:231], v191 offset:4360
  s_waitcnt lgkmcnt(14)
  ds_read_b64_tr_b16 v[232:233], v191 offset:16
  s_waitcnt lgkmcnt(14)
  ds_read_b64_tr_b16 v[234:235], v191 offset:4368
  s_waitcnt lgkmcnt(14)
  ds_read_b64_tr_b16 v[236:237], v191 offset:24
  s_waitcnt lgkmcnt(14)
  ds_read_b64_tr_b16 v[238:239], v191 offset:4376
  s_waitcnt lgkmcnt(14)
  ds_read_b64_tr_b16 v[240:241], v191 offset:128
  s_waitcnt lgkmcnt(14)
  ds_read_b64_tr_b16 v[242:243], v191 offset:4480
  s_waitcnt lgkmcnt(14)
  ds_read_b64_tr_b16 v[244:245], v191 offset:136
  s_waitcnt lgkmcnt(14)
  ds_read_b64_tr_b16 v[246:247], v191 offset:4488
  s_waitcnt lgkmcnt(14)
  ds_read_b64_tr_b16 v[248:249], v191 offset:144
  s_waitcnt lgkmcnt(14)
  ds_read_b64_tr_b16 v[250:251], v191 offset:4496
  s_waitcnt lgkmcnt(14)
  ds_read_b64_tr_b16 v[252:253], v191 offset:152
  s_waitcnt lgkmcnt(14)
  ds_read_b64_tr_b16 v[254:255], v191 offset:4504
  s_waitcnt vmcnt(0) lgkmcnt(0)
  v_mov_b32 v15, 0x10000000
  v_cmp_gt_u32 vcc, 8, v13
  s_nop 1
  v_cndmask_b32 v179, v15, v10, vcc
  v_and_b32 v24, 1, v0
  v_lshlrev_b32 v24, 4, v24
  s_mov_b32 s28, 0x3f80
  v_lshlrev_b32 v15, v24, s28
  s_mov_b32 s66, 0x3030303
  s_mov_b32 s67, 0x3030303
  s_mov_b32 s68, 0xc0c0c0c
  s_mov_b32 s69, 0xc0c0c0c
  s_mov_b32 s70, 0x30303030
  s_mov_b32 s71, 0x30303030
  s_mov_b32 s72, 0xc0c0c0c0
  s_mov_b32 s73, 0xc0c0c0c0
  v_cndmask_b32 v144, 0, v15, s[66:67]
  v_cndmask_b32 v145, 0, v15, s[68:69]
  v_cndmask_b32 v146, 0, v15, s[70:71]
  v_cndmask_b32 v147, 0, v15, s[72:73]
  s_lshr_b32 s30, s5, 1
  s_lshl_b32 s30, s30, 4
  v_and_b32 v15, 15, v0
  v_lshrrev_b32 v180, 4, v0
  v_lshlrev_b32 v180, 2, v180
  v_sub_u32 v15, v15, v180
  v_add_u32 v15, s30, v15
  v_cmp_le_i32 s[64:65], 0, v15
  v_cmp_le_i32 s[66:67], 1, v15
  v_cmp_le_i32 s[68:69], 2, v15
  v_cmp_le_i32 s[70:71], 3, v15
  v_cmp_le_i32 s[72:73], 16, v15
  v_cmp_le_i32 s[74:75], 17, v15
  v_cmp_le_i32 s[76:77], 18, v15
  v_cmp_le_i32 s[78:79], 19, v15
  s_lshl_b32 s28, s30, 15
  s_add_u32 s12, s28, s80
  s_xor_b32 s30, s30, 16
  s_lshl_b32 s28, s30, 15
  s_add_u32 s13, s28, s80
  s_xor_b32 s30, s30, 16
  s_mov_b32 s96, 0x3db504f3
  s_mov_b32 s97, 0x3db504f3
  s_mov_b32 s98, 0x3fb8aa3b
  s_mov_b32 s63, 0
  s_mov_b32 s85, s62
  s_mov_b32 s94, -1
  s_mov_b32 s95, 0
  s_lshl_b32 s28, s5, 9
  v_lshrrev_b32 v15, 5, v0
  v_lshl_add_u32 v15, v15, 4, v13
  v_lshlrev_b32 v15, 4, v15
  v_and_b32 v2, 1, v14
  v_lshl_add_u32 v15, v2, 3, v15
  v_add_u32 v2, s28, v15
  v_lshrrev_b32 v15, 2, v0
  v_lshlrev_b32 v15, 4, v15
  v_and_b32 v3, 1, v0
  v_lshl_add_u32 v3, v3, 3, v15
  v_lshl_add_u32 v4, v0, 3, s28
  s_and_b32 s28, s5, 1
  s_lshl_b32 s28, s28, 10
  v_lshl_add_u32 v5, v0, 3, s28
  s_mov_b32 s34, 0
  s_mov_b32 s35, 6
  s_lshl_b32 s33, s3, 5
L_g2_110:
  buffer_load_dword v15, off, s[24:27], s33 offset:4 sc1
  s_add_u32 s34, s34, 1
  s_cmp_gt_u32 s34, 40000
  s_cbranch_scc1 L_fail
  s_waitcnt vmcnt(0)
  v_cmp_ne_u32 vcc, 32, v15
  s_cbranch_vccz L_g2d_111
  s_sleep 8
  s_branch L_g2_110
L_g2d_111:
  s_cmp_eq_u32 s62, 0
  s_cselect_b32 s84, 10, 9
  s_lshl_b32 s28, s62, 12
  s_lshl_b32 s29, s4, 7
  s_add_u32 s28, s28, s29
  s_add_u32 s33, s28, 335872
  s_mov_b32 s34, 0
  s_mov_b32 s35, 11
L_g3_112:
  buffer_load_dword v15, off, s[8:11], s33 sc1
  s_add_u32 s34, s34, 1
  s_cmp_gt_u32 s34, 40000
  s_cbranch_scc1 L_fail
  s_waitcnt vmcnt(0)
  v_cmp_ge_u32 vcc, s84, v15
  s_cbranch_vccz L_g3d_113
  s_sleep 8
  s_branch L_g3_112
L_g3d_113:
  s_mov_b32 s86, 0
  s_mov_b32 s92, 1
  s_mov_b32 s99, 1
  s_sub_u32 s28, s62, 1
  s_cmp_lt_u32 s28, 2
  s_cbranch_scc0 L_nh_114
  s_cmp_eq_u32 s28, 0
  s_cselect_b32 s30, 9, 10
  s_cselect_b32 s28, 24576, 0
  s_lshl_b32 s29, s4, 7
  s_add_u32 s28, s28, s29
  s_add_u32 s33, s28, 335872
  s_mov_b32 s34, 0
  s_mov_b32 s35, 12
L_g4_115:
  buffer_load_dword v15, off, s[8:11], s33 sc1
  s_add_u32 s34, s34, 1
  s_cmp_gt_u32 s34, 40000
  s_cbranch_scc1 L_fail
  s_waitcnt vmcnt(0)
  v_cmp_ge_u32 vcc, s30, v15
  s_cbranch_vccz L_g4d_116
  s_sleep 8
  s_branch L_g4_115
L_g4d_116:
  s_mov_b32 s84, 10
L_nh_114:
  s_waitcnt vmcnt(0)
  s_mul_i32 s91, s5, 6144
  s_add_u32 s89, s91, 81920
  s_lshl_b32 s28, s85, 20
  s_mul_i32 s29, s4, 29696
  s_add_u32 s28, s28, s29
  s_add_u32 s90, s28, 0x1800000
  s_add_u32 s28, s90, s91
  s_mov_b32 m0, s89
  s_nop 0
  buffer_load_dwordx4 v1, s[8:11], s28 offen offset:0 sc1 lds
  buffer_load_dwordx4 v1, s[8:11], s28 offen offset:1024 sc1 lds
  buffer_load_dwordx4 v1, s[8:11], s28 offen offset:2048 sc1 lds
  buffer_load_dwordx4 v1, s[8:11], s28 offen offset:3072 sc1 lds
  s_add_u32 s28, s28, 4096
  s_add_u32 m0, s89, 4096
  s_nop 0
  buffer_load_dwordx4 v1, s[8:11], s28 offen offset:0 sc1 lds
  buffer_load_dwordx4 v1, s[8:11], s28 offen offset:1024 sc1 lds
  v_add_u32 v13, 0x14000, v1
  s_lshr_b32 s30, s5, 1
  s_lshl_b32 s30, s30, 12
  s_add_u32 s30, s30, 98304
  v_add_u32 v14, s30, v1
  s_and_b32 s30, s5, 1
  s_lshl_b32 s30, s30, 12
  s_add_u32 s30, s30, 90112
  v_add_u32 v15, s30, v1
  s_waitcnt vmcnt(0)
  s_barrier
L_wf_loop:
  s_bfe_u32 s81, s63, 0x10001
  s_cmp_ge_u32 s4, 22
  s_cselect_b32 s82, s81, 0
  s_sub_u32 s29, s62, 1
  s_cmp_lt_u32 s29, 2
  s_cselect_b32 s30, 8, 99
  s_cmp_eq_u32 s30, s63
  s_cselect_b32 s87, 5, 7
  s_cmp_lt_u32 s85, 62
  s_cbranch_scc1 L_full_117
  s_cmp_lt_u32 s29, 2
  s_cselect_b32 s31, 1, 0
  s_mov_b32 s86, 1
  s_lshr_b32 s28, s4, 4
  s_cmp_eq_u32 s28, s31
  s_cselect_b32 s92, 1, 0
  s_lshr_b32 s28, s5, 1
  s_cmp_eq_u32 s28, s31
  s_cselect_b32 s99, 1, 0
  s_sub_i32 s28, s31, s28
  s_lshl_b32 s29, s28, 12
  v_add_u32 v14, s29, v14
  s_mul_i32 s29, s28, 16640
  v_add_u32 v12, s29, v12
  s_lshl_b32 s30, s31, 4
  v_and_b32 v180, 15, v0
  v_lshrrev_b32 v181, 4, v0
  v_lshlrev_b32 v181, 2, v181
  v_sub_u32 v180, v180, v181
  v_add_u32 v180, s30, v180
  v_cmp_le_i32 s[64:65], 0, v180
  v_cmp_le_i32 s[66:67], 1, v180
  v_cmp_le_i32 s[68:69], 2, v180
  v_cmp_le_i32 s[70:71], 3, v180
  v_cmp_le_i32 s[72:73], 16, v180
  v_cmp_le_i32 s[74:75], 17, v180
  v_cmp_le_i32 s[76:77], 18, v180
  v_cmp_le_i32 s[78:79], 19, v180
  s_lshl_b32 s28, s30, 15
  s_add_u32 s12, s28, s80
  s_xor_b32 s30, s30, 16
  s_lshl_b32 s28, s30, 15
  s_add_u32 s13, s28, s80
  s_xor_b32 s30, s30, 16
L_full_117:
  s_lshl_b32 s28, s85, 20
  s_mul_i32 s29, s4, 29696
  s_add_u32 s28, s28, s29
  s_add_u32 s90, s28, 0x1800000
  s_lshl_b32 s29, s5, 10
  s_add_u32 s29, s29, s90
  s_add_u32 s93, s29, 24576
  s_lshl_b32 s28, 1, s3
  s_and_b32 s28, s28, 238
  s_cbranch_scc0 L_nwb_118
  s_lshl_b32 s28, s4, 2
  s_add_u32 s28, s28, s5
  s_cmp_lg_u32 s28, 124
  s_cbranch_scc1 L_nwb_118
  s_add_u32 s28, s63, 1
  s_cmp_lg_u32 s28, s84
  s_cbranch_scc1 L_nwb_118
  buffer_wbl2 sc1
L_nwb_118:
  s_lshl_b32 s28, 1, s3
  s_and_b32 s28, s28, 8
  s_cbranch_scc0 L_nwb_119
  s_lshl_b32 s28, s4, 2
  s_add_u32 s28, s28, s5
  s_cmp_lg_u32 s28, 124
  s_cbranch_scc1 L_nwb_119
  s_add_u32 s28, s63, 2
  s_cmp_lg_u32 s28, s84
  s_cbranch_scc1 L_nwb_119
  buffer_wbl2 sc1
L_nwb_119:
  buffer_load_dwordx4 v[184:187], v1, s[8:11], s93 offen sc1
  s_cmp_eq_u32 s85, 0
  s_cselect_b32 s29, 0, 0x100000
  s_sub_u32 s83, s93, s29
  s_lshl_b32 s28, s85, 15
  s_lshl_b32 s29, s4, 10
  s_add_u32 s88, s28, s29
  buffer_load_dwordx2 v[138:139], v10, s[16:19], s88 offen
  ds_read_b128 v[16:19], v14 offset:0
  ds_read_b128 v[32:35], v13 offset:0
  ds_read_b128 v[48:51], v13 offset:4096
  ds_read_b128 v[20:23], v14 offset:1024
  ds_read_b128 v[36:39], v13 offset:1024
  ds_read_b128 v[52:55], v13 offset:5120
  ds_read_b128 v[24:27], v14 offset:2048
  ds_read_b128 v[40:43], v13 offset:2048
  ds_read_b128 v[56:59], v13 offset:6144
  ds_read_b128 v[28:31], v14 offset:3072
  ds_read_b128 v[44:47], v13 offset:3072
  ds_read_b128 v[60:63], v13 offset:7168
  ds_read_b128 v[64:67], v15 offset:0
  ds_read_b128 v[68:71], v15 offset:1024
  ds_read_b128 v[72:75], v15 offset:2048
  s_waitcnt lgkmcnt(14)
  ds_read_b128 v[76:79], v15 offset:3072
  s_waitcnt lgkmcnt(14)
  v_mfma_f32_16x16x32_bf16 v[104:107], v[32:35], v[16:19], 0
  s_waitcnt lgkmcnt(13)
  v_mfma_f32_16x16x32_bf16 v[108:111], v[48:51], v[16:19], 0
  s_waitcnt lgkmcnt(11)
  v_mfma_f32_16x16x32_bf16 v[104:107], v[36:39], v[20:23], v[104:107]
  s_waitcnt lgkmcnt(10)
  v_mfma_f32_16x16x32_bf16 v[108:111], v[52:55], v[20:23], v[108:111]
  s_waitcnt lgkmcnt(8)
  v_mfma_f32_16x16x32_bf16 v[104:107], v[40:43], v[24:27], v[104:107]
  s_waitcnt lgkmcnt(7)
  v_mfma_f32_16x16x32_bf16 v[108:111], v[56:59], v[24:27], v[108:111]
  s_waitcnt lgkmcnt(5)
  v_mfma_f32_16x16x32_bf16 v[104:107], v[44:47], v[28:31], v[104:107]
  s_waitcnt lgkmcnt(4)
  v_mfma_f32_16x16x32_bf16 v[108:111], v[60:63], v[28:31], v[108:111]
  s_nop 3
  v_cvt_pk_bf16_f32 v104, v104, v105
  v_and_b32 v105, 0xffff0000, v104
  v_lshlrev_b32 v104, 16, v104
  v_pk_mul_f32 v[104:105], v[104:105], s[96:97]
  v_cvt_pk_bf16_f32 v104, v104, v105
  v_and_b32 v105, 0xffff0000, v104
  v_lshlrev_b32 v104, 16, v104
  v_cvt_pk_bf16_f32 v106, v106, v107
  v_and_b32 v107, 0xffff0000, v106
  v_lshlrev_b32 v106, 16, v106
  v_pk_mul_f32 v[106:107], v[106:107], s[96:97]
  v_cvt_pk_bf16_f32 v106, v106, v107
  v_and_b32 v107, 0xffff0000, v106
  v_lshlrev_b32 v106, 16, v106
  v_cvt_pk_bf16_f32 v108, v108, v109
  v_and_b32 v109, 0xffff0000, v108
  v_lshlrev_b32 v108, 16, v108
  v_pk_mul_f32 v[108:109], v[108:109], s[96:97]
  v_cvt_pk_bf16_f32 v108, v108, v109
  v_and_b32 v109, 0xffff0000, v108
  v_lshlrev_b32 v108, 16, v108
  v_cvt_pk_bf16_f32 v110, v110, v111
  v_and_b32 v111, 0xffff0000, v110
  v_lshlrev_b32 v110, 16, v110
  v_pk_mul_f32 v[110:111], v[110:111], s[96:97]
  v_cvt_pk_bf16_f32 v110, v110, v111
  v_and_b32 v111, 0xffff0000, v110
  v_lshlrev_b32 v110, 16, v110
  v_mov_b32 v180, 0xce6e6b28
  v_cndmask_b32 v104, v180, v104, s[64:65]
  v_cndmask_b32 v105, v180, v105, s[66:67]
  v_cndmask_b32 v106, v180, v106, s[68:69]
  v_cndmask_b32 v107, v180, v107, s[70:71]
  v_cndmask_b32 v108, v180, v108, s[72:73]
  v_cndmask_b32 v109, v180, v109, s[74:75]
  v_cndmask_b32 v110, v180, v110, s[76:77]
  v_cndmask_b32 v111, v180, v111, s[78:79]
  v_max3_f32 v181, v104, v105, v106
  v_max3_f32 v181, v181, v107, v108
  v_max3_f32 v181, v181, v109, v110
  v_max_f32 v181, v181, v111
  v_mov_b32 v182, v181
  s_nop 1
  v_permlane16_swap_b32 v181, v182
  v_max_f32 v181, v181, v182
  v_mov_b32 v182, v181
  s_nop 1
  v_permlane32_swap_b32 v181, v182
  v_max_f32 v181, v181, v182
  v_sub_f32 v104, v104, v181
  v_sub_f32 v105, v105, v181
  v_sub_f32 v106, v106, v181
  v_sub_f32 v107, v107, v181
  v_sub_f32 v108, v108, v181
  v_sub_f32 v109, v109, v181
  v_sub_f32 v110, v110, v181
  v_sub_f32 v111, v111, v181
  v_mul_f32 v104, s98, v104
  v_mul_f32 v105, s98, v105
  v_mul_f32 v106, s98, v106
  v_mul_f32 v107, s98, v107
  v_mul_f32 v108, s98, v108
  v_mul_f32 v109, s98, v109
  v_mul_f32 v110, s98, v110
  v_mul_f32 v111, s98, v111
  v_exp_f32 v104, v104
  v_exp_f32 v105, v105
  v_exp_f32 v106, v106
  v_exp_f32 v107, v107
  v_exp_f32 v108, v108
  v_exp_f32 v109, v109
  v_exp_f32 v110, v110
  v_exp_f32 v111, v111
  v_add_f32 v183, v104, v105
  v_add_f32 v183, v183, v106
  v_add_f32 v183, v183, v107
  v_add_f32 v183, v183, v108
  v_add_f32 v183, v183, v109
  v_add_f32 v183, v183, v110
  v_add_f32 v183, v183, v111
  v_cvt_pk_bf16_f32 v132, v104, v105
  v_cvt_pk_bf16_f32 v133, v106, v107
  v_cvt_pk_bf16_f32 v134, v108, v109
  v_cvt_pk_bf16_f32 v135, v110, v111
  v_mov_b32 v182, v183
  s_nop 1
  v_permlane16_swap_b32 v183, v182
  v_add_f32 v183, v183, v182
  v_mov_b32 v182, v183
  s_nop 1
  v_permlane32_swap_b32 v183, v182
  v_add_f32 v183, v183, v182
  s_waitcnt lgkmcnt(3)
  v_mfma_f32_16x16x32_bf16 v[116:119], v[64:67], v[132:135], 0
  s_waitcnt lgkmcnt(2)
  v_mfma_f32_16x16x32_bf16 v[120:123], v[68:71], v[132:135], 0
  s_waitcnt lgkmcnt(1)
  v_mfma_f32_16x16x32_bf16 v[124:127], v[72:75], v[132:135], 0
  s_waitcnt lgkmcnt(0)
  v_mfma_f32_16x16x32_bf16 v[128:131], v[76:79], v[132:135], 0
  s_waitcnt vmcnt(0)
  s_add_u32 s30, s63, 1
  s_cmp_lt_u32 s30, s84
  s_cbranch_scc0 L_nd_121
  s_waitcnt lgkmcnt(0)
  s_barrier
  s_add_u32 s29, s63, 1
  s_cmp_lt_u32 s29, s84
  s_cselect_b32 s29, s87, 0
  s_lshl_b32 s29, s29, 20
  s_add_u32 s29, s29, s90
  s_add_u32 s28, s29, s91
  s_mov_b32 m0, s89
  s_nop 0
  buffer_load_dwordx4 v1, s[8:11], s28 offen offset:0 sc1 lds
  buffer_load_dwordx4 v1, s[8:11], s28 offen offset:1024 sc1 lds
  buffer_load_dwordx4 v1, s[8:11], s28 offen offset:2048 sc1 lds
  buffer_load_dwordx4 v1, s[8:11], s28 offen offset:3072 sc1 lds
  s_add_u32 s28, s28, 4096
  s_add_u32 m0, s89, 4096
  s_nop 0
  buffer_load_dwordx4 v1, s[8:11], s28 offen offset:0 sc1 lds
  buffer_load_dwordx4 v1, s[8:11], s28 offen offset:1024 sc1 lds
L_nd_121:
  v_and_b32 v182, 1, v184
  v_cmp_eq_u32 vcc, 0, v182
  s_cbranch_vccz L_ok_120
  s_mov_b32 s34, 0
  s_mov_b32 s35, 7
  s_cmp_ge_u32 s85, 61
  s_cbranch_scc1 L_pf_123
L_pp_124:
  buffer_load_dword v184, off, s[8:11], s83 sc1
  s_add_u32 s34, s34, 1
  s_cmp_gt_u32 s34, 40000
  s_cbranch_scc1 L_fail
  s_waitcnt vmcnt(0)
  v_and_b32 v184, 1, v184
  v_cmp_eq_u32 vcc, 0, v184
  s_cbranch_vccz L_pd_125
  s_sleep 6
  s_branch L_pp_124
L_pd_125:
L_pq_126:
  buffer_load_dwordx4 v[184:187], v1, s[8:11], s93 offen sc1
  s_add_u32 s34, s34, 1
  s_cmp_gt_u32 s34, 40000
  s_cbranch_scc1 L_fail
  s_waitcnt vmcnt(0)
  v_and_b32 v182, 1, v184
  v_cmp_eq_u32 vcc, 0, v182
  s_cbranch_vccz L_ok_120
  s_sleep 2
  s_branch L_pq_126
L_ok_120:
  ds_write_b64 v2, v[184:185] offset:16384
  ds_write_b64 v4, v[186:187] offset:18432
L_ok2_122:
  s_waitcnt lgkmcnt(0)
  s_barrier
  ds_read_b64_tr_b16 v[80:81], v3 offset:16384
  ds_read_b64_tr_b16 v[82:83], v3 offset:16640
  ds_read_b64_tr_b16 v[84:85], v3 offset:16896
  ds_read_b64_tr_b16 v[86:87], v3 offset:17152
  ds_read_b64_tr_b16 v[88:89], v3 offset:17408
  ds_read_b64_tr_b16 v[90:91], v3 offset:17664
  ds_read_b64_tr_b16 v[92:93], v3 offset:17920
  ds_read_b64_tr_b16 v[94:95], v3 offset:18176
  ds_read_b64 v[96:97], v5 offset:18432
  ds_read_b64 v[98:99], v5 offset:18944
  s_waitcnt lgkmcnt(8)
  v_mfma_f32_16x16x32_bf16 v[112:115], v[80:83], v[16:19], 0
  s_waitcnt lgkmcnt(6)
  v_mfma_f32_16x16x32_bf16 v[112:115], v[84:87], v[20:23], v[112:115]
  s_waitcnt lgkmcnt(4)
  v_mfma_f32_16x16x32_bf16 v[112:115], v[88:91], v[24:27], v[112:115]
  s_waitcnt lgkmcnt(2)
  v_mfma_f32_16x16x32_bf16 v[112:115], v[92:95], v[28:31], v[112:115]
  s_nop 7
  v_cvt_pk_bf16_f32 v112, v112, v113
  v_and_b32 v113, 0xffff0000, v112
  v_lshlrev_b32 v112, 16, v112
  v_pk_mul_f32 v[112:113], v[112:113], s[96:97]
  v_cvt_pk_bf16_f32 v112, v112, v113
  v_and_b32 v113, 0xffff0000, v112
  v_lshlrev_b32 v112, 16, v112
  v_cvt_pk_bf16_f32 v114, v114, v115
  v_and_b32 v115, 0xffff0000, v114
  v_lshlrev_b32 v114, 16, v114
  v_pk_mul_f32 v[114:115], v[114:115], s[96:97]
  v_cvt_pk_bf16_f32 v114, v114, v115
  v_and_b32 v115, 0xffff0000, v114
  v_lshlrev_b32 v114, 16, v114
  v_max3_f32 v104, v181, v112, v113
  v_max3_f32 v104, v104, v114, v115
  v_mov_b32 v182, v104
  s_nop 1
  v_permlane16_swap_b32 v104, v182
  v_max_f32 v104, v104, v182
  v_sub_f32 v112, v112, v104
  v_sub_f32 v113, v113, v104
  v_sub_f32 v114, v114, v104
  v_sub_f32 v115, v115, v104
  v_sub_f32 v105, v181, v104
  v_mul_f32 v112, s98, v112
  v_mul_f32 v113, s98, v113
  v_mul_f32 v114, s98, v114
  v_mul_f32 v115, s98, v115
  v_mul_f32 v105, s98, v105
  v_exp_f32 v112, v112
  v_exp_f32 v113, v113
  v_exp_f32 v114, v114
  v_exp_f32 v115, v115
  v_exp_f32 v105, v105
  v_add_f32 v106, v112, v113
  v_add_f32 v104, v114, v115
  v_add_f32 v106, v106, v104
  v_mov_b32 v182, v106
  s_nop 1
  v_permlane16_swap_b32 v106, v182
  v_add_f32 v106, v106, v182
  v_fmac_f32 v106, v105, v183
  v_rcp_f32 v106, v106
  s_nop 0
  v_pk_mul_f32 v[112:113], v[112:113], v[106:107] op_sel_hi:[1,0]
  v_pk_mul_f32 v[114:115], v[114:115], v[106:107] op_sel_hi:[1,0]
  v_mul_f32 v104, v105, v106
  v_cvt_pk_bf16_f32 v136, v112, v113
  v_cvt_pk_bf16_f32 v137, v114, v115
  v_pk_mul_f32 v[116:117], v[116:117], v[104:105] op_sel_hi:[1,0]
  v_pk_mul_f32 v[118:119], v[118:119], v[104:105] op_sel_hi:[1,0]
  v_cndmask_b32 v100, 0, v136, s[94:95]
  v_cndmask_b32 v101, 0, v137, s[94:95]
  v_pk_mul_f32 v[124:125], v[124:125], v[104:105] op_sel_hi:[1,0]
  v_pk_mul_f32 v[126:127], v[126:127], v[104:105] op_sel_hi:[1,0]
  s_waitcnt lgkmcnt(1)
  v_mfma_f32_16x16x16_bf16 v[116:119], v[96:97], v[100:101], v[116:119]
  v_cndmask_b32 v102, v136, 0, s[94:95]
  v_cndmask_b32 v103, v137, 0, s[94:95]
  v_pk_mul_f32 v[120:121], v[120:121], v[104:105] op_sel_hi:[1,0]
  v_pk_mul_f32 v[122:123], v[122:123], v[104:105] op_sel_hi:[1,0]
  s_waitcnt lgkmcnt(0)
  v_mfma_f32_16x16x16_bf16 v[124:127], v[98:99], v[100:101], v[124:127]
  v_pk_mul_f32 v[128:129], v[128:129], v[104:105] op_sel_hi:[1,0]
  v_pk_mul_f32 v[130:131], v[130:131], v[104:105] op_sel_hi:[1,0]
  v_mfma_f32_16x16x16_bf16 v[120:123], v[96:97], v[102:103], v[120:123]
  v_mfma_f32_16x16x16_bf16 v[128:131], v[98:99], v[102:103], v[128:131]
  v_cvt_pk_bf16_f32 v164, v116, v117
  v_cvt_pk_bf16_f32 v165, v118, v119
  s_nop 1
  v_cvt_pk_bf16_f32 v166, v120, v121
  v_cvt_pk_bf16_f32 v167, v122, v123
  ds_write_b128 v176, v[164:167] offset:0
  v_cvt_pk_bf16_f32 v168, v124, v125
  v_cvt_pk_bf16_f32 v169, v126, v127
  v_cvt_pk_bf16_f32 v170, v128, v129
  v_cvt_pk_bf16_f32 v171, v130, v131
  ds_write_b128 v176, v[168:171] offset:1024
  v_mfma_f32_16x16x32_bf16 v[96:99], v[164:167], a[0:3], 0
  v_xor_b32 v185, 2048, v176
  v_mfma_f32_16x16x32_bf16 v[100:103], v[164:167], a[4:7], 0
  v_xor_b32 v186, 4096, v176
  v_mfma_f32_16x16x32_bf16 v[104:107], v[164:167], a[8:11], 0
  v_xor_b32 v187, 6144, v176
  v_mfma_f32_16x16x32_bf16 v[108:111], v[164:167], a[12:15], 0
  v_mfma_f32_16x16x32_bf16 v[112:115], v[164:167], a[16:19], 0
  v_mfma_f32_16x16x32_bf16 v[116:119], v[164:167], a[20:23], 0
  s_waitcnt lgkmcnt(0)
  s_barrier
  ds_read_b128 v[32:35], v185 offset:0
  ds_read_b128 v[36:39], v185 offset:1024
  ds_read_b128 v[40:43], v186 offset:0
  ds_read_b128 v[44:47], v186 offset:1024
  ds_read_b128 v[48:51], v187 offset:0
  ds_read_b128 v[52:55], v187 offset:1024
  v_mfma_f32_16x16x32_bf16 v[120:123], v[164:167], a[24:27], 0
  v_mfma_f32_16x16x32_bf16 v[124:127], v[164:167], a[28:31], 0
  v_mfma_f32_16x16x32_bf16 v[96:99], v[168:171], a[32:35], v[96:99]
  v_mfma_f32_16x16x32_bf16 v[100:103], v[168:171], a[36:39], v[100:103]
  v_mfma_f32_16x16x32_bf16 v[104:107], v[168:171], a[40:43], v[104:107]
  v_mfma_f32_16x16x32_bf16 v[108:111], v[168:171], a[44:47], v[108:111]
  v_mfma_f32_16x16x32_bf16 v[112:115], v[168:171], a[48:51], v[112:115]
  v_mfma_f32_16x16x32_bf16 v[116:119], v[168:171], a[52:55], v[116:119]
  v_mfma_f32_16x16x32_bf16 v[120:123], v[168:171], a[56:59], v[120:123]
  v_mfma_f32_16x16x32_bf16 v[124:127], v[168:171], a[60:63], v[124:127]
  s_waitcnt lgkmcnt(5)
  v_mfma_f32_16x16x32_bf16 v[96:99], v[32:35], a[64:67], v[96:99]
  v_mfma_f32_16x16x32_bf16 v[100:103], v[32:35], a[68:71], v[100:103]
  s_waitcnt lgkmcnt(4)
  v_mfma_f32_16x16x32_bf16 v[96:99], v[36:39], a[96:99], v[96:99]
  v_mfma_f32_16x16x32_bf16 v[100:103], v[36:39], a[100:103], v[100:103]
  v_mfma_f32_16x16x32_bf16 v[104:107], v[32:35], a[72:75], v[104:107]
  v_mfma_f32_16x16x32_bf16 v[108:111], v[32:35], a[76:79], v[108:111]
  v_cvt_pk_bf16_f32 v64, v96, v100
  v_cvt_pk_bf16_f32 v68, v97, v101
  v_mfma_f32_16x16x32_bf16 v[104:107], v[36:39], a[104:107], v[104:107]
  v_cvt_pk_bf16_f32 v72, v98, v102
  v_cvt_pk_bf16_f32 v76, v99, v103
  v_mfma_f32_16x16x32_bf16 v[108:111], v[36:39], a[108:111], v[108:111]
  v_bfi_b32 v64, v9, s82, v64
  v_bfi_b32 v68, v9, s82, v68
  v_mfma_f32_16x16x32_bf16 v[112:115], v[32:35], a[80:83], v[112:115]
  v_bfi_b32 v72, v9, s82, v72
  v_bfi_b32 v76, v9, s82, v76
  v_mfma_f32_16x16x32_bf16 v[116:119], v[32:35], a[84:87], v[116:119]
  v_cvt_pk_bf16_f32 v65, v104, v108
  v_cvt_pk_bf16_f32 v69, v105, v109
  v_mfma_f32_16x16x32_bf16 v[112:115], v[36:39], a[112:115], v[112:115]
  v_cvt_pk_bf16_f32 v73, v106, v110
  v_cvt_pk_bf16_f32 v77, v107, v111
  v_mfma_f32_16x16x32_bf16 v[116:119], v[36:39], a[116:119], v[116:119]
  s_add_u32 s28, s12, 0
  buffer_store_dwordx2 v[64:65], v8, s[8:11], s28 offen offset:0
  v_mfma_f32_16x16x32_bf16 v[120:123], v[32:35], a[88:91], v[120:123]
  s_add_u32 s28, s12, 32768
  buffer_store_dwordx2 v[68:69], v8, s[8:11], s28 offen offset:0
  v_mfma_f32_16x16x32_bf16 v[124:127], v[32:35], a[92:95], v[124:127]
  v_cvt_pk_bf16_f32 v66, v112, v116
  v_cvt_pk_bf16_f32 v70, v113, v117
  s_add_u32 s28, s12, 65536
  buffer_store_dwordx2 v[72:73], v8, s[8:11], s28 offen offset:0
  v_mfma_f32_16x16x32_bf16 v[120:123], v[36:39], a[120:123], v[120:123]
  v_cvt_pk_bf16_f32 v74, v114, v118
  v_cvt_pk_bf16_f32 v78, v115, v119
  s_add_u32 s28, s12, 98304
  buffer_store_dwordx2 v[76:77], v8, s[8:11], s28 offen offset:0
  v_mfma_f32_16x16x32_bf16 v[124:127], v[36:39], a[124:127], v[124:127]
  v_bfi_b32 v66, v9, s82, v66
  v_bfi_b32 v70, v9, s82, v70
  s_cmp_lg_u32 s86, 0
  s_cbranch_scc1 L_ph_128
  s_waitcnt lgkmcnt(3)
  v_mfma_f32_16x16x32_bf16 v[148:151], v[40:43], a[0:3], 0
  v_bfi_b32 v74, v9, s82, v74
  v_bfi_b32 v78, v9, s82, v78
  v_mfma_f32_16x16x32_bf16 v[152:155], v[40:43], a[4:7], 0
  v_cvt_pk_bf16_f32 v67, v120, v124
  v_cvt_pk_bf16_f32 v71, v121, v125
  s_waitcnt lgkmcnt(2)
  v_mfma_f32_16x16x32_bf16 v[148:151], v[44:47], a[32:35], v[148:151]
  v_cvt_pk_bf16_f32 v75, v122, v126
  v_cvt_pk_bf16_f32 v79, v123, v127
  v_mfma_f32_16x16x32_bf16 v[152:155], v[44:47], a[36:39], v[152:155]
  s_waitcnt lgkmcnt(1)
  v_mfma_f32_16x16x32_bf16 v[148:151], v[48:51], a[64:67], v[148:151]
  s_add_u32 s28, s12, 0
  buffer_store_dwordx2 v[66:67], v8, s[8:11], s28 offen offset:128
  v_mfma_f32_16x16x32_bf16 v[152:155], v[48:51], a[68:71], v[152:155]
  s_waitcnt lgkmcnt(0)
  v_mfma_f32_16x16x32_bf16 v[148:151], v[52:55], a[96:99], v[148:151]
  v_mfma_f32_16x16x32_bf16 v[152:155], v[52:55], a[100:103], v[152:155]
  s_add_u32 s28, s12, 32768
  buffer_store_dwordx2 v[70:71], v8, s[8:11], s28 offen offset:128
  v_mfma_f32_16x16x32_bf16 v[156:159], v[40:43], a[8:11], 0
  v_mfma_f32_16x16x32_bf16 v[160:163], v[40:43], a[12:15], 0
  v_cvt_pk_bf16_f32 v80, v148, v152
  v_cvt_pk_bf16_f32 v84, v149, v153
  v_mfma_f32_16x16x32_bf16 v[156:159], v[44:47], a[40:43], v[156:159]
  s_add_u32 s28, s12, 65536
  buffer_store_dwordx2 v[74:75], v8, s[8:11], s28 offen offset:128
  v_cvt_pk_bf16_f32 v88, v150, v154
  v_cvt_pk_bf16_f32 v92, v151, v155
  v_mfma_f32_16x16x32_bf16 v[160:163], v[44:47], a[44:47], v[160:163]
  v_bfi_b32 v80, v9, s82, v80
  v_bfi_b32 v84, v9, s82, v84
  v_mfma_f32_16x16x32_bf16 v[156:159], v[48:51], a[72:75], v[156:159]
  v_mfma_f32_16x16x32_bf16 v[160:163], v[48:51], a[76:79], v[160:163]
  s_add_u32 s28, s12, 98304
  buffer_store_dwordx2 v[78:79], v8, s[8:11], s28 offen offset:128
  v_bfi_b32 v88, v9, s82, v88
  v_bfi_b32 v92, v9, s82, v92
  v_mfma_f32_16x16x32_bf16 v[156:159], v[52:55], a[104:107], v[156:159]
  v_mfma_f32_16x16x32_bf16 v[160:163], v[52:55], a[108:111], v[160:163]
  v_mfma_f32_16x16x32_bf16 v[148:151], v[40:43], a[16:19], 0
  v_mfma_f32_16x16x32_bf16 v[152:155], v[40:43], a[20:23], 0
  v_cvt_pk_bf16_f32 v81, v156, v160
  v_cvt_pk_bf16_f32 v85, v157, v161
  v_mfma_f32_16x16x32_bf16 v[148:151], v[44:47], a[48:51], v[148:151]
  v_cvt_pk_bf16_f32 v89, v158, v162
  v_cvt_pk_bf16_f32 v93, v159, v163
  v_mfma_f32_16x16x32_bf16 v[152:155], v[44:47], a[52:55], v[152:155]
  s_add_u32 s28, s13, 0
  buffer_store_dwordx2 v[80:81], v8, s[8:11], s28 offen offset:0
  v_mfma_f32_16x16x32_bf16 v[148:151], v[48:51], a[80:83], v[148:151]
  v_mfma_f32_16x16x32_bf16 v[152:155], v[48:51], a[84:87], v[152:155]
  s_add_u32 s28, s13, 32768
  buffer_store_dwordx2 v[84:85], v8, s[8:11], s28 offen offset:0
  v_mfma_f32_16x16x32_bf16 v[148:151], v[52:55], a[112:115], v[148:151]
  v_mfma_f32_16x16x32_bf16 v[152:155], v[52:55], a[116:119], v[152:155]
  s_add_u32 s28, s13, 65536
  buffer_store_dwordx2 v[88:89], v8, s[8:11], s28 offen offset:0
  v_mfma_f32_16x16x32_bf16 v[156:159], v[40:43], a[24:27], 0
  v_mfma_f32_16x16x32_bf16 v[160:163], v[40:43], a[28:31], 0
  v_cvt_pk_bf16_f32 v82, v148, v152
  v_cvt_pk_bf16_f32 v86, v149, v153
  s_add_u32 s28, s13, 98304
  buffer_store_dwordx2 v[92:93], v8, s[8:11], s28 offen offset:0
  v_mfma_f32_16x16x32_bf16 v[156:159], v[44:47], a[56:59], v[156:159]
  v_cvt_pk_bf16_f32 v90, v150, v154
  v_cvt_pk_bf16_f32 v94, v151, v155
  v_mfma_f32_16x16x32_bf16 v[160:163], v[44:47], a[60:63], v[160:163]
  v_bfi_b32 v82, v9, s82, v82
  v_bfi_b32 v86, v9, s82, v86
  v_mfma_f32_16x16x32_bf16 v[156:159], v[48:51], a[88:91], v[156:159]
  v_bfi_b32 v90, v9, s82, v90
  v_bfi_b32 v94, v9, s82, v94
  v_mfma_f32_16x16x32_bf16 v[160:163], v[48:51], a[92:95], v[160:163]
  v_mfma_f32_16x16x32_bf16 v[156:159], v[52:55], a[120:123], v[156:159]
  v_mfma_f32_16x16x32_bf16 v[160:163], v[52:55], a[124:127], v[160:163]
  s_nop 7
  v_cvt_pk_bf16_f32 v83, v156, v160
  s_add_u32 s28, s13, 0
  buffer_store_dwordx2 v[82:83], v8, s[8:11], s28 offen offset:128
  v_cvt_pk_bf16_f32 v87, v157, v161
  s_add_u32 s28, s13, 32768
  buffer_store_dwordx2 v[86:87], v8, s[8:11], s28 offen offset:128
  v_cvt_pk_bf16_f32 v91, v158, v162
  s_add_u32 s28, s13, 65536
  buffer_store_dwordx2 v[90:91], v8, s[8:11], s28 offen offset:128
  v_cvt_pk_bf16_f32 v95, v159, v163
  s_add_u32 s28, s13, 98304
  buffer_store_dwordx2 v[94:95], v8, s[8:11], s28 offen offset:128
L_pj_127:
  s_cmp_eq_u32 s92, 0
  s_cbranch_scc1 L_norow_129
  v_and_b32 v141, 0xffff0000, v138
  v_lshlrev_b32 v140, 16, v138
  v_and_b32 v143, 0xffff0000, v139
  v_lshlrev_b32 v142, 16, v139
  s_mov_b32 s30, 0x3c000000
  v_mov_b32 v183, 12288
  s_lshl_b32 s33, s4, 15
  s_add_u32 s33, s33, s80
  v_mov_b32 v181, s81
  v_cndmask_b32 v181, v181, 0, s[94:95]
  s_sleep 4
  s_mov_b32 s34, 0
  s_mov_b32 s35, 8
L_rd_131:
  s_add_u32 s28, s33, 0
  buffer_load_dwordx4 v[32:35], v6, s[8:11], s28 offen sc1
  s_add_u32 s28, s33, 4096
  buffer_load_dwordx4 v[36:39], v6, s[8:11], s28 offen sc1
  s_add_u32 s28, s33, 8192
  buffer_load_dwordx4 v[40:43], v6, s[8:11], s28 offen sc1
  s_add_u32 s28, s33, 12288
  buffer_load_dwordx4 v[44:47], v6, s[8:11], s28 offen sc1
  s_add_u32 s28, s33, 16384
  buffer_load_dwordx4 v[48:51], v6, s[8:11], s28 offen sc1
  s_add_u32 s28, s33, 20480
  buffer_load_dwordx4 v[52:55], v6, s[8:11], s28 offen sc1
  s_add_u32 s28, s33, 24576
  buffer_load_dwordx4 v[56:59], v6, s[8:11], s28 offen sc1
  s_add_u32 s28, s33, 28672
  buffer_load_dwordx4 v[60:63], v6, s[8:11], s28 offen sc1
  s_add_u32 s34, s34, 1
  s_cmp_gt_u32 s34, 40000
  s_cbranch_scc1 L_fail
  s_waitcnt vmcnt(7)
  v_xor_b32 v180, 0, v32
  v_mfma_f32_16x16x32_bf16 v[172:175], v[32:35], v[144:147], 0
  s_waitcnt vmcnt(6)
  v_bitop3_b32 v180, v36, 0, v180 bitop3:0xbe
  v_mfma_f32_16x16x32_bf16 v[172:175], v[36:39], v[144:147], v[172:175]
  s_waitcnt vmcnt(5)
  v_bitop3_b32 v180, v40, 0, v180 bitop3:0xbe
  v_mfma_f32_16x16x32_bf16 v[172:175], v[40:43], v[144:147], v[172:175]
  s_waitcnt vmcnt(4)
  v_bitop3_b32 v180, v44, 0, v180 bitop3:0xbe
  v_mfma_f32_16x16x32_bf16 v[172:175], v[44:47], v[144:147], v[172:175]
  s_waitcnt vmcnt(3)
  v_bitop3_b32 v180, v48, 0, v180 bitop3:0xbe
  v_mfma_f32_16x16x32_bf16 v[172:175], v[48:51], v[144:147], v[172:175]
  s_waitcnt vmcnt(2)
  v_bitop3_b32 v180, v52, v181, v180 bitop3:0xbe
  v_mfma_f32_16x16x32_bf16 v[172:175], v[52:55], v[144:147], v[172:175]
  s_waitcnt vmcnt(1)
  v_bitop3_b32 v180, v56, s81, v180 bitop3:0xbe
  v_mfma_f32_16x16x32_bf16 v[172:175], v[56:59], v[144:147], v[172:175]
  s_waitcnt vmcnt(0)
  v_bitop3_b32 v180, v60, s81, v180 bitop3:0xbe
  v_mfma_f32_16x16x32_bf16 v[172:175], v[60:63], v[144:147], v[172:175]
  v_and_b32 v180, 1, v180
  v_cmp_ne_u32 vcc, 0, v180
  s_cbranch_vccnz L_rd_131
  s_nop 4
  v_cvt_pk_bf16_f32 v172, v172, v173
  v_and_b32 v173, 0xffff0000, v172
  v_lshlrev_b32 v172, 16, v172
  v_cvt_pk_bf16_f32 v174, v174, v175
  v_and_b32 v175, 0xffff0000, v174
  v_lshlrev_b32 v174, 16, v174
  v_pk_add_f32 v[140:141], v[140:141], v[172:173]
  v_pk_add_f32 v[142:143], v[142:143], v[174:175]
  v_cvt_pk_bf16_f32 v140, v140, v141
  v_and_b32 v141, 0xffff0000, v140
  v_lshlrev_b32 v140, 16, v140
  v_cvt_pk_bf16_f32 v142, v142, v143
  v_readfirstlane_b32 s28, v140
  v_and_b32 v143, 0xffff0000, v142
  v_lshlrev_b32 v142, 16, v142
  v_pk_add_f32 v[172:173], v[140:141], s[28:29] op_sel_hi:[1,0] neg_lo:[0,1] neg_hi:[0,1]
  v_pk_add_f32 v[174:175], v[142:143], s[28:29] op_sel_hi:[1,0] neg_lo:[0,1] neg_hi:[0,1]
  v_mov_b32 v182, s28
  v_pk_add_f32 v[184:185], v[172:173], v[174:175]
  v_pk_mul_f32 v[186:187], v[172:173], v[172:173]
  ds_write_b32 v178, v182 offset:32
  v_pk_fma_f32 v[186:187], v[174:175], v[174:175], v[186:187]
  v_add_f32 v180, v184, v185
  v_add_f32 v181, v186, v187
  s_nop 0
  v_add_f32_dpp v180, v180, v180 row_ror:4 row_mask:0xf bank_mask:0xf
  v_add_f32_dpp v181, v181, v181 row_ror:4 row_mask:0xf bank_mask:0xf
  s_nop 0
  v_add_f32_dpp v180, v180, v180 row_ror:2 row_mask:0xf bank_mask:0xf
  v_add_f32_dpp v181, v181, v181 row_ror:2 row_mask:0xf bank_mask:0xf
  s_nop 0
  v_add_f32_dpp v180, v180, v180 row_ror:1 row_mask:0xf bank_mask:0xf
  v_add_f32_dpp v181, v181, v181 row_ror:1 row_mask:0xf bank_mask:0xf
  s_nop 1
  v_permlane16_swap_b32 v180, v181
  v_add_f32 v180, v180, v181
  v_mov_b32 v182, v180
  s_nop 1
  v_permlane32_swap_b32 v180, v182
  v_add_f32 v180, v180, v182
  ds_write_b32 v178, v180
  s_waitcnt lgkmcnt(0)
  s_barrier
  ds_read_b128 v[32:35], v183 offset:0
  ds_read_b128 v[36:39], v183 offset:16
  ds_read_b128 v[40:43], v183 offset:32
  s_waitcnt lgkmcnt(2)
  v_pk_mul_f32 v[184:185], v[32:33], s[30:31] op_sel_hi:[1,0]
  v_pk_mul_f32 v[186:187], v[34:35], s[30:31] op_sel_hi:[1,0]
  s_waitcnt lgkmcnt(1)
  v_pk_fma_f32 v[36:37], v[184:185], v[32:33], v[36:37] neg_lo:[1,0,0] neg_hi:[1,0,0]
  v_pk_fma_f32 v[38:39], v[186:187], v[34:35], v[38:39] neg_lo:[1,0,0] neg_hi:[1,0,0]
  s_waitcnt lgkmcnt(0)
  v_pk_add_f32 v[40:41], v[40:41], v[184:185]
  v_pk_add_f32 v[42:43], v[42:43], v[186:187]
  v_pk_add_f32 v[36:37], v[36:37], v[38:39]
  v_pk_add_f32 v[184:185], v[40:41], v[42:43]
  v_add_f32 v181, v36, v37
  v_add_f32 v180, v184, v185
  v_mul_f32 v180, 0x3e800000, v180
  v_pk_add_f32 v[40:41], v[40:41], v[180:181] op_sel_hi:[1,0] neg_lo:[0,1] neg_hi:[0,1]
  v_pk_add_f32 v[42:43], v[42:43], v[180:181] op_sel_hi:[1,0] neg_lo:[0,1] neg_hi:[0,1]
  v_pk_mul_f32 v[40:41], v[40:41], v[40:41]
  v_pk_fma_f32 v[40:41], v[42:43], v[42:43], v[40:41]
  v_cvt_pk_bf16_f32 v180, v180, v180
  v_and_b32 v180, 0xffff0000, v180
  v_add_f32 v182, v40, v41
  v_fmac_f32 v181, 0x43000000, v182
  v_mul_f32 v181, 0x3b000000, v181
  v_max_f32 v181, 0, v181
  v_cvt_pk_bf16_f32 v181, v181, v181
  v_and_b32 v181, 0xffff0000, v181
  v_add_f32 v181, 0x3727c5ac, v181
  v_cvt_pk_bf16_f32 v181, v181, v181
  v_and_b32 v181, 0xffff0000, v181
  v_sqrt_f32 v182, v181
  v_pk_add_f32 v[184:185], v[140:141], v[180:181] op_sel_hi:[1,0] neg_lo:[0,1] neg_hi:[0,1]
  v_pk_add_f32 v[186:187], v[142:143], v[180:181] op_sel_hi:[1,0] neg_lo:[0,1] neg_hi:[0,1]
  v_cvt_pk_bf16_f32 v182, v182, v182
  v_and_b32 v182, 0xffff0000, v182
  v_rcp_f32 v182, v182
  v_cvt_pk_bf16_f32 v184, v184, v185
  v_and_b32 v185, 0xffff0000, v184
  v_lshlrev_b32 v184, 16, v184
  v_cvt_pk_bf16_f32 v186, v186, v187
  v_and_b32 v187, 0xffff0000, v186
  v_lshlrev_b32 v186, 16, v186
  v_pk_mul_f32 v[184:185], v[184:185], v[182:183] op_sel_hi:[1,0]
  v_pk_mul_f32 v[186:187], v[186:187], v[182:183] op_sel_hi:[1,0]
  v_cvt_pk_bf16_f32 v172, v184, v185
  v_min_u32 v172, -2, v172
  v_cvt_pk_bf16_f32 v173, v186, v187
  v_min_u32 v173, -2, v173
  s_add_u32 s28, s88, 0x300000
  buffer_store_dwordx2 v[172:173], v179, s[8:11], s28 offen
L_norow_129:
  s_cmp_ge_u32 s4, 22
  s_cbranch_scc1 L_noffn_132
  s_lshl_b32 s33, s85, 15
  s_add_u32 s33, s33, 0x300000
  s_lshl_b32 s28, s5, 13
  s_add_u32 s33, s33, s28
  s_add_u32 s32, s33, 4096
  s_cmp_eq_u32 s99, 0
  s_cbranch_scc1 L_nohl_133
  s_sleep 3
  s_mov_b32 s34, 0
  s_mov_b32 s35, 9
L_hl_134:
  buffer_load_dwordx4 v[32:35], v1, s[8:11], s33 offen offset:0 sc1
  buffer_load_dwordx4 v[36:39], v1, s[8:11], s33 offen offset:1024 sc1
  buffer_load_dwordx4 v[40:43], v1, s[8:11], s33 offen offset:2048 sc1
  buffer_load_dwordx4 v[44:47], v1, s[8:11], s33 offen offset:3072 sc1
  buffer_load_dwordx4 v[48:51], v1, s[8:11], s32 offen offset:0 sc1
  buffer_load_dwordx4 v[52:55], v1, s[8:11], s32 offen offset:1024 sc1
  buffer_load_dwordx4 v[56:59], v1, s[8:11], s32 offen offset:2048 sc1
  buffer_load_dwordx4 v[60:63], v1, s[8:11], s32 offen offset:3072 sc1
  s_add_u32 s34, s34, 1
  s_cmp_gt_u32 s34, 40000
  s_cbranch_scc1 L_fail
  s_waitcnt vmcnt(5)
  v_max3_u32 v180, v32, v36, v40
  s_waitcnt vmcnt(3)
  v_max3_u32 v180, v180, v44, v48
  ds_write_b128 v11, v[32:35] offset:0
  ds_write_b128 v11, v[36:39] offset:1040
  ds_write_b128 v11, v[40:43] offset:2080
  ds_write_b128 v11, v[44:47] offset:3120
  s_waitcnt vmcnt(1)
  v_max3_u32 v180, v180, v52, v56
  s_waitcnt vmcnt(0)
  v_max_u32 v180, v180, v60
  v_cmp_eq_u32 vcc, -1, v180
  s_cbranch_vccnz L_hl_134
  ds_write_b128 v11, v[48:51] offset:4160
  ds_write_b128 v11, v[52:55] offset:5200
  ds_write_b128 v11, v[56:59] offset:6240
  ds_write_b128 v11, v[60:63] offset:7280
L_nohl_133:
  s_waitcnt lgkmcnt(0)
  s_barrier
  ds_read_b128 v[32:35], v12 offset:0
  ds_read_b128 v[36:39], v12 offset:64
  ds_read_b128 v[40:43], v12 offset:128
  ds_read_b128 v[44:47], v12 offset:192
  ds_read_b128 v[48:51], v12 offset:256
  ds_read_b128 v[52:55], v12 offset:320
  ds_read_b128 v[56:59], v12 offset:384
  ds_read_b128 v[60:63], v12 offset:448
  s_waitcnt lgkmcnt(7)
  v_mfma_f32_16x16x32_bf16 v[148:151], a[128:131], v[32:35], 0
  v_mfma_f32_16x16x32_bf16 v[152:155], a[136:139], v[32:35], 0
  ds_read_b128 v[32:35], v12 offset:512
  s_waitcnt lgkmcnt(7)
  v_mfma_f32_16x16x32_bf16 v[148:151], a[132:135], v[36:39], v[148:151]
  v_mfma_f32_16x16x32_bf16 v[152:155], a[140:143], v[36:39], v[152:155]
  ds_read_b128 v[36:39], v12 offset:576
  s_waitcnt lgkmcnt(7)
  v_mfma_f32_16x16x32_bf16 v[148:151], a[144:147], v[40:43], v[148:151]
  v_mfma_f32_16x16x32_bf16 v[152:155], a[152:155], v[40:43], v[152:155]
  ds_read_b128 v[40:43], v12 offset:640
  s_waitcnt lgkmcnt(7)
  v_mfma_f32_16x16x32_bf16 v[148:151], a[148:151], v[44:47], v[148:151]
  v_mfma_f32_16x16x32_bf16 v[152:155], a[156:159], v[44:47], v[152:155]
  ds_read_b128 v[44:47], v12 offset:704
  s_waitcnt lgkmcnt(7)
  v_mfma_f32_16x16x32_bf16 v[148:151], a[160:163], v[48:51], v[148:151]
  v_mfma_f32_16x16x32_bf16 v[152:155], a[168:171], v[48:51], v[152:155]
  ds_read_b128 v[48:51], v12 offset:768
  s_waitcnt lgkmcnt(7)
  v_mfma_f32_16x16x32_bf16 v[148:151], a[164:167], v[52:55], v[148:151]
  v_mfma_f32_16x16x32_bf16 v[152:155], a[172:175], v[52:55], v[152:155]
  ds_read_b128 v[52:55], v12 offset:832
  s_waitcnt lgkmcnt(7)
  v_mfma_f32_16x16x32_bf16 v[148:151], a[176:179], v[56:59], v[148:151]
  v_mfma_f32_16x16x32_bf16 v[152:155], a[184:187], v[56:59], v[152:155]
  ds_read_b128 v[56:59], v12 offset:896
  s_waitcnt lgkmcnt(7)
  v_mfma_f32_16x16x32_bf16 v[148:151], a[180:183], v[60:63], v[148:151]
  v_mfma_f32_16x16x32_bf16 v[152:155], a[188:191], v[60:63], v[152:155]
  ds_read_b128 v[60:63], v12 offset:960
  s_waitcnt lgkmcnt(7)
  v_mfma_f32_16x16x32_bf16 v[148:151], a[192:195], v[32:35], v[148:151]
  v_mfma_f32_16x16x32_bf16 v[152:155], a[200:203], v[32:35], v[152:155]
  s_waitcnt lgkmcnt(6)
  v_mfma_f32_16x16x32_bf16 v[148:151], a[196:199], v[36:39], v[148:151]
  v_mfma_f32_16x16x32_bf16 v[152:155], a[204:207], v[36:39], v[152:155]
  s_waitcnt lgkmcnt(5)
  v_mfma_f32_16x16x32_bf16 v[148:151], a[208:211], v[40:43], v[148:151]
  v_mfma_f32_16x16x32_bf16 v[152:155], a[216:219], v[40:43], v[152:155]
  s_waitcnt lgkmcnt(4)
  v_mfma_f32_16x16x32_bf16 v[148:151], a[212:215], v[44:47], v[148:151]
  v_mfma_f32_16x16x32_bf16 v[152:155], a[220:223], v[44:47], v[152:155]
  s_waitcnt lgkmcnt(3)
  v_mfma_f32_16x16x32_bf16 v[148:151], a[224:227], v[48:51], v[148:151]
  v_mfma_f32_16x16x32_bf16 v[152:155], a[232:235], v[48:51], v[152:155]
  s_waitcnt lgkmcnt(2)
  v_mfma_f32_16x16x32_bf16 v[148:151], a[228:231], v[52:55], v[148:151]
  v_mfma_f32_16x16x32_bf16 v[152:155], a[236:239], v[52:55], v[152:155]
  s_waitcnt lgkmcnt(1)
  v_mfma_f32_16x16x32_bf16 v[148:151], a[240:243], v[56:59], v[148:151]
  v_mfma_f32_16x16x32_bf16 v[152:155], a[248:251], v[56:59], v[152:155]
  s_waitcnt lgkmcnt(0)
  v_mfma_f32_16x16x32_bf16 v[148:151], a[244:247], v[60:63], v[148:151]
  v_mfma_f32_16x16x32_bf16 v[152:155], a[252:255], v[60:63], v[152:155]
  s_nop 3
  v_max_f32 v148, 0, v148
  v_max_f32 v149, 0, v149
  v_max_f32 v150, 0, v150
  v_max_f32 v151, 0, v151
  v_max_f32 v152, 0, v152
  v_max_f32 v153, 0, v153
  v_max_f32 v154, 0, v154
  v_max_f32 v155, 0, v155
  v_cvt_pk_bf16_f32 v164, v148, v149
  v_cvt_pk_bf16_f32 v165, v150, v151
  v_cvt_pk_bf16_f32 v166, v152, v153
  v_cvt_pk_bf16_f32 v167, v154, v155
  ds_write_b128 v177, v[164:167]
  s_nop 0
  v_mfma_f32_16x16x32_bf16 v[96:99], v[164:167], v[192:195], 0
  v_xor_b32 v185, 1024, v177
  v_mfma_f32_16x16x32_bf16 v[100:103], v[164:167], v[196:199], 0
  v_xor_b32 v186, 2048, v177
  v_mfma_f32_16x16x32_bf16 v[104:107], v[164:167], v[200:203], 0
  v_xor_b32 v187, 3072, v177
  v_mfma_f32_16x16x32_bf16 v[108:111], v[164:167], v[204:207], 0
  s_waitcnt lgkmcnt(0)
  s_barrier
  ds_read_b128 v[32:35], v185 offset:0
  ds_read_b128 v[36:39], v186 offset:0
  ds_read_b128 v[40:43], v187 offset:0
  v_mfma_f32_16x16x32_bf16 v[112:115], v[164:167], v[208:211], 0
  v_mfma_f32_16x16x32_bf16 v[116:119], v[164:167], v[212:215], 0
  v_mfma_f32_16x16x32_bf16 v[120:123], v[164:167], v[216:219], 0
  v_mfma_f32_16x16x32_bf16 v[124:127], v[164:167], v[220:223], 0
  s_waitcnt lgkmcnt(2)
  v_mfma_f32_16x16x32_bf16 v[96:99], v[32:35], v[224:227], v[96:99]
  v_mfma_f32_16x16x32_bf16 v[100:103], v[32:35], v[228:231], v[100:103]
  v_mfma_f32_16x16x32_bf16 v[104:107], v[32:35], v[232:235], v[104:107]
  v_mfma_f32_16x16x32_bf16 v[108:111], v[32:35], v[236:239], v[108:111]
  v_cvt_pk_bf16_f32 v64, v96, v100
  v_cvt_pk_bf16_f32 v68, v97, v101
  v_mfma_f32_16x16x32_bf16 v[112:115], v[32:35], v[240:243], v[112:115]
  v_cvt_pk_bf16_f32 v72, v98, v102
  v_cvt_pk_bf16_f32 v76, v99, v103
  v_or_b32 v64, v9, v64
  v_mfma_f32_16x16x32_bf16 v[116:119], v[32:35], v[244:247], v[116:119]
  v_cvt_pk_bf16_f32 v65, v104, v108
  v_cvt_pk_bf16_f32 v69, v105, v109
  v_or_b32 v68, v9, v68
  v_mfma_f32_16x16x32_bf16 v[120:123], v[32:35], v[248:251], v[120:123]
  v_cvt_pk_bf16_f32 v73, v106, v110
  v_cvt_pk_bf16_f32 v77, v107, v111
  v_or_b32 v72, v9, v72
  v_or_b32 v76, v9, v76
  s_add_u32 s28, s12, 0
  buffer_store_dwordx2 v[64:65], v8, s[8:11], s28 offen offset:0
  v_mfma_f32_16x16x32_bf16 v[124:127], v[32:35], v[252:255], v[124:127]
  v_cvt_pk_bf16_f32 v66, v112, v116
  v_cvt_pk_bf16_f32 v70, v113, v117
  v_or_b32 v66, v9, v66
  v_or_b32 v70, v9, v70
  s_add_u32 s28, s12, 32768
  buffer_store_dwordx2 v[68:69], v8, s[8:11], s28 offen offset:0
  s_cmp_lg_u32 s86, 0
  s_cbranch_scc1 L_ph_136
  s_waitcnt lgkmcnt(1)
  v_mfma_f32_16x16x32_bf16 v[148:151], v[36:39], v[192:195], 0
  v_cvt_pk_bf16_f32 v74, v114, v118
  v_cvt_pk_bf16_f32 v78, v115, v119
  v_or_b32 v74, v9, v74
  v_or_b32 v78, v9, v78
  s_add_u32 s28, s12, 65536
  buffer_store_dwordx2 v[72:73], v8, s[8:11], s28 offen offset:0
  v_mfma_f32_16x16x32_bf16 v[152:155], v[36:39], v[196:199], 0
  v_cvt_pk_bf16_f32 v67, v120, v124
  v_cvt_pk_bf16_f32 v71, v121, v125
  s_add_u32 s28, s12, 98304
  buffer_store_dwordx2 v[76:77], v8, s[8:11], s28 offen offset:0
  s_waitcnt lgkmcnt(0)
  v_mfma_f32_16x16x32_bf16 v[148:151], v[40:43], v[224:227], v[148:151]
  v_cvt_pk_bf16_f32 v75, v122, v126
  v_cvt_pk_bf16_f32 v79, v123, v127
  v_mfma_f32_16x16x32_bf16 v[152:155], v[40:43], v[228:231], v[152:155]
  s_add_u32 s28, s12, 0
  buffer_store_dwordx2 v[66:67], v8, s[8:11], s28 offen offset:128
  v_mfma_f32_16x16x32_bf16 v[156:159], v[36:39], v[200:203], 0
  s_add_u32 s28, s12, 32768
  buffer_store_dwordx2 v[70:71], v8, s[8:11], s28 offen offset:128
  v_mfma_f32_16x16x32_bf16 v[160:163], v[36:39], v[204:207], 0
  v_cvt_pk_bf16_f32 v80, v148, v152
  v_cvt_pk_bf16_f32 v84, v149, v153
  v_mfma_f32_16x16x32_bf16 v[156:159], v[40:43], v[232:235], v[156:159]
  v_cvt_pk_bf16_f32 v88, v150, v154
  v_cvt_pk_bf16_f32 v92, v151, v155
  v_mfma_f32_16x16x32_bf16 v[160:163], v[40:43], v[236:239], v[160:163]
  s_add_u32 s28, s12, 65536
  buffer_store_dwordx2 v[74:75], v8, s[8:11], s28 offen offset:128
  v_or_b32 v80, v9, v80
  v_or_b32 v84, v9, v84
  v_mfma_f32_16x16x32_bf16 v[148:151], v[36:39], v[208:211], 0
  s_add_u32 s28, s12, 98304
  buffer_store_dwordx2 v[78:79], v8, s[8:11], s28 offen offset:128
  v_or_b32 v88, v9, v88
  v_or_b32 v92, v9, v92
  v_mfma_f32_16x16x32_bf16 v[152:155], v[36:39], v[212:215], 0
  v_cvt_pk_bf16_f32 v81, v156, v160
  v_cvt_pk_bf16_f32 v85, v157, v161
  v_mfma_f32_16x16x32_bf16 v[148:151], v[40:43], v[240:243], v[148:151]
  v_cvt_pk_bf16_f32 v89, v158, v162
  v_cvt_pk_bf16_f32 v93, v159, v163
  v_mfma_f32_16x16x32_bf16 v[152:155], v[40:43], v[244:247], v[152:155]
  s_add_u32 s28, s13, 0
  buffer_store_dwordx2 v[80:81], v8, s[8:11], s28 offen offset:0
  s_add_u32 s28, s13, 32768
  buffer_store_dwordx2 v[84:85], v8, s[8:11], s28 offen offset:0
  v_mfma_f32_16x16x32_bf16 v[156:159], v[36:39], v[216:219], 0
  s_add_u32 s28, s13, 65536
  buffer_store_dwordx2 v[88:89], v8, s[8:11], s28 offen offset:0
  s_add_u32 s28, s13, 98304
  buffer_store_dwordx2 v[92:93], v8, s[8:11], s28 offen offset:0
  v_mfma_f32_16x16x32_bf16 v[160:163], v[36:39], v[220:223], 0
  v_cvt_pk_bf16_f32 v82, v148, v152
  v_cvt_pk_bf16_f32 v86, v149, v153
  v_mfma_f32_16x16x32_bf16 v[156:159], v[40:43], v[248:251], v[156:159]
  v_cvt_pk_bf16_f32 v90, v150, v154
  v_cvt_pk_bf16_f32 v94, v151, v155
  v_or_b32 v82, v9, v82
  v_or_b32 v86, v9, v86
  v_mfma_f32_16x16x32_bf16 v[160:163], v[40:43], v[252:255], v[160:163]
  v_or_b32 v90, v9, v90
  v_or_b32 v94, v9, v94
  s_nop 5
  v_cvt_pk_bf16_f32 v83, v156, v160
  s_add_u32 s28, s13, 0
  buffer_store_dwordx2 v[82:83], v8, s[8:11], s28 offen offset:128
  v_cvt_pk_bf16_f32 v87, v157, v161
  s_add_u32 s28, s13, 32768
  buffer_store_dwordx2 v[86:87], v8, s[8:11], s28 offen offset:128
  v_cvt_pk_bf16_f32 v91, v158, v162
  s_add_u32 s28, s13, 65536
  buffer_store_dwordx2 v[90:91], v8, s[8:11], s28 offen offset:128
  v_cvt_pk_bf16_f32 v95, v159, v163
  s_add_u32 s28, s13, 98304
  buffer_store_dwordx2 v[94:95], v8, s[8:11], s28 offen offset:128
L_pj_135:
L_noffn_132:
  s_cmp_eq_u32 s92, 0
  s_cbranch_scc1 L_norow2_130
  s_lshl_b32 s33, s4, 15
  s_add_u32 s33, s33, s80
  s_sleep 4
  s_mov_b32 s34, 0
  s_mov_b32 s35, 10
L_rd_137:
  s_add_u32 s28, s33, 0
  buffer_load_dwordx4 v[32:35], v6, s[8:11], s28 offen sc1
  s_add_u32 s28, s33, 4096
  buffer_load_dwordx4 v[36:39], v6, s[8:11], s28 offen sc1
  s_add_u32 s28, s33, 8192
  buffer_load_dwordx4 v[40:43], v6, s[8:11], s28 offen sc1
  s_add_u32 s28, s33, 12288
  buffer_load_dwordx4 v[44:47], v6, s[8:11], s28 offen sc1
  s_add_u32 s28, s33, 16384
  buffer_load_dwordx4 v[48:51], v6, s[8:11], s28 offen sc1
  s_add_u32 s28, s33, 20480
  buffer_load_dwordx4 v[52:55], v7, s[8:11], s28 offen sc1
  s_add_u32 s34, s34, 1
  s_cmp_gt_u32 s34, 40000
  s_cbranch_scc1 L_fail
  s_waitcnt vmcnt(5)
  v_xor_b32 v180, 1, v32
  v_mfma_f32_16x16x32_bf16 v[172:175], v[32:35], v[144:147], 0
  s_waitcnt vmcnt(4)
  v_bitop3_b32 v180, v36, 1, v180 bitop3:0xbe
  v_mfma_f32_16x16x32_bf16 v[172:175], v[36:39], v[144:147], v[172:175]
  s_waitcnt vmcnt(3)
  v_bitop3_b32 v180, v40, 1, v180 bitop3:0xbe
  v_mfma_f32_16x16x32_bf16 v[172:175], v[40:43], v[144:147], v[172:175]
  s_waitcnt vmcnt(2)
  v_bitop3_b32 v180, v44, 1, v180 bitop3:0xbe
  v_mfma_f32_16x16x32_bf16 v[172:175], v[44:47], v[144:147], v[172:175]
  s_waitcnt vmcnt(1)
  v_bitop3_b32 v180, v48, 1, v180 bitop3:0xbe
  v_mfma_f32_16x16x32_bf16 v[172:175], v[48:51], v[144:147], v[172:175]
  s_mov_b32 exec_hi, 0
  s_waitcnt vmcnt(0)
  v_bitop3_b32 v180, v52, 1, v180 bitop3:0xbe
  s_mov_b64 exec, -1
  v_mfma_f32_16x16x32_bf16 v[172:175], v[52:55], v[144:147], v[172:175]
  v_and_b32 v180, 1, v180
  v_cmp_ne_u32 vcc, 0, v180
  s_cbranch_vccnz L_rd_137
  s_nop 4
  v_cvt_pk_bf16_f32 v172, v172, v173
  v_and_b32 v173, 0xffff0000, v172
  v_lshlrev_b32 v172, 16, v172
  v_cvt_pk_bf16_f32 v174, v174, v175
  v_and_b32 v175, 0xffff0000, v174
  v_lshlrev_b32 v174, 16, v174
  v_add_f32 v172, v172, v140
  v_add_f32 v173, v173, v141
  v_add_f32 v174, v174, v142
  v_add_f32 v175, v175, v143
  v_cvt_pk_bf16_f32 v172, v172, v173
  v_cvt_pk_bf16_f32 v173, v174, v175
  buffer_store_dwordx2 v[172:173], v179, s[20:23], s88 offen
L_norow2_130:
  s_xor_b32 s80, s80, 0x1800000
  s_xor_b32 s12, s12, 0x1800000
  s_xor_b32 s13, s13, 0x1800000
  s_add_u32 s63, s63, 1
  s_add_u32 s85, s85, s87
  s_cmp_lt_u32 s63, s84
  s_cbranch_scc1 L_wf_loop
  s_waitcnt vmcnt(0)
  s_lshl_b32 s28, 1, s3
  s_and_b32 s28, s28, 112
  s_cbranch_scc0 L_end
  s_lshl_b32 s28, s4, 2
  s_add_u32 s28, s28, s5
  s_cmp_lg_u32 s28, 0
  s_cbranch_scc1 L_end
  buffer_wbl2 sc1
  s_waitcnt vmcnt(0)
  s_endpgm
L_pf_123:
  s_cmp_eq_u32 s85, 63
  s_cselect_b32 s28, 0x100000, 0
  s_sub_u32 s83, s83, s28
  s_lshl_b32 s28, 1, s3
  s_and_b32 s28, s28, 8
  s_cbranch_scc1 L_fd_139
L_fp_138:
  buffer_load_dword v184, off, s[8:11], s83 sc1
  s_add_u32 s34, s34, 1
  s_cmp_gt_u32 s34, 40000
  s_cbranch_scc1 L_fail
  s_waitcnt vmcnt(0)
  v_and_b32 v184, 1, v184
  v_cmp_eq_u32 vcc, 0, v184
  s_cbranch_vccz L_fd_139
  s_sleep 6
  s_branch L_fp_138
L_fd_139:
  buffer_load_dwordx4 v[32:35], v1, s[8:11], s93 offen sc1
L_fq_140:
  s_waitcnt vmcnt(0)
  v_and_b32 v182, 1, v32
  v_cmp_eq_u32 vcc, 0, v182
  s_cbranch_vccz L_fs_141
  buffer_load_dwordx4 v[32:35], v1, s[8:11], s93 offen sc1
  s_add_u32 s34, s34, 1
  s_cmp_gt_u32 s34, 40000
  s_cbranch_scc1 L_fail
  s_branch L_fq_140
L_fs_141:
  ds_write_b64 v2, v[32:33] offset:16384
  ds_write_b64 v4, v[34:35] offset:18432
  s_branch L_ok2_122
L_ph_128:
  v_bfi_b32 v74, v9, s82, v74
  v_bfi_b32 v78, v9, s82, v78
  s_nop 1
  v_cvt_pk_bf16_f32 v67, v120, v124
  s_add_u32 s28, s12, 0
  buffer_store_dwordx2 v[66:67], v8, s[8:11], s28 offen offset:128
  v_cvt_pk_bf16_f32 v71, v121, v125
  s_add_u32 s28, s12, 32768
  buffer_store_dwordx2 v[70:71], v8, s[8:11], s28 offen offset:128
  v_cvt_pk_bf16_f32 v75, v122, v126
  s_add_u32 s28, s12, 65536
  buffer_store_dwordx2 v[74:75], v8, s[8:11], s28 offen offset:128
  v_cvt_pk_bf16_f32 v79, v123, v127
  s_add_u32 s28, s12, 98304
  buffer_store_dwordx2 v[78:79], v8, s[8:11], s28 offen offset:128
  s_waitcnt lgkmcnt(0)
  s_branch L_pj_127
L_ph_136:
  s_add_u32 s28, s12, 65536
  buffer_store_dwordx2 v[72:73], v8, s[8:11], s28 offen offset:0
  s_add_u32 s28, s12, 98304
  buffer_store_dwordx2 v[76:77], v8, s[8:11], s28 offen offset:0
  v_cvt_pk_bf16_f32 v74, v114, v118
  v_cvt_pk_bf16_f32 v78, v115, v119
  v_or_b32 v74, v9, v74
  v_or_b32 v78, v9, v78
  v_cvt_pk_bf16_f32 v67, v120, v124
  s_add_u32 s28, s12, 0
  buffer_store_dwordx2 v[66:67], v8, s[8:11], s28 offen offset:128
  v_cvt_pk_bf16_f32 v71, v121, v125
  s_add_u32 s28, s12, 32768
  buffer_store_dwordx2 v[70:71], v8, s[8:11], s28 offen offset:128
  v_cvt_pk_bf16_f32 v75, v122, v126
  s_add_u32 s28, s12, 65536
  buffer_store_dwordx2 v[74:75], v8, s[8:11], s28 offen offset:128
  v_cvt_pk_bf16_f32 v79, v123, v127
  s_add_u32 s28, s12, 98304
  buffer_store_dwordx2 v[78:79], v8, s[8:11], s28 offen offset:128
  s_waitcnt lgkmcnt(0)
  s_branch L_pj_135
L_w2_slow:
  s_mov_b32 s64, s46
  s_mov_b32 s65, s47
  s_mov_b32 s66, 0x400000
  s_mov_b32 s67, 0x20000
  s_mov_b32 s68, s52
  s_mov_b32 s69, s53
  s_mov_b32 s70, 0x158000
  s_mov_b32 s71, 0x20000
  s_mov_b32 s72, s54
  s_mov_b32 s73, s55
  s_mov_b32 s74, 0x158000
  s_mov_b32 s75, 0x20000
  s_lshl_b32 s28, s4, 1
  s_and_b32 s29, s5, 1
  s_add_u32 s28, s28, s29
  s_cmp_lt_u32 s28, 43
  s_cselect_b32 s70, s70, 0
  s_lshl_b32 s88, s28, 6
  s_lshl_b32 s28, s4, 17
  s_lshl_b32 s29, s5, 8
  s_add_u32 s89, s28, s29
  s_lshl_b32 s28, s4, 16
  s_add_u32 s90, s28, s29
  v_lshrrev_b32 v13, 4, v0
  v_and_b32 v14, 15, v0
  v_lshlrev_b32 v2, 4, v14
  s_mul_i32 s28, s5, 8704
  s_add_u32 s28, s28, 24576
  s_mov_b32 s29, 272
  v_mad_u32_u24 v179, v13, s29, v2
  v_add_u32 v179, s28, v179
  v_lshl_add_u32 v2, v13, 10, v2
  v_lshrrev_b32 v13, 2, v0
  v_and_b32 v14, 3, v0
  v_lshlrev_b32 v14, 5, v14
  v_mad_u32_u24 v191, v13, s29, v14
  v_add_u32 v191, s28, v191
  v_lshrrev_b32 v13, 4, v0
  v_bfe_u32 v14, v0, 2, 2
  v_lshl_add_u32 v3, v13, 3, v14
  s_mov_b32 s28, 2752
  v_mul_lo_u32 v3, v3, s28
  v_and_b32 v13, 3, v0
  v_lshl_add_u32 v3, v13, 4, v3
  s_lshl_b32 s28, s5, 12
  s_add_u32 s28, s28, 65536
  v_lshl_add_u32 v5, v0, 3, s28
  v_bfe_u32 v13, v0, 1, 1
  v_lshlrev_b32 v4, 11, v13
  v_lshrrev_b32 v13, 2, v0
  v_lshl_add_u32 v4, v13, 5, v4
  v_and_b32 v13, 1, v0
  v_lshl_add_u32 v4, v13, 4, v4
  v_add_u32 v4, s28, v4
  s_and_b32 s28, s5, 1
  s_lshl_b32 s28, s28, 16
  s_xor_b32 s29, s28, 0x10000
  s_add_u32 s12, s89, s29
  s_add_u32 s89, s89, s28
  s_lshr_b32 s28, s28, 1
  s_lshr_b32 s29, s29, 1
  s_add_u32 s13, s90, s29
  s_add_u32 s90, s90, s28
  v_and_b32 v13, 15, v0
  v_lshrrev_b32 v14, 4, v0
  s_lshl_b32 s29, s5, 8
  v_lshlrev_b32 v15, 4, v13
  v_lshl_add_u32 v15, v14, 10, v15
  v_add_u32 v6, s29, v15
  v_mov_b32 v15, 0x10000000
  v_cmp_gt_u32 vcc, 2, v14
  s_nop 1
  v_cndmask_b32 v7, v15, v6, vcc
  s_lshl_b32 s28, s4, 10
  s_add_u32 s28, s28, s29
  v_lshlrev_b32 v15, 4, v13
  v_add_u32 v15, s28, v15
  v_lshl_add_u32 v8, v14, 17, v15
  s_mov_b32 s30, 98304
  v_mad_u32_u24 v9, v14, s30, v15
  v_and_b32 v15, 7, v13
  v_lshlrev_b32 v15, 3, v15
  v_lshl_add_u32 v15, v14, 6, v15
  v_add_u32 v10, s29, v15
  v_lshlrev_b32 v15, 10, v13
  v_lshl_add_u32 v15, v14, 4, v15
  s_lshr_b32 s30, s5, 1
  s_lshl_b32 s31, s30, 14
  s_and_b32 s32, s5, 1
  s_lshl_b32 s33, s32, 9
  s_add_u32 s33, s33, s31
  s_mul_i32 s33, s5, 8320
  s_add_u32 s33, s33, 32768
  v_add_u32 v11, s33, v1
  s_mul_i32 s33, s30, 16640
  s_add_u32 s33, s33, 32768
  s_mov_b32 s31, 1040
  v_lshlrev_b32 v15, 4, v14
  v_mad_u32_u24 v15, v13, s31, v15
  v_add_u32 v12, s33, v15
  s_lshl_b32 s31, s5, 11
  v_add_u32 v176, s31, v1
  s_lshl_b32 s31, s5, 10
  s_add_u32 s31, s31, 8192
  v_add_u32 v177, s31, v1
  s_lshl_b32 s31, s5, 2
  s_add_u32 s31, s31, 12288
  v_bfe_u32 v178, v0, 4, 1
  v_lshlrev_b32 v178, 4, v178
  v_add_u32 v178, s31, v178
  s_lshl_b32 s28, s62, 20
  s_add_u32 s80, s28, 0x800000
  v_mov_b32 v16, 1
  v_mov_b32 v20, -1
  v_mov_b32 v17, 1
  v_mov_b32 v21, -1
  v_mov_b32 v18, 1
  v_mov_b32 v22, -1
  v_mov_b32 v19, 1
  v_mov_b32 v23, -1
  s_add_u32 s28, s80, 0
  s_xor_b32 s29, s28, 0x1800000
  buffer_store_dwordx4 v[16:19], v8, s[8:11], s28 offen sc1
  buffer_store_dwordx4 v[16:19], v8, s[8:11], s29 offen sc1
  s_add_u32 s28, s28, 32768
  s_xor_b32 s29, s28, 0x1800000
  buffer_store_dwordx4 v[16:19], v8, s[8:11], s28 offen sc1
  buffer_store_dwordx4 v[16:19], v8, s[8:11], s29 offen sc1
  s_add_u32 s28, s28, 32768
  s_xor_b32 s29, s28, 0x1800000
  buffer_store_dwordx4 v[16:19], v8, s[8:11], s28 offen sc1
  buffer_store_dwordx4 v[16:19], v8, s[8:11], s29 offen sc1
  s_add_u32 s28, s28, 32768
  s_xor_b32 s29, s28, 0x1800000
  buffer_store_dwordx4 v[16:19], v8, s[8:11], s28 offen sc1
  buffer_store_dwordx4 v[16:19], v8, s[8:11], s29 offen sc1
  s_add_u32 s28, s80, 524288
  s_xor_b32 s29, s28, 0x1800000
  buffer_store_dwordx4 v[16:19], v8, s[8:11], s28 offen sc1
  buffer_store_dwordx4 v[16:19], v8, s[8:11], s29 offen sc1
  s_add_u32 s28, s28, 32768
  s_xor_b32 s29, s28, 0x1800000
  buffer_store_dwordx4 v[16:19], v8, s[8:11], s28 offen sc1
  buffer_store_dwordx4 v[16:19], v8, s[8:11], s29 offen sc1
  s_add_u32 s28, s28, 32768
  s_xor_b32 s29, s28, 0x1800000
  buffer_store_dwordx4 v[16:19], v8, s[8:11], s28 offen sc1
  buffer_store_dwordx4 v[16:19], v8, s[8:11], s29 offen sc1
  s_add_u32 s28, s28, 32768
  s_xor_b32 s29, s28, 0x1800000
  buffer_store_dwordx4 v[16:19], v8, s[8:11], s28 offen sc1
  buffer_store_dwordx4 v[16:19], v8, s[8:11], s29 offen sc1
  v_lshlrev_b32 v15, 4, v13
  v_sub_u32 v8, v8, v15
  v_lshrrev_b32 v15, 3, v13
  v_lshl_add_u32 v8, v15, 6, v8
  v_and_b32 v15, 3, v13
  v_lshl_add_u32 v8, v15, 4, v8
  v_bfe_u32 v15, v13, 2, 1
  v_lshl_add_u32 v8, v15, 3, v8
  v_xor_b32 v9, 1, v15
  s_mul_i32 s29, s5, 7
  s_add_u32 s29, s29, s62
  s_add_u32 s30, s29, 0
  s_lshl_b32 s28, s30, 15
  s_lshl_b32 s31, s4, 10
  s_add_u32 s28, s28, s31
  s_add_u32 s28, s28, 0x300000
  s_cmp_lt_u32 s30, 64
  s_cselect_b32 s28, s28, 0x10000000
  buffer_store_dwordx4 v[20:23], v1, s[8:11], s28 offen sc1
  s_add_u32 s30, s29, 28
  s_lshl_b32 s28, s30, 15
  s_lshl_b32 s31, s4, 10
  s_add_u32 s28, s28, s31
  s_add_u32 s28, s28, 0x300000
  s_cmp_lt_u32 s30, 64
  s_cselect_b32 s28, s28, 0x10000000
  buffer_store_dwordx4 v[20:23], v1, s[8:11], s28 offen sc1
  s_add_u32 s30, s29, 56
  s_lshl_b32 s28, s30, 15
  s_lshl_b32 s31, s4, 10
  s_add_u32 s28, s28, s31
  s_add_u32 s28, s28, 0x300000
  s_cmp_ge_u32 s4, 16
  s_cselect_b32 s31, 62, 64
  s_cmp_lt_u32 s30, s31
  s_cselect_b32 s28, s28, 0x10000000
  buffer_store_dwordx4 v[20:23], v1, s[8:11], s28 offen sc1
  s_add_u32 s30, s62, 61
  s_lshl_b32 s28, s30, 15
  s_lshl_b32 s31, s4, 10
  s_add_u32 s28, s28, s31
  s_add_u32 s28, s28, 0x300000
  s_sub_u32 s30, s62, 1
  s_cmp_lt_u32 s30, 2
  s_cselect_b32 s28, s28, 0x10000000
  s_cmp_ge_u32 s4, 16
  s_cselect_b32 s28, s28, 0x10000000
  s_cmp_eq_u32 s5, 3
  s_cselect_b32 s28, s28, 0x10000000
  buffer_store_dwordx4 v[20:23], v1, s[8:11], s28 offen sc1
  s_add_u32 s28, s89, 0x0
  buffer_load_dwordx4 a[0:3], v2, s[64:67], s28 offen
  s_add_u32 s28, s89, 0x1000
  buffer_load_dwordx4 a[4:7], v2, s[64:67], s28 offen
  s_add_u32 s28, s89, 0x2000
  buffer_load_dwordx4 a[8:11], v2, s[64:67], s28 offen
  s_add_u32 s28, s89, 0x3000
  buffer_load_dwordx4 a[12:15], v2, s[64:67], s28 offen
  s_add_u32 s28, s89, 0x4000
  buffer_load_dwordx4 a[16:19], v2, s[64:67], s28 offen
  s_add_u32 s28, s89, 0x5000
  buffer_load_dwordx4 a[20:23], v2, s[64:67], s28 offen
  s_add_u32 s28, s89, 0x6000
  buffer_load_dwordx4 a[24:27], v2, s[64:67], s28 offen
  s_add_u32 s28, s89, 0x7000
  buffer_load_dwordx4 a[28:31], v2, s[64:67], s28 offen
  s_add_u32 s28, s89, 0x8000
  buffer_load_dwordx4 a[32:35], v2, s[64:67], s28 offen
  s_add_u32 s28, s89, 0x9000
  buffer_load_dwordx4 a[36:39], v2, s[64:67], s28 offen
  s_add_u32 s28, s89, 0xa000
  buffer_load_dwordx4 a[40:43], v2, s[64:67], s28 offen
  s_add_u32 s28, s89, 0xb000
  buffer_load_dwordx4 a[44:47], v2, s[64:67], s28 offen
  s_add_u32 s28, s89, 0xc000
  buffer_load_dwordx4 a[48:51], v2, s[64:67], s28 offen
  s_add_u32 s28, s89, 0xd000
  buffer_load_dwordx4 a[52:55], v2, s[64:67], s28 offen
  s_add_u32 s28, s89, 0xe000
  buffer_load_dwordx4 a[56:59], v2, s[64:67], s28 offen
  s_add_u32 s28, s89, 0xf000
  buffer_load_dwordx4 a[60:63], v2, s[64:67], s28 offen
  s_add_u32 s28, s12, 0x0
  buffer_load_dwordx4 a[64:67], v2, s[64:67], s28 offen
  s_add_u32 s28, s12, 0x1000
  buffer_load_dwordx4 a[68:71], v2, s[64:67], s28 offen
  s_add_u32 s28, s12, 0x2000
  buffer_load_dwordx4 a[72:75], v2, s[64:67], s28 offen
  s_add_u32 s28, s12, 0x3000
  buffer_load_dwordx4 a[76:79], v2, s[64:67], s28 offen
  s_add_u32 s28, s12, 0x4000
  buffer_load_dwordx4 a[80:83], v2, s[64:67], s28 offen
  s_add_u32 s28, s12, 0x5000
  buffer_load_dwordx4 a[84:87], v2, s[64:67], s28 offen
  s_add_u32 s28, s12, 0x6000
  buffer_load_dwordx4 a[88:91], v2, s[64:67], s28 offen
  s_add_u32 s28, s12, 0x7000
  buffer_load_dwordx4 a[92:95], v2, s[64:67], s28 offen
  s_add_u32 s28, s12, 0x8000
  buffer_load_dwordx4 a[96:99], v2, s[64:67], s28 offen
  s_add_u32 s28, s12, 0x9000
  buffer_load_dwordx4 a[100:103], v2, s[64:67], s28 offen
  s_add_u32 s28, s12, 0xa000
  buffer_load_dwordx4 a[104:107], v2, s[64:67], s28 offen
  s_add_u32 s28, s12, 0xb000
  buffer_load_dwordx4 a[108:111], v2, s[64:67], s28 offen
  s_add_u32 s28, s12, 0xc000
  buffer_load_dwordx4 a[112:115], v2, s[64:67], s28 offen
  s_add_u32 s28, s12, 0xd000
  buffer_load_dwordx4 a[116:119], v2, s[64:67], s28 offen
  s_add_u32 s28, s12, 0xe000
  buffer_load_dwordx4 a[120:123], v2, s[64:67], s28 offen
  s_add_u32 s28, s12, 0xf000
  buffer_load_dwordx4 a[124:127], v2, s[64:67], s28 offen
  s_add_u32 s28, s88, 0x0
  buffer_load_dwordx4 a[128:131], v3, s[68:71], s28 offen
  s_add_u32 s28, s88, 0x2b00
  buffer_load_dwordx4 a[132:135], v3, s[68:71], s28 offen
  s_add_u32 s28, s88, 0x15800
  buffer_load_dwordx4 a[136:139], v3, s[68:71], s28 offen
  s_add_u32 s28, s88, 0x18300
  buffer_load_dwordx4 a[140:143], v3, s[68:71], s28 offen
  s_add_u32 s28, s88, 0x2b000
  buffer_load_dwordx4 a[144:147], v3, s[68:71], s28 offen
  s_add_u32 s28, s88, 0x2db00
  buffer_load_dwordx4 a[148:151], v3, s[68:71], s28 offen
  s_add_u32 s28, s88, 0x40800
  buffer_load_dwordx4 a[152:155], v3, s[68:71], s28 offen
  s_add_u32 s28, s88, 0x43300
  buffer_load_dwordx4 a[156:159], v3, s[68:71], s28 offen
  s_waitcnt vmcnt(39)
  ds_write_b128 v179, a[0:3] offset:0
  s_waitcnt vmcnt(38)
  ds_write_b128 v179, a[4:7] offset:1088
  s_waitcnt vmcnt(37)
  ds_write_b128 v179, a[8:11] offset:2176
  s_waitcnt vmcnt(36)
  ds_write_b128 v179, a[12:15] offset:3264
  s_waitcnt vmcnt(35)
  ds_write_b128 v179, a[16:19] offset:4352
  s_waitcnt vmcnt(34)
  ds_write_b128 v179, a[20:23] offset:5440
  s_waitcnt vmcnt(33)
  ds_write_b128 v179, a[24:27] offset:6528
  s_waitcnt vmcnt(32)
  ds_write_b128 v179, a[28:31] offset:7616
  ds_read_b64_tr_b16 a[0:1], v191 offset:0
  ds_read_b64_tr_b16 a[2:3], v191 offset:4352
  ds_read_b64_tr_b16 a[4:5], v191 offset:8
  ds_read_b64_tr_b16 a[6:7], v191 offset:4360
  ds_read_b64_tr_b16 a[8:9], v191 offset:16
  ds_read_b64_tr_b16 a[10:11], v191 offset:4368
  ds_read_b64_tr_b16 a[12:13], v191 offset:24
  s_waitcnt lgkmcnt(14)
  ds_read_b64_tr_b16 a[14:15], v191 offset:4376
  s_waitcnt lgkmcnt(14)
  ds_read_b64_tr_b16 a[16:17], v191 offset:128
  s_waitcnt lgkmcnt(14)
  ds_read_b64_tr_b16 a[18:19], v191 offset:4480
  s_waitcnt lgkmcnt(14)
  ds_read_b64_tr_b16 a[20:21], v191 offset:136
  s_waitcnt lgkmcnt(14)
  ds_read_b64_tr_b16 a[22:23], v191 offset:4488
  s_waitcnt lgkmcnt(14)
  ds_read_b64_tr_b16 a[24:25], v191 offset:144
  s_waitcnt lgkmcnt(14)
  ds_read_b64_tr_b16 a[26:27], v191 offset:4496
  s_waitcnt lgkmcnt(14)
  ds_read_b64_tr_b16 a[28:29], v191 offset:152
  s_waitcnt lgkmcnt(14)
  ds_read_b64_tr_b16 a[30:31], v191 offset:4504
  s_add_u32 s28, s88, 0x56000
  buffer_load_dwordx4 a[160:163], v3, s[68:71], s28 offen
  s_add_u32 s28, s88, 0x58b00
  buffer_load_dwordx4 a[164:167], v3, s[68:71], s28 offen
  s_add_u32 s28, s88, 0x6b800
  buffer_load_dwordx4 a[168:171], v3, s[68:71], s28 offen
  s_add_u32 s28, s88, 0x6e300
  buffer_load_dwordx4 a[172:175], v3, s[68:71], s28 offen
  s_add_u32 s28, s88, 0x81000
  buffer_load_dwordx4 a[176:179], v3, s[68:71], s28 offen
  s_add_u32 s28, s88, 0x83b00
  buffer_load_dwordx4 a[180:183], v3, s[68:71], s28 offen
  s_add_u32 s28, s88, 0x96800
  buffer_load_dwordx4 a[184:187], v3, s[68:71], s28 offen
  s_add_u32 s28, s88, 0x99300
  buffer_load_dwordx4 a[188:191], v3, s[68:71], s28 offen
  s_barrier
  s_cmp_lg_u32 s5, 0
  s_cbranch_scc1 L_arr_142
  s_lshl_b32 s28, s3, 5
  v_mov_b32 v24, 1
  s_mov_b64 exec, 1
  buffer_atomic_add v24, off, s[24:27], s28 offset:4 sc1
  s_mov_b64 exec, -1
L_arr_142:
  s_waitcnt vmcnt(39)
  s_waitcnt lgkmcnt(14)
  ds_write_b128 v179, a[32:35] offset:0
  s_waitcnt vmcnt(38)
  s_waitcnt lgkmcnt(14)
  ds_write_b128 v179, a[36:39] offset:1088
  s_waitcnt vmcnt(37)
  s_waitcnt lgkmcnt(14)
  ds_write_b128 v179, a[40:43] offset:2176
  s_waitcnt vmcnt(36)
  s_waitcnt lgkmcnt(14)
  ds_write_b128 v179, a[44:47] offset:3264
  s_waitcnt vmcnt(35)
  s_waitcnt lgkmcnt(14)
  ds_write_b128 v179, a[48:51] offset:4352
  s_waitcnt vmcnt(34)
  s_waitcnt lgkmcnt(14)
  ds_write_b128 v179, a[52:55] offset:5440
  s_waitcnt vmcnt(33)
  s_waitcnt lgkmcnt(14)
  ds_write_b128 v179, a[56:59] offset:6528
  s_waitcnt vmcnt(32)
  s_waitcnt lgkmcnt(14)
  ds_write_b128 v179, a[60:63] offset:7616
  s_waitcnt lgkmcnt(14)
  ds_read_b64_tr_b16 a[32:33], v191 offset:0
  s_waitcnt lgkmcnt(14)
  ds_read_b64_tr_b16 a[34:35], v191 offset:4352
  s_waitcnt lgkmcnt(14)
  ds_read_b64_tr_b16 a[36:37], v191 offset:8
  s_waitcnt lgkmcnt(14)
  ds_read_b64_tr_b16 a[38:39], v191 offset:4360
  s_waitcnt lgkmcnt(14)
  ds_read_b64_tr_b16 a[40:41], v191 offset:16
  s_waitcnt lgkmcnt(14)
  ds_read_b64_tr_b16 a[42:43], v191 offset:4368
  s_waitcnt lgkmcnt(14)
  ds_read_b64_tr_b16 a[44:45], v191 offset:24
  s_waitcnt lgkmcnt(14)
  ds_read_b64_tr_b16 a[46:47], v191 offset:4376
  s_waitcnt lgkmcnt(14)
  ds_read_b64_tr_b16 a[48:49], v191 offset:128
  s_waitcnt lgkmcnt(14)
  ds_read_b64_tr_b16 a[50:51], v191 offset:4480
  s_waitcnt lgkmcnt(14)
  ds_read_b64_tr_b16 a[52:53], v191 offset:136
  s_waitcnt lgkmcnt(14)
  ds_read_b64_tr_b16 a[54:55], v191 offset:4488
  s_waitcnt lgkmcnt(14)
  ds_read_b64_tr_b16 a[56:57], v191 offset:144
  s_waitcnt lgkmcnt(14)
  ds_read_b64_tr_b16 a[58:59], v191 offset:4496
  s_waitcnt lgkmcnt(14)
  ds_read_b64_tr_b16 a[60:61], v191 offset:152
  s_waitcnt lgkmcnt(14)
  ds_read_b64_tr_b16 a[62:63], v191 offset:4504
  s_add_u32 s28, s88, 0xac000
  buffer_load_dwordx4 a[192:195], v3, s[68:71], s28 offen
  s_add_u32 s28, s88, 0xaeb00
  buffer_load_dwordx4 a[196:199], v3, s[68:71], s28 offen
  s_add_u32 s28, s88, 0xc1800
  buffer_load_dwordx4 a[200:203], v3, s[68:71], s28 offen
  s_add_u32 s28, s88, 0xc4300
  buffer_load_dwordx4 a[204:207], v3, s[68:71], s28 offen
  s_add_u32 s28, s88, 0xd7000
  buffer_load_dwordx4 a[208:211], v3, s[68:71], s28 offen
  s_add_u32 s28, s88, 0xd9b00
  buffer_load_dwordx4 a[212:215], v3, s[68:71], s28 offen
  s_add_u32 s28, s88, 0xec800
  buffer_load_dwordx4 a[216:219], v3, s[68:71], s28 offen
  s_add_u32 s28, s88, 0xef300
  buffer_load_dwordx4 a[220:223], v3, s[68:71], s28 offen
  s_waitcnt vmcnt(39)
  s_waitcnt lgkmcnt(14)
  ds_write_b128 v179, a[64:67] offset:0
  s_waitcnt vmcnt(38)
  s_waitcnt lgkmcnt(14)
  ds_write_b128 v179, a[68:71] offset:1088
  s_waitcnt vmcnt(37)
  s_waitcnt lgkmcnt(14)
  ds_write_b128 v179, a[72:75] offset:2176
  s_waitcnt vmcnt(36)
  s_waitcnt lgkmcnt(14)
  ds_write_b128 v179, a[76:79] offset:3264
  s_waitcnt vmcnt(35)
  s_waitcnt lgkmcnt(14)
  ds_write_b128 v179, a[80:83] offset:4352
  s_waitcnt vmcnt(34)
  s_waitcnt lgkmcnt(14)
  ds_write_b128 v179, a[84:87] offset:5440
  s_waitcnt vmcnt(33)
  s_waitcnt lgkmcnt(14)
  ds_write_b128 v179, a[88:91] offset:6528
  s_waitcnt vmcnt(32)
  s_waitcnt lgkmcnt(14)
  ds_write_b128 v179, a[92:95] offset:7616
  s_waitcnt lgkmcnt(14)
  ds_read_b64_tr_b16 a[64:65], v191 offset:0
  s_waitcnt lgkmcnt(14)
  ds_read_b64_tr_b16 a[66:67], v191 offset:4352
  s_waitcnt lgkmcnt(14)
  ds_read_b64_tr_b16 a[68:69], v191 offset:8
  s_waitcnt lgkmcnt(14)
  ds_read_b64_tr_b16 a[70:71], v191 offset:4360
  s_waitcnt lgkmcnt(14)
  ds_read_b64_tr_b16 a[72:73], v191 offset:16
  s_waitcnt lgkmcnt(14)
  ds_read_b64_tr_b16 a[74:75], v191 offset:4368
  s_waitcnt lgkmcnt(14)
  ds_read_b64_tr_b16 a[76:77], v191 offset:24
  s_waitcnt lgkmcnt(14)
  ds_read_b64_tr_b16 a[78:79], v191 offset:4376
  s_waitcnt lgkmcnt(14)
  ds_read_b64_tr_b16 a[80:81], v191 offset:128
  s_waitcnt lgkmcnt(14)
  ds_read_b64_tr_b16 a[82:83], v191 offset:4480
  s_waitcnt lgkmcnt(14)
  ds_read_b64_tr_b16 a[84:85], v191 offset:136
  s_waitcnt lgkmcnt(14)
  ds_read_b64_tr_b16 a[86:87], v191 offset:4488
  s_waitcnt lgkmcnt(14)
  ds_read_b64_tr_b16 a[88:89], v191 offset:144
  s_waitcnt lgkmcnt(14)
  ds_read_b64_tr_b16 a[90:91], v191 offset:4496
  s_waitcnt lgkmcnt(14)
  ds_read_b64_tr_b16 a[92:93], v191 offset:152
  s_waitcnt lgkmcnt(14)
  ds_read_b64_tr_b16 a[94:95], v191 offset:4504
  s_add_u32 s28, s88, 0x102000
  buffer_load_dwordx4 a[224:227], v3, s[68:71], s28 offen
  s_add_u32 s28, s88, 0x104b00
  buffer_load_dwordx4 a[228:231], v3, s[68:71], s28 offen
  s_add_u32 s28, s88, 0x117800
  buffer_load_dwordx4 a[232:235], v3, s[68:71], s28 offen
  s_add_u32 s28, s88, 0x11a300
  buffer_load_dwordx4 a[236:239], v3, s[68:71], s28 offen
  s_add_u32 s28, s88, 0x12d000
  buffer_load_dwordx4 a[240:243], v3, s[68:71], s28 offen
  s_add_u32 s28, s88, 0x12fb00
  buffer_load_dwordx4 a[244:247], v3, s[68:71], s28 offen
  s_add_u32 s28, s88, 0x142800
  buffer_load_dwordx4 a[248:251], v3, s[68:71], s28 offen
  s_add_u32 s28, s88, 0x145300
  buffer_load_dwordx4 a[252:255], v3, s[68:71], s28 offen
  s_waitcnt vmcnt(39)
  s_waitcnt lgkmcnt(14)
  ds_write_b128 v179, a[96:99] offset:0
  s_waitcnt vmcnt(38)
  s_waitcnt lgkmcnt(14)
  ds_write_b128 v179, a[100:103] offset:1088
  s_waitcnt vmcnt(37)
  s_waitcnt lgkmcnt(14)
  ds_write_b128 v179, a[104:107] offset:2176
  s_waitcnt vmcnt(36)
  s_waitcnt lgkmcnt(14)
  ds_write_b128 v179, a[108:111] offset:3264
  s_waitcnt vmcnt(35)
  s_waitcnt lgkmcnt(14)
  ds_write_b128 v179, a[112:115] offset:4352
  s_waitcnt vmcnt(34)
  s_waitcnt lgkmcnt(14)
  ds_write_b128 v179, a[116:119] offset:5440
  s_waitcnt vmcnt(33)
  s_waitcnt lgkmcnt(14)
  ds_write_b128 v179, a[120:123] offset:6528
  s_waitcnt vmcnt(32)
  s_waitcnt lgkmcnt(14)
  ds_write_b128 v179, a[124:127] offset:7616
  s_waitcnt lgkmcnt(14)
  ds_read_b64_tr_b16 a[96:97], v191 offset:0
  s_waitcnt lgkmcnt(14)
  ds_read_b64_tr_b16 a[98:99], v191 offset:4352
  s_waitcnt lgkmcnt(14)
  ds_read_b64_tr_b16 a[100:101], v191 offset:8
  s_waitcnt lgkmcnt(14)
  ds_read_b64_tr_b16 a[102:103], v191 offset:4360
  s_waitcnt lgkmcnt(14)
  ds_read_b64_tr_b16 a[104:105], v191 offset:16
  s_waitcnt lgkmcnt(14)
  ds_read_b64_tr_b16 a[106:107], v191 offset:4368
  s_waitcnt lgkmcnt(14)
  ds_read_b64_tr_b16 a[108:109], v191 offset:24
  s_waitcnt lgkmcnt(14)
  ds_read_b64_tr_b16 a[110:111], v191 offset:4376
  s_waitcnt lgkmcnt(14)
  ds_read_b64_tr_b16 a[112:113], v191 offset:128
  s_waitcnt lgkmcnt(14)
  ds_read_b64_tr_b16 a[114:115], v191 offset:4480
  s_waitcnt lgkmcnt(14)
  ds_read_b64_tr_b16 a[116:117], v191 offset:136
  s_waitcnt lgkmcnt(14)
  ds_read_b64_tr_b16 a[118:119], v191 offset:4488
  s_waitcnt lgkmcnt(14)
  ds_read_b64_tr_b16 a[120:121], v191 offset:144
  s_waitcnt lgkmcnt(14)
  ds_read_b64_tr_b16 a[122:123], v191 offset:4496
  s_waitcnt lgkmcnt(14)
  ds_read_b64_tr_b16 a[124:125], v191 offset:152
  s_waitcnt lgkmcnt(14)
  ds_read_b64_tr_b16 a[126:127], v191 offset:4504
  s_add_u32 s28, s90, 0x0
  buffer_load_dwordx4 v[192:195], v2, s[72:75], s28 offen
  s_add_u32 s28, s90, 0x1000
  buffer_load_dwordx4 v[196:199], v2, s[72:75], s28 offen
  s_add_u32 s28, s90, 0x2000
  buffer_load_dwordx4 v[200:203], v2, s[72:75], s28 offen
  s_add_u32 s28, s90, 0x3000
  buffer_load_dwordx4 v[204:207], v2, s[72:75], s28 offen
  s_add_u32 s28, s90, 0x4000
  buffer_load_dwordx4 v[208:211], v2, s[72:75], s28 offen
  s_add_u32 s28, s90, 0x5000
  buffer_load_dwordx4 v[212:215], v2, s[72:75], s28 offen
  s_add_u32 s28, s90, 0x6000
  buffer_load_dwordx4 v[216:219], v2, s[72:75], s28 offen
  s_add_u32 s28, s90, 0x7000
  buffer_load_dwordx4 v[220:223], v2, s[72:75], s28 offen
  s_waitcnt vmcnt(39)
  s_waitcnt lgkmcnt(14)
  ds_write_b128 v4, a[128:131] offset:0
  s_waitcnt vmcnt(38)
  s_waitcnt lgkmcnt(14)
  ds_write_b128 v4, a[132:135] offset:512
  s_waitcnt vmcnt(37)
  s_waitcnt lgkmcnt(14)
  ds_write_b128 v4, a[136:139] offset:1024
  s_waitcnt vmcnt(36)
  s_waitcnt lgkmcnt(14)
  ds_write_b128 v4, a[140:143] offset:1536
  s_waitcnt lgkmcnt(14)
  ds_read_b64_tr_b16 a[128:129], v5 offset:0
  s_waitcnt lgkmcnt(14)
  ds_read_b64_tr_b16 a[130:131], v5 offset:512
  s_waitcnt lgkmcnt(14)
  ds_read_b64_tr_b16 a[132:133], v5 offset:1024
  s_waitcnt lgkmcnt(14)
  ds_read_b64_tr_b16 a[134:135], v5 offset:1536
  s_waitcnt lgkmcnt(14)
  ds_read_b64_tr_b16 a[136:137], v5 offset:2048
  s_waitcnt lgkmcnt(14)
  ds_read_b64_tr_b16 a[138:139], v5 offset:2560
  s_waitcnt lgkmcnt(14)
  ds_read_b64_tr_b16 a[140:141], v5 offset:3072
  s_waitcnt lgkmcnt(14)
  ds_read_b64_tr_b16 a[142:143], v5 offset:3584
  s_waitcnt vmcnt(35)
  s_waitcnt lgkmcnt(14)
  ds_write_b128 v4, a[144:147] offset:0
  s_waitcnt vmcnt(34)
  s_waitcnt lgkmcnt(14)
  ds_write_b128 v4, a[148:151] offset:512
  s_waitcnt vmcnt(33)
  s_waitcnt lgkmcnt(14)
  ds_write_b128 v4, a[152:155] offset:1024
  s_waitcnt vmcnt(32)
  s_waitcnt lgkmcnt(14)
  ds_write_b128 v4, a[156:159] offset:1536
  s_waitcnt lgkmcnt(14)
  ds_read_b64_tr_b16 a[144:145], v5 offset:0
  s_waitcnt lgkmcnt(14)
  ds_read_b64_tr_b16 a[146:147], v5 offset:512
  s_waitcnt lgkmcnt(14)
  ds_read_b64_tr_b16 a[148:149], v5 offset:1024
  s_waitcnt lgkmcnt(14)
  ds_read_b64_tr_b16 a[150:151], v5 offset:1536
  s_waitcnt lgkmcnt(14)
  ds_read_b64_tr_b16 a[152:153], v5 offset:2048
  s_waitcnt lgkmcnt(14)
  ds_read_b64_tr_b16 a[154:155], v5 offset:2560
  s_waitcnt lgkmcnt(14)
  ds_read_b64_tr_b16 a[156:157], v5 offset:3072
  s_waitcnt lgkmcnt(14)
  ds_read_b64_tr_b16 a[158:159], v5 offset:3584
  s_add_u32 s28, s13, 0x0
  buffer_load_dwordx4 v[224:227], v2, s[72:75], s28 offen
  s_add_u32 s28, s13, 0x1000
  buffer_load_dwordx4 v[228:231], v2, s[72:75], s28 offen
  s_add_u32 s28, s13, 0x2000
  buffer_load_dwordx4 v[232:235], v2, s[72:75], s28 offen
  s_add_u32 s28, s13, 0x3000
  buffer_load_dwordx4 v[236:239], v2, s[72:75], s28 offen
  s_add_u32 s28, s13, 0x4000
  buffer_load_dwordx4 v[240:243], v2, s[72:75], s28 offen
  s_add_u32 s28, s13, 0x5000
  buffer_load_dwordx4 v[244:247], v2, s[72:75], s28 offen
  s_add_u32 s28, s13, 0x6000
  buffer_load_dwordx4 v[248:251], v2, s[72:75], s28 offen
  s_add_u32 s28, s13, 0x7000
  buffer_load_dwordx4 v[252:255], v2, s[72:75], s28 offen
  s_waitcnt vmcnt(39)
  s_waitcnt lgkmcnt(14)
  ds_write_b128 v4, a[160:163] offset:0
  s_waitcnt vmcnt(38)
  s_waitcnt lgkmcnt(14)
  ds_write_b128 v4, a[164:167] offset:512
  s_waitcnt vmcnt(37)
  s_waitcnt lgkmcnt(14)
  ds_write_b128 v4, a[168:171] offset:1024
  s_waitcnt vmcnt(36)
  s_waitcnt lgkmcnt(14)
  ds_write_b128 v4, a[172:175] offset:1536
  s_waitcnt lgkmcnt(14)
  ds_read_b64_tr_b16 a[160:161], v5 offset:0
  s_waitcnt lgkmcnt(14)
  ds_read_b64_tr_b16 a[162:163], v5 offset:512
  s_waitcnt lgkmcnt(14)
  ds_read_b64_tr_b16 a[164:165], v5 offset:1024
  s_waitcnt lgkmcnt(14)
  ds_read_b64_tr_b16 a[166:167], v5 offset:1536
  s_waitcnt lgkmcnt(14)
  ds_read_b64_tr_b16 a[168:169], v5 offset:2048
  s_waitcnt lgkmcnt(14)
  ds_read_b64_tr_b16 a[170:171], v5 offset:2560
  s_waitcnt lgkmcnt(14)
  ds_read_b64_tr_b16 a[172:173], v5 offset:3072
  s_waitcnt lgkmcnt(14)
  ds_read_b64_tr_b16 a[174:175], v5 offset:3584
  s_waitcnt vmcnt(35)
  s_waitcnt lgkmcnt(14)
  ds_write_b128 v4, a[176:179] offset:0
  s_waitcnt vmcnt(34)
  s_waitcnt lgkmcnt(14)
  ds_write_b128 v4, a[180:183] offset:512
  s_waitcnt vmcnt(33)
  s_waitcnt lgkmcnt(14)
  ds_write_b128 v4, a[184:187] offset:1024
  s_waitcnt vmcnt(32)
  s_waitcnt lgkmcnt(14)
  ds_write_b128 v4, a[188:191] offset:1536
  s_waitcnt lgkmcnt(14)
  ds_read_b64_tr_b16 a[176:177], v5 offset:0
  s_waitcnt lgkmcnt(14)
  ds_read_b64_tr_b16 a[178:179], v5 offset:512
  s_waitcnt lgkmcnt(14)
  ds_read_b64_tr_b16 a[180:181], v5 offset:1024
  s_waitcnt lgkmcnt(14)
  ds_read_b64_tr_b16 a[182:183], v5 offset:1536
  s_waitcnt lgkmcnt(14)
  ds_read_b64_tr_b16 a[184:185], v5 offset:2048
  s_waitcnt lgkmcnt(14)
  ds_read_b64_tr_b16 a[186:187], v5 offset:2560
  s_waitcnt lgkmcnt(14)
  ds_read_b64_tr_b16 a[188:189], v5 offset:3072
  s_waitcnt lgkmcnt(14)
  ds_read_b64_tr_b16 a[190:191], v5 offset:3584
  s_waitcnt vmcnt(31)
  s_waitcnt lgkmcnt(14)
  ds_write_b128 v4, a[192:195] offset:0
  s_waitcnt vmcnt(30)
  s_waitcnt lgkmcnt(14)
  ds_write_b128 v4, a[196:199] offset:512
  s_waitcnt vmcnt(29)
  s_waitcnt lgkmcnt(14)
  ds_write_b128 v4, a[200:203] offset:1024
  s_waitcnt vmcnt(28)
  s_waitcnt lgkmcnt(14)
  ds_write_b128 v4, a[204:207] offset:1536
  s_waitcnt lgkmcnt(14)
  ds_read_b64_tr_b16 a[192:193], v5 offset:0
  s_waitcnt lgkmcnt(14)
  ds_read_b64_tr_b16 a[194:195], v5 offset:512
  s_waitcnt lgkmcnt(14)
  ds_read_b64_tr_b16 a[196:197], v5 offset:1024
  s_waitcnt lgkmcnt(14)
  ds_read_b64_tr_b16 a[198:199], v5 offset:1536
  s_waitcnt lgkmcnt(14)
  ds_read_b64_tr_b16 a[200:201], v5 offset:2048
  s_waitcnt lgkmcnt(14)
  ds_read_b64_tr_b16 a[202:203], v5 offset:2560
  s_waitcnt lgkmcnt(14)
  ds_read_b64_tr_b16 a[204:205], v5 offset:3072
  s_waitcnt lgkmcnt(14)
  ds_read_b64_tr_b16 a[206:207], v5 offset:3584
  s_waitcnt vmcnt(27)
  s_waitcnt lgkmcnt(14)
  ds_write_b128 v4, a[208:211] offset:0
  s_waitcnt vmcnt(26)
  s_waitcnt lgkmcnt(14)
  ds_write_b128 v4, a[212:215] offset:512
  s_waitcnt vmcnt(25)
  s_waitcnt lgkmcnt(14)
  ds_write_b128 v4, a[216:219] offset:1024
  s_waitcnt vmcnt(24)
  s_waitcnt lgkmcnt(14)
  ds_write_b128 v4, a[220:223] offset:1536
  s_waitcnt lgkmcnt(14)
  ds_read_b64_tr_b16 a[208:209], v5 offset:0
  s_waitcnt lgkmcnt(14)
  ds_read_b64_tr_b16 a[210:211], v5 offset:512
  s_waitcnt lgkmcnt(14)
  ds_read_b64_tr_b16 a[212:213], v5 offset:1024
  s_waitcnt lgkmcnt(14)
  ds_read_b64_tr_b16 a[214:215], v5 offset:1536
  s_waitcnt lgkmcnt(14)
  ds_read_b64_tr_b16 a[216:217], v5 offset:2048
  s_waitcnt lgkmcnt(14)
  ds_read_b64_tr_b16 a[218:219], v5 offset:2560
  s_waitcnt lgkmcnt(14)
  ds_read_b64_tr_b16 a[220:221], v5 offset:3072
  s_waitcnt lgkmcnt(14)
  ds_read_b64_tr_b16 a[222:223], v5 offset:3584
  s_waitcnt vmcnt(23)
  s_waitcnt lgkmcnt(14)
  ds_write_b128 v4, a[224:227] offset:0
  s_waitcnt vmcnt(22)
  s_waitcnt lgkmcnt(14)
  ds_write_b128 v4, a[228:231] offset:512
  s_waitcnt vmcnt(21)
  s_waitcnt lgkmcnt(14)
  ds_write_b128 v4, a[232:235] offset:1024
  s_waitcnt vmcnt(20)
  s_waitcnt lgkmcnt(14)
  ds_write_b128 v4, a[236:239] offset:1536
  s_waitcnt lgkmcnt(14)
  ds_read_b64_tr_b16 a[224:225], v5 offset:0
  s_waitcnt lgkmcnt(14)
  ds_read_b64_tr_b16 a[226:227], v5 offset:512
  s_waitcnt lgkmcnt(14)
  ds_read_b64_tr_b16 a[228:229], v5 offset:1024
  s_waitcnt lgkmcnt(14)
  ds_read_b64_tr_b16 a[230:231], v5 offset:1536
  s_waitcnt lgkmcnt(14)
  ds_read_b64_tr_b16 a[232:233], v5 offset:2048
  s_waitcnt lgkmcnt(14)
  ds_read_b64_tr_b16 a[234:235], v5 offset:2560
  s_waitcnt lgkmcnt(14)
  ds_read_b64_tr_b16 a[236:237], v5 offset:3072
  s_waitcnt lgkmcnt(14)
  ds_read_b64_tr_b16 a[238:239], v5 offset:3584
  s_waitcnt vmcnt(19)
  s_waitcnt lgkmcnt(14)
  ds_write_b128 v4, a[240:243] offset:0
  s_waitcnt vmcnt(18)
  s_waitcnt lgkmcnt(14)
  ds_write_b128 v4, a[244:247] offset:512
  s_waitcnt vmcnt(17)
  s_waitcnt lgkmcnt(14)
  ds_write_b128 v4, a[248:251] offset:1024
  s_waitcnt vmcnt(16)
  s_waitcnt lgkmcnt(14)
  ds_write_b128 v4, a[252:255] offset:1536
  s_waitcnt lgkmcnt(14)
  ds_read_b64_tr_b16 a[240:241], v5 offset:0
  s_waitcnt lgkmcnt(14)
  ds_read_b64_tr_b16 a[242:243], v5 offset:512
  s_waitcnt lgkmcnt(14)
  ds_read_b64_tr_b16 a[244:245], v5 offset:1024
  s_waitcnt lgkmcnt(14)
  ds_read_b64_tr_b16 a[246:247], v5 offset:1536
  s_waitcnt lgkmcnt(14)
  ds_read_b64_tr_b16 a[248:249], v5 offset:2048
  s_waitcnt lgkmcnt(14)
  ds_read_b64_tr_b16 a[250:251], v5 offset:2560
  s_waitcnt lgkmcnt(14)
  ds_read_b64_tr_b16 a[252:253], v5 offset:3072
  s_waitcnt lgkmcnt(14)
  ds_read_b64_tr_b16 a[254:255], v5 offset:3584
  s_waitcnt vmcnt(15)
  s_waitcnt lgkmcnt(14)
  ds_write_b128 v179, v[192:195] offset:0
  s_waitcnt vmcnt(14)
  s_waitcnt lgkmcnt(14)
  ds_write_b128 v179, v[196:199] offset:1088
  s_waitcnt vmcnt(13)
  s_waitcnt lgkmcnt(14)
  ds_write_b128 v179, v[200:203] offset:2176
  s_waitcnt vmcnt(12)
  s_waitcnt lgkmcnt(14)
  ds_write_b128 v179, v[204:207] offset:3264
  s_waitcnt vmcnt(11)
  s_waitcnt lgkmcnt(14)
  ds_write_b128 v179, v[208:211] offset:4352
  s_waitcnt vmcnt(10)
  s_waitcnt lgkmcnt(14)
  ds_write_b128 v179, v[212:215] offset:5440
  s_waitcnt vmcnt(9)
  s_waitcnt lgkmcnt(14)
  ds_write_b128 v179, v[216:219] offset:6528
  s_waitcnt vmcnt(8)
  s_waitcnt lgkmcnt(14)
  ds_write_b128 v179, v[220:223] offset:7616
  s_waitcnt lgkmcnt(14)
  ds_read_b64_tr_b16 v[192:193], v191 offset:0
  s_waitcnt lgkmcnt(14)
  ds_read_b64_tr_b16 v[194:195], v191 offset:4352
  s_waitcnt lgkmcnt(14)
  ds_read_b64_tr_b16 v[196:197], v191 offset:8
  s_waitcnt lgkmcnt(14)
  ds_read_b64_tr_b16 v[198:199], v191 offset:4360
  s_waitcnt lgkmcnt(14)
  ds_read_b64_tr_b16 v[200:201], v191 offset:16
  s_waitcnt lgkmcnt(14)
  ds_read_b64_tr_b16 v[202:203], v191 offset:4368
  s_waitcnt lgkmcnt(14)
  ds_read_b64_tr_b16 v[204:205], v191 offset:24
  s_waitcnt lgkmcnt(14)
  ds_read_b64_tr_b16 v[206:207], v191 offset:4376
  s_waitcnt lgkmcnt(14)
  ds_read_b64_tr_b16 v[208:209], v191 offset:128
  s_waitcnt lgkmcnt(14)
  ds_read_b64_tr_b16 v[210:211], v191 offset:4480
  s_waitcnt lgkmcnt(14)
  ds_read_b64_tr_b16 v[212:213], v191 offset:136
  s_waitcnt lgkmcnt(14)
  ds_read_b64_tr_b16 v[214:215], v191 offset:4488
  s_waitcnt lgkmcnt(14)
  ds_read_b64_tr_b16 v[216:217], v191 offset:144
  s_waitcnt lgkmcnt(14)
  ds_read_b64_tr_b16 v[218:219], v191 offset:4496
  s_waitcnt lgkmcnt(14)
  ds_read_b64_tr_b16 v[220:221], v191 offset:152
  s_waitcnt lgkmcnt(14)
  ds_read_b64_tr_b16 v[222:223], v191 offset:4504
  s_waitcnt vmcnt(7)
  s_waitcnt lgkmcnt(14)
  ds_write_b128 v179, v[224:227] offset:0
  s_waitcnt vmcnt(6)
  s_waitcnt lgkmcnt(14)
  ds_write_b128 v179, v[228:231] offset:1088
  s_waitcnt vmcnt(5)
  s_waitcnt lgkmcnt(14)
  ds_write_b128 v179, v[232:235] offset:2176
  s_waitcnt vmcnt(4)
  s_waitcnt lgkmcnt(14)
  ds_write_b128 v179, v[236:239] offset:3264
  s_waitcnt vmcnt(3)
  s_waitcnt lgkmcnt(14)
  ds_write_b128 v179, v[240:243] offset:4352
  s_waitcnt vmcnt(2)
  s_waitcnt lgkmcnt(14)
  ds_write_b128 v179, v[244:247] offset:5440
  s_waitcnt vmcnt(1)
  s_waitcnt lgkmcnt(14)
  ds_write_b128 v179, v[248:251] offset:6528
  s_waitcnt vmcnt(0)
  s_waitcnt lgkmcnt(14)
  ds_write_b128 v179, v[252:255] offset:7616
  s_waitcnt lgkmcnt(14)
  ds_read_b64_tr_b16 v[224:225], v191 offset:0
  s_waitcnt lgkmcnt(14)
  ds_read_b64_tr_b16 v[226:227], v191 offset:4352
  s_waitcnt lgkmcnt(14)
  ds_read_b64_tr_b16 v[228:229], v191 offset:8
  s_waitcnt lgkmcnt(14)
  ds_read_b64_tr_b16 v[230:231], v191 offset:4360
  s_waitcnt lgkmcnt(14)
  ds_read_b64_tr_b16 v[232:233], v191 offset:16
  s_waitcnt lgkmcnt(14)
  ds_read_b64_tr_b16 v[234:235], v191 offset:4368
  s_waitcnt lgkmcnt(14)
  ds_read_b64_tr_b16 v[236:237], v191 offset:24
  s_waitcnt lgkmcnt(14)
  ds_read_b64_tr_b16 v[238:239], v191 offset:4376
  s_waitcnt lgkmcnt(14)
  ds_read_b64_tr_b16 v[240:241], v191 offset:128
  s_waitcnt lgkmcnt(14)
  ds_read_b64_tr_b16 v[242:243], v191 offset:4480
  s_waitcnt lgkmcnt(14)
  ds_read_b64_tr_b16 v[244:245], v191 offset:136
  s_waitcnt lgkmcnt(14)
  ds_read_b64_tr_b16 v[246:247], v191 offset:4488
  s_waitcnt lgkmcnt(14)
  ds_read_b64_tr_b16 v[248:249], v191 offset:144
  s_waitcnt lgkmcnt(14)
  ds_read_b64_tr_b16 v[250:251], v191 offset:4496
  s_waitcnt lgkmcnt(14)
  ds_read_b64_tr_b16 v[252:253], v191 offset:152
  s_waitcnt lgkmcnt(14)
  ds_read_b64_tr_b16 v[254:255], v191 offset:4504
  s_waitcnt vmcnt(0) lgkmcnt(0)
  v_mov_b32 v15, 0x10000000
  v_cmp_gt_u32 vcc, 8, v13
  s_nop 1
  v_cndmask_b32 v179, v15, v10, vcc
  v_and_b32 v24, 1, v0
  v_lshlrev_b32 v24, 4, v24
  s_mov_b32 s28, 0x3f80
  v_lshlrev_b32 v15, v24, s28
  s_mov_b32 s66, 0x3030303
  s_mov_b32 s67, 0x3030303
  s_mov_b32 s68, 0xc0c0c0c
  s_mov_b32 s69, 0xc0c0c0c
  s_mov_b32 s70, 0x30303030
  s_mov_b32 s71, 0x30303030
  s_mov_b32 s72, 0xc0c0c0c0
  s_mov_b32 s73, 0xc0c0c0c0
  v_cndmask_b32 v144, 0, v15, s[66:67]
  v_cndmask_b32 v145, 0, v15, s[68:69]
  v_cndmask_b32 v146, 0, v15, s[70:71]
  v_cndmask_b32 v147, 0, v15, s[72:73]
  s_lshr_b32 s30, s5, 1
  s_lshl_b32 s30, s30, 4
  v_and_b32 v15, 15, v0
  v_lshrrev_b32 v180, 4, v0
  v_lshlrev_b32 v180, 2, v180
  v_sub_u32 v15, v15, v180
  v_add_u32 v15, s30, v15
  v_cmp_le_i32 s[64:65], 0, v15
  v_cmp_le_i32 s[66:67], 1, v15
  v_cmp_le_i32 s[68:69], 2, v15
  v_cmp_le_i32 s[70:71], 3, v15
  v_cmp_le_i32 s[72:73], 16, v15
  v_cmp_le_i32 s[74:75], 17, v15
  v_cmp_le_i32 s[76:77], 18, v15
  v_cmp_le_i32 s[78:79], 19, v15
  s_lshl_b32 s28, s30, 15
  s_add_u32 s12, s28, s80
  s_xor_b32 s30, s30, 16
  s_lshl_b32 s28, s30, 15
  s_add_u32 s13, s28, s80
  s_xor_b32 s30, s30, 16
  s_mov_b32 s96, 0x3db504f3
  s_mov_b32 s97, 0x3db504f3
  s_mov_b32 s98, 0x3fb8aa3b
  s_mov_b32 s63, 0
  s_mov_b32 s85, s62
  s_mov_b32 s94, -1
  s_mov_b32 s95, 0
  s_lshl_b32 s28, s5, 9
  v_lshrrev_b32 v15, 5, v0
  v_lshl_add_u32 v15, v15, 4, v13
  v_lshlrev_b32 v15, 4, v15
  v_and_b32 v2, 1, v14
  v_lshl_add_u32 v15, v2, 3, v15
  v_add_u32 v2, s28, v15
  v_lshrrev_b32 v15, 2, v0
  v_lshlrev_b32 v15, 4, v15
  v_and_b32 v3, 1, v0
  v_lshl_add_u32 v3, v3, 3, v15
  v_lshl_add_u32 v4, v0, 3, s28
  s_and_b32 s28, s5, 1
  s_lshl_b32 s28, s28, 10
  v_lshl_add_u32 v5, v0, 3, s28
  s_mov_b32 s34, 0
  s_mov_b32 s35, 6
  s_lshl_b32 s33, s3, 5
L_g2_143:
  buffer_load_dword v15, off, s[24:27], s33 offset:4 sc1
  s_add_u32 s34, s34, 1
  s_cmp_gt_u32 s34, 40000
  s_cbranch_scc1 L_fail
  s_waitcnt vmcnt(0)
  v_cmp_ne_u32 vcc, 32, v15
  s_cbranch_vccz L_g2d_144
  s_sleep 8
  s_branch L_g2_143
L_g2d_144:
  s_cmp_eq_u32 s62, 0
  s_cselect_b32 s84, 10, 9
  s_lshl_b32 s28, s62, 12
  s_lshl_b32 s29, s4, 7
  s_add_u32 s28, s28, s29
  s_add_u32 s33, s28, 335872
  s_mov_b32 s34, 0
  s_mov_b32 s35, 11
L_g3_145:
  buffer_load_dword v15, off, s[8:11], s33 sc1
  s_add_u32 s34, s34, 1
  s_cmp_gt_u32 s34, 40000
  s_cbranch_scc1 L_fail
  s_waitcnt vmcnt(0)
  v_cmp_ge_u32 vcc, s84, v15
  s_cbranch_vccz L_g3d_146
  s_sleep 8
  s_branch L_g3_145
L_g3d_146:
  s_mov_b32 s86, 0
  s_mov_b32 s92, 1
  s_mov_b32 s99, 1
  s_sub_u32 s28, s62, 1
  s_cmp_lt_u32 s28, 2
  s_cbranch_scc0 L_nh_147
  s_cmp_eq_u32 s28, 0
  s_cselect_b32 s30, 9, 10
  s_cselect_b32 s28, 24576, 0
  s_lshl_b32 s29, s4, 7
  s_add_u32 s28, s28, s29
  s_add_u32 s33, s28, 335872
  s_mov_b32 s34, 0
  s_mov_b32 s35, 12
L_g4_148:
  buffer_load_dword v15, off, s[8:11], s33 sc1
  s_add_u32 s34, s34, 1
  s_cmp_gt_u32 s34, 40000
  s_cbranch_scc1 L_fail
  s_waitcnt vmcnt(0)
  v_cmp_ge_u32 vcc, s30, v15
  s_cbranch_vccz L_g4d_149
  s_sleep 8
  s_branch L_g4_148
L_g4d_149:
  s_mov_b32 s84, 10
L_nh_147:
  s_waitcnt vmcnt(0)
  s_mul_i32 s91, s5, 6144
  s_add_u32 s89, s91, 81920
  s_lshl_b32 s28, s85, 20
  s_mul_i32 s29, s4, 29696
  s_add_u32 s28, s28, s29
  s_add_u32 s90, s28, 0x1800000
  s_add_u32 s28, s90, s91
  s_mov_b32 m0, s89
  s_nop 0
  buffer_load_dwordx4 v1, s[8:11], s28 offen offset:0 sc1 lds
  buffer_load_dwordx4 v1, s[8:11], s28 offen offset:1024 sc1 lds
  buffer_load_dwordx4 v1, s[8:11], s28 offen offset:2048 sc1 lds
  buffer_load_dwordx4 v1, s[8:11], s28 offen offset:3072 sc1 lds
  s_add_u32 s28, s28, 4096
  s_add_u32 m0, s89, 4096
  s_nop 0
  buffer_load_dwordx4 v1, s[8:11], s28 offen offset:0 sc1 lds
  buffer_load_dwordx4 v1, s[8:11], s28 offen offset:1024 sc1 lds
  v_add_u32 v13, 0x14000, v1
  s_lshr_b32 s30, s5, 1
  s_lshl_b32 s30, s30, 12
  s_add_u32 s30, s30, 98304
  v_add_u32 v14, s30, v1
  s_and_b32 s30, s5, 1
  s_lshl_b32 s30, s30, 12
  s_add_u32 s30, s30, 90112
  v_add_u32 v15, s30, v1
  s_waitcnt vmcnt(0)
  s_barrier
L_ws_loop:
  s_bfe_u32 s81, s63, 0x10001
  s_cmp_ge_u32 s4, 22
  s_cselect_b32 s82, s81, 0
  s_sub_u32 s29, s62, 1
  s_cmp_lt_u32 s29, 2
  s_cselect_b32 s30, 8, 99
  s_cmp_eq_u32 s30, s63
  s_cselect_b32 s87, 5, 7
  s_cmp_lt_u32 s85, 62
  s_cbranch_scc1 L_full_150
  s_cmp_lt_u32 s29, 2
  s_cselect_b32 s31, 1, 0
  s_mov_b32 s86, 1
  s_lshr_b32 s28, s4, 4
  s_cmp_eq_u32 s28, s31
  s_cselect_b32 s92, 1, 0
  s_lshr_b32 s28, s5, 1
  s_cmp_eq_u32 s28, s31
  s_cselect_b32 s99, 1, 0
  s_sub_i32 s28, s31, s28
  s_lshl_b32 s29, s28, 12
  v_add_u32 v14, s29, v14
  s_mul_i32 s29, s28, 16640
  v_add_u32 v12, s29, v12
  s_lshl_b32 s30, s31, 4
  v_and_b32 v180, 15, v0
  v_lshrrev_b32 v181, 4, v0
  v_lshlrev_b32 v181, 2, v181
  v_sub_u32 v180, v180, v181
  v_add_u32 v180, s30, v180
  v_cmp_le_i32 s[64:65], 0, v180
  v_cmp_le_i32 s[66:67], 1, v180
  v_cmp_le_i32 s[68:69], 2, v180
  v_cmp_le_i32 s[70:71], 3, v180
  v_cmp_le_i32 s[72:73], 16, v180
  v_cmp_le_i32 s[74:75], 17, v180
  v_cmp_le_i32 s[76:77], 18, v180
  v_cmp_le_i32 s[78:79], 19, v180
  s_lshl_b32 s28, s30, 15
  s_add_u32 s12, s28, s80
  s_xor_b32 s30, s30, 16
  s_lshl_b32 s28, s30, 15
  s_add_u32 s13, s28, s80
  s_xor_b32 s30, s30, 16
L_full_150:
  s_lshl_b32 s28, s85, 20
  s_mul_i32 s29, s4, 29696
  s_add_u32 s28, s28, s29
  s_add_u32 s90, s28, 0x1800000
  s_lshl_b32 s29, s5, 10
  s_add_u32 s29, s29, s90
  s_add_u32 s93, s29, 24576
  buffer_load_dwordx4 v[184:187], v1, s[8:11], s93 offen sc1
  s_cmp_eq_u32 s85, 0
  s_cselect_b32 s29, 0, 0x100000
  s_sub_u32 s83, s93, s29
  s_lshl_b32 s28, s85, 15
  s_lshl_b32 s29, s4, 10
  s_add_u32 s88, s28, s29
  buffer_load_dwordx2 v[138:139], v10, s[16:19], s88 offen
  ds_read_b128 v[16:19], v14 offset:0
  ds_read_b128 v[32:35], v13 offset:0
  ds_read_b128 v[48:51], v13 offset:4096
  ds_read_b128 v[20:23], v14 offset:1024
  ds_read_b128 v[36:39], v13 offset:1024
  ds_read_b128 v[52:55], v13 offset:5120
  ds_read_b128 v[24:27], v14 offset:2048
  ds_read_b128 v[40:43], v13 offset:2048
  ds_read_b128 v[56:59], v13 offset:6144
  ds_read_b128 v[28:31], v14 offset:3072
  ds_read_b128 v[44:47], v13 offset:3072
  ds_read_b128 v[60:63], v13 offset:7168
  ds_read_b128 v[64:67], v15 offset:0
  ds_read_b128 v[68:71], v15 offset:1024
  ds_read_b128 v[72:75], v15 offset:2048
  s_waitcnt lgkmcnt(14)
  ds_read_b128 v[76:79], v15 offset:3072
  s_waitcnt lgkmcnt(14)
  v_mfma_f32_16x16x32_bf16 v[104:107], v[32:35], v[16:19], 0
  s_waitcnt lgkmcnt(13)
  v_mfma_f32_16x16x32_bf16 v[108:111], v[48:51], v[16:19], 0
  s_waitcnt lgkmcnt(11)
  v_mfma_f32_16x16x32_bf16 v[104:107], v[36:39], v[20:23], v[104:107]
  s_waitcnt lgkmcnt(10)
  v_mfma_f32_16x16x32_bf16 v[108:111], v[52:55], v[20:23], v[108:111]
  s_waitcnt lgkmcnt(8)
  v_mfma_f32_16x16x32_bf16 v[104:107], v[40:43], v[24:27], v[104:107]
  s_waitcnt lgkmcnt(7)
  v_mfma_f32_16x16x32_bf16 v[108:111], v[56:59], v[24:27], v[108:111]
  s_waitcnt lgkmcnt(5)
  v_mfma_f32_16x16x32_bf16 v[104:107], v[44:47], v[28:31], v[104:107]
  s_waitcnt lgkmcnt(4)
  v_mfma_f32_16x16x32_bf16 v[108:111], v[60:63], v[28:31], v[108:111]
  s_nop 3
  v_cvt_pk_bf16_f32 v104, v104, v105
  v_and_b32 v105, 0xffff0000, v104
  v_lshlrev_b32 v104, 16, v104
  v_pk_mul_f32 v[104:105], v[104:105], s[96:97]
  v_cvt_pk_bf16_f32 v104, v104, v105
  v_and_b32 v105, 0xffff0000, v104
  v_lshlrev_b32 v104, 16, v104
  v_cvt_pk_bf16_f32 v106, v106, v107
  v_and_b32 v107, 0xffff0000, v106
  v_lshlrev_b32 v106, 16, v106
  v_pk_mul_f32 v[106:107], v[106:107], s[96:97]
  v_cvt_pk_bf16_f32 v106, v106, v107
  v_and_b32 v107, 0xffff0000, v106
  v_lshlrev_b32 v106, 16, v106
  v_cvt_pk_bf16_f32 v108, v108, v109
  v_and_b32 v109, 0xffff0000, v108
  v_lshlrev_b32 v108, 16, v108
  v_pk_mul_f32 v[108:109], v[108:109], s[96:97]
  v_cvt_pk_bf16_f32 v108, v108, v109
  v_and_b32 v109, 0xffff0000, v108
  v_lshlrev_b32 v108, 16, v108
  v_cvt_pk_bf16_f32 v110, v110, v111
  v_and_b32 v111, 0xffff0000, v110
  v_lshlrev_b32 v110, 16, v110
  v_pk_mul_f32 v[110:111], v[110:111], s[96:97]
  v_cvt_pk_bf16_f32 v110, v110, v111
  v_and_b32 v111, 0xffff0000, v110
  v_lshlrev_b32 v110, 16, v110
  v_mov_b32 v180, 0xce6e6b28
  v_cndmask_b32 v104, v180, v104, s[64:65]
  v_cndmask_b32 v105, v180, v105, s[66:67]
  v_cndmask_b32 v106, v180, v106, s[68:69]
  v_cndmask_b32 v107, v180, v107, s[70:71]
  v_cndmask_b32 v108, v180, v108, s[72:73]
  v_cndmask_b32 v109, v180, v109, s[74:75]
  v_cndmask_b32 v110, v180, v110, s[76:77]
  v_cndmask_b32 v111, v180, v111, s[78:79]
  v_max3_f32 v181, v104, v105, v106
  v_max3_f32 v181, v181, v107, v108
  v_max3_f32 v181, v181, v109, v110
  v_max_f32 v181, v181, v111
  v_mov_b32 v182, v181
  s_nop 1
  v_permlane16_swap_b32 v181, v182
  v_max_f32 v181, v181, v182
  v_mov_b32 v182, v181
  s_nop 1
  v_permlane32_swap_b32 v181, v182
  v_max_f32 v181, v181, v182
  v_sub_f32 v104, v104, v181
  v_sub_f32 v105, v105, v181
  v_sub_f32 v106, v106, v181
  v_sub_f32 v107, v107, v181
  v_sub_f32 v108, v108, v181
  v_sub_f32 v109, v109, v181
  v_sub_f32 v110, v110, v181
  v_sub_f32 v111, v111, v181
  v_mul_f32 v104, s98, v104
  v_mul_f32 v105, s98, v105
  v_mul_f32 v106, s98, v106
  v_mul_f32 v107, s98, v107
  v_mul_f32 v108, s98, v108
  v_mul_f32 v109, s98, v109
  v_mul_f32 v110, s98, v110
  v_mul_f32 v111, s98, v111
  v_exp_f32 v104, v104
  v_exp_f32 v105, v105
  v_exp_f32 v106, v106
  v_exp_f32 v107, v107
  v_exp_f32 v108, v108
  v_exp_f32 v109, v109
  v_exp_f32 v110, v110
  v_exp_f32 v111, v111
  v_add_f32 v183, v104, v105
  v_add_f32 v183, v183, v106
  v_add_f32 v183, v183, v107
  v_add_f32 v183, v183, v108
  v_add_f32 v183, v183, v109
  v_add_f32 v183, v183, v110
  v_add_f32 v183, v183, v111
  v_cvt_pk_bf16_f32 v132, v104, v105
  v_cvt_pk_bf16_f32 v133, v106, v107
  v_cvt_pk_bf16_f32 v134, v108, v109
  v_cvt_pk_bf16_f32 v135, v110, v111
  v_mov_b32 v182, v183
  s_nop 1
  v_permlane16_swap_b32 v183, v182
  v_add_f32 v183, v183, v182
  v_mov_b32 v182, v183
  s_nop 1
  v_permlane32_swap_b32 v183, v182
  v_add_f32 v183, v183, v182
  s_waitcnt lgkmcnt(3)
  v_mfma_f32_16x16x32_bf16 v[116:119], v[64:67], v[132:135], 0
  s_waitcnt lgkmcnt(2)
  v_mfma_f32_16x16x32_bf16 v[120:123], v[68:71], v[132:135], 0
  s_waitcnt lgkmcnt(1)
  v_mfma_f32_16x16x32_bf16 v[124:127], v[72:75], v[132:135], 0
  s_waitcnt lgkmcnt(0)
  v_mfma_f32_16x16x32_bf16 v[128:131], v[76:79], v[132:135], 0
  s_waitcnt vmcnt(0)
  s_add_u32 s30, s63, 1
  s_cmp_lt_u32 s30, s84
  s_cbranch_scc0 L_nd_152
  s_waitcnt lgkmcnt(0)
  s_barrier
  s_add_u32 s29, s63, 1
  s_cmp_lt_u32 s29, s84
  s_cselect_b32 s29, s87, 0
  s_lshl_b32 s29, s29, 20
  s_add_u32 s29, s29, s90
  s_add_u32 s28, s29, s91
  s_mov_b32 m0, s89
  s_nop 0
  buffer_load_dwordx4 v1, s[8:11], s28 offen offset:0 sc1 lds
  buffer_load_dwordx4 v1, s[8:11], s28 offen offset:1024 sc1 lds
  buffer_load_dwordx4 v1, s[8:11], s28 offen offset:2048 sc1 lds
  buffer_load_dwordx4 v1, s[8:11], s28 offen offset:3072 sc1 lds
  s_add_u32 s28, s28, 4096
  s_add_u32 m0, s89, 4096
  s_nop 0
  buffer_load_dwordx4 v1, s[8:11], s28 offen offset:0 sc1 lds
  buffer_load_dwordx4 v1, s[8:11], s28 offen offset:1024 sc1 lds
L_nd_152:
  v_and_b32 v182, 1, v184
  v_cmp_eq_u32 vcc, 0, v182
  s_cbranch_vccz L_ok_151
  s_mov_b32 s34, 0
  s_mov_b32 s35, 7
  s_cmp_ge_u32 s85, 61
  s_cbranch_scc1 L_pf_154
L_pp_155:
  buffer_load_dword v184, off, s[8:11], s83 sc1
  s_add_u32 s34, s34, 1
  s_cmp_gt_u32 s34, 40000
  s_cbranch_scc1 L_fail
  s_waitcnt vmcnt(0)
  v_and_b32 v184, 1, v184
  v_cmp_eq_u32 vcc, 0, v184
  s_cbranch_vccz L_pd_156
  s_sleep 6
  s_branch L_pp_155
L_pd_156:
L_pq_157:
  buffer_load_dwordx4 v[184:187], v1, s[8:11], s93 offen sc1
  s_add_u32 s34, s34, 1
  s_cmp_gt_u32 s34, 40000
  s_cbranch_scc1 L_fail
  s_waitcnt vmcnt(0)
  v_and_b32 v182, 1, v184
  v_cmp_eq_u32 vcc, 0, v182
  s_cbranch_vccz L_ok_151
  s_sleep 2
  s_branch L_pq_157
L_ok_151:
  ds_write_b64 v2, v[184:185] offset:16384
  ds_write_b64 v4, v[186:187] offset:18432
L_ok2_153:
  s_waitcnt lgkmcnt(0)
  s_barrier
  ds_read_b64_tr_b16 v[80:81], v3 offset:16384
  ds_read_b64_tr_b16 v[82:83], v3 offset:16640
  ds_read_b64_tr_b16 v[84:85], v3 offset:16896
  ds_read_b64_tr_b16 v[86:87], v3 offset:17152
  ds_read_b64_tr_b16 v[88:89], v3 offset:17408
  ds_read_b64_tr_b16 v[90:91], v3 offset:17664
  ds_read_b64_tr_b16 v[92:93], v3 offset:17920
  ds_read_b64_tr_b16 v[94:95], v3 offset:18176
  ds_read_b64 v[96:97], v5 offset:18432
  ds_read_b64 v[98:99], v5 offset:18944
  s_waitcnt lgkmcnt(8)
  v_mfma_f32_16x16x32_bf16 v[112:115], v[80:83], v[16:19], 0
  s_waitcnt lgkmcnt(6)
  v_mfma_f32_16x16x32_bf16 v[112:115], v[84:87], v[20:23], v[112:115]
  s_waitcnt lgkmcnt(4)
  v_mfma_f32_16x16x32_bf16 v[112:115], v[88:91], v[24:27], v[112:115]
  s_waitcnt lgkmcnt(2)
  v_mfma_f32_16x16x32_bf16 v[112:115], v[92:95], v[28:31], v[112:115]
  s_nop 7
  v_cvt_pk_bf16_f32 v112, v112, v113
  v_and_b32 v113, 0xffff0000, v112
  v_lshlrev_b32 v112, 16, v112
  v_pk_mul_f32 v[112:113], v[112:113], s[96:97]
  v_cvt_pk_bf16_f32 v112, v112, v113
  v_and_b32 v113, 0xffff0000, v112
  v_lshlrev_b32 v112, 16, v112
  v_cvt_pk_bf16_f32 v114, v114, v115
  v_and_b32 v115, 0xffff0000, v114
  v_lshlrev_b32 v114, 16, v114
  v_pk_mul_f32 v[114:115], v[114:115], s[96:97]
  v_cvt_pk_bf16_f32 v114, v114, v115
  v_and_b32 v115, 0xffff0000, v114
  v_lshlrev_b32 v114, 16, v114
  v_max3_f32 v104, v181, v112, v113
  v_max3_f32 v104, v104, v114, v115
  v_mov_b32 v182, v104
  s_nop 1
  v_permlane16_swap_b32 v104, v182
  v_max_f32 v104, v104, v182
  v_sub_f32 v112, v112, v104
  v_sub_f32 v113, v113, v104
  v_sub_f32 v114, v114, v104
  v_sub_f32 v115, v115, v104
  v_sub_f32 v105, v181, v104
  v_mul_f32 v112, s98, v112
  v_mul_f32 v113, s98, v113
  v_mul_f32 v114, s98, v114
  v_mul_f32 v115, s98, v115
  v_mul_f32 v105, s98, v105
  v_exp_f32 v112, v112
  v_exp_f32 v113, v113
  v_exp_f32 v114, v114
  v_exp_f32 v115, v115
  v_exp_f32 v105, v105
  v_add_f32 v106, v112, v113
  v_add_f32 v104, v114, v115
  v_add_f32 v106, v106, v104
  v_mov_b32 v182, v106
  s_nop 1
  v_permlane16_swap_b32 v106, v182
  v_add_f32 v106, v106, v182
  v_fmac_f32 v106, v105, v183
  v_rcp_f32 v106, v106
  s_nop 0
  v_pk_mul_f32 v[112:113], v[112:113], v[106:107] op_sel_hi:[1,0]
  v_pk_mul_f32 v[114:115], v[114:115], v[106:107] op_sel_hi:[1,0]
  v_mul_f32 v104, v105, v106
  v_cvt_pk_bf16_f32 v136, v112, v113
  v_cvt_pk_bf16_f32 v137, v114, v115
  v_pk_mul_f32 v[116:117], v[116:117], v[104:105] op_sel_hi:[1,0]
  v_pk_mul_f32 v[118:119], v[118:119], v[104:105] op_sel_hi:[1,0]
  v_cndmask_b32 v100, 0, v136, s[94:95]
  v_cndmask_b32 v101, 0, v137, s[94:95]
  v_pk_mul_f32 v[124:125], v[124:125], v[104:105] op_sel_hi:[1,0]
  v_pk_mul_f32 v[126:127], v[126:127], v[104:105] op_sel_hi:[1,0]
  s_waitcnt lgkmcnt(1)
  v_mfma_f32_16x16x16_bf16 v[116:119], v[96:97], v[100:101], v[116:119]
  v_cndmask_b32 v102, v136, 0, s[94:95]
  v_cndmask_b32 v103, v137, 0, s[94:95]
  v_pk_mul_f32 v[120:121], v[120:121], v[104:105] op_sel_hi:[1,0]
  v_pk_mul_f32 v[122:123], v[122:123], v[104:105] op_sel_hi:[1,0]
  s_waitcnt lgkmcnt(0)
  v_mfma_f32_16x16x16_bf16 v[124:127], v[98:99], v[100:101], v[124:127]
  v_pk_mul_f32 v[128:129], v[128:129], v[104:105] op_sel_hi:[1,0]
  v_pk_mul_f32 v[130:131], v[130:131], v[104:105] op_sel_hi:[1,0]
  v_mfma_f32_16x16x16_bf16 v[120:123], v[96:97], v[102:103], v[120:123]
  v_mfma_f32_16x16x16_bf16 v[128:131], v[98:99], v[102:103], v[128:131]
  v_cvt_pk_bf16_f32 v164, v116, v117
  v_cvt_pk_bf16_f32 v165, v118, v119
  s_nop 1
  v_cvt_pk_bf16_f32 v166, v120, v121
  v_cvt_pk_bf16_f32 v167, v122, v123
  ds_write_b128 v176, v[164:167] offset:0
  v_cvt_pk_bf16_f32 v168, v124, v125
  v_cvt_pk_bf16_f32 v169, v126, v127
  v_cvt_pk_bf16_f32 v170, v128, v129
  v_cvt_pk_bf16_f32 v171, v130, v131
  ds_write_b128 v176, v[168:171] offset:1024
  v_mfma_f32_16x16x32_bf16 v[96:99], v[164:167], a[0:3], 0
  v_xor_b32 v185, 2048, v176
  v_mfma_f32_16x16x32_bf16 v[100:103], v[164:167], a[4:7], 0
  v_xor_b32 v186, 4096, v176
  v_mfma_f32_16x16x32_bf16 v[104:107], v[164:167], a[8:11], 0
  v_xor_b32 v187, 6144, v176
  v_mfma_f32_16x16x32_bf16 v[108:111], v[164:167], a[12:15], 0
  v_mfma_f32_16x16x32_bf16 v[112:115], v[164:167], a[16:19], 0
  v_mfma_f32_16x16x32_bf16 v[116:119], v[164:167], a[20:23], 0
  s_waitcnt lgkmcnt(0)
  s_barrier
  ds_read_b128 v[32:35], v185 offset:0
  ds_read_b128 v[36:39], v185 offset:1024
  ds_read_b128 v[40:43], v186 offset:0
  ds_read_b128 v[44:47], v186 offset:1024
  ds_read_b128 v[48:51], v187 offset:0
  ds_read_b128 v[52:55], v187 offset:1024
  v_mfma_f32_16x16x32_bf16 v[120:123], v[164:167], a[24:27], 0
  v_mfma_f32_16x16x32_bf16 v[124:127], v[164:167], a[28:31], 0
  v_mfma_f32_16x16x32_bf16 v[96:99], v[168:171], a[32:35], v[96:99]
  v_mfma_f32_16x16x32_bf16 v[100:103], v[168:171], a[36:39], v[100:103]
  v_mfma_f32_16x16x32_bf16 v[104:107], v[168:171], a[40:43], v[104:107]
  v_mfma_f32_16x16x32_bf16 v[108:111], v[168:171], a[44:47], v[108:111]
  v_mfma_f32_16x16x32_bf16 v[112:115], v[168:171], a[48:51], v[112:115]
  v_mfma_f32_16x16x32_bf16 v[116:119], v[168:171], a[52:55], v[116:119]
  v_mfma_f32_16x16x32_bf16 v[120:123], v[168:171], a[56:59], v[120:123]
  v_mfma_f32_16x16x32_bf16 v[124:127], v[168:171], a[60:63], v[124:127]
  s_waitcnt lgkmcnt(5)
  v_mfma_f32_16x16x32_bf16 v[96:99], v[32:35], a[64:67], v[96:99]
  v_mfma_f32_16x16x32_bf16 v[100:103], v[32:35], a[68:71], v[100:103]
  s_waitcnt lgkmcnt(4)
  v_mfma_f32_16x16x32_bf16 v[96:99], v[36:39], a[96:99], v[96:99]
  v_mfma_f32_16x16x32_bf16 v[100:103], v[36:39], a[100:103], v[100:103]
  v_mfma_f32_16x16x32_bf16 v[104:107], v[32:35], a[72:75], v[104:107]
  v_mfma_f32_16x16x32_bf16 v[108:111], v[32:35], a[76:79], v[108:111]
  v_cvt_pk_bf16_f32 v64, v96, v100
  v_cvt_pk_bf16_f32 v68, v97, v101
  v_mfma_f32_16x16x32_bf16 v[104:107], v[36:39], a[104:107], v[104:107]
  v_cvt_pk_bf16_f32 v72, v98, v102
  v_cvt_pk_bf16_f32 v76, v99, v103
  v_mfma_f32_16x16x32_bf16 v[108:111], v[36:39], a[108:111], v[108:111]
  v_bfi_b32 v64, v9, s82, v64
  v_bfi_b32 v68, v9, s82, v68
  v_mfma_f32_16x16x32_bf16 v[112:115], v[32:35], a[80:83], v[112:115]
  v_bfi_b32 v72, v9, s82, v72
  v_bfi_b32 v76, v9, s82, v76
  v_mfma_f32_16x16x32_bf16 v[116:119], v[32:35], a[84:87], v[116:119]
  v_cvt_pk_bf16_f32 v65, v104, v108
  v_cvt_pk_bf16_f32 v69, v105, v109
  v_mfma_f32_16x16x32_bf16 v[112:115], v[36:39], a[112:115], v[112:115]
  v_cvt_pk_bf16_f32 v73, v106, v110
  v_cvt_pk_bf16_f32 v77, v107, v111
  v_mfma_f32_16x16x32_bf16 v[116:119], v[36:39], a[116:119], v[116:119]
  s_add_u32 s28, s12, 0
  buffer_store_dwordx2 v[64:65], v8, s[8:11], s28 offen offset:0 sc1
  v_mfma_f32_16x16x32_bf16 v[120:123], v[32:35], a[88:91], v[120:123]
  s_add_u32 s28, s12, 32768
  buffer_store_dwordx2 v[68:69], v8, s[8:11], s28 offen offset:0 sc1
  v_mfma_f32_16x16x32_bf16 v[124:127], v[32:35], a[92:95], v[124:127]
  v_cvt_pk_bf16_f32 v66, v112, v116
  v_cvt_pk_bf16_f32 v70, v113, v117
  s_add_u32 s28, s12, 65536
  buffer_store_dwordx2 v[72:73], v8, s[8:11], s28 offen offset:0 sc1
  v_mfma_f32_16x16x32_bf16 v[120:123], v[36:39], a[120:123], v[120:123]
  v_cvt_pk_bf16_f32 v74, v114, v118
  v_cvt_pk_bf16_f32 v78, v115, v119
  s_add_u32 s28, s12, 98304
  buffer_store_dwordx2 v[76:77], v8, s[8:11], s28 offen offset:0 sc1
  v_mfma_f32_16x16x32_bf16 v[124:127], v[36:39], a[124:127], v[124:127]
  v_bfi_b32 v66, v9, s82, v66
  v_bfi_b32 v70, v9, s82, v70
  s_cmp_lg_u32 s86, 0
  s_cbranch_scc1 L_ph_159
  s_waitcnt lgkmcnt(3)
  v_mfma_f32_16x16x32_bf16 v[148:151], v[40:43], a[0:3], 0
  v_bfi_b32 v74, v9, s82, v74
  v_bfi_b32 v78, v9, s82, v78
  v_mfma_f32_16x16x32_bf16 v[152:155], v[40:43], a[4:7], 0
  v_cvt_pk_bf16_f32 v67, v120, v124
  v_cvt_pk_bf16_f32 v71, v121, v125
  s_waitcnt lgkmcnt(2)
  v_mfma_f32_16x16x32_bf16 v[148:151], v[44:47], a[32:35], v[148:151]
  v_cvt_pk_bf16_f32 v75, v122, v126
  v_cvt_pk_bf16_f32 v79, v123, v127
  v_mfma_f32_16x16x32_bf16 v[152:155], v[44:47], a[36:39], v[152:155]
  s_waitcnt lgkmcnt(1)
  v_mfma_f32_16x16x32_bf16 v[148:151], v[48:51], a[64:67], v[148:151]
  s_add_u32 s28, s12, 0
  buffer_store_dwordx2 v[66:67], v8, s[8:11], s28 offen offset:128 sc1
  v_mfma_f32_16x16x32_bf16 v[152:155], v[48:51], a[68:71], v[152:155]
  s_waitcnt lgkmcnt(0)
  v_mfma_f32_16x16x32_bf16 v[148:151], v[52:55], a[96:99], v[148:151]
  v_mfma_f32_16x16x32_bf16 v[152:155], v[52:55], a[100:103], v[152:155]
  s_add_u32 s28, s12, 32768
  buffer_store_dwordx2 v[70:71], v8, s[8:11], s28 offen offset:128 sc1
  v_mfma_f32_16x16x32_bf16 v[156:159], v[40:43], a[8:11], 0
  v_mfma_f32_16x16x32_bf16 v[160:163], v[40:43], a[12:15], 0
  v_cvt_pk_bf16_f32 v80, v148, v152
  v_cvt_pk_bf16_f32 v84, v149, v153
  v_mfma_f32_16x16x32_bf16 v[156:159], v[44:47], a[40:43], v[156:159]
  s_add_u32 s28, s12, 65536
  buffer_store_dwordx2 v[74:75], v8, s[8:11], s28 offen offset:128 sc1
  v_cvt_pk_bf16_f32 v88, v150, v154
  v_cvt_pk_bf16_f32 v92, v151, v155
  v_mfma_f32_16x16x32_bf16 v[160:163], v[44:47], a[44:47], v[160:163]
  v_bfi_b32 v80, v9, s82, v80
  v_bfi_b32 v84, v9, s82, v84
  v_mfma_f32_16x16x32_bf16 v[156:159], v[48:51], a[72:75], v[156:159]
  v_mfma_f32_16x16x32_bf16 v[160:163], v[48:51], a[76:79], v[160:163]
  s_add_u32 s28, s12, 98304
  buffer_store_dwordx2 v[78:79], v8, s[8:11], s28 offen offset:128 sc1
  v_bfi_b32 v88, v9, s82, v88
  v_bfi_b32 v92, v9, s82, v92
  v_mfma_f32_16x16x32_bf16 v[156:159], v[52:55], a[104:107], v[156:159]
  v_mfma_f32_16x16x32_bf16 v[160:163], v[52:55], a[108:111], v[160:163]
  v_mfma_f32_16x16x32_bf16 v[148:151], v[40:43], a[16:19], 0
  v_mfma_f32_16x16x32_bf16 v[152:155], v[40:43], a[20:23], 0
  v_cvt_pk_bf16_f32 v81, v156, v160
  v_cvt_pk_bf16_f32 v85, v157, v161
  v_mfma_f32_16x16x32_bf16 v[148:151], v[44:47], a[48:51], v[148:151]
  v_cvt_pk_bf16_f32 v89, v158, v162
  v_cvt_pk_bf16_f32 v93, v159, v163
  v_mfma_f32_16x16x32_bf16 v[152:155], v[44:47], a[52:55], v[152:155]
  s_add_u32 s28, s13, 0
  buffer_store_dwordx2 v[80:81], v8, s[8:11], s28 offen offset:0 sc1
  v_mfma_f32_16x16x32_bf16 v[148:151], v[48:51], a[80:83], v[148:151]
  v_mfma_f32_16x16x32_bf16 v[152:155], v[48:51], a[84:87], v[152:155]
  s_add_u32 s28, s13, 32768
  buffer_store_dwordx2 v[84:85], v8, s[8:11], s28 offen offset:0 sc1
  v_mfma_f32_16x16x32_bf16 v[148:151], v[52:55], a[112:115], v[148:151]
  v_mfma_f32_16x16x32_bf16 v[152:155], v[52:55], a[116:119], v[152:155]
  s_add_u32 s28, s13, 65536
  buffer_store_dwordx2 v[88:89], v8, s[8:11], s28 offen offset:0 sc1
  v_mfma_f32_16x16x32_bf16 v[156:159], v[40:43], a[24:27], 0
  v_mfma_f32_16x16x32_bf16 v[160:163], v[40:43], a[28:31], 0
  v_cvt_pk_bf16_f32 v82, v148, v152
  v_cvt_pk_bf16_f32 v86, v149, v153
  s_add_u32 s28, s13, 98304
  buffer_store_dwordx2 v[92:93], v8, s[8:11], s28 offen offset:0 sc1
  v_mfma_f32_16x16x32_bf16 v[156:159], v[44:47], a[56:59], v[156:159]
  v_cvt_pk_bf16_f32 v90, v150, v154
  v_cvt_pk_bf16_f32 v94, v151, v155
  v_mfma_f32_16x16x32_bf16 v[160:163], v[44:47], a[60:63], v[160:163]
  v_bfi_b32 v82, v9, s82, v82
  v_bfi_b32 v86, v9, s82, v86
  v_mfma_f32_16x16x32_bf16 v[156:159], v[48:51], a[88:91], v[156:159]
  v_bfi_b32 v90, v9, s82, v90
  v_bfi_b32 v94, v9, s82, v94
  v_mfma_f32_16x16x32_bf16 v[160:163], v[48:51], a[92:95], v[160:163]
  v_mfma_f32_16x16x32_bf16 v[156:159], v[52:55], a[120:123], v[156:159]
  v_mfma_f32_16x16x32_bf16 v[160:163], v[52:55], a[124:127], v[160:163]
  s_nop 7
  v_cvt_pk_bf16_f32 v83, v156, v160
  s_add_u32 s28, s13, 0
  buffer_store_dwordx2 v[82:83], v8, s[8:11], s28 offen offset:128 sc1
  v_cvt_pk_bf16_f32 v87, v157, v161
  s_add_u32 s28, s13, 32768
  buffer_store_dwordx2 v[86:87], v8, s[8:11], s28 offen offset:128 sc1
  v_cvt_pk_bf16_f32 v91, v158, v162
  s_add_u32 s28, s13, 65536
  buffer_store_dwordx2 v[90:91], v8, s[8:11], s28 offen offset:128 sc1
  v_cvt_pk_bf16_f32 v95, v159, v163
  s_add_u32 s28, s13, 98304
  buffer_store_dwordx2 v[94:95], v8, s[8:11], s28 offen offset:128 sc1
L_pj_158:
  s_cmp_eq_u32 s92, 0
  s_cbranch_scc1 L_norow_160
  v_and_b32 v141, 0xffff0000, v138
  v_lshlrev_b32 v140, 16, v138
  v_and_b32 v143, 0xffff0000, v139
  v_lshlrev_b32 v142, 16, v139
  s_mov_b32 s30, 0x3c000000
  v_mov_b32 v183, 12288
  s_lshl_b32 s33, s4, 15
  s_add_u32 s33, s33, s80
  v_mov_b32 v181, s81
  v_cndmask_b32 v181, v181, 0, s[94:95]
  s_sleep 4
  s_mov_b32 s34, 0
  s_mov_b32 s35, 8
L_rd_162:
  s_add_u32 s28, s33, 0
  buffer_load_dwordx4 v[32:35], v6, s[8:11], s28 offen sc1
  s_add_u32 s28, s33, 4096
  buffer_load_dwordx4 v[36:39], v6, s[8:11], s28 offen sc1
  s_add_u32 s28, s33, 8192
  buffer_load_dwordx4 v[40:43], v6, s[8:11], s28 offen sc1
  s_add_u32 s28, s33, 12288
  buffer_load_dwordx4 v[44:47], v6, s[8:11], s28 offen sc1
  s_add_u32 s28, s33, 16384
  buffer_load_dwordx4 v[48:51], v6, s[8:11], s28 offen sc1
  s_add_u32 s28, s33, 20480
  buffer_load_dwordx4 v[52:55], v6, s[8:11], s28 offen sc1
  s_add_u32 s28, s33, 24576
  buffer_load_dwordx4 v[56:59], v6, s[8:11], s28 offen sc1
  s_add_u32 s28, s33, 28672
  buffer_load_dwordx4 v[60:63], v6, s[8:11], s28 offen sc1
  s_add_u32 s34, s34, 1
  s_cmp_gt_u32 s34, 40000
  s_cbranch_scc1 L_fail
  s_waitcnt vmcnt(7)
  v_xor_b32 v180, 0, v32
  v_mfma_f32_16x16x32_bf16 v[172:175], v[32:35], v[144:147], 0
  s_waitcnt vmcnt(6)
  v_bitop3_b32 v180, v36, 0, v180 bitop3:0xbe
  v_mfma_f32_16x16x32_bf16 v[172:175], v[36:39], v[144:147], v[172:175]
  s_waitcnt vmcnt(5)
  v_bitop3_b32 v180, v40, 0, v180 bitop3:0xbe
  v_mfma_f32_16x16x32_bf16 v[172:175], v[40:43], v[144:147], v[172:175]
  s_waitcnt vmcnt(4)
  v_bitop3_b32 v180, v44, 0, v180 bitop3:0xbe
  v_mfma_f32_16x16x32_bf16 v[172:175], v[44:47], v[144:147], v[172:175]
  s_waitcnt vmcnt(3)
  v_bitop3_b32 v180, v48, 0, v180 bitop3:0xbe
  v_mfma_f32_16x16x32_bf16 v[172:175], v[48:51], v[144:147], v[172:175]
  s_waitcnt vmcnt(2)
  v_bitop3_b32 v180, v52, v181, v180 bitop3:0xbe
  v_mfma_f32_16x16x32_bf16 v[172:175], v[52:55], v[144:147], v[172:175]
  s_waitcnt vmcnt(1)
  v_bitop3_b32 v180, v56, s81, v180 bitop3:0xbe
  v_mfma_f32_16x16x32_bf16 v[172:175], v[56:59], v[144:147], v[172:175]
  s_waitcnt vmcnt(0)
  v_bitop3_b32 v180, v60, s81, v180 bitop3:0xbe
  v_mfma_f32_16x16x32_bf16 v[172:175], v[60:63], v[144:147], v[172:175]
  v_and_b32 v180, 1, v180
  v_cmp_ne_u32 vcc, 0, v180
  s_cbranch_vccnz L_rd_162
  s_nop 4
  v_cvt_pk_bf16_f32 v172, v172, v173
  v_and_b32 v173, 0xffff0000, v172
  v_lshlrev_b32 v172, 16, v172
  v_cvt_pk_bf16_f32 v174, v174, v175
  v_and_b32 v175, 0xffff0000, v174
  v_lshlrev_b32 v174, 16, v174
  v_pk_add_f32 v[140:141], v[140:141], v[172:173]
  v_pk_add_f32 v[142:143], v[142:143], v[174:175]
  v_cvt_pk_bf16_f32 v140, v140, v141
  v_and_b32 v141, 0xffff0000, v140
  v_lshlrev_b32 v140, 16, v140
  v_cvt_pk_bf16_f32 v142, v142, v143
  v_readfirstlane_b32 s28, v140
  v_and_b32 v143, 0xffff0000, v142
  v_lshlrev_b32 v142, 16, v142
  v_pk_add_f32 v[172:173], v[140:141], s[28:29] op_sel_hi:[1,0] neg_lo:[0,1] neg_hi:[0,1]
  v_pk_add_f32 v[174:175], v[142:143], s[28:29] op_sel_hi:[1,0] neg_lo:[0,1] neg_hi:[0,1]
  v_mov_b32 v182, s28
  v_pk_add_f32 v[184:185], v[172:173], v[174:175]
  v_pk_mul_f32 v[186:187], v[172:173], v[172:173]
  ds_write_b32 v178, v182 offset:32
  v_pk_fma_f32 v[186:187], v[174:175], v[174:175], v[186:187]
  v_add_f32 v180, v184, v185
  v_add_f32 v181, v186, v187
  s_nop 0
  v_add_f32_dpp v180, v180, v180 row_ror:4 row_mask:0xf bank_mask:0xf
  v_add_f32_dpp v181, v181, v181 row_ror:4 row_mask:0xf bank_mask:0xf
  s_nop 0
  v_add_f32_dpp v180, v180, v180 row_ror:2 row_mask:0xf bank_mask:0xf
  v_add_f32_dpp v181, v181, v181 row_ror:2 row_mask:0xf bank_mask:0xf
  s_nop 0
  v_add_f32_dpp v180, v180, v180 row_ror:1 row_mask:0xf bank_mask:0xf
  v_add_f32_dpp v181, v181, v181 row_ror:1 row_mask:0xf bank_mask:0xf
  s_nop 1
  v_permlane16_swap_b32 v180, v181
  v_add_f32 v180, v180, v181
  v_mov_b32 v182, v180
  s_nop 1
  v_permlane32_swap_b32 v180, v182
  v_add_f32 v180, v180, v182
  ds_write_b32 v178, v180
  s_waitcnt lgkmcnt(0)
  s_barrier
  ds_read_b128 v[32:35], v183 offset:0
  ds_read_b128 v[36:39], v183 offset:16
  ds_read_b128 v[40:43], v183 offset:32
  s_waitcnt lgkmcnt(2)
  v_pk_mul_f32 v[184:185], v[32:33], s[30:31] op_sel_hi:[1,0]
  v_pk_mul_f32 v[186:187], v[34:35], s[30:31] op_sel_hi:[1,0]
  s_waitcnt lgkmcnt(1)
  v_pk_fma_f32 v[36:37], v[184:185], v[32:33], v[36:37] neg_lo:[1,0,0] neg_hi:[1,0,0]
  v_pk_fma_f32 v[38:39], v[186:187], v[34:35], v[38:39] neg_lo:[1,0,0] neg_hi:[1,0,0]
  s_waitcnt lgkmcnt(0)
  v_pk_add_f32 v[40:41], v[40:41], v[184:185]
  v_pk_add_f32 v[42:43], v[42:43], v[186:187]
  v_pk_add_f32 v[36:37], v[36:37], v[38:39]
  v_pk_add_f32 v[184:185], v[40:41], v[42:43]
  v_add_f32 v181, v36, v37
  v_add_f32 v180, v184, v185
  v_mul_f32 v180, 0x3e800000, v180
  v_pk_add_f32 v[40:41], v[40:41], v[180:181] op_sel_hi:[1,0] neg_lo:[0,1] neg_hi:[0,1]
  v_pk_add_f32 v[42:43], v[42:43], v[180:181] op_sel_hi:[1,0] neg_lo:[0,1] neg_hi:[0,1]
  v_pk_mul_f32 v[40:41], v[40:41], v[40:41]
  v_pk_fma_f32 v[40:41], v[42:43], v[42:43], v[40:41]
  v_cvt_pk_bf16_f32 v180, v180, v180
  v_and_b32 v180, 0xffff0000, v180
  v_add_f32 v182, v40, v41
  v_fmac_f32 v181, 0x43000000, v182
  v_mul_f32 v181, 0x3b000000, v181
  v_max_f32 v181, 0, v181
  v_cvt_pk_bf16_f32 v181, v181, v181
  v_and_b32 v181, 0xffff0000, v181
  v_add_f32 v181, 0x3727c5ac, v181
  v_cvt_pk_bf16_f32 v181, v181, v181
  v_and_b32 v181, 0xffff0000, v181
  v_sqrt_f32 v182, v181
  v_pk_add_f32 v[184:185], v[140:141], v[180:181] op_sel_hi:[1,0] neg_lo:[0,1] neg_hi:[0,1]
  v_pk_add_f32 v[186:187], v[142:143], v[180:181] op_sel_hi:[1,0] neg_lo:[0,1] neg_hi:[0,1]
  v_cvt_pk_bf16_f32 v182, v182, v182
  v_and_b32 v182, 0xffff0000, v182
  v_rcp_f32 v182, v182
  v_cvt_pk_bf16_f32 v184, v184, v185
  v_and_b32 v185, 0xffff0000, v184
  v_lshlrev_b32 v184, 16, v184
  v_cvt_pk_bf16_f32 v186, v186, v187
  v_and_b32 v187, 0xffff0000, v186
  v_lshlrev_b32 v186, 16, v186
  v_pk_mul_f32 v[184:185], v[184:185], v[182:183] op_sel_hi:[1,0]
  v_pk_mul_f32 v[186:187], v[186:187], v[182:183] op_sel_hi:[1,0]
  v_cvt_pk_bf16_f32 v172, v184, v185
  v_min_u32 v172, -2, v172
  v_cvt_pk_bf16_f32 v173, v186, v187
  v_min_u32 v173, -2, v173
  s_add_u32 s28, s88, 0x300000
  buffer_store_dwordx2 v[172:173], v179, s[8:11], s28 offen sc1
L_norow_160:
  s_cmp_ge_u32 s4, 22
  s_cbranch_scc1 L_noffn_163
  s_lshl_b32 s33, s85, 15
  s_add_u32 s33, s33, 0x300000
  s_lshl_b32 s28, s5, 13
  s_add_u32 s33, s33, s28
  s_add_u32 s32, s33, 4096
  s_cmp_eq_u32 s99, 0
  s_cbranch_scc1 L_nohl_164
  s_sleep 3
  s_mov_b32 s34, 0
  s_mov_b32 s35, 9
L_hl_165:
  buffer_load_dwordx4 v[32:35], v1, s[8:11], s33 offen offset:0 sc1
  buffer_load_dwordx4 v[36:39], v1, s[8:11], s33 offen offset:1024 sc1
  buffer_load_dwordx4 v[40:43], v1, s[8:11], s33 offen offset:2048 sc1
  buffer_load_dwordx4 v[44:47], v1, s[8:11], s33 offen offset:3072 sc1
  buffer_load_dwordx4 v[48:51], v1, s[8:11], s32 offen offset:0 sc1
  buffer_load_dwordx4 v[52:55], v1, s[8:11], s32 offen offset:1024 sc1
  buffer_load_dwordx4 v[56:59], v1, s[8:11], s32 offen offset:2048 sc1
  buffer_load_dwordx4 v[60:63], v1, s[8:11], s32 offen offset:3072 sc1
  s_add_u32 s34, s34, 1
  s_cmp_gt_u32 s34, 40000
  s_cbranch_scc1 L_fail
  s_waitcnt vmcnt(5)
  v_max3_u32 v180, v32, v36, v40
  s_waitcnt vmcnt(3)
  v_max3_u32 v180, v180, v44, v48
  ds_write_b128 v11, v[32:35] offset:0
  ds_write_b128 v11, v[36:39] offset:1040
  ds_write_b128 v11, v[40:43] offset:2080
  ds_write_b128 v11, v[44:47] offset:3120
  s_waitcnt vmcnt(1)
  v_max3_u32 v180, v180, v52, v56
  s_waitcnt vmcnt(0)
  v_max_u32 v180, v180, v60
  v_cmp_eq_u32 vcc, -1, v180
  s_cbranch_vccnz L_hl_165
  ds_write_b128 v11, v[48:51] offset:4160
  ds_write_b128 v11, v[52:55] offset:5200
  ds_write_b128 v11, v[56:59] offset:6240
  ds_write_b128 v11, v[60:63] offset:7280
L_nohl_164:
  s_waitcnt lgkmcnt(0)
  s_barrier
  ds_read_b128 v[32:35], v12 offset:0
  ds_read_b128 v[36:39], v12 offset:64
  ds_read_b128 v[40:43], v12 offset:128
  ds_read_b128 v[44:47], v12 offset:192
  ds_read_b128 v[48:51], v12 offset:256
  ds_read_b128 v[52:55], v12 offset:320
  ds_read_b128 v[56:59], v12 offset:384
  ds_read_b128 v[60:63], v12 offset:448
  s_waitcnt lgkmcnt(7)
  v_mfma_f32_16x16x32_bf16 v[148:151], a[128:131], v[32:35], 0
  v_mfma_f32_16x16x32_bf16 v[152:155], a[136:139], v[32:35], 0
  ds_read_b128 v[32:35], v12 offset:512
  s_waitcnt lgkmcnt(7)
  v_mfma_f32_16x16x32_bf16 v[148:151], a[132:135], v[36:39], v[148:151]
  v_mfma_f32_16x16x32_bf16 v[152:155], a[140:143], v[36:39], v[152:155]
  ds_read_b128 v[36:39], v12 offset:576
  s_waitcnt lgkmcnt(7)
  v_mfma_f32_16x16x32_bf16 v[148:151], a[144:147], v[40:43], v[148:151]
  v_mfma_f32_16x16x32_bf16 v[152:155], a[152:155], v[40:43], v[152:155]
  ds_read_b128 v[40:43], v12 offset:640
  s_waitcnt lgkmcnt(7)
  v_mfma_f32_16x16x32_bf16 v[148:151], a[148:151], v[44:47], v[148:151]
  v_mfma_f32_16x16x32_bf16 v[152:155], a[156:159], v[44:47], v[152:155]
  ds_read_b128 v[44:47], v12 offset:704
  s_waitcnt lgkmcnt(7)
  v_mfma_f32_16x16x32_bf16 v[148:151], a[160:163], v[48:51], v[148:151]
  v_mfma_f32_16x16x32_bf16 v[152:155], a[168:171], v[48:51], v[152:155]
  ds_read_b128 v[48:51], v12 offset:768
  s_waitcnt lgkmcnt(7)
  v_mfma_f32_16x16x32_bf16 v[148:151], a[164:167], v[52:55], v[148:151]
  v_mfma_f32_16x16x32_bf16 v[152:155], a[172:175], v[52:55], v[152:155]
  ds_read_b128 v[52:55], v12 offset:832
  s_waitcnt lgkmcnt(7)
  v_mfma_f32_16x16x32_bf16 v[148:151], a[176:179], v[56:59], v[148:151]
  v_mfma_f32_16x16x32_bf16 v[152:155], a[184:187], v[56:59], v[152:155]
  ds_read_b128 v[56:59], v12 offset:896
  s_waitcnt lgkmcnt(7)
  v_mfma_f32_16x16x32_bf16 v[148:151], a[180:183], v[60:63], v[148:151]
  v_mfma_f32_16x16x32_bf16 v[152:155], a[188:191], v[60:63], v[152:155]
  ds_read_b128 v[60:63], v12 offset:960
  s_waitcnt lgkmcnt(7)
  v_mfma_f32_16x16x32_bf16 v[148:151], a[192:195], v[32:35], v[148:151]
  v_mfma_f32_16x16x32_bf16 v[152:155], a[200:203], v[32:35], v[152:155]
  s_waitcnt lgkmcnt(6)
  v_mfma_f32_16x16x32_bf16 v[148:151], a[196:199], v[36:39], v[148:151]
  v_mfma_f32_16x16x32_bf16 v[152:155], a[204:207], v[36:39], v[152:155]
  s_waitcnt lgkmcnt(5)
  v_mfma_f32_16x16x32_bf16 v[148:151], a[208:211], v[40:43], v[148:151]
  v_mfma_f32_16x16x32_bf16 v[152:155], a[216:219], v[40:43], v[152:155]
  s_waitcnt lgkmcnt(4)
  v_mfma_f32_16x16x32_bf16 v[148:151], a[212:215], v[44:47], v[148:151]
  v_mfma_f32_16x16x32_bf16 v[152:155], a[220:223], v[44:47], v[152:155]
  s_waitcnt lgkmcnt(3)
  v_mfma_f32_16x16x32_bf16 v[148:151], a[224:227], v[48:51], v[148:151]
  v_mfma_f32_16x16x32_bf16 v[152:155], a[232:235], v[48:51], v[152:155]
  s_waitcnt lgkmcnt(2)
  v_mfma_f32_16x16x32_bf16 v[148:151], a[228:231], v[52:55], v[148:151]
  v_mfma_f32_16x16x32_bf16 v[152:155], a[236:239], v[52:55], v[152:155]
  s_waitcnt lgkmcnt(1)
  v_mfma_f32_16x16x32_bf16 v[148:151], a[240:243], v[56:59], v[148:151]
  v_mfma_f32_16x16x32_bf16 v[152:155], a[248:251], v[56:59], v[152:155]
  s_waitcnt lgkmcnt(0)
  v_mfma_f32_16x16x32_bf16 v[148:151], a[244:247], v[60:63], v[148:151]
  v_mfma_f32_16x16x32_bf16 v[152:155], a[252:255], v[60:63], v[152:155]
  s_nop 3
  v_max_f32 v148, 0, v148
  v_max_f32 v149, 0, v149
  v_max_f32 v150, 0, v150
  v_max_f32 v151, 0, v151
  v_max_f32 v152, 0, v152
  v_max_f32 v153, 0, v153
  v_max_f32 v154, 0, v154
  v_max_f32 v155, 0, v155
  v_cvt_pk_bf16_f32 v164, v148, v149
  v_cvt_pk_bf16_f32 v165, v150, v151
  v_cvt_pk_bf16_f32 v166, v152, v153
  v_cvt_pk_bf16_f32 v167, v154, v155
  ds_write_b128 v177, v[164:167]
  s_nop 0
  v_mfma_f32_16x16x32_bf16 v[96:99], v[164:167], v[192:195], 0
  v_xor_b32 v185, 1024, v177
  v_mfma_f32_16x16x32_bf16 v[100:103], v[164:167], v[196:199], 0
  v_xor_b32 v186, 2048, v177
  v_mfma_f32_16x16x32_bf16 v[104:107], v[164:167], v[200:203], 0
  v_xor_b32 v187, 3072, v177
  v_mfma_f32_16x16x32_bf16 v[108:111], v[164:167], v[204:207], 0
  s_waitcnt lgkmcnt(0)
  s_barrier
  ds_read_b128 v[32:35], v185 offset:0
  ds_read_b128 v[36:39], v186 offset:0
  ds_read_b128 v[40:43], v187 offset:0
  v_mfma_f32_16x16x32_bf16 v[112:115], v[164:167], v[208:211], 0
  v_mfma_f32_16x16x32_bf16 v[116:119], v[164:167], v[212:215], 0
  v_mfma_f32_16x16x32_bf16 v[120:123], v[164:167], v[216:219], 0
  v_mfma_f32_16x16x32_bf16 v[124:127], v[164:167], v[220:223], 0
  s_waitcnt lgkmcnt(2)
  v_mfma_f32_16x16x32_bf16 v[96:99], v[32:35], v[224:227], v[96:99]
  v_mfma_f32_16x16x32_bf16 v[100:103], v[32:35], v[228:231], v[100:103]
  v_mfma_f32_16x16x32_bf16 v[104:107], v[32:35], v[232:235], v[104:107]
  v_mfma_f32_16x16x32_bf16 v[108:111], v[32:35], v[236:239], v[108:111]
  v_cvt_pk_bf16_f32 v64, v96, v100
  v_cvt_pk_bf16_f32 v68, v97, v101
  v_mfma_f32_16x16x32_bf16 v[112:115], v[32:35], v[240:243], v[112:115]
  v_cvt_pk_bf16_f32 v72, v98, v102
  v_cvt_pk_bf16_f32 v76, v99, v103
  v_or_b32 v64, v9, v64
  v_mfma_f32_16x16x32_bf16 v[116:119], v[32:35], v[244:247], v[116:119]
  v_cvt_pk_bf16_f32 v65, v104, v108
  v_cvt_pk_bf16_f32 v69, v105, v109
  v_or_b32 v68, v9, v68
  v_mfma_f32_16x16x32_bf16 v[120:123], v[32:35], v[248:251], v[120:123]
  v_cvt_pk_bf16_f32 v73, v106, v110
  v_cvt_pk_bf16_f32 v77, v107, v111
  v_or_b32 v72, v9, v72
  v_or_b32 v76, v9, v76
  s_add_u32 s28, s12, 0
  buffer_store_dwordx2 v[64:65], v8, s[8:11], s28 offen offset:0 sc1
  v_mfma_f32_16x16x32_bf16 v[124:127], v[32:35], v[252:255], v[124:127]
  v_cvt_pk_bf16_f32 v66, v112, v116
  v_cvt_pk_bf16_f32 v70, v113, v117
  v_or_b32 v66, v9, v66
  v_or_b32 v70, v9, v70
  s_add_u32 s28, s12, 32768
  buffer_store_dwordx2 v[68:69], v8, s[8:11], s28 offen offset:0 sc1
  s_cmp_lg_u32 s86, 0
  s_cbranch_scc1 L_ph_167
  s_waitcnt lgkmcnt(1)
  v_mfma_f32_16x16x32_bf16 v[148:151], v[36:39], v[192:195], 0
  v_cvt_pk_bf16_f32 v74, v114, v118
  v_cvt_pk_bf16_f32 v78, v115, v119
  v_or_b32 v74, v9, v74
  v_or_b32 v78, v9, v78
  s_add_u32 s28, s12, 65536
  buffer_store_dwordx2 v[72:73], v8, s[8:11], s28 offen offset:0 sc1
  v_mfma_f32_16x16x32_bf16 v[152:155], v[36:39], v[196:199], 0
  v_cvt_pk_bf16_f32 v67, v120, v124
  v_cvt_pk_bf16_f32 v71, v121, v125
  s_add_u32 s28, s12, 98304
  buffer_store_dwordx2 v[76:77], v8, s[8:11], s28 offen offset:0 sc1
  s_waitcnt lgkmcnt(0)
  v_mfma_f32_16x16x32_bf16 v[148:151], v[40:43], v[224:227], v[148:151]
  v_cvt_pk_bf16_f32 v75, v122, v126
  v_cvt_pk_bf16_f32 v79, v123, v127
  v_mfma_f32_16x16x32_bf16 v[152:155], v[40:43], v[228:231], v[152:155]
  s_add_u32 s28, s12, 0
  buffer_store_dwordx2 v[66:67], v8, s[8:11], s28 offen offset:128 sc1
  v_mfma_f32_16x16x32_bf16 v[156:159], v[36:39], v[200:203], 0
  s_add_u32 s28, s12, 32768
  buffer_store_dwordx2 v[70:71], v8, s[8:11], s28 offen offset:128 sc1
  v_mfma_f32_16x16x32_bf16 v[160:163], v[36:39], v[204:207], 0
  v_cvt_pk_bf16_f32 v80, v148, v152
  v_cvt_pk_bf16_f32 v84, v149, v153
  v_mfma_f32_16x16x32_bf16 v[156:159], v[40:43], v[232:235], v[156:159]
  v_cvt_pk_bf16_f32 v88, v150, v154
  v_cvt_pk_bf16_f32 v92, v151, v155
  v_mfma_f32_16x16x32_bf16 v[160:163], v[40:43], v[236:239], v[160:163]
  s_add_u32 s28, s12, 65536
  buffer_store_dwordx2 v[74:75], v8, s[8:11], s28 offen offset:128 sc1
  v_or_b32 v80, v9, v80
  v_or_b32 v84, v9, v84
  v_mfma_f32_16x16x32_bf16 v[148:151], v[36:39], v[208:211], 0
  s_add_u32 s28, s12, 98304
  buffer_store_dwordx2 v[78:79], v8, s[8:11], s28 offen offset:128 sc1
  v_or_b32 v88, v9, v88
  v_or_b32 v92, v9, v92
  v_mfma_f32_16x16x32_bf16 v[152:155], v[36:39], v[212:215], 0
  v_cvt_pk_bf16_f32 v81, v156, v160
  v_cvt_pk_bf16_f32 v85, v157, v161
  v_mfma_f32_16x16x32_bf16 v[148:151], v[40:43], v[240:243], v[148:151]
  v_cvt_pk_bf16_f32 v89, v158, v162
  v_cvt_pk_bf16_f32 v93, v159, v163
  v_mfma_f32_16x16x32_bf16 v[152:155], v[40:43], v[244:247], v[152:155]
  s_add_u32 s28, s13, 0
  buffer_store_dwordx2 v[80:81], v8, s[8:11], s28 offen offset:0 sc1
  s_add_u32 s28, s13, 32768
  buffer_store_dwordx2 v[84:85], v8, s[8:11], s28 offen offset:0 sc1
  v_mfma_f32_16x16x32_bf16 v[156:159], v[36:39], v[216:219], 0
  s_add_u32 s28, s13, 65536
  buffer_store_dwordx2 v[88:89], v8, s[8:11], s28 offen offset:0 sc1
  s_add_u32 s28, s13, 98304
  buffer_store_dwordx2 v[92:93], v8, s[8:11], s28 offen offset:0 sc1
  v_mfma_f32_16x16x32_bf16 v[160:163], v[36:39], v[220:223], 0
  v_cvt_pk_bf16_f32 v82, v148, v152
  v_cvt_pk_bf16_f32 v86, v149, v153
  v_mfma_f32_16x16x32_bf16 v[156:159], v[40:43], v[248:251], v[156:159]
  v_cvt_pk_bf16_f32 v90, v150, v154
  v_cvt_pk_bf16_f32 v94, v151, v155
  v_or_b32 v82, v9, v82
  v_or_b32 v86, v9, v86
  v_mfma_f32_16x16x32_bf16 v[160:163], v[40:43], v[252:255], v[160:163]
  v_or_b32 v90, v9, v90
  v_or_b32 v94, v9, v94
  s_nop 5
  v_cvt_pk_bf16_f32 v83, v156, v160
  s_add_u32 s28, s13, 0
  buffer_store_dwordx2 v[82:83], v8, s[8:11], s28 offen offset:128 sc1
  v_cvt_pk_bf16_f32 v87, v157, v161
  s_add_u32 s28, s13, 32768
  buffer_store_dwordx2 v[86:87], v8, s[8:11], s28 offen offset:128 sc1
  v_cvt_pk_bf16_f32 v91, v158, v162
  s_add_u32 s28, s13, 65536
  buffer_store_dwordx2 v[90:91], v8, s[8:11], s28 offen offset:128 sc1
  v_cvt_pk_bf16_f32 v95, v159, v163
  s_add_u32 s28, s13, 98304
  buffer_store_dwordx2 v[94:95], v8, s[8:11], s28 offen offset:128 sc1
L_pj_166:
L_noffn_163:
  s_cmp_eq_u32 s92, 0
  s_cbranch_scc1 L_norow2_161
  s_lshl_b32 s33, s4, 15
  s_add_u32 s33, s33, s80
  s_sleep 4
  s_mov_b32 s34, 0
  s_mov_b32 s35, 10
L_rd_168:
  s_add_u32 s28, s33, 0
  buffer_load_dwordx4 v[32:35], v6, s[8:11], s28 offen sc1
  s_add_u32 s28, s33, 4096
  buffer_load_dwordx4 v[36:39], v6, s[8:11], s28 offen sc1
  s_add_u32 s28, s33, 8192
  buffer_load_dwordx4 v[40:43], v6, s[8:11], s28 offen sc1
  s_add_u32 s28, s33, 12288
  buffer_load_dwordx4 v[44:47], v6, s[8:11], s28 offen sc1
  s_add_u32 s28, s33, 16384
  buffer_load_dwordx4 v[48:51], v6, s[8:11], s28 offen sc1
  s_add_u32 s28, s33, 20480
  buffer_load_dwordx4 v[52:55], v7, s[8:11], s28 offen sc1
  s_add_u32 s34, s34, 1
  s_cmp_gt_u32 s34, 40000
  s_cbranch_scc1 L_fail
  s_waitcnt vmcnt(5)
  v_xor_b32 v180, 1, v32
  v_mfma_f32_16x16x32_bf16 v[172:175], v[32:35], v[144:147], 0
  s_waitcnt vmcnt(4)
  v_bitop3_b32 v180, v36, 1, v180 bitop3:0xbe
  v_mfma_f32_16x16x32_bf16 v[172:175], v[36:39], v[144:147], v[172:175]
  s_waitcnt vmcnt(3)
  v_bitop3_b32 v180, v40, 1, v180 bitop3:0xbe
  v_mfma_f32_16x16x32_bf16 v[172:175], v[40:43], v[144:147], v[172:175]
  s_waitcnt vmcnt(2)
  v_bitop3_b32 v180, v44, 1, v180 bitop3:0xbe
  v_mfma_f32_16x16x32_bf16 v[172:175], v[44:47], v[144:147], v[172:175]
  s_waitcnt vmcnt(1)
  v_bitop3_b32 v180, v48, 1, v180 bitop3:0xbe
  v_mfma_f32_16x16x32_bf16 v[172:175], v[48:51], v[144:147], v[172:175]
  s_mov_b32 exec_hi, 0
  s_waitcnt vmcnt(0)
  v_bitop3_b32 v180, v52, 1, v180 bitop3:0xbe
  s_mov_b64 exec, -1
  v_mfma_f32_16x16x32_bf16 v[172:175], v[52:55], v[144:147], v[172:175]
  v_and_b32 v180, 1, v180
  v_cmp_ne_u32 vcc, 0, v180
  s_cbranch_vccnz L_rd_168
  s_nop 4
  v_cvt_pk_bf16_f32 v172, v172, v173
  v_and_b32 v173, 0xffff0000, v172
  v_lshlrev_b32 v172, 16, v172
  v_cvt_pk_bf16_f32 v174, v174, v175
  v_and_b32 v175, 0xffff0000, v174
  v_lshlrev_b32 v174, 16, v174
  v_add_f32 v172, v172, v140
  v_add_f32 v173, v173, v141
  v_add_f32 v174, v174, v142
  v_add_f32 v175, v175, v143
  v_cvt_pk_bf16_f32 v172, v172, v173
  v_cvt_pk_bf16_f32 v173, v174, v175
  buffer_store_dwordx2 v[172:173], v179, s[20:23], s88 offen
L_norow2_161:
  s_xor_b32 s80, s80, 0x1800000
  s_xor_b32 s12, s12, 0x1800000
  s_xor_b32 s13, s13, 0x1800000
  s_add_u32 s63, s63, 1
  s_add_u32 s85, s85, s87
  s_cmp_lt_u32 s63, s84
  s_cbranch_scc1 L_ws_loop
  s_waitcnt vmcnt(0)
  s_endpgm
L_pf_154:
  s_cmp_eq_u32 s85, 63
  s_cselect_b32 s28, 0x100000, 0
  s_sub_u32 s83, s83, s28
  s_lshl_b32 s28, 1, s3
  s_and_b32 s28, s28, 8
  s_cbranch_scc1 L_fd_170
L_fp_169:
  buffer_load_dword v184, off, s[8:11], s83 sc1
  s_add_u32 s34, s34, 1
  s_cmp_gt_u32 s34, 40000
  s_cbranch_scc1 L_fail
  s_waitcnt vmcnt(0)
  v_and_b32 v184, 1, v184
  v_cmp_eq_u32 vcc, 0, v184
  s_cbranch_vccz L_fd_170
  s_sleep 6
  s_branch L_fp_169
L_fd_170:
  buffer_load_dwordx4 v[32:35], v1, s[8:11], s93 offen sc1
L_fq_171:
  s_waitcnt vmcnt(0)
  v_and_b32 v182, 1, v32
  v_cmp_eq_u32 vcc, 0, v182
  s_cbranch_vccz L_fs_172
  buffer_load_dwordx4 v[32:35], v1, s[8:11], s93 offen sc1
  s_add_u32 s34, s34, 1
  s_cmp_gt_u32 s34, 40000
  s_cbranch_scc1 L_fail
  s_branch L_fq_171
L_fs_172:
  ds_write_b64 v2, v[32:33] offset:16384
  ds_write_b64 v4, v[34:35] offset:18432
  s_branch L_ok2_153
L_ph_159:
  v_bfi_b32 v74, v9, s82, v74
  v_bfi_b32 v78, v9, s82, v78
  s_nop 1
  v_cvt_pk_bf16_f32 v67, v120, v124
  s_add_u32 s28, s12, 0
  buffer_store_dwordx2 v[66:67], v8, s[8:11], s28 offen offset:128 sc1
  v_cvt_pk_bf16_f32 v71, v121, v125
  s_add_u32 s28, s12, 32768
  buffer_store_dwordx2 v[70:71], v8, s[8:11], s28 offen offset:128 sc1
  v_cvt_pk_bf16_f32 v75, v122, v126
  s_add_u32 s28, s12, 65536
  buffer_store_dwordx2 v[74:75], v8, s[8:11], s28 offen offset:128 sc1
  v_cvt_pk_bf16_f32 v79, v123, v127
  s_add_u32 s28, s12, 98304
  buffer_store_dwordx2 v[78:79], v8, s[8:11], s28 offen offset:128 sc1
  s_waitcnt lgkmcnt(0)
  s_branch L_pj_158
L_ph_167:
  s_add_u32 s28, s12, 65536
  buffer_store_dwordx2 v[72:73], v8, s[8:11], s28 offen offset:0 sc1
  s_add_u32 s28, s12, 98304
  buffer_store_dwordx2 v[76:77], v8, s[8:11], s28 offen offset:0 sc1
  v_cvt_pk_bf16_f32 v74, v114, v118
  v_cvt_pk_bf16_f32 v78, v115, v119
  v_or_b32 v74, v9, v74
  v_or_b32 v78, v9, v78
  v_cvt_pk_bf16_f32 v67, v120, v124
  s_add_u32 s28, s12, 0
  buffer_store_dwordx2 v[66:67], v8, s[8:11], s28 offen offset:128 sc1
  v_cvt_pk_bf16_f32 v71, v121, v125
  s_add_u32 s28, s12, 32768
  buffer_store_dwordx2 v[70:71], v8, s[8:11], s28 offen offset:128 sc1
  v_cvt_pk_bf16_f32 v75, v122, v126
  s_add_u32 s28, s12, 65536
  buffer_store_dwordx2 v[74:75], v8, s[8:11], s28 offen offset:128 sc1
  v_cvt_pk_bf16_f32 v79, v123, v127
  s_add_u32 s28, s12, 98304
  buffer_store_dwordx2 v[78:79], v8, s[8:11], s28 offen offset:128 sc1
  s_waitcnt lgkmcnt(0)
  s_branch L_pj_166
L_gs_104:
  s_mov_b32 s34, 0
  s_mov_b32 s35, 1
L_gw_173:
  buffer_load_dword v14, v12, s[24:27], 0 offen sc1
  s_add_u32 s34, s34, 1
  s_cmp_gt_u32 s34, 40000
  s_cbranch_scc1 L_fail
  s_waitcnt vmcnt(0)
  v_and_b32 v13, 63, v14
  v_cmp_ne_u32 vcc, 32, v13
  s_cbranch_vccz L_gb_105
  s_sleep 4
  s_branch L_gw_173
L_fail:
  s_mov_b64 exec, 1
  s_lshl_b32 s28, s2, 8
  s_or_b32 s28, s28, s35
  s_or_b32 s28, s28, 0x40000000
  v_mov_b32 v1, s28
  buffer_store_dword v1, off, s[24:27], 0 offset:8 sc1
  s_waitcnt vmcnt(0)
L_end:
  s_endpgm
.section .rodata,"a"
.p2align 6
.amdhsa_kernel sequential_preLN__memory_aug_recurrent_mem_tr__dense_activation_relu__prompt_kernel
  .amdhsa_next_free_vgpr 512
  .amdhsa_next_free_sgpr 102
  .amdhsa_accum_offset 256
  .amdhsa_group_segment_fixed_size 0
  .amdhsa_kernarg_size 104
  .amdhsa_user_sgpr_count 2
  .amdhsa_user_sgpr_kernarg_segment_ptr 1
  .amdhsa_system_sgpr_workgroup_id_x 1
  .amdhsa_float_denorm_mode_32 3
  .amdhsa_ieee_mode 0
  .amdhsa_dx10_clamp 0
.end_amdhsa_kernel
```
